```python
import torch

def _softmax(x, axis=-1):
    return torch.softmax(x, dim=axis)
def _gelu(x):
    return torch.nn.functional.gelu(x, approximate="tanh")
def _silu(x):
    return torch.nn.functional.silu(x)
def _sigmoid(x):
    return torch.sigmoid(x)
def _layernorm(x, axis=-1, eps=1e-5):
    m = x.mean(dim=axis, keepdim=True)
    v = x.var(dim=axis, keepdim=True, unbiased=False)
    return (x - m) / torch.sqrt(v + eps)
def _scatter_add(tgt, idx, src, axis=0):
    return tgt.clone().index_add_(axis, idx, src)
def _segment_sum(src, seg, n):
    out = torch.zeros((n,) + src.shape[1:], dtype=src.dtype)
    return out.index_add_(0, seg, src)
def _pad(x, pw):
    flat = tuple(v for pair in reversed(pw) for v in pair)
    return torch.nn.functional.pad(x, flat)

kernel_name = 'gated_mix__ssm_conv_h3__compressed_kv_cla__prompt'

def setup_inputs():

    _w = (lambda a: (lambda t: t.to(torch.bfloat16) if t.is_floating_point() else t)(torch.as_tensor(a)))
    def _A_setup():
        B, S, D = 1, 2048, 448
        ks = 4
        return {
            "q": _w((lambda *s: torch.randn(*s, dtype=torch.bfloat16) * 0.05)(B, S, D)),
            "k": _w((lambda *s: torch.randn(*s, dtype=torch.bfloat16) * 0.4)(B, S, D)),
            "v": _w((lambda *s: torch.randn(*s, dtype=torch.bfloat16) * 0.4)(B, S, D)),
            "shift_k": _w((lambda *s: torch.randn(*s, dtype=torch.bfloat16) * 0.4)(D, ks) * 0.5),
            "ssm_k": _w((lambda *s: torch.randn(*s, dtype=torch.bfloat16) * 0.8)(D, S) * (1.0 / S ** 0.5)),
            "ssm_D": _w((lambda *s: torch.randn(*s, dtype=torch.bfloat16) * 0.4)(D)),
        }
    _A_in = _A_setup()

    def _B_setup():
        B, H, Sq, Sk, D, M = 1, 16, 2048, 2048, 256, 448
        Dc = 4 * D
        return {
            "x": _w((lambda *s: torch.randn(*s, dtype=torch.bfloat16) * 0.05)(B, Sq, M)),
            "c_kv": _w((lambda *s: torch.randn(*s, dtype=torch.bfloat16) * 0.4)(B, Sk, Dc)),
            "w_q": _w((lambda *s: torch.randn(*s, dtype=torch.bfloat16) * 6.4)(M, H, D) * (M ** -0.5)),
            "w_uk": _w((lambda *s: torch.randn(*s, dtype=torch.bfloat16) * 6.4)(Dc, H, D) * (Dc ** -0.5)),
            "w_uv": _w((lambda *s: torch.randn(*s, dtype=torch.bfloat16) * 0.4)(Dc, H, D) * (Dc ** -0.5)),
            "w_o": _w((lambda *s: torch.randn(*s, dtype=torch.bfloat16) * 0.4)(H, D, M) * ((H * D) ** -0.5)),
        }
    _B_in = _B_setup()

    return {
        "A_q": _A_in["q"],
        "A_k": _A_in["k"],
        "A_v": _A_in["v"],
        "A_shift_k": _A_in["shift_k"],
        "A_ssm_k": _A_in["ssm_k"],
        "A_ssm_D": _A_in["ssm_D"],
        "B_x": _B_in["x"],
        "B_c_kv": _B_in["c_kv"],
        "B_w_q": _B_in["w_q"],
        "B_w_uk": _B_in["w_uk"],
        "B_w_uv": _B_in["w_uv"],
        "B_w_o": _B_in["w_o"],
        "gate_w": _w((lambda *s: torch.randn(*s, dtype=torch.bfloat16) * 0.05)(448) * 16.0),
    }

def reference(A_q, A_k, A_v, A_shift_k, A_ssm_k, A_ssm_D, B_x, B_c_kv, B_w_q, B_w_uk, B_w_uv, B_w_o, gate_w):
    def _A_ref(q, k, v, shift_k, ssm_k, ssm_D):
        B, S, D = q.shape
        ks = shift_k.shape[-1]
        k_pad = _pad(k, ((0, 0), (ks - 1, 0), (0, 0)))
        k_shift = torch.zeros_like(k)
        for t in range(ks):
            k_shift = k_shift + k_pad[:, t:t + S, :] * shift_k[:, ks - 1 - t][None, None, :]
        kv = k_shift * v
        L = 2 * S
        kv_pad = _pad(kv, ((0, 0), (0, S), (0, 0)))
        kf_pad = _pad(ssm_k, ((0, 0), (0, S)))
        kv_f = (lambda x, axes=(-2,-1): torch.fft.rfft2(x.float(), dim=axes))(kv_pad[:, None, :, :], axes=(1, 2))
        kf_f = (lambda x, axes=(-2,-1): torch.fft.rfft2(x.float(), dim=axes))(kf_pad[:, None, :], axes=(1, 2))
        kf_f = (lambda x, *d: x.permute(*d))(kf_f, 1, 2, 0)
        y_f = kv_f * kf_f[None, :, :, :]
        y = (lambda x, s, axes=(-2,-1): torch.fft.irfft2(x, s=s, dim=axes).to(torch.bfloat16))(y_f, (1, L), axes=(1, 2))[:, 0, :S, :]
        y = y + kv * ssm_D[None, None, :]
        return q * y

    def _B_ref(x, c_kv, w_q, w_uk, w_uv, w_o):
        B, Sq, M = x.shape[0], x.shape[1], x.shape[2]
        Sk = c_kv.shape[1]
        H, D = w_q.shape[1], w_q.shape[2]
        q = torch.einsum("bqm,mhd->bhqd", x, w_q)
        k = torch.einsum("bkc,chd->bhkd", c_kv, w_uk)
        v = torch.einsum("bkc,chd->bhkd", c_kv, w_uv)
        scores = torch.einsum("bhqd,bhkd->bhqk", q, k) * (D ** -0.5)
        off = Sk - Sq
        qi = torch.arange(Sq)[:, None]
        kj = torch.arange(Sk)[None, :]
        cmask = kj <= (qi + off)
        scores = torch.where(cmask[None, None], scores, -1e9)
        p = _softmax(scores, axis=-1)
        ctx = torch.einsum("bhqk,bhkd->bhqd", p, v)
        return torch.einsum("bhqd,hdm->bqm", ctx, w_o)

    x = A_q
    g = _sigmoid((x * gate_w).sum(-1, keepdims=True))
    a = _A_ref(x, A_k, A_v, A_shift_k, A_ssm_k, A_ssm_D)
    b = _B_ref(x, B_c_kv, B_w_q, B_w_uk, B_w_uv, B_w_o)
    return g * a + (1 - g) * b
```

```asm
; @launch kernel=proj_kernel grid=(256,1,1) block=(512,1,1) lds=147456
; @launch kernel=attn_kernel grid=(256,1,1) block=(256,1,1) lds=163840
; @launch kernel=out_kernel grid=(224,1,1) block=(256,1,1) lds=131072
.amdgcn_target "amdgcn-amd-amdhsa--gfx950"
.text
.globl proj_kernel
.p2align 8
.type proj_kernel,@function
proj_kernel:
    s_cmp_ge_u32 s2, 256
    s_cbranch_scc1 L_proj_end
    s_load_dwordx2 s[4:5], s[0:1], 0
    s_load_dwordx2 s[6:7], s[0:1], 56
    s_load_dwordx2 s[20:21], s[0:1], 64
    s_load_dwordx2 s[22:23], s[0:1], 72
    s_load_dwordx2 s[24:25], s[0:1], 80
    s_load_dwordx2 s[26:27], s[0:1], 120
    s_load_dwordx2 s[56:57], s[0:1], 8
    s_load_dwordx2 s[58:59], s[0:1], 16
    s_load_dwordx2 s[60:61], s[0:1], 24
    s_load_dwordx2 s[62:63], s[0:1], 96
    s_load_dwordx2 s[86:87], s[0:1], 88
    v_lshrrev_b32 v18, 6, v0
    v_and_b32 v1, 63, v0
    v_readfirstlane_b32 s30, v18
    s_nop 3
    s_lshr_b32 s37, s30, 2
    s_and_b32 s38, s30, 3
    s_lshl_b32 s32, s30, 12
    s_and_b32 s48, s2, 7
    s_lshr_b32 s49, s2, 3
    s_and_b32 s50, s49, 3
    s_lshl_b32 s51, s48, 2
    s_add_u32 s50, s50, s51
    s_lshr_b32 s51, s49, 2
    s_lshl_b32 s40, s51, 8
    s_and_b32 s52, s50, 15
    s_lshl_b32 s41, s52, 9
    v_lshrrev_b32 v18, 5, v1
    v_and_b32 v19, 31, v1
    v_lshlrev_b32 v20, 2, v18
    v_xor_b32 v19, v19, v20
    v_lshlrev_b32 v21, 13, v18
    v_lshl_add_u32 v4, v19, 4, v21
    v_xor_b32 v19, 8, v19
    v_lshl_add_u32 v5, v19, 4, v21
    s_and_b32 s35, s30, 1
    s_lshl_b32 s35, s35, 5
    v_xor_b32 v4, s35, v4
    v_xor_b32 v5, s35, v5
    v_lshrrev_b32 v19, 4, v1
    v_bfe_u32 v18, v1, 2, 2
    v_lshl_add_u32 v20, v19, 3, v18
    v_lshlrev_b32 v20, 9, v20
    v_and_b32 v21, 1, v1
    v_lshl_add_u32 v20, v21, 3, v20
    v_add_u32 v20, 0x8000, v20
    v_bfe_u32 v21, v1, 1, 1
    s_lshl_b32 s35, s38, 3
    v_add_u32 v21, s35, v21
    v_lshlrev_b32 v22, 2, v18
    v_xor_b32 v21, v21, v22
    v_bfe_u32 v22, v1, 4, 1
    v_lshlrev_b32 v22, 1, v22
    v_xor_b32 v21, v21, v22
    v_lshl_add_u32 v10, v21, 4, v20
    v_xor_b32 v11, 32, v10
    v_xor_b32 v12, 64, v10
    v_xor_b32 v13, 96, v10
    v_add_u32 v14, 0x10000, v10
    v_add_u32 v15, 0x10000, v11
    v_add_u32 v16, 0x10000, v12
    v_add_u32 v17, 0x10000, v13
    s_waitcnt lgkmcnt(0)
    s_mov_b32 s8, s6
    s_mov_b32 s9, s7
    s_mov_b32 s10, 4194304
    s_mov_b32 s11, 0x00020000
    s_and_b32 s53, s49, 1
    s_lshl_b32 s54, s48, 1
    s_add_u32 s53, s53, s54
    s_lshr_b32 s54, s49, 1
    s_lshl_b32 s54, s54, 7
    s_lshl_b32 s55, s53, 9
    s_cmp_ge_u32 s50, 16
    s_cbranch_scc1 L_proj_v
    s_mov_b32 s12, s22
    s_mov_b32 s13, s23
    s_mov_b32 s14, 8388608
    s_mov_b32 s15, 0x00020000
    s_add_u32 s16, s26, 16777216
    s_addc_u32 s17, s27, 0
    s_mov_b32 s18, 16777216
    s_mov_b32 s19, 0x00020000
    v_lshrrev_b32 v18, 3, v1
    v_mul_u32_u24 v19, 2048, v18
    v_lshrrev_b32 v20, 4, v1
    v_and_b32 v21, 7, v1
    v_xor_b32 v22, v21, v20
    v_lshl_add_u32 v2, v22, 4, v19
    v_xor_b32 v22, 4, v22
    v_lshl_add_u32 v3, v22, 4, v19
    s_mul_i32 s31, s30, 4096
    s_mul_i32 s33, s30, 32
    s_add_u32 s33, s33, s40
    s_mul_i32 s33, s33, 2048
    s_lshl_b32 s34, s30, 16
    s_add_u32 s34, s34, s41
    s_add_u32 m0, s31, 0
    s_add_u32 s35, s33, 0
    buffer_load_dwordx4 v2, s[8:11], s35 offen lds
    s_add_u32 m0, s31, 1024
    s_add_u32 s35, s33, 16384
    buffer_load_dwordx4 v3, s[8:11], s35 offen lds
    s_add_u32 m0, s31, 2048
    s_add_u32 s35, s33, 32768
    buffer_load_dwordx4 v2, s[8:11], s35 offen lds
    s_add_u32 m0, s31, 3072
    s_add_u32 s35, s33, 49152
    buffer_load_dwordx4 v3, s[8:11], s35 offen lds
    s_add_u32 m0, s32, 32768
    s_add_u32 s35, s34, 0
    buffer_load_dwordx4 v4, s[12:15], s35 offen lds
    s_add_u32 m0, s32, 33792
    s_add_u32 s35, s34, 16384
    buffer_load_dwordx4 v5, s[12:15], s35 offen lds
    s_add_u32 m0, s32, 34816
    s_add_u32 s35, s34, 32768
    buffer_load_dwordx4 v4, s[12:15], s35 offen lds
    s_add_u32 m0, s32, 35840
    s_add_u32 s35, s34, 49152
    buffer_load_dwordx4 v5, s[12:15], s35 offen lds
    s_lshl_b32 s80, s2, 3
    s_mov_b32 s64, s56
    s_mov_b32 s65, s57
    s_mov_b32 s66, 1835008
    s_mov_b32 s67, 0x00020000
    s_mov_b32 s68, s58
    s_mov_b32 s69, s59
    s_mov_b32 s70, 1835008
    s_mov_b32 s71, 0x00020000
    s_mov_b32 s72, s60
    s_mov_b32 s73, s61
    s_mov_b32 s74, 3584
    s_mov_b32 s75, 0x00020000
    s_mov_b32 s76, s62
    s_mov_b32 s77, s63
    s_mov_b32 s78, 896
    s_mov_b32 s79, 0x00020000
    s_mov_b32 s84, s86
    s_mov_b32 s85, s87
    s_mov_b32 s86, 3670016
    s_mov_b32 s87, 0x00020000
    s_mov_b32 s44, s4
    s_mov_b32 s45, s5
    s_mov_b32 s46, 1835008
    s_mov_b32 s47, 0x00020000
    v_lshlrev_b32 v18, 4, v1
    s_mul_i32 s81, s2, 14336
    s_lshl_b32 s82, s30, 10
    s_add_u32 s81, s81, s82
    s_add_u32 m0, s82, 131072
    s_nop 0
    buffer_load_dwordx4 v18, s[84:87], s81 offen lds
    s_cmp_ge_u32 s30, 6
    s_cbranch_scc1 L_sd_now2_0
    s_add_u32 m0, s82, 139264
    s_add_u32 s81, s81, 8192
    buffer_load_dwordx4 v18, s[84:87], s81 offen lds
L_sd_now2_0:
    s_add_u32 s81, s80, s30
    s_mul_i32 s81, s81, 896
    v_cmp_gt_u32 vcc, 56, v1
    v_mov_b32 v19, 0x7f000000
    s_nop 0
    v_cndmask_b32 v19, v19, v18, vcc
    buffer_load_dwordx4 v[118:121], v19, s[44:47], s81 offen
    buffer_load_dwordx4 v[122:125], v19, s[76:79], 0 offen
    s_mul_i32 s81, s80, 896
    s_sub_u32 s82, s81, 2688
    v_lshlrev_b32 v18, 1, v0
    v_add_u32 v19, s82, v18
    buffer_load_ushort v96, v19, s[64:67], 0 offen
    v_add_u32 v19, 896, v19
    buffer_load_ushort v97, v19, s[64:67], 0 offen
    v_add_u32 v19, 896, v19
    buffer_load_ushort v98, v19, s[64:67], 0 offen
    v_add_u32 v19, 896, v19
    buffer_load_ushort v99, v19, s[64:67], 0 offen
    v_add_u32 v19, 896, v19
    buffer_load_ushort v100, v19, s[64:67], 0 offen
    v_add_u32 v19, 896, v19
    buffer_load_ushort v101, v19, s[64:67], 0 offen
    v_add_u32 v19, 896, v19
    buffer_load_ushort v102, v19, s[64:67], 0 offen
    v_add_u32 v19, 896, v19
    buffer_load_ushort v103, v19, s[64:67], 0 offen
    v_add_u32 v19, 896, v19
    buffer_load_ushort v104, v19, s[64:67], 0 offen
    v_add_u32 v19, 896, v19
    buffer_load_ushort v105, v19, s[64:67], 0 offen
    v_add_u32 v19, 896, v19
    buffer_load_ushort v106, v19, s[64:67], 0 offen
    v_add_u32 v19, s81, v18
    buffer_load_ushort v107, v19, s[68:71], 0 offen
    v_add_u32 v19, 896, v19
    buffer_load_ushort v108, v19, s[68:71], 0 offen
    v_add_u32 v19, 896, v19
    buffer_load_ushort v109, v19, s[68:71], 0 offen
    v_add_u32 v19, 896, v19
    buffer_load_ushort v110, v19, s[68:71], 0 offen
    v_add_u32 v19, 896, v19
    buffer_load_ushort v111, v19, s[68:71], 0 offen
    v_add_u32 v19, 896, v19
    buffer_load_ushort v112, v19, s[68:71], 0 offen
    v_add_u32 v19, 896, v19
    buffer_load_ushort v113, v19, s[68:71], 0 offen
    v_add_u32 v19, 896, v19
    buffer_load_ushort v114, v19, s[68:71], 0 offen
    v_lshlrev_b32 v20, 3, v0
    buffer_load_dwordx2 v[116:117], v20, s[72:75], 0 offen
    v_and_b32 v18, 15, v1
    v_lshrrev_b32 v19, 4, v1
    v_bfe_u32 v20, v1, 1, 3
    v_xor_b32 v20, v20, v19
    s_mul_i32 s35, s37, 16384
    v_lshlrev_b32 v21, 7, v18
    v_add_u32 v21, s35, v21
    v_lshl_add_u32 v6, v20, 4, v21
    v_xor_b32 v7, 64, v6
    v_add_u32 v8, 0x10000, v6
    v_add_u32 v9, 0x10000, v7
    s_and_b32 s83, s49, 3
    s_lshl_b32 s83, s83, 6
    s_add_u32 s83, s83, s40
    s_lshl_b32 s83, s83, 11
    s_lshr_b32 s88, s49, 2
    s_lshl_b32 s88, s88, 16
    s_add_u32 s88, s88, s41
    v_lshlrev_b32 v115, 11, v1
    v_bfe_u32 v126, v1, 2, 3
    v_lshlrev_b32 v126, 13, v126
    v_and_b32 v127, 3, v1
    v_lshl_add_u32 v126, v127, 7, v126
    s_cmp_lg_u32 s30, 7
    s_cbranch_scc1 L_lp_2
    s_add_u32 s35, s83, 256
    buffer_load_dword v26, v115, s[8:11], s35 offen
    s_add_u32 s35, s88, 1048576
    buffer_load_dword v27, v126, s[12:15], s35 offen
L_lp_2:
    s_cmp_eq_u32 s30, 7
    s_cbranch_scc1 L_lw_3
    s_waitcnt vmcnt(23)
L_lw_3:
    s_waitcnt vmcnt(25)
    s_barrier
    ds_read_b64_tr_b16 v[32:33], v10 offset:0
    ds_read_b64_tr_b16 v[34:35], v10 offset:2048
    ds_read_b64_tr_b16 v[36:37], v11 offset:0
    ds_read_b64_tr_b16 v[38:39], v11 offset:2048
    ds_read_b64_tr_b16 v[40:41], v12 offset:0
    ds_read_b64_tr_b16 v[42:43], v12 offset:2048
    ds_read_b64_tr_b16 v[44:45], v13 offset:0
    ds_read_b64_tr_b16 v[46:47], v13 offset:2048
    ds_read_b128 v[64:67], v6 offset:0
    ds_read_b128 v[68:71], v6 offset:2048
    ds_read_b128 v[72:75], v6 offset:4096
    ds_read_b128 v[76:79], v6 offset:6144
    ds_read_b128 v[80:83], v6 offset:8192
    ds_read_b128 v[84:87], v6 offset:10240
    ds_read_b128 v[88:91], v6 offset:12288
    ds_read_b128 v[92:95], v6 offset:14336
    s_waitcnt lgkmcnt(4)
    s_add_u32 m0, s31, 65536
    s_add_u32 s35, s33, 128
    buffer_load_dwordx4 v2, s[8:11], s35 offen lds
    s_add_u32 m0, s31, 66560
    s_add_u32 s35, s33, 16512
    buffer_load_dwordx4 v3, s[8:11], s35 offen lds
    s_add_u32 m0, s31, 67584
    s_add_u32 s35, s33, 32896
    buffer_load_dwordx4 v2, s[8:11], s35 offen lds
    s_add_u32 m0, s31, 68608
    s_add_u32 s35, s33, 49280
    buffer_load_dwordx4 v3, s[8:11], s35 offen lds
    v_mfma_f32_16x16x32_bf16 v[128:131], v[32:35], v[64:67], 0
    v_mfma_f32_16x16x32_bf16 v[132:135], v[36:39], v[64:67], 0
    v_mfma_f32_16x16x32_bf16 v[136:139], v[40:43], v[64:67], 0
    v_mfma_f32_16x16x32_bf16 v[140:143], v[44:47], v[64:67], 0
    v_mfma_f32_16x16x32_bf16 v[144:147], v[32:35], v[68:71], 0
    v_mfma_f32_16x16x32_bf16 v[148:151], v[36:39], v[68:71], 0
    v_mfma_f32_16x16x32_bf16 v[152:155], v[40:43], v[68:71], 0
    v_mfma_f32_16x16x32_bf16 v[156:159], v[44:47], v[68:71], 0
    v_mfma_f32_16x16x32_bf16 v[160:163], v[32:35], v[72:75], 0
    v_mfma_f32_16x16x32_bf16 v[164:167], v[36:39], v[72:75], 0
    v_mfma_f32_16x16x32_bf16 v[168:171], v[40:43], v[72:75], 0
    v_mfma_f32_16x16x32_bf16 v[172:175], v[44:47], v[72:75], 0
    v_mfma_f32_16x16x32_bf16 v[176:179], v[32:35], v[76:79], 0
    v_mfma_f32_16x16x32_bf16 v[180:183], v[36:39], v[76:79], 0
    v_mfma_f32_16x16x32_bf16 v[184:187], v[40:43], v[76:79], 0
    v_mfma_f32_16x16x32_bf16 v[188:191], v[44:47], v[76:79], 0
    ds_read_b64_tr_b16 v[48:49], v10 offset:16384
    ds_read_b64_tr_b16 v[50:51], v10 offset:18432
    ds_read_b64_tr_b16 v[52:53], v11 offset:16384
    ds_read_b64_tr_b16 v[54:55], v11 offset:18432
    ds_read_b64_tr_b16 v[56:57], v12 offset:16384
    ds_read_b64_tr_b16 v[58:59], v12 offset:18432
    ds_read_b64_tr_b16 v[60:61], v13 offset:16384
    ds_read_b64_tr_b16 v[62:63], v13 offset:18432
    ds_read_b128 v[64:67], v7 offset:0
    ds_read_b128 v[68:71], v7 offset:2048
    ds_read_b128 v[72:75], v7 offset:4096
    ds_read_b128 v[76:79], v7 offset:6144
    s_waitcnt lgkmcnt(12)
    s_add_u32 m0, s32, 98304
    s_add_u32 s35, s34, 524288
    buffer_load_dwordx4 v4, s[12:15], s35 offen lds
    s_add_u32 m0, s32, 99328
    s_add_u32 s35, s34, 540672
    buffer_load_dwordx4 v5, s[12:15], s35 offen lds
    s_add_u32 m0, s32, 100352
    s_add_u32 s35, s34, 557056
    buffer_load_dwordx4 v4, s[12:15], s35 offen lds
    s_add_u32 m0, s32, 101376
    s_add_u32 s35, s34, 573440
    buffer_load_dwordx4 v5, s[12:15], s35 offen lds
    v_mfma_f32_16x16x32_bf16 v[192:195], v[32:35], v[80:83], 0
    v_mfma_f32_16x16x32_bf16 v[196:199], v[36:39], v[80:83], 0
    v_mfma_f32_16x16x32_bf16 v[200:203], v[40:43], v[80:83], 0
    v_mfma_f32_16x16x32_bf16 v[204:207], v[44:47], v[80:83], 0
    v_mfma_f32_16x16x32_bf16 v[208:211], v[32:35], v[84:87], 0
    v_mfma_f32_16x16x32_bf16 v[212:215], v[36:39], v[84:87], 0
    v_mfma_f32_16x16x32_bf16 v[216:219], v[40:43], v[84:87], 0
    v_mfma_f32_16x16x32_bf16 v[220:223], v[44:47], v[84:87], 0
    v_mfma_f32_16x16x32_bf16 v[224:227], v[32:35], v[88:91], 0
    v_mfma_f32_16x16x32_bf16 v[228:231], v[36:39], v[88:91], 0
    v_mfma_f32_16x16x32_bf16 v[232:235], v[40:43], v[88:91], 0
    v_mfma_f32_16x16x32_bf16 v[236:239], v[44:47], v[88:91], 0
    v_mfma_f32_16x16x32_bf16 v[240:243], v[32:35], v[92:95], 0
    v_mfma_f32_16x16x32_bf16 v[244:247], v[36:39], v[92:95], 0
    v_mfma_f32_16x16x32_bf16 v[248:251], v[40:43], v[92:95], 0
    v_mfma_f32_16x16x32_bf16 v[252:255], v[44:47], v[92:95], 0
    ds_read_b128 v[80:83], v7 offset:8192
    ds_read_b128 v[84:87], v7 offset:10240
    ds_read_b128 v[88:91], v7 offset:12288
    ds_read_b128 v[92:95], v7 offset:14336
    s_waitcnt lgkmcnt(4)
    v_mfma_f32_16x16x32_bf16 v[128:131], v[48:51], v[64:67], v[128:131]
    v_mfma_f32_16x16x32_bf16 v[132:135], v[52:55], v[64:67], v[132:135]
    v_mfma_f32_16x16x32_bf16 v[136:139], v[56:59], v[64:67], v[136:139]
    v_mfma_f32_16x16x32_bf16 v[140:143], v[60:63], v[64:67], v[140:143]
    v_mfma_f32_16x16x32_bf16 v[144:147], v[48:51], v[68:71], v[144:147]
    v_mfma_f32_16x16x32_bf16 v[148:151], v[52:55], v[68:71], v[148:151]
    v_mfma_f32_16x16x32_bf16 v[152:155], v[56:59], v[68:71], v[152:155]
    v_mfma_f32_16x16x32_bf16 v[156:159], v[60:63], v[68:71], v[156:159]
    v_mfma_f32_16x16x32_bf16 v[160:163], v[48:51], v[72:75], v[160:163]
    v_mfma_f32_16x16x32_bf16 v[164:167], v[52:55], v[72:75], v[164:167]
    v_mfma_f32_16x16x32_bf16 v[168:171], v[56:59], v[72:75], v[168:171]
    v_mfma_f32_16x16x32_bf16 v[172:175], v[60:63], v[72:75], v[172:175]
    v_mfma_f32_16x16x32_bf16 v[176:179], v[48:51], v[76:79], v[176:179]
    v_mfma_f32_16x16x32_bf16 v[180:183], v[52:55], v[76:79], v[180:183]
    v_mfma_f32_16x16x32_bf16 v[184:187], v[56:59], v[76:79], v[184:187]
    v_mfma_f32_16x16x32_bf16 v[188:191], v[60:63], v[76:79], v[188:191]
    s_waitcnt lgkmcnt(0)
    v_mfma_f32_16x16x32_bf16 v[192:195], v[48:51], v[80:83], v[192:195]
    v_mfma_f32_16x16x32_bf16 v[196:199], v[52:55], v[80:83], v[196:199]
    v_mfma_f32_16x16x32_bf16 v[200:203], v[56:59], v[80:83], v[200:203]
    v_mfma_f32_16x16x32_bf16 v[204:207], v[60:63], v[80:83], v[204:207]
    v_mfma_f32_16x16x32_bf16 v[208:211], v[48:51], v[84:87], v[208:211]
    v_mfma_f32_16x16x32_bf16 v[212:215], v[52:55], v[84:87], v[212:215]
    v_mfma_f32_16x16x32_bf16 v[216:219], v[56:59], v[84:87], v[216:219]
    v_mfma_f32_16x16x32_bf16 v[220:223], v[60:63], v[84:87], v[220:223]
    v_mfma_f32_16x16x32_bf16 v[224:227], v[48:51], v[88:91], v[224:227]
    v_mfma_f32_16x16x32_bf16 v[228:231], v[52:55], v[88:91], v[228:231]
    v_mfma_f32_16x16x32_bf16 v[232:235], v[56:59], v[88:91], v[232:235]
    v_mfma_f32_16x16x32_bf16 v[236:239], v[60:63], v[88:91], v[236:239]
    v_mfma_f32_16x16x32_bf16 v[240:243], v[48:51], v[92:95], v[240:243]
    v_mfma_f32_16x16x32_bf16 v[244:247], v[52:55], v[92:95], v[244:247]
    v_mfma_f32_16x16x32_bf16 v[248:251], v[56:59], v[92:95], v[248:251]
    v_mfma_f32_16x16x32_bf16 v[252:255], v[60:63], v[92:95], v[252:255]
    s_cmp_lg_u32 s30, 0
    s_cbranch_scc1 L_lp_4
    s_add_u32 s35, s83, 384
    buffer_load_dword v26, v115, s[8:11], s35 offen
    s_add_u32 s35, s88, 1572864
    buffer_load_dword v27, v126, s[12:15], s35 offen
L_lp_4:
    s_cmp_eq_u32 s30, 0
    s_cbranch_scc1 L_lw_5
    s_waitcnt vmcnt(0)
L_lw_5:
    s_waitcnt vmcnt(2)
    s_barrier
    ds_read_b64_tr_b16 v[32:33], v14 offset:0
    ds_read_b64_tr_b16 v[34:35], v14 offset:2048
    ds_read_b64_tr_b16 v[36:37], v15 offset:0
    ds_read_b64_tr_b16 v[38:39], v15 offset:2048
    ds_read_b64_tr_b16 v[40:41], v16 offset:0
    ds_read_b64_tr_b16 v[42:43], v16 offset:2048
    ds_read_b64_tr_b16 v[44:45], v17 offset:0
    ds_read_b64_tr_b16 v[46:47], v17 offset:2048
    ds_read_b128 v[64:67], v8 offset:0
    ds_read_b128 v[68:71], v8 offset:2048
    ds_read_b128 v[72:75], v8 offset:4096
    ds_read_b128 v[76:79], v8 offset:6144
    ds_read_b128 v[80:83], v8 offset:8192
    ds_read_b128 v[84:87], v8 offset:10240
    ds_read_b128 v[88:91], v8 offset:12288
    ds_read_b128 v[92:95], v8 offset:14336
    s_waitcnt lgkmcnt(4)
    s_add_u32 m0, s31, 0
    s_add_u32 s35, s33, 256
    buffer_load_dwordx4 v2, s[8:11], s35 offen lds
    s_add_u32 m0, s31, 1024
    s_add_u32 s35, s33, 16640
    buffer_load_dwordx4 v3, s[8:11], s35 offen lds
    s_add_u32 m0, s31, 2048
    s_add_u32 s35, s33, 33024
    buffer_load_dwordx4 v2, s[8:11], s35 offen lds
    s_add_u32 m0, s31, 3072
    s_add_u32 s35, s33, 49408
    buffer_load_dwordx4 v3, s[8:11], s35 offen lds
    v_mfma_f32_16x16x32_bf16 v[128:131], v[32:35], v[64:67], v[128:131]
    v_mfma_f32_16x16x32_bf16 v[132:135], v[36:39], v[64:67], v[132:135]
    v_mfma_f32_16x16x32_bf16 v[136:139], v[40:43], v[64:67], v[136:139]
    v_mfma_f32_16x16x32_bf16 v[140:143], v[44:47], v[64:67], v[140:143]
    v_mfma_f32_16x16x32_bf16 v[144:147], v[32:35], v[68:71], v[144:147]
    v_mfma_f32_16x16x32_bf16 v[148:151], v[36:39], v[68:71], v[148:151]
    v_mfma_f32_16x16x32_bf16 v[152:155], v[40:43], v[68:71], v[152:155]
    v_mfma_f32_16x16x32_bf16 v[156:159], v[44:47], v[68:71], v[156:159]
    v_mfma_f32_16x16x32_bf16 v[160:163], v[32:35], v[72:75], v[160:163]
    v_mfma_f32_16x16x32_bf16 v[164:167], v[36:39], v[72:75], v[164:167]
    v_mfma_f32_16x16x32_bf16 v[168:171], v[40:43], v[72:75], v[168:171]
    v_mfma_f32_16x16x32_bf16 v[172:175], v[44:47], v[72:75], v[172:175]
    v_mfma_f32_16x16x32_bf16 v[176:179], v[32:35], v[76:79], v[176:179]
    v_mfma_f32_16x16x32_bf16 v[180:183], v[36:39], v[76:79], v[180:183]
    v_mfma_f32_16x16x32_bf16 v[184:187], v[40:43], v[76:79], v[184:187]
    v_mfma_f32_16x16x32_bf16 v[188:191], v[44:47], v[76:79], v[188:191]
    s_add_u32 s64, s26, 69206016
    s_addc_u32 s65, s27, 0
    s_mov_b32 s66, 1835008
    s_mov_b32 s67, 0x00020000
    s_add_u32 s68, s26, 71303168
    s_addc_u32 s69, s27, 0
    s_mov_b32 s70, 8192
    s_mov_b32 s71, 0x00020000
    s_add_u32 s72, s26, 72351744
    s_addc_u32 s73, s27, 0
    s_mov_b32 s74, 3670016
    s_mov_b32 s75, 0x00020000
    v_lshrrev_b32 v18, 5, v1
    ds_read_b64_tr_b16 v[48:49], v14 offset:16384
    ds_read_b64_tr_b16 v[50:51], v14 offset:18432
    ds_read_b64_tr_b16 v[52:53], v15 offset:16384
    ds_read_b64_tr_b16 v[54:55], v15 offset:18432
    ds_read_b64_tr_b16 v[56:57], v16 offset:16384
    ds_read_b64_tr_b16 v[58:59], v16 offset:18432
    ds_read_b64_tr_b16 v[60:61], v17 offset:16384
    ds_read_b64_tr_b16 v[62:63], v17 offset:18432
    ds_read_b128 v[64:67], v9 offset:0
    ds_read_b128 v[68:71], v9 offset:2048
    ds_read_b128 v[72:75], v9 offset:4096
    ds_read_b128 v[76:79], v9 offset:6144
    s_waitcnt lgkmcnt(12)
    s_add_u32 m0, s32, 32768
    s_add_u32 s35, s34, 1048576
    buffer_load_dwordx4 v4, s[12:15], s35 offen lds
    s_add_u32 m0, s32, 33792
    s_add_u32 s35, s34, 1064960
    buffer_load_dwordx4 v5, s[12:15], s35 offen lds
    s_add_u32 m0, s32, 34816
    s_add_u32 s35, s34, 1081344
    buffer_load_dwordx4 v4, s[12:15], s35 offen lds
    s_add_u32 m0, s32, 35840
    s_add_u32 s35, s34, 1097728
    buffer_load_dwordx4 v5, s[12:15], s35 offen lds
    v_mfma_f32_16x16x32_bf16 v[192:195], v[32:35], v[80:83], v[192:195]
    v_mfma_f32_16x16x32_bf16 v[196:199], v[36:39], v[80:83], v[196:199]
    v_mfma_f32_16x16x32_bf16 v[200:203], v[40:43], v[80:83], v[200:203]
    v_mfma_f32_16x16x32_bf16 v[204:207], v[44:47], v[80:83], v[204:207]
    v_mfma_f32_16x16x32_bf16 v[208:211], v[32:35], v[84:87], v[208:211]
    v_mfma_f32_16x16x32_bf16 v[212:215], v[36:39], v[84:87], v[212:215]
    v_mfma_f32_16x16x32_bf16 v[216:219], v[40:43], v[84:87], v[216:219]
    v_mfma_f32_16x16x32_bf16 v[220:223], v[44:47], v[84:87], v[220:223]
    v_mfma_f32_16x16x32_bf16 v[224:227], v[32:35], v[88:91], v[224:227]
    v_mfma_f32_16x16x32_bf16 v[228:231], v[36:39], v[88:91], v[228:231]
    v_mfma_f32_16x16x32_bf16 v[232:235], v[40:43], v[88:91], v[232:235]
    v_mfma_f32_16x16x32_bf16 v[236:239], v[44:47], v[88:91], v[236:239]
    v_mfma_f32_16x16x32_bf16 v[240:243], v[32:35], v[92:95], v[240:243]
    v_mfma_f32_16x16x32_bf16 v[244:247], v[36:39], v[92:95], v[244:247]
    v_mfma_f32_16x16x32_bf16 v[248:251], v[40:43], v[92:95], v[248:251]
    v_mfma_f32_16x16x32_bf16 v[252:255], v[44:47], v[92:95], v[252:255]
    v_bfe_u32 v19, v1, 2, 2
    v_lshl_add_u32 v18, v18, 2, v19
    v_mul_u32_u24 v18, 896, v18
    v_bfe_u32 v19, v1, 4, 1
    v_lshl_add_u32 v18, v19, 5, v18
    v_and_b32 v19, 3, v1
    v_lshl_add_u32 v18, v19, 3, v18
    s_lshl_b32 s81, s30, 6
    s_add_u32 s81, s81, 131072
    v_add_u32 v18, s81, v18
    ds_read_b64_tr_b16 v[28:29], v18
    ds_read_b64_tr_b16 v[30:31], v18 offset:7168
    ds_read_b64_tr_b16 v[22:23], v18 offset:512
    ds_read_b64_tr_b16 v[24:25], v18 offset:7680
    v_lshlrev_b32 v19, 4, v1
    ds_read_b128 v[80:83], v9 offset:8192
    ds_read_b128 v[84:87], v9 offset:10240
    ds_read_b128 v[88:91], v9 offset:12288
    ds_read_b128 v[92:95], v9 offset:14336
    s_waitcnt lgkmcnt(4)
    v_mfma_f32_16x16x32_bf16 v[128:131], v[48:51], v[64:67], v[128:131]
    v_mfma_f32_16x16x32_bf16 v[132:135], v[52:55], v[64:67], v[132:135]
    v_mfma_f32_16x16x32_bf16 v[136:139], v[56:59], v[64:67], v[136:139]
    v_mfma_f32_16x16x32_bf16 v[140:143], v[60:63], v[64:67], v[140:143]
    v_mfma_f32_16x16x32_bf16 v[144:147], v[48:51], v[68:71], v[144:147]
    v_mfma_f32_16x16x32_bf16 v[148:151], v[52:55], v[68:71], v[148:151]
    v_mfma_f32_16x16x32_bf16 v[152:155], v[56:59], v[68:71], v[152:155]
    v_mfma_f32_16x16x32_bf16 v[156:159], v[60:63], v[68:71], v[156:159]
    v_mfma_f32_16x16x32_bf16 v[160:163], v[48:51], v[72:75], v[160:163]
    v_mfma_f32_16x16x32_bf16 v[164:167], v[52:55], v[72:75], v[164:167]
    v_mfma_f32_16x16x32_bf16 v[168:171], v[56:59], v[72:75], v[168:171]
    v_mfma_f32_16x16x32_bf16 v[172:175], v[60:63], v[72:75], v[172:175]
    v_mfma_f32_16x16x32_bf16 v[176:179], v[48:51], v[76:79], v[176:179]
    v_mfma_f32_16x16x32_bf16 v[180:183], v[52:55], v[76:79], v[180:183]
    v_mfma_f32_16x16x32_bf16 v[184:187], v[56:59], v[76:79], v[184:187]
    v_mfma_f32_16x16x32_bf16 v[188:191], v[60:63], v[76:79], v[188:191]
    s_lshl_b32 s81, s30, 18
    s_lshl_b32 s82, s2, 10
    s_add_u32 s81, s81, s82
    s_waitcnt lgkmcnt(0)
    buffer_store_dwordx4 v[28:31], v19, s[72:75], s81 offen
    s_add_u32 s81, s81, 2097152
    buffer_store_dwordx4 v[22:25], v19, s[72:75], s81 offen
    s_nop 1
    v_mov_b32 v21, 0
    v_lshlrev_b32 v22, 16, v118
    v_lshlrev_b32 v23, 16, v122
    s_waitcnt lgkmcnt(0)
    v_mfma_f32_16x16x32_bf16 v[192:195], v[48:51], v[80:83], v[192:195]
    v_mfma_f32_16x16x32_bf16 v[196:199], v[52:55], v[80:83], v[196:199]
    v_mfma_f32_16x16x32_bf16 v[200:203], v[56:59], v[80:83], v[200:203]
    v_mfma_f32_16x16x32_bf16 v[204:207], v[60:63], v[80:83], v[204:207]
    v_mfma_f32_16x16x32_bf16 v[208:211], v[48:51], v[84:87], v[208:211]
    v_mfma_f32_16x16x32_bf16 v[212:215], v[52:55], v[84:87], v[212:215]
    v_mfma_f32_16x16x32_bf16 v[216:219], v[56:59], v[84:87], v[216:219]
    v_mfma_f32_16x16x32_bf16 v[220:223], v[60:63], v[84:87], v[220:223]
    v_mfma_f32_16x16x32_bf16 v[224:227], v[48:51], v[88:91], v[224:227]
    v_mfma_f32_16x16x32_bf16 v[228:231], v[52:55], v[88:91], v[228:231]
    v_mfma_f32_16x16x32_bf16 v[232:235], v[56:59], v[88:91], v[232:235]
    v_mfma_f32_16x16x32_bf16 v[236:239], v[60:63], v[88:91], v[236:239]
    v_mfma_f32_16x16x32_bf16 v[240:243], v[48:51], v[92:95], v[240:243]
    v_mfma_f32_16x16x32_bf16 v[244:247], v[52:55], v[92:95], v[244:247]
    v_mfma_f32_16x16x32_bf16 v[248:251], v[56:59], v[92:95], v[248:251]
    v_mfma_f32_16x16x32_bf16 v[252:255], v[60:63], v[92:95], v[252:255]
    v_and_b32 v24, 0xffff0000, v118
    v_and_b32 v25, 0xffff0000, v122
    v_mul_f32 v22, v22, v23
    v_mul_f32 v24, v24, v25
    v_cvt_pk_bf16_f32 v22, v22, v24
    v_lshlrev_b32 v23, 16, v22
    v_and_b32 v24, 0xffff0000, v22
    v_add_f32 v21, v21, v23
    v_add_f32 v21, v21, v24
    v_lshlrev_b32 v22, 16, v119
    v_lshlrev_b32 v23, 16, v123
    s_cmp_lg_u32 s30, 1
    s_cbranch_scc1 L_lp_6
    s_add_u32 s35, s83, 512
    buffer_load_dword v26, v115, s[8:11], s35 offen
    s_add_u32 s35, s88, 2097152
    buffer_load_dword v27, v126, s[12:15], s35 offen
L_lp_6:
    s_cmp_eq_u32 s30, 1
    s_cbranch_scc1 L_lw_7
    s_waitcnt vmcnt(0)
L_lw_7:
    s_waitcnt vmcnt(2)
    s_barrier
    ds_read_b64_tr_b16 v[32:33], v10 offset:0
    ds_read_b64_tr_b16 v[34:35], v10 offset:2048
    ds_read_b64_tr_b16 v[36:37], v11 offset:0
    ds_read_b64_tr_b16 v[38:39], v11 offset:2048
    ds_read_b64_tr_b16 v[40:41], v12 offset:0
    ds_read_b64_tr_b16 v[42:43], v12 offset:2048
    ds_read_b64_tr_b16 v[44:45], v13 offset:0
    ds_read_b64_tr_b16 v[46:47], v13 offset:2048
    ds_read_b128 v[64:67], v6 offset:0
    ds_read_b128 v[68:71], v6 offset:2048
    ds_read_b128 v[72:75], v6 offset:4096
    ds_read_b128 v[76:79], v6 offset:6144
    ds_read_b128 v[80:83], v6 offset:8192
    ds_read_b128 v[84:87], v6 offset:10240
    ds_read_b128 v[88:91], v6 offset:12288
    ds_read_b128 v[92:95], v6 offset:14336
    s_waitcnt lgkmcnt(4)
    s_add_u32 m0, s31, 65536
    s_add_u32 s35, s33, 384
    buffer_load_dwordx4 v2, s[8:11], s35 offen lds
    s_add_u32 m0, s31, 66560
    s_add_u32 s35, s33, 16768
    buffer_load_dwordx4 v3, s[8:11], s35 offen lds
    s_add_u32 m0, s31, 67584
    s_add_u32 s35, s33, 33152
    buffer_load_dwordx4 v2, s[8:11], s35 offen lds
    s_add_u32 m0, s31, 68608
    s_add_u32 s35, s33, 49536
    buffer_load_dwordx4 v3, s[8:11], s35 offen lds
    v_mfma_f32_16x16x32_bf16 v[128:131], v[32:35], v[64:67], v[128:131]
    v_mfma_f32_16x16x32_bf16 v[132:135], v[36:39], v[64:67], v[132:135]
    v_mfma_f32_16x16x32_bf16 v[136:139], v[40:43], v[64:67], v[136:139]
    v_mfma_f32_16x16x32_bf16 v[140:143], v[44:47], v[64:67], v[140:143]
    v_mfma_f32_16x16x32_bf16 v[144:147], v[32:35], v[68:71], v[144:147]
    v_mfma_f32_16x16x32_bf16 v[148:151], v[36:39], v[68:71], v[148:151]
    v_mfma_f32_16x16x32_bf16 v[152:155], v[40:43], v[68:71], v[152:155]
    v_mfma_f32_16x16x32_bf16 v[156:159], v[44:47], v[68:71], v[156:159]
    v_mfma_f32_16x16x32_bf16 v[160:163], v[32:35], v[72:75], v[160:163]
    v_mfma_f32_16x16x32_bf16 v[164:167], v[36:39], v[72:75], v[164:167]
    v_mfma_f32_16x16x32_bf16 v[168:171], v[40:43], v[72:75], v[168:171]
    v_mfma_f32_16x16x32_bf16 v[172:175], v[44:47], v[72:75], v[172:175]
    v_mfma_f32_16x16x32_bf16 v[176:179], v[32:35], v[76:79], v[176:179]
    v_mfma_f32_16x16x32_bf16 v[180:183], v[36:39], v[76:79], v[180:183]
    v_mfma_f32_16x16x32_bf16 v[184:187], v[40:43], v[76:79], v[184:187]
    v_mfma_f32_16x16x32_bf16 v[188:191], v[44:47], v[76:79], v[188:191]
    v_and_b32 v24, 0xffff0000, v119
    v_and_b32 v25, 0xffff0000, v123
    v_mul_f32 v22, v22, v23
    v_mul_f32 v24, v24, v25
    v_cvt_pk_bf16_f32 v22, v22, v24
    v_lshlrev_b32 v23, 16, v22
    v_and_b32 v24, 0xffff0000, v22
    v_add_f32 v21, v21, v23
    v_add_f32 v21, v21, v24
    v_lshlrev_b32 v22, 16, v120
    v_lshlrev_b32 v23, 16, v124
    ds_read_b64_tr_b16 v[48:49], v10 offset:16384
    ds_read_b64_tr_b16 v[50:51], v10 offset:18432
    ds_read_b64_tr_b16 v[52:53], v11 offset:16384
    ds_read_b64_tr_b16 v[54:55], v11 offset:18432
    ds_read_b64_tr_b16 v[56:57], v12 offset:16384
    ds_read_b64_tr_b16 v[58:59], v12 offset:18432
    ds_read_b64_tr_b16 v[60:61], v13 offset:16384
    ds_read_b64_tr_b16 v[62:63], v13 offset:18432
    ds_read_b128 v[64:67], v7 offset:0
    ds_read_b128 v[68:71], v7 offset:2048
    ds_read_b128 v[72:75], v7 offset:4096
    ds_read_b128 v[76:79], v7 offset:6144
    s_waitcnt lgkmcnt(12)
    s_add_u32 m0, s32, 98304
    s_add_u32 s35, s34, 1572864
    buffer_load_dwordx4 v4, s[12:15], s35 offen lds
    s_add_u32 m0, s32, 99328
    s_add_u32 s35, s34, 1589248
    buffer_load_dwordx4 v5, s[12:15], s35 offen lds
    s_add_u32 m0, s32, 100352
    s_add_u32 s35, s34, 1605632
    buffer_load_dwordx4 v4, s[12:15], s35 offen lds
    s_add_u32 m0, s32, 101376
    s_add_u32 s35, s34, 1622016
    buffer_load_dwordx4 v5, s[12:15], s35 offen lds
    v_mfma_f32_16x16x32_bf16 v[192:195], v[32:35], v[80:83], v[192:195]
    v_mfma_f32_16x16x32_bf16 v[196:199], v[36:39], v[80:83], v[196:199]
    v_mfma_f32_16x16x32_bf16 v[200:203], v[40:43], v[80:83], v[200:203]
    v_mfma_f32_16x16x32_bf16 v[204:207], v[44:47], v[80:83], v[204:207]
    v_mfma_f32_16x16x32_bf16 v[208:211], v[32:35], v[84:87], v[208:211]
    v_mfma_f32_16x16x32_bf16 v[212:215], v[36:39], v[84:87], v[212:215]
    v_mfma_f32_16x16x32_bf16 v[216:219], v[40:43], v[84:87], v[216:219]
    v_mfma_f32_16x16x32_bf16 v[220:223], v[44:47], v[84:87], v[220:223]
    v_mfma_f32_16x16x32_bf16 v[224:227], v[32:35], v[88:91], v[224:227]
    v_mfma_f32_16x16x32_bf16 v[228:231], v[36:39], v[88:91], v[228:231]
    v_mfma_f32_16x16x32_bf16 v[232:235], v[40:43], v[88:91], v[232:235]
    v_mfma_f32_16x16x32_bf16 v[236:239], v[44:47], v[88:91], v[236:239]
    v_mfma_f32_16x16x32_bf16 v[240:243], v[32:35], v[92:95], v[240:243]
    v_mfma_f32_16x16x32_bf16 v[244:247], v[36:39], v[92:95], v[244:247]
    v_mfma_f32_16x16x32_bf16 v[248:251], v[40:43], v[92:95], v[248:251]
    v_mfma_f32_16x16x32_bf16 v[252:255], v[44:47], v[92:95], v[252:255]
    v_and_b32 v24, 0xffff0000, v120
    v_and_b32 v25, 0xffff0000, v124
    v_mul_f32 v22, v22, v23
    v_mul_f32 v24, v24, v25
    v_cvt_pk_bf16_f32 v22, v22, v24
    v_lshlrev_b32 v23, 16, v22
    v_and_b32 v24, 0xffff0000, v22
    v_add_f32 v21, v21, v23
    v_add_f32 v21, v21, v24
    v_lshlrev_b32 v22, 16, v121
    v_lshlrev_b32 v23, 16, v125
    ds_read_b128 v[80:83], v7 offset:8192
    ds_read_b128 v[84:87], v7 offset:10240
    ds_read_b128 v[88:91], v7 offset:12288
    ds_read_b128 v[92:95], v7 offset:14336
    s_waitcnt lgkmcnt(4)
    v_mfma_f32_16x16x32_bf16 v[128:131], v[48:51], v[64:67], v[128:131]
    v_mfma_f32_16x16x32_bf16 v[132:135], v[52:55], v[64:67], v[132:135]
    v_mfma_f32_16x16x32_bf16 v[136:139], v[56:59], v[64:67], v[136:139]
    v_mfma_f32_16x16x32_bf16 v[140:143], v[60:63], v[64:67], v[140:143]
    v_mfma_f32_16x16x32_bf16 v[144:147], v[48:51], v[68:71], v[144:147]
    v_mfma_f32_16x16x32_bf16 v[148:151], v[52:55], v[68:71], v[148:151]
    v_mfma_f32_16x16x32_bf16 v[152:155], v[56:59], v[68:71], v[152:155]
    v_mfma_f32_16x16x32_bf16 v[156:159], v[60:63], v[68:71], v[156:159]
    v_mfma_f32_16x16x32_bf16 v[160:163], v[48:51], v[72:75], v[160:163]
    v_mfma_f32_16x16x32_bf16 v[164:167], v[52:55], v[72:75], v[164:167]
    v_mfma_f32_16x16x32_bf16 v[168:171], v[56:59], v[72:75], v[168:171]
    v_mfma_f32_16x16x32_bf16 v[172:175], v[60:63], v[72:75], v[172:175]
    v_mfma_f32_16x16x32_bf16 v[176:179], v[48:51], v[76:79], v[176:179]
    v_mfma_f32_16x16x32_bf16 v[180:183], v[52:55], v[76:79], v[180:183]
    v_mfma_f32_16x16x32_bf16 v[184:187], v[56:59], v[76:79], v[184:187]
    v_mfma_f32_16x16x32_bf16 v[188:191], v[60:63], v[76:79], v[188:191]
    v_and_b32 v24, 0xffff0000, v121
    v_and_b32 v25, 0xffff0000, v125
    v_mul_f32 v22, v22, v23
    v_mul_f32 v24, v24, v25
    v_cvt_pk_bf16_f32 v22, v22, v24
    v_lshlrev_b32 v23, 16, v22
    v_and_b32 v24, 0xffff0000, v22
    v_add_f32 v21, v21, v23
    v_add_f32 v21, v21, v24
    ds_swizzle_b32 v22, v21 offset:1055
    s_waitcnt lgkmcnt(0)
    s_waitcnt lgkmcnt(0)
    v_mfma_f32_16x16x32_bf16 v[192:195], v[48:51], v[80:83], v[192:195]
    v_mfma_f32_16x16x32_bf16 v[196:199], v[52:55], v[80:83], v[196:199]
    v_mfma_f32_16x16x32_bf16 v[200:203], v[56:59], v[80:83], v[200:203]
    v_mfma_f32_16x16x32_bf16 v[204:207], v[60:63], v[80:83], v[204:207]
    v_mfma_f32_16x16x32_bf16 v[208:211], v[48:51], v[84:87], v[208:211]
    v_mfma_f32_16x16x32_bf16 v[212:215], v[52:55], v[84:87], v[212:215]
    v_mfma_f32_16x16x32_bf16 v[216:219], v[56:59], v[84:87], v[216:219]
    v_mfma_f32_16x16x32_bf16 v[220:223], v[60:63], v[84:87], v[220:223]
    v_mfma_f32_16x16x32_bf16 v[224:227], v[48:51], v[88:91], v[224:227]
    v_mfma_f32_16x16x32_bf16 v[228:231], v[52:55], v[88:91], v[228:231]
    v_mfma_f32_16x16x32_bf16 v[232:235], v[56:59], v[88:91], v[232:235]
    v_mfma_f32_16x16x32_bf16 v[236:239], v[60:63], v[88:91], v[236:239]
    v_mfma_f32_16x16x32_bf16 v[240:243], v[48:51], v[92:95], v[240:243]
    v_mfma_f32_16x16x32_bf16 v[244:247], v[52:55], v[92:95], v[244:247]
    v_mfma_f32_16x16x32_bf16 v[248:251], v[56:59], v[92:95], v[248:251]
    v_mfma_f32_16x16x32_bf16 v[252:255], v[60:63], v[92:95], v[252:255]
    v_add_f32 v21, v21, v22
    ds_swizzle_b32 v22, v21 offset:2079
    s_waitcnt lgkmcnt(0)
    v_add_f32 v21, v21, v22
    ds_swizzle_b32 v22, v21 offset:4127
    s_waitcnt lgkmcnt(0)
    v_add_f32 v21, v21, v22
    ds_swizzle_b32 v22, v21 offset:8223
    s_waitcnt lgkmcnt(0)
    v_add_f32 v21, v21, v22
    ds_swizzle_b32 v22, v21 offset:16415
    s_waitcnt lgkmcnt(0)
    s_cmp_lg_u32 s30, 2
    s_cbranch_scc1 L_lp_8
    s_add_u32 s35, s83, 640
    buffer_load_dword v26, v115, s[8:11], s35 offen
    s_add_u32 s35, s88, 2621440
    buffer_load_dword v27, v126, s[12:15], s35 offen
L_lp_8:
    s_cmp_eq_u32 s30, 2
    s_cbranch_scc1 L_lw_9
    s_waitcnt vmcnt(0)
L_lw_9:
    s_waitcnt vmcnt(2)
    s_barrier
    ds_read_b64_tr_b16 v[32:33], v14 offset:0
    ds_read_b64_tr_b16 v[34:35], v14 offset:2048
    ds_read_b64_tr_b16 v[36:37], v15 offset:0
    ds_read_b64_tr_b16 v[38:39], v15 offset:2048
    ds_read_b64_tr_b16 v[40:41], v16 offset:0
    ds_read_b64_tr_b16 v[42:43], v16 offset:2048
    ds_read_b64_tr_b16 v[44:45], v17 offset:0
    ds_read_b64_tr_b16 v[46:47], v17 offset:2048
    ds_read_b128 v[64:67], v8 offset:0
    ds_read_b128 v[68:71], v8 offset:2048
    ds_read_b128 v[72:75], v8 offset:4096
    ds_read_b128 v[76:79], v8 offset:6144
    ds_read_b128 v[80:83], v8 offset:8192
    ds_read_b128 v[84:87], v8 offset:10240
    ds_read_b128 v[88:91], v8 offset:12288
    ds_read_b128 v[92:95], v8 offset:14336
    s_waitcnt lgkmcnt(4)
    s_add_u32 m0, s31, 0
    s_add_u32 s35, s33, 512
    buffer_load_dwordx4 v2, s[8:11], s35 offen lds
    s_add_u32 m0, s31, 1024
    s_add_u32 s35, s33, 16896
    buffer_load_dwordx4 v3, s[8:11], s35 offen lds
    s_add_u32 m0, s31, 2048
    s_add_u32 s35, s33, 33280
    buffer_load_dwordx4 v2, s[8:11], s35 offen lds
    s_add_u32 m0, s31, 3072
    s_add_u32 s35, s33, 49664
    buffer_load_dwordx4 v3, s[8:11], s35 offen lds
    v_mfma_f32_16x16x32_bf16 v[128:131], v[32:35], v[64:67], v[128:131]
    v_mfma_f32_16x16x32_bf16 v[132:135], v[36:39], v[64:67], v[132:135]
    v_mfma_f32_16x16x32_bf16 v[136:139], v[40:43], v[64:67], v[136:139]
    v_mfma_f32_16x16x32_bf16 v[140:143], v[44:47], v[64:67], v[140:143]
    v_mfma_f32_16x16x32_bf16 v[144:147], v[32:35], v[68:71], v[144:147]
    v_mfma_f32_16x16x32_bf16 v[148:151], v[36:39], v[68:71], v[148:151]
    v_mfma_f32_16x16x32_bf16 v[152:155], v[40:43], v[68:71], v[152:155]
    v_mfma_f32_16x16x32_bf16 v[156:159], v[44:47], v[68:71], v[156:159]
    v_mfma_f32_16x16x32_bf16 v[160:163], v[32:35], v[72:75], v[160:163]
    v_mfma_f32_16x16x32_bf16 v[164:167], v[36:39], v[72:75], v[164:167]
    v_mfma_f32_16x16x32_bf16 v[168:171], v[40:43], v[72:75], v[168:171]
    v_mfma_f32_16x16x32_bf16 v[172:175], v[44:47], v[72:75], v[172:175]
    v_mfma_f32_16x16x32_bf16 v[176:179], v[32:35], v[76:79], v[176:179]
    v_mfma_f32_16x16x32_bf16 v[180:183], v[36:39], v[76:79], v[180:183]
    v_mfma_f32_16x16x32_bf16 v[184:187], v[40:43], v[76:79], v[184:187]
    v_mfma_f32_16x16x32_bf16 v[188:191], v[44:47], v[76:79], v[188:191]
    v_add_f32 v21, v21, v22
    v_mov_b32 v22, v21
    s_nop 1
    v_permlane32_swap_b32 v21, v22
    v_add_f32 v21, v21, v22
    v_cvt_pk_bf16_f32 v21, v21, v21
    v_lshlrev_b32 v21, 16, v21
    v_mul_f32 v21, 0xbfb8aa3b, v21
    v_exp_f32 v21, v21
    s_nop 0
    v_add_f32 v21, 1.0, v21
    ds_read_b64_tr_b16 v[48:49], v14 offset:16384
    ds_read_b64_tr_b16 v[50:51], v14 offset:18432
    ds_read_b64_tr_b16 v[52:53], v15 offset:16384
    ds_read_b64_tr_b16 v[54:55], v15 offset:18432
    ds_read_b64_tr_b16 v[56:57], v16 offset:16384
    ds_read_b64_tr_b16 v[58:59], v16 offset:18432
    ds_read_b64_tr_b16 v[60:61], v17 offset:16384
    ds_read_b64_tr_b16 v[62:63], v17 offset:18432
    ds_read_b128 v[64:67], v9 offset:0
    ds_read_b128 v[68:71], v9 offset:2048
    ds_read_b128 v[72:75], v9 offset:4096
    ds_read_b128 v[76:79], v9 offset:6144
    s_waitcnt lgkmcnt(12)
    s_add_u32 m0, s32, 32768
    s_add_u32 s35, s34, 2097152
    buffer_load_dwordx4 v4, s[12:15], s35 offen lds
    s_add_u32 m0, s32, 33792
    s_add_u32 s35, s34, 2113536
    buffer_load_dwordx4 v5, s[12:15], s35 offen lds
    s_add_u32 m0, s32, 34816
    s_add_u32 s35, s34, 2129920
    buffer_load_dwordx4 v4, s[12:15], s35 offen lds
    s_add_u32 m0, s32, 35840
    s_add_u32 s35, s34, 2146304
    buffer_load_dwordx4 v5, s[12:15], s35 offen lds
    v_mfma_f32_16x16x32_bf16 v[192:195], v[32:35], v[80:83], v[192:195]
    v_mfma_f32_16x16x32_bf16 v[196:199], v[36:39], v[80:83], v[196:199]
    v_mfma_f32_16x16x32_bf16 v[200:203], v[40:43], v[80:83], v[200:203]
    v_mfma_f32_16x16x32_bf16 v[204:207], v[44:47], v[80:83], v[204:207]
    v_mfma_f32_16x16x32_bf16 v[208:211], v[32:35], v[84:87], v[208:211]
    v_mfma_f32_16x16x32_bf16 v[212:215], v[36:39], v[84:87], v[212:215]
    v_mfma_f32_16x16x32_bf16 v[216:219], v[40:43], v[84:87], v[216:219]
    v_mfma_f32_16x16x32_bf16 v[220:223], v[44:47], v[84:87], v[220:223]
    v_mfma_f32_16x16x32_bf16 v[224:227], v[32:35], v[88:91], v[224:227]
    v_mfma_f32_16x16x32_bf16 v[228:231], v[36:39], v[88:91], v[228:231]
    v_mfma_f32_16x16x32_bf16 v[232:235], v[40:43], v[88:91], v[232:235]
    v_mfma_f32_16x16x32_bf16 v[236:239], v[44:47], v[88:91], v[236:239]
    v_mfma_f32_16x16x32_bf16 v[240:243], v[32:35], v[92:95], v[240:243]
    v_mfma_f32_16x16x32_bf16 v[244:247], v[36:39], v[92:95], v[244:247]
    v_mfma_f32_16x16x32_bf16 v[248:251], v[40:43], v[92:95], v[248:251]
    v_mfma_f32_16x16x32_bf16 v[252:255], v[44:47], v[92:95], v[252:255]
    v_rcp_f32 v21, v21
    s_nop 0
    v_cvt_pk_bf16_f32 v21, v21, v21
    v_lshlrev_b32 v21, 16, v21
    s_add_u32 s81, s80, s30
    s_lshl_b32 s81, s81, 2
    v_mov_b32 v22, s81
    buffer_store_dword v21, v22, s[68:71], 0 offen
    v_lshlrev_b32 v96, 16, v96
    v_lshlrev_b32 v97, 16, v97
    v_lshlrev_b32 v98, 16, v98
    ds_read_b128 v[80:83], v9 offset:8192
    ds_read_b128 v[84:87], v9 offset:10240
    ds_read_b128 v[88:91], v9 offset:12288
    ds_read_b128 v[92:95], v9 offset:14336
    s_waitcnt lgkmcnt(4)
    v_mfma_f32_16x16x32_bf16 v[128:131], v[48:51], v[64:67], v[128:131]
    v_mfma_f32_16x16x32_bf16 v[132:135], v[52:55], v[64:67], v[132:135]
    v_mfma_f32_16x16x32_bf16 v[136:139], v[56:59], v[64:67], v[136:139]
    v_mfma_f32_16x16x32_bf16 v[140:143], v[60:63], v[64:67], v[140:143]
    v_mfma_f32_16x16x32_bf16 v[144:147], v[48:51], v[68:71], v[144:147]
    v_mfma_f32_16x16x32_bf16 v[148:151], v[52:55], v[68:71], v[148:151]
    v_mfma_f32_16x16x32_bf16 v[152:155], v[56:59], v[68:71], v[152:155]
    v_mfma_f32_16x16x32_bf16 v[156:159], v[60:63], v[68:71], v[156:159]
    v_mfma_f32_16x16x32_bf16 v[160:163], v[48:51], v[72:75], v[160:163]
    v_mfma_f32_16x16x32_bf16 v[164:167], v[52:55], v[72:75], v[164:167]
    v_mfma_f32_16x16x32_bf16 v[168:171], v[56:59], v[72:75], v[168:171]
    v_mfma_f32_16x16x32_bf16 v[172:175], v[60:63], v[72:75], v[172:175]
    v_mfma_f32_16x16x32_bf16 v[176:179], v[48:51], v[76:79], v[176:179]
    v_mfma_f32_16x16x32_bf16 v[180:183], v[52:55], v[76:79], v[180:183]
    v_mfma_f32_16x16x32_bf16 v[184:187], v[56:59], v[76:79], v[184:187]
    v_mfma_f32_16x16x32_bf16 v[188:191], v[60:63], v[76:79], v[188:191]
    v_lshlrev_b32 v99, 16, v99
    v_lshlrev_b32 v100, 16, v100
    v_lshlrev_b32 v101, 16, v101
    v_lshlrev_b32 v102, 16, v102
    v_lshlrev_b32 v103, 16, v103
    v_lshlrev_b32 v104, 16, v104
    v_lshlrev_b32 v105, 16, v105
    v_lshlrev_b32 v106, 16, v106
    v_lshlrev_b32 v107, 16, v107
    v_lshlrev_b32 v108, 16, v108
    v_lshlrev_b32 v109, 16, v109
    s_waitcnt lgkmcnt(0)
    v_mfma_f32_16x16x32_bf16 v[192:195], v[48:51], v[80:83], v[192:195]
    v_mfma_f32_16x16x32_bf16 v[196:199], v[52:55], v[80:83], v[196:199]
    v_mfma_f32_16x16x32_bf16 v[200:203], v[56:59], v[80:83], v[200:203]
    v_mfma_f32_16x16x32_bf16 v[204:207], v[60:63], v[80:83], v[204:207]
    v_mfma_f32_16x16x32_bf16 v[208:211], v[48:51], v[84:87], v[208:211]
    v_mfma_f32_16x16x32_bf16 v[212:215], v[52:55], v[84:87], v[212:215]
    v_mfma_f32_16x16x32_bf16 v[216:219], v[56:59], v[84:87], v[216:219]
    v_mfma_f32_16x16x32_bf16 v[220:223], v[60:63], v[84:87], v[220:223]
    v_mfma_f32_16x16x32_bf16 v[224:227], v[48:51], v[88:91], v[224:227]
    v_mfma_f32_16x16x32_bf16 v[228:231], v[52:55], v[88:91], v[228:231]
    v_mfma_f32_16x16x32_bf16 v[232:235], v[56:59], v[88:91], v[232:235]
    v_mfma_f32_16x16x32_bf16 v[236:239], v[60:63], v[88:91], v[236:239]
    v_mfma_f32_16x16x32_bf16 v[240:243], v[48:51], v[92:95], v[240:243]
    v_mfma_f32_16x16x32_bf16 v[244:247], v[52:55], v[92:95], v[244:247]
    v_mfma_f32_16x16x32_bf16 v[248:251], v[56:59], v[92:95], v[248:251]
    v_mfma_f32_16x16x32_bf16 v[252:255], v[60:63], v[92:95], v[252:255]
    v_lshlrev_b32 v110, 16, v110
    v_lshlrev_b32 v111, 16, v111
    v_lshlrev_b32 v112, 16, v112
    v_lshlrev_b32 v113, 16, v113
    v_lshlrev_b32 v114, 16, v114
    s_nop 0
    v_lshlrev_b32 v118, 16, v116
    v_and_b32 v119, 0xffff0000, v116
    v_lshlrev_b32 v120, 16, v117
    v_and_b32 v121, 0xffff0000, v117
    v_mul_f32 v18, v96, v121
    s_cmp_lg_u32 s30, 3
    s_cbranch_scc1 L_lp_10
    s_add_u32 s35, s83, 768
    buffer_load_dword v26, v115, s[8:11], s35 offen
    s_add_u32 s35, s88, 3145728
    buffer_load_dword v27, v126, s[12:15], s35 offen
L_lp_10:
    s_cmp_eq_u32 s30, 3
    s_cbranch_scc1 L_lw_11
    s_waitcnt vmcnt(0)
L_lw_11:
    s_waitcnt vmcnt(2)
    s_barrier
    ds_read_b64_tr_b16 v[32:33], v10 offset:0
    ds_read_b64_tr_b16 v[34:35], v10 offset:2048
    ds_read_b64_tr_b16 v[36:37], v11 offset:0
    ds_read_b64_tr_b16 v[38:39], v11 offset:2048
    ds_read_b64_tr_b16 v[40:41], v12 offset:0
    ds_read_b64_tr_b16 v[42:43], v12 offset:2048
    ds_read_b64_tr_b16 v[44:45], v13 offset:0
    ds_read_b64_tr_b16 v[46:47], v13 offset:2048
    ds_read_b128 v[64:67], v6 offset:0
    ds_read_b128 v[68:71], v6 offset:2048
    ds_read_b128 v[72:75], v6 offset:4096
    ds_read_b128 v[76:79], v6 offset:6144
    ds_read_b128 v[80:83], v6 offset:8192
    ds_read_b128 v[84:87], v6 offset:10240
    ds_read_b128 v[88:91], v6 offset:12288
    ds_read_b128 v[92:95], v6 offset:14336
    s_waitcnt lgkmcnt(4)
    s_add_u32 m0, s31, 65536
    s_add_u32 s35, s33, 640
    buffer_load_dwordx4 v2, s[8:11], s35 offen lds
    s_add_u32 m0, s31, 66560
    s_add_u32 s35, s33, 17024
    buffer_load_dwordx4 v3, s[8:11], s35 offen lds
    s_add_u32 m0, s31, 67584
    s_add_u32 s35, s33, 33408
    buffer_load_dwordx4 v2, s[8:11], s35 offen lds
    s_add_u32 m0, s31, 68608
    s_add_u32 s35, s33, 49792
    buffer_load_dwordx4 v3, s[8:11], s35 offen lds
    v_mfma_f32_16x16x32_bf16 v[128:131], v[32:35], v[64:67], v[128:131]
    v_mfma_f32_16x16x32_bf16 v[132:135], v[36:39], v[64:67], v[132:135]
    v_mfma_f32_16x16x32_bf16 v[136:139], v[40:43], v[64:67], v[136:139]
    v_mfma_f32_16x16x32_bf16 v[140:143], v[44:47], v[64:67], v[140:143]
    v_mfma_f32_16x16x32_bf16 v[144:147], v[32:35], v[68:71], v[144:147]
    v_mfma_f32_16x16x32_bf16 v[148:151], v[36:39], v[68:71], v[148:151]
    v_mfma_f32_16x16x32_bf16 v[152:155], v[40:43], v[68:71], v[152:155]
    v_mfma_f32_16x16x32_bf16 v[156:159], v[44:47], v[68:71], v[156:159]
    v_mfma_f32_16x16x32_bf16 v[160:163], v[32:35], v[72:75], v[160:163]
    v_mfma_f32_16x16x32_bf16 v[164:167], v[36:39], v[72:75], v[164:167]
    v_mfma_f32_16x16x32_bf16 v[168:171], v[40:43], v[72:75], v[168:171]
    v_mfma_f32_16x16x32_bf16 v[172:175], v[44:47], v[72:75], v[172:175]
    v_mfma_f32_16x16x32_bf16 v[176:179], v[32:35], v[76:79], v[176:179]
    v_mfma_f32_16x16x32_bf16 v[180:183], v[36:39], v[76:79], v[180:183]
    v_mfma_f32_16x16x32_bf16 v[184:187], v[40:43], v[76:79], v[184:187]
    v_mfma_f32_16x16x32_bf16 v[188:191], v[44:47], v[76:79], v[188:191]
    v_mul_f32 v19, v97, v121
    v_cvt_pk_bf16_f32 v20, v18, v19
    v_lshlrev_b32 v21, 16, v20
    v_and_b32 v22, 0xffff0000, v20
    v_mul_f32 v18, v97, v120
    v_mul_f32 v19, v98, v120
    v_cvt_pk_bf16_f32 v20, v18, v19
    v_lshlrev_b32 v18, 16, v20
    v_and_b32 v19, 0xffff0000, v20
    v_add_f32 v21, v21, v18
    v_add_f32 v22, v22, v19
    ds_read_b64_tr_b16 v[48:49], v10 offset:16384
    ds_read_b64_tr_b16 v[50:51], v10 offset:18432
    ds_read_b64_tr_b16 v[52:53], v11 offset:16384
    ds_read_b64_tr_b16 v[54:55], v11 offset:18432
    ds_read_b64_tr_b16 v[56:57], v12 offset:16384
    ds_read_b64_tr_b16 v[58:59], v12 offset:18432
    ds_read_b64_tr_b16 v[60:61], v13 offset:16384
    ds_read_b64_tr_b16 v[62:63], v13 offset:18432
    ds_read_b128 v[64:67], v7 offset:0
    ds_read_b128 v[68:71], v7 offset:2048
    ds_read_b128 v[72:75], v7 offset:4096
    ds_read_b128 v[76:79], v7 offset:6144
    s_waitcnt lgkmcnt(12)
    s_add_u32 m0, s32, 98304
    s_add_u32 s35, s34, 2621440
    buffer_load_dwordx4 v4, s[12:15], s35 offen lds
    s_add_u32 m0, s32, 99328
    s_add_u32 s35, s34, 2637824
    buffer_load_dwordx4 v5, s[12:15], s35 offen lds
    s_add_u32 m0, s32, 100352
    s_add_u32 s35, s34, 2654208
    buffer_load_dwordx4 v4, s[12:15], s35 offen lds
    s_add_u32 m0, s32, 101376
    s_add_u32 s35, s34, 2670592
    buffer_load_dwordx4 v5, s[12:15], s35 offen lds
    v_mfma_f32_16x16x32_bf16 v[192:195], v[32:35], v[80:83], v[192:195]
    v_mfma_f32_16x16x32_bf16 v[196:199], v[36:39], v[80:83], v[196:199]
    v_mfma_f32_16x16x32_bf16 v[200:203], v[40:43], v[80:83], v[200:203]
    v_mfma_f32_16x16x32_bf16 v[204:207], v[44:47], v[80:83], v[204:207]
    v_mfma_f32_16x16x32_bf16 v[208:211], v[32:35], v[84:87], v[208:211]
    v_mfma_f32_16x16x32_bf16 v[212:215], v[36:39], v[84:87], v[212:215]
    v_mfma_f32_16x16x32_bf16 v[216:219], v[40:43], v[84:87], v[216:219]
    v_mfma_f32_16x16x32_bf16 v[220:223], v[44:47], v[84:87], v[220:223]
    v_mfma_f32_16x16x32_bf16 v[224:227], v[32:35], v[88:91], v[224:227]
    v_mfma_f32_16x16x32_bf16 v[228:231], v[36:39], v[88:91], v[228:231]
    v_mfma_f32_16x16x32_bf16 v[232:235], v[40:43], v[88:91], v[232:235]
    v_mfma_f32_16x16x32_bf16 v[236:239], v[44:47], v[88:91], v[236:239]
    v_mfma_f32_16x16x32_bf16 v[240:243], v[32:35], v[92:95], v[240:243]
    v_mfma_f32_16x16x32_bf16 v[244:247], v[36:39], v[92:95], v[244:247]
    v_mfma_f32_16x16x32_bf16 v[248:251], v[40:43], v[92:95], v[248:251]
    v_mfma_f32_16x16x32_bf16 v[252:255], v[44:47], v[92:95], v[252:255]
    v_cvt_pk_bf16_f32 v20, v21, v22
    v_lshlrev_b32 v21, 16, v20
    v_and_b32 v22, 0xffff0000, v20
    v_mul_f32 v18, v98, v119
    v_mul_f32 v19, v99, v119
    v_cvt_pk_bf16_f32 v20, v18, v19
    v_lshlrev_b32 v18, 16, v20
    v_and_b32 v19, 0xffff0000, v20
    v_add_f32 v21, v21, v18
    v_add_f32 v22, v22, v19
    v_cvt_pk_bf16_f32 v20, v21, v22
    ds_read_b128 v[80:83], v7 offset:8192
    ds_read_b128 v[84:87], v7 offset:10240
    ds_read_b128 v[88:91], v7 offset:12288
    ds_read_b128 v[92:95], v7 offset:14336
    s_waitcnt lgkmcnt(4)
    v_mfma_f32_16x16x32_bf16 v[128:131], v[48:51], v[64:67], v[128:131]
    v_mfma_f32_16x16x32_bf16 v[132:135], v[52:55], v[64:67], v[132:135]
    v_mfma_f32_16x16x32_bf16 v[136:139], v[56:59], v[64:67], v[136:139]
    v_mfma_f32_16x16x32_bf16 v[140:143], v[60:63], v[64:67], v[140:143]
    v_mfma_f32_16x16x32_bf16 v[144:147], v[48:51], v[68:71], v[144:147]
    v_mfma_f32_16x16x32_bf16 v[148:151], v[52:55], v[68:71], v[148:151]
    v_mfma_f32_16x16x32_bf16 v[152:155], v[56:59], v[68:71], v[152:155]
    v_mfma_f32_16x16x32_bf16 v[156:159], v[60:63], v[68:71], v[156:159]
    v_mfma_f32_16x16x32_bf16 v[160:163], v[48:51], v[72:75], v[160:163]
    v_mfma_f32_16x16x32_bf16 v[164:167], v[52:55], v[72:75], v[164:167]
    v_mfma_f32_16x16x32_bf16 v[168:171], v[56:59], v[72:75], v[168:171]
    v_mfma_f32_16x16x32_bf16 v[172:175], v[60:63], v[72:75], v[172:175]
    v_mfma_f32_16x16x32_bf16 v[176:179], v[48:51], v[76:79], v[176:179]
    v_mfma_f32_16x16x32_bf16 v[180:183], v[52:55], v[76:79], v[180:183]
    v_mfma_f32_16x16x32_bf16 v[184:187], v[56:59], v[76:79], v[184:187]
    v_mfma_f32_16x16x32_bf16 v[188:191], v[60:63], v[76:79], v[188:191]
    v_lshlrev_b32 v21, 16, v20
    v_and_b32 v22, 0xffff0000, v20
    v_mul_f32 v18, v99, v118
    v_mul_f32 v19, v100, v118
    v_cvt_pk_bf16_f32 v20, v18, v19
    v_lshlrev_b32 v18, 16, v20
    v_and_b32 v19, 0xffff0000, v20
    v_add_f32 v21, v21, v18
    v_add_f32 v22, v22, v19
    v_cvt_pk_bf16_f32 v20, v21, v22
    v_lshlrev_b32 v21, 16, v20
    s_waitcnt lgkmcnt(0)
    v_mfma_f32_16x16x32_bf16 v[192:195], v[48:51], v[80:83], v[192:195]
    v_mfma_f32_16x16x32_bf16 v[196:199], v[52:55], v[80:83], v[196:199]
    v_mfma_f32_16x16x32_bf16 v[200:203], v[56:59], v[80:83], v[200:203]
    v_mfma_f32_16x16x32_bf16 v[204:207], v[60:63], v[80:83], v[204:207]
    v_mfma_f32_16x16x32_bf16 v[208:211], v[48:51], v[84:87], v[208:211]
    v_mfma_f32_16x16x32_bf16 v[212:215], v[52:55], v[84:87], v[212:215]
    v_mfma_f32_16x16x32_bf16 v[216:219], v[56:59], v[84:87], v[216:219]
    v_mfma_f32_16x16x32_bf16 v[220:223], v[60:63], v[84:87], v[220:223]
    v_mfma_f32_16x16x32_bf16 v[224:227], v[48:51], v[88:91], v[224:227]
    v_mfma_f32_16x16x32_bf16 v[228:231], v[52:55], v[88:91], v[228:231]
    v_mfma_f32_16x16x32_bf16 v[232:235], v[56:59], v[88:91], v[232:235]
    v_mfma_f32_16x16x32_bf16 v[236:239], v[60:63], v[88:91], v[236:239]
    v_mfma_f32_16x16x32_bf16 v[240:243], v[48:51], v[92:95], v[240:243]
    v_mfma_f32_16x16x32_bf16 v[244:247], v[52:55], v[92:95], v[244:247]
    v_mfma_f32_16x16x32_bf16 v[248:251], v[56:59], v[92:95], v[248:251]
    v_mfma_f32_16x16x32_bf16 v[252:255], v[60:63], v[92:95], v[252:255]
    v_and_b32 v22, 0xffff0000, v20
    v_mul_f32 v21, v21, v107
    v_mul_f32 v22, v22, v108
    v_cvt_pk_bf16_f32 v31, v22, v21
    v_mul_f32 v18, v98, v121
    v_mul_f32 v19, v99, v121
    v_cvt_pk_bf16_f32 v20, v18, v19
    v_lshlrev_b32 v21, 16, v20
    v_and_b32 v22, 0xffff0000, v20
    v_mul_f32 v18, v99, v120
    v_mul_f32 v19, v100, v120
    s_cmp_lg_u32 s30, 4
    s_cbranch_scc1 L_lp_12
    s_add_u32 s35, s83, 896
    buffer_load_dword v26, v115, s[8:11], s35 offen
    s_add_u32 s35, s88, 3670016
    buffer_load_dword v27, v126, s[12:15], s35 offen
L_lp_12:
    s_cmp_eq_u32 s30, 4
    s_cbranch_scc1 L_lw_13
    s_waitcnt vmcnt(0)
L_lw_13:
    s_waitcnt vmcnt(2)
    s_barrier
    ds_read_b64_tr_b16 v[32:33], v14 offset:0
    ds_read_b64_tr_b16 v[34:35], v14 offset:2048
    ds_read_b64_tr_b16 v[36:37], v15 offset:0
    ds_read_b64_tr_b16 v[38:39], v15 offset:2048
    ds_read_b64_tr_b16 v[40:41], v16 offset:0
    ds_read_b64_tr_b16 v[42:43], v16 offset:2048
    ds_read_b64_tr_b16 v[44:45], v17 offset:0
    ds_read_b64_tr_b16 v[46:47], v17 offset:2048
    ds_read_b128 v[64:67], v8 offset:0
    ds_read_b128 v[68:71], v8 offset:2048
    ds_read_b128 v[72:75], v8 offset:4096
    ds_read_b128 v[76:79], v8 offset:6144
    ds_read_b128 v[80:83], v8 offset:8192
    ds_read_b128 v[84:87], v8 offset:10240
    ds_read_b128 v[88:91], v8 offset:12288
    ds_read_b128 v[92:95], v8 offset:14336
    s_waitcnt lgkmcnt(4)
    s_add_u32 m0, s31, 0
    s_add_u32 s35, s33, 768
    buffer_load_dwordx4 v2, s[8:11], s35 offen lds
    s_add_u32 m0, s31, 1024
    s_add_u32 s35, s33, 17152
    buffer_load_dwordx4 v3, s[8:11], s35 offen lds
    s_add_u32 m0, s31, 2048
    s_add_u32 s35, s33, 33536
    buffer_load_dwordx4 v2, s[8:11], s35 offen lds
    s_add_u32 m0, s31, 3072
    s_add_u32 s35, s33, 49920
    buffer_load_dwordx4 v3, s[8:11], s35 offen lds
    v_mfma_f32_16x16x32_bf16 v[128:131], v[32:35], v[64:67], v[128:131]
    v_mfma_f32_16x16x32_bf16 v[132:135], v[36:39], v[64:67], v[132:135]
    v_mfma_f32_16x16x32_bf16 v[136:139], v[40:43], v[64:67], v[136:139]
    v_mfma_f32_16x16x32_bf16 v[140:143], v[44:47], v[64:67], v[140:143]
    v_mfma_f32_16x16x32_bf16 v[144:147], v[32:35], v[68:71], v[144:147]
    v_mfma_f32_16x16x32_bf16 v[148:151], v[36:39], v[68:71], v[148:151]
    v_mfma_f32_16x16x32_bf16 v[152:155], v[40:43], v[68:71], v[152:155]
    v_mfma_f32_16x16x32_bf16 v[156:159], v[44:47], v[68:71], v[156:159]
    v_mfma_f32_16x16x32_bf16 v[160:163], v[32:35], v[72:75], v[160:163]
    v_mfma_f32_16x16x32_bf16 v[164:167], v[36:39], v[72:75], v[164:167]
    v_mfma_f32_16x16x32_bf16 v[168:171], v[40:43], v[72:75], v[168:171]
    v_mfma_f32_16x16x32_bf16 v[172:175], v[44:47], v[72:75], v[172:175]
    v_mfma_f32_16x16x32_bf16 v[176:179], v[32:35], v[76:79], v[176:179]
    v_mfma_f32_16x16x32_bf16 v[180:183], v[36:39], v[76:79], v[180:183]
    v_mfma_f32_16x16x32_bf16 v[184:187], v[40:43], v[76:79], v[184:187]
    v_mfma_f32_16x16x32_bf16 v[188:191], v[44:47], v[76:79], v[188:191]
    v_cvt_pk_bf16_f32 v20, v18, v19
    v_lshlrev_b32 v18, 16, v20
    v_and_b32 v19, 0xffff0000, v20
    v_add_f32 v21, v21, v18
    v_add_f32 v22, v22, v19
    v_cvt_pk_bf16_f32 v20, v21, v22
    v_lshlrev_b32 v21, 16, v20
    v_and_b32 v22, 0xffff0000, v20
    v_mul_f32 v18, v100, v119
    v_mul_f32 v19, v101, v119
    v_cvt_pk_bf16_f32 v20, v18, v19
    ds_read_b64_tr_b16 v[48:49], v14 offset:16384
    ds_read_b64_tr_b16 v[50:51], v14 offset:18432
    ds_read_b64_tr_b16 v[52:53], v15 offset:16384
    ds_read_b64_tr_b16 v[54:55], v15 offset:18432
    ds_read_b64_tr_b16 v[56:57], v16 offset:16384
    ds_read_b64_tr_b16 v[58:59], v16 offset:18432
    ds_read_b64_tr_b16 v[60:61], v17 offset:16384
    ds_read_b64_tr_b16 v[62:63], v17 offset:18432
    ds_read_b128 v[64:67], v9 offset:0
    ds_read_b128 v[68:71], v9 offset:2048
    ds_read_b128 v[72:75], v9 offset:4096
    ds_read_b128 v[76:79], v9 offset:6144
    s_waitcnt lgkmcnt(12)
    s_add_u32 m0, s32, 32768
    s_add_u32 s35, s34, 3145728
    buffer_load_dwordx4 v4, s[12:15], s35 offen lds
    s_add_u32 m0, s32, 33792
    s_add_u32 s35, s34, 3162112
    buffer_load_dwordx4 v5, s[12:15], s35 offen lds
    s_add_u32 m0, s32, 34816
    s_add_u32 s35, s34, 3178496
    buffer_load_dwordx4 v4, s[12:15], s35 offen lds
    s_add_u32 m0, s32, 35840
    s_add_u32 s35, s34, 3194880
    buffer_load_dwordx4 v5, s[12:15], s35 offen lds
    v_mfma_f32_16x16x32_bf16 v[192:195], v[32:35], v[80:83], v[192:195]
    v_mfma_f32_16x16x32_bf16 v[196:199], v[36:39], v[80:83], v[196:199]
    v_mfma_f32_16x16x32_bf16 v[200:203], v[40:43], v[80:83], v[200:203]
    v_mfma_f32_16x16x32_bf16 v[204:207], v[44:47], v[80:83], v[204:207]
    v_mfma_f32_16x16x32_bf16 v[208:211], v[32:35], v[84:87], v[208:211]
    v_mfma_f32_16x16x32_bf16 v[212:215], v[36:39], v[84:87], v[212:215]
    v_mfma_f32_16x16x32_bf16 v[216:219], v[40:43], v[84:87], v[216:219]
    v_mfma_f32_16x16x32_bf16 v[220:223], v[44:47], v[84:87], v[220:223]
    v_mfma_f32_16x16x32_bf16 v[224:227], v[32:35], v[88:91], v[224:227]
    v_mfma_f32_16x16x32_bf16 v[228:231], v[36:39], v[88:91], v[228:231]
    v_mfma_f32_16x16x32_bf16 v[232:235], v[40:43], v[88:91], v[232:235]
    v_mfma_f32_16x16x32_bf16 v[236:239], v[44:47], v[88:91], v[236:239]
    v_mfma_f32_16x16x32_bf16 v[240:243], v[32:35], v[92:95], v[240:243]
    v_mfma_f32_16x16x32_bf16 v[244:247], v[36:39], v[92:95], v[244:247]
    v_mfma_f32_16x16x32_bf16 v[248:251], v[40:43], v[92:95], v[248:251]
    v_mfma_f32_16x16x32_bf16 v[252:255], v[44:47], v[92:95], v[252:255]
    v_lshlrev_b32 v18, 16, v20
    v_and_b32 v19, 0xffff0000, v20
    v_add_f32 v21, v21, v18
    v_add_f32 v22, v22, v19
    v_cvt_pk_bf16_f32 v20, v21, v22
    v_lshlrev_b32 v21, 16, v20
    v_and_b32 v22, 0xffff0000, v20
    v_mul_f32 v18, v101, v118
    v_mul_f32 v19, v102, v118
    v_cvt_pk_bf16_f32 v20, v18, v19
    v_lshlrev_b32 v18, 16, v20
    ds_read_b128 v[80:83], v9 offset:8192
    ds_read_b128 v[84:87], v9 offset:10240
    ds_read_b128 v[88:91], v9 offset:12288
    ds_read_b128 v[92:95], v9 offset:14336
    s_waitcnt lgkmcnt(4)
    v_mfma_f32_16x16x32_bf16 v[128:131], v[48:51], v[64:67], v[128:131]
    v_mfma_f32_16x16x32_bf16 v[132:135], v[52:55], v[64:67], v[132:135]
    v_mfma_f32_16x16x32_bf16 v[136:139], v[56:59], v[64:67], v[136:139]
    v_mfma_f32_16x16x32_bf16 v[140:143], v[60:63], v[64:67], v[140:143]
    v_mfma_f32_16x16x32_bf16 v[144:147], v[48:51], v[68:71], v[144:147]
    v_mfma_f32_16x16x32_bf16 v[148:151], v[52:55], v[68:71], v[148:151]
    v_mfma_f32_16x16x32_bf16 v[152:155], v[56:59], v[68:71], v[152:155]
    v_mfma_f32_16x16x32_bf16 v[156:159], v[60:63], v[68:71], v[156:159]
    v_mfma_f32_16x16x32_bf16 v[160:163], v[48:51], v[72:75], v[160:163]
    v_mfma_f32_16x16x32_bf16 v[164:167], v[52:55], v[72:75], v[164:167]
    v_mfma_f32_16x16x32_bf16 v[168:171], v[56:59], v[72:75], v[168:171]
    v_mfma_f32_16x16x32_bf16 v[172:175], v[60:63], v[72:75], v[172:175]
    v_mfma_f32_16x16x32_bf16 v[176:179], v[48:51], v[76:79], v[176:179]
    v_mfma_f32_16x16x32_bf16 v[180:183], v[52:55], v[76:79], v[180:183]
    v_mfma_f32_16x16x32_bf16 v[184:187], v[56:59], v[76:79], v[184:187]
    v_mfma_f32_16x16x32_bf16 v[188:191], v[60:63], v[76:79], v[188:191]
    v_and_b32 v19, 0xffff0000, v20
    v_add_f32 v21, v21, v18
    v_add_f32 v22, v22, v19
    v_cvt_pk_bf16_f32 v20, v21, v22
    v_lshlrev_b32 v21, 16, v20
    v_and_b32 v22, 0xffff0000, v20
    v_mul_f32 v21, v21, v109
    v_mul_f32 v22, v22, v110
    v_cvt_pk_bf16_f32 v30, v22, v21
    v_mul_f32 v18, v100, v121
    v_mul_f32 v19, v101, v121
    s_waitcnt lgkmcnt(0)
    v_mfma_f32_16x16x32_bf16 v[192:195], v[48:51], v[80:83], v[192:195]
    v_mfma_f32_16x16x32_bf16 v[196:199], v[52:55], v[80:83], v[196:199]
    v_mfma_f32_16x16x32_bf16 v[200:203], v[56:59], v[80:83], v[200:203]
    v_mfma_f32_16x16x32_bf16 v[204:207], v[60:63], v[80:83], v[204:207]
    v_mfma_f32_16x16x32_bf16 v[208:211], v[48:51], v[84:87], v[208:211]
    v_mfma_f32_16x16x32_bf16 v[212:215], v[52:55], v[84:87], v[212:215]
    v_mfma_f32_16x16x32_bf16 v[216:219], v[56:59], v[84:87], v[216:219]
    v_mfma_f32_16x16x32_bf16 v[220:223], v[60:63], v[84:87], v[220:223]
    v_mfma_f32_16x16x32_bf16 v[224:227], v[48:51], v[88:91], v[224:227]
    v_mfma_f32_16x16x32_bf16 v[228:231], v[52:55], v[88:91], v[228:231]
    v_mfma_f32_16x16x32_bf16 v[232:235], v[56:59], v[88:91], v[232:235]
    v_mfma_f32_16x16x32_bf16 v[236:239], v[60:63], v[88:91], v[236:239]
    v_mfma_f32_16x16x32_bf16 v[240:243], v[48:51], v[92:95], v[240:243]
    v_mfma_f32_16x16x32_bf16 v[244:247], v[52:55], v[92:95], v[244:247]
    v_mfma_f32_16x16x32_bf16 v[248:251], v[56:59], v[92:95], v[248:251]
    v_mfma_f32_16x16x32_bf16 v[252:255], v[60:63], v[92:95], v[252:255]
    v_cvt_pk_bf16_f32 v20, v18, v19
    v_lshlrev_b32 v21, 16, v20
    v_and_b32 v22, 0xffff0000, v20
    v_mul_f32 v18, v101, v120
    v_mul_f32 v19, v102, v120
    v_cvt_pk_bf16_f32 v20, v18, v19
    v_lshlrev_b32 v18, 16, v20
    v_and_b32 v19, 0xffff0000, v20
    v_add_f32 v21, v21, v18
    v_add_f32 v22, v22, v19
    v_cvt_pk_bf16_f32 v20, v21, v22
    s_cmp_lg_u32 s30, 5
    s_cbranch_scc1 L_lp_14
    s_add_u32 s35, s83, 1024
    buffer_load_dword v26, v115, s[8:11], s35 offen
    s_add_u32 s35, s88, 4194304
    buffer_load_dword v27, v126, s[12:15], s35 offen
L_lp_14:
    s_cmp_eq_u32 s30, 5
    s_cbranch_scc1 L_lw_15
    s_waitcnt vmcnt(0)
L_lw_15:
    s_waitcnt vmcnt(2)
    s_barrier
    ds_read_b64_tr_b16 v[32:33], v10 offset:0
    ds_read_b64_tr_b16 v[34:35], v10 offset:2048
    ds_read_b64_tr_b16 v[36:37], v11 offset:0
    ds_read_b64_tr_b16 v[38:39], v11 offset:2048
    ds_read_b64_tr_b16 v[40:41], v12 offset:0
    ds_read_b64_tr_b16 v[42:43], v12 offset:2048
    ds_read_b64_tr_b16 v[44:45], v13 offset:0
    ds_read_b64_tr_b16 v[46:47], v13 offset:2048
    ds_read_b128 v[64:67], v6 offset:0
    ds_read_b128 v[68:71], v6 offset:2048
    ds_read_b128 v[72:75], v6 offset:4096
    ds_read_b128 v[76:79], v6 offset:6144
    ds_read_b128 v[80:83], v6 offset:8192
    ds_read_b128 v[84:87], v6 offset:10240
    ds_read_b128 v[88:91], v6 offset:12288
    ds_read_b128 v[92:95], v6 offset:14336
    s_waitcnt lgkmcnt(4)
    s_add_u32 m0, s31, 65536
    s_add_u32 s35, s33, 896
    buffer_load_dwordx4 v2, s[8:11], s35 offen lds
    s_add_u32 m0, s31, 66560
    s_add_u32 s35, s33, 17280
    buffer_load_dwordx4 v3, s[8:11], s35 offen lds
    s_add_u32 m0, s31, 67584
    s_add_u32 s35, s33, 33664
    buffer_load_dwordx4 v2, s[8:11], s35 offen lds
    s_add_u32 m0, s31, 68608
    s_add_u32 s35, s33, 50048
    buffer_load_dwordx4 v3, s[8:11], s35 offen lds
    v_mfma_f32_16x16x32_bf16 v[128:131], v[32:35], v[64:67], v[128:131]
    v_mfma_f32_16x16x32_bf16 v[132:135], v[36:39], v[64:67], v[132:135]
    v_mfma_f32_16x16x32_bf16 v[136:139], v[40:43], v[64:67], v[136:139]
    v_mfma_f32_16x16x32_bf16 v[140:143], v[44:47], v[64:67], v[140:143]
    v_mfma_f32_16x16x32_bf16 v[144:147], v[32:35], v[68:71], v[144:147]
    v_mfma_f32_16x16x32_bf16 v[148:151], v[36:39], v[68:71], v[148:151]
    v_mfma_f32_16x16x32_bf16 v[152:155], v[40:43], v[68:71], v[152:155]
    v_mfma_f32_16x16x32_bf16 v[156:159], v[44:47], v[68:71], v[156:159]
    v_mfma_f32_16x16x32_bf16 v[160:163], v[32:35], v[72:75], v[160:163]
    v_mfma_f32_16x16x32_bf16 v[164:167], v[36:39], v[72:75], v[164:167]
    v_mfma_f32_16x16x32_bf16 v[168:171], v[40:43], v[72:75], v[168:171]
    v_mfma_f32_16x16x32_bf16 v[172:175], v[44:47], v[72:75], v[172:175]
    v_mfma_f32_16x16x32_bf16 v[176:179], v[32:35], v[76:79], v[176:179]
    v_mfma_f32_16x16x32_bf16 v[180:183], v[36:39], v[76:79], v[180:183]
    v_mfma_f32_16x16x32_bf16 v[184:187], v[40:43], v[76:79], v[184:187]
    v_mfma_f32_16x16x32_bf16 v[188:191], v[44:47], v[76:79], v[188:191]
    v_lshlrev_b32 v21, 16, v20
    v_and_b32 v22, 0xffff0000, v20
    v_mul_f32 v18, v102, v119
    v_mul_f32 v19, v103, v119
    v_cvt_pk_bf16_f32 v20, v18, v19
    v_lshlrev_b32 v18, 16, v20
    v_and_b32 v19, 0xffff0000, v20
    v_add_f32 v21, v21, v18
    v_add_f32 v22, v22, v19
    v_cvt_pk_bf16_f32 v20, v21, v22
    v_lshlrev_b32 v21, 16, v20
    ds_read_b64_tr_b16 v[48:49], v10 offset:16384
    ds_read_b64_tr_b16 v[50:51], v10 offset:18432
    ds_read_b64_tr_b16 v[52:53], v11 offset:16384
    ds_read_b64_tr_b16 v[54:55], v11 offset:18432
    ds_read_b64_tr_b16 v[56:57], v12 offset:16384
    ds_read_b64_tr_b16 v[58:59], v12 offset:18432
    ds_read_b64_tr_b16 v[60:61], v13 offset:16384
    ds_read_b64_tr_b16 v[62:63], v13 offset:18432
    ds_read_b128 v[64:67], v7 offset:0
    ds_read_b128 v[68:71], v7 offset:2048
    ds_read_b128 v[72:75], v7 offset:4096
    ds_read_b128 v[76:79], v7 offset:6144
    s_waitcnt lgkmcnt(12)
    s_add_u32 m0, s32, 98304
    s_add_u32 s35, s34, 3670016
    buffer_load_dwordx4 v4, s[12:15], s35 offen lds
    s_add_u32 m0, s32, 99328
    s_add_u32 s35, s34, 3686400
    buffer_load_dwordx4 v5, s[12:15], s35 offen lds
    s_add_u32 m0, s32, 100352
    s_add_u32 s35, s34, 3702784
    buffer_load_dwordx4 v4, s[12:15], s35 offen lds
    s_add_u32 m0, s32, 101376
    s_add_u32 s35, s34, 3719168
    buffer_load_dwordx4 v5, s[12:15], s35 offen lds
    v_mfma_f32_16x16x32_bf16 v[192:195], v[32:35], v[80:83], v[192:195]
    v_mfma_f32_16x16x32_bf16 v[196:199], v[36:39], v[80:83], v[196:199]
    v_mfma_f32_16x16x32_bf16 v[200:203], v[40:43], v[80:83], v[200:203]
    v_mfma_f32_16x16x32_bf16 v[204:207], v[44:47], v[80:83], v[204:207]
    v_mfma_f32_16x16x32_bf16 v[208:211], v[32:35], v[84:87], v[208:211]
    v_mfma_f32_16x16x32_bf16 v[212:215], v[36:39], v[84:87], v[212:215]
    v_mfma_f32_16x16x32_bf16 v[216:219], v[40:43], v[84:87], v[216:219]
    v_mfma_f32_16x16x32_bf16 v[220:223], v[44:47], v[84:87], v[220:223]
    v_mfma_f32_16x16x32_bf16 v[224:227], v[32:35], v[88:91], v[224:227]
    v_mfma_f32_16x16x32_bf16 v[228:231], v[36:39], v[88:91], v[228:231]
    v_mfma_f32_16x16x32_bf16 v[232:235], v[40:43], v[88:91], v[232:235]
    v_mfma_f32_16x16x32_bf16 v[236:239], v[44:47], v[88:91], v[236:239]
    v_mfma_f32_16x16x32_bf16 v[240:243], v[32:35], v[92:95], v[240:243]
    v_mfma_f32_16x16x32_bf16 v[244:247], v[36:39], v[92:95], v[244:247]
    v_mfma_f32_16x16x32_bf16 v[248:251], v[40:43], v[92:95], v[248:251]
    v_mfma_f32_16x16x32_bf16 v[252:255], v[44:47], v[92:95], v[252:255]
    v_and_b32 v22, 0xffff0000, v20
    v_mul_f32 v18, v103, v118
    v_mul_f32 v19, v104, v118
    v_cvt_pk_bf16_f32 v20, v18, v19
    v_lshlrev_b32 v18, 16, v20
    v_and_b32 v19, 0xffff0000, v20
    v_add_f32 v21, v21, v18
    v_add_f32 v22, v22, v19
    v_cvt_pk_bf16_f32 v20, v21, v22
    v_lshlrev_b32 v21, 16, v20
    v_and_b32 v22, 0xffff0000, v20
    ds_read_b128 v[80:83], v7 offset:8192
    ds_read_b128 v[84:87], v7 offset:10240
    ds_read_b128 v[88:91], v7 offset:12288
    ds_read_b128 v[92:95], v7 offset:14336
    s_waitcnt lgkmcnt(4)
    v_mfma_f32_16x16x32_bf16 v[128:131], v[48:51], v[64:67], v[128:131]
    v_mfma_f32_16x16x32_bf16 v[132:135], v[52:55], v[64:67], v[132:135]
    v_mfma_f32_16x16x32_bf16 v[136:139], v[56:59], v[64:67], v[136:139]
    v_mfma_f32_16x16x32_bf16 v[140:143], v[60:63], v[64:67], v[140:143]
    v_mfma_f32_16x16x32_bf16 v[144:147], v[48:51], v[68:71], v[144:147]
    v_mfma_f32_16x16x32_bf16 v[148:151], v[52:55], v[68:71], v[148:151]
    v_mfma_f32_16x16x32_bf16 v[152:155], v[56:59], v[68:71], v[152:155]
    v_mfma_f32_16x16x32_bf16 v[156:159], v[60:63], v[68:71], v[156:159]
    v_mfma_f32_16x16x32_bf16 v[160:163], v[48:51], v[72:75], v[160:163]
    v_mfma_f32_16x16x32_bf16 v[164:167], v[52:55], v[72:75], v[164:167]
    v_mfma_f32_16x16x32_bf16 v[168:171], v[56:59], v[72:75], v[168:171]
    v_mfma_f32_16x16x32_bf16 v[172:175], v[60:63], v[72:75], v[172:175]
    v_mfma_f32_16x16x32_bf16 v[176:179], v[48:51], v[76:79], v[176:179]
    v_mfma_f32_16x16x32_bf16 v[180:183], v[52:55], v[76:79], v[180:183]
    v_mfma_f32_16x16x32_bf16 v[184:187], v[56:59], v[76:79], v[184:187]
    v_mfma_f32_16x16x32_bf16 v[188:191], v[60:63], v[76:79], v[188:191]
    v_mul_f32 v21, v21, v111
    v_mul_f32 v22, v22, v112
    v_cvt_pk_bf16_f32 v29, v22, v21
    v_mul_f32 v18, v102, v121
    v_mul_f32 v19, v103, v121
    v_cvt_pk_bf16_f32 v20, v18, v19
    v_lshlrev_b32 v21, 16, v20
    v_and_b32 v22, 0xffff0000, v20
    v_mul_f32 v18, v103, v120
    v_mul_f32 v19, v104, v120
    v_cvt_pk_bf16_f32 v20, v18, v19
    s_waitcnt lgkmcnt(0)
    v_mfma_f32_16x16x32_bf16 v[192:195], v[48:51], v[80:83], v[192:195]
    v_mfma_f32_16x16x32_bf16 v[196:199], v[52:55], v[80:83], v[196:199]
    v_mfma_f32_16x16x32_bf16 v[200:203], v[56:59], v[80:83], v[200:203]
    v_mfma_f32_16x16x32_bf16 v[204:207], v[60:63], v[80:83], v[204:207]
    v_mfma_f32_16x16x32_bf16 v[208:211], v[48:51], v[84:87], v[208:211]
    v_mfma_f32_16x16x32_bf16 v[212:215], v[52:55], v[84:87], v[212:215]
    v_mfma_f32_16x16x32_bf16 v[216:219], v[56:59], v[84:87], v[216:219]
    v_mfma_f32_16x16x32_bf16 v[220:223], v[60:63], v[84:87], v[220:223]
    v_mfma_f32_16x16x32_bf16 v[224:227], v[48:51], v[88:91], v[224:227]
    v_mfma_f32_16x16x32_bf16 v[228:231], v[52:55], v[88:91], v[228:231]
    v_mfma_f32_16x16x32_bf16 v[232:235], v[56:59], v[88:91], v[232:235]
    v_mfma_f32_16x16x32_bf16 v[236:239], v[60:63], v[88:91], v[236:239]
    v_mfma_f32_16x16x32_bf16 v[240:243], v[48:51], v[92:95], v[240:243]
    v_mfma_f32_16x16x32_bf16 v[244:247], v[52:55], v[92:95], v[244:247]
    v_mfma_f32_16x16x32_bf16 v[248:251], v[56:59], v[92:95], v[248:251]
    v_mfma_f32_16x16x32_bf16 v[252:255], v[60:63], v[92:95], v[252:255]
    v_lshlrev_b32 v18, 16, v20
    v_and_b32 v19, 0xffff0000, v20
    v_add_f32 v21, v21, v18
    v_add_f32 v22, v22, v19
    v_cvt_pk_bf16_f32 v20, v21, v22
    v_lshlrev_b32 v21, 16, v20
    v_and_b32 v22, 0xffff0000, v20
    v_mul_f32 v18, v104, v119
    v_mul_f32 v19, v105, v119
    v_cvt_pk_bf16_f32 v20, v18, v19
    v_lshlrev_b32 v18, 16, v20
    s_cmp_lg_u32 s30, 6
    s_cbranch_scc1 L_lp_16
    s_add_u32 s35, s83, 1152
    buffer_load_dword v26, v115, s[8:11], s35 offen
    s_add_u32 s35, s88, 4718592
    buffer_load_dword v27, v126, s[12:15], s35 offen
L_lp_16:
    s_cmp_eq_u32 s30, 6
    s_cbranch_scc1 L_lw_17
    s_waitcnt vmcnt(0)
L_lw_17:
    s_waitcnt vmcnt(2)
    s_barrier
    ds_read_b64_tr_b16 v[32:33], v14 offset:0
    ds_read_b64_tr_b16 v[34:35], v14 offset:2048
    ds_read_b64_tr_b16 v[36:37], v15 offset:0
    ds_read_b64_tr_b16 v[38:39], v15 offset:2048
    ds_read_b64_tr_b16 v[40:41], v16 offset:0
    ds_read_b64_tr_b16 v[42:43], v16 offset:2048
    ds_read_b64_tr_b16 v[44:45], v17 offset:0
    ds_read_b64_tr_b16 v[46:47], v17 offset:2048
    ds_read_b128 v[64:67], v8 offset:0
    ds_read_b128 v[68:71], v8 offset:2048
    ds_read_b128 v[72:75], v8 offset:4096
    ds_read_b128 v[76:79], v8 offset:6144
    ds_read_b128 v[80:83], v8 offset:8192
    ds_read_b128 v[84:87], v8 offset:10240
    ds_read_b128 v[88:91], v8 offset:12288
    ds_read_b128 v[92:95], v8 offset:14336
    s_waitcnt lgkmcnt(4)
    s_add_u32 m0, s31, 0
    s_add_u32 s35, s33, 1024
    buffer_load_dwordx4 v2, s[8:11], s35 offen lds
    s_add_u32 m0, s31, 1024
    s_add_u32 s35, s33, 17408
    buffer_load_dwordx4 v3, s[8:11], s35 offen lds
    s_add_u32 m0, s31, 2048
    s_add_u32 s35, s33, 33792
    buffer_load_dwordx4 v2, s[8:11], s35 offen lds
    s_add_u32 m0, s31, 3072
    s_add_u32 s35, s33, 50176
    buffer_load_dwordx4 v3, s[8:11], s35 offen lds
    v_mfma_f32_16x16x32_bf16 v[128:131], v[32:35], v[64:67], v[128:131]
    v_mfma_f32_16x16x32_bf16 v[132:135], v[36:39], v[64:67], v[132:135]
    v_mfma_f32_16x16x32_bf16 v[136:139], v[40:43], v[64:67], v[136:139]
    v_mfma_f32_16x16x32_bf16 v[140:143], v[44:47], v[64:67], v[140:143]
    v_mfma_f32_16x16x32_bf16 v[144:147], v[32:35], v[68:71], v[144:147]
    v_mfma_f32_16x16x32_bf16 v[148:151], v[36:39], v[68:71], v[148:151]
    v_mfma_f32_16x16x32_bf16 v[152:155], v[40:43], v[68:71], v[152:155]
    v_mfma_f32_16x16x32_bf16 v[156:159], v[44:47], v[68:71], v[156:159]
    v_mfma_f32_16x16x32_bf16 v[160:163], v[32:35], v[72:75], v[160:163]
    v_mfma_f32_16x16x32_bf16 v[164:167], v[36:39], v[72:75], v[164:167]
    v_mfma_f32_16x16x32_bf16 v[168:171], v[40:43], v[72:75], v[168:171]
    v_mfma_f32_16x16x32_bf16 v[172:175], v[44:47], v[72:75], v[172:175]
    v_mfma_f32_16x16x32_bf16 v[176:179], v[32:35], v[76:79], v[176:179]
    v_mfma_f32_16x16x32_bf16 v[180:183], v[36:39], v[76:79], v[180:183]
    v_mfma_f32_16x16x32_bf16 v[184:187], v[40:43], v[76:79], v[184:187]
    v_mfma_f32_16x16x32_bf16 v[188:191], v[44:47], v[76:79], v[188:191]
    v_and_b32 v19, 0xffff0000, v20
    v_add_f32 v21, v21, v18
    v_add_f32 v22, v22, v19
    v_cvt_pk_bf16_f32 v20, v21, v22
    v_lshlrev_b32 v21, 16, v20
    v_and_b32 v22, 0xffff0000, v20
    v_mul_f32 v18, v105, v118
    v_mul_f32 v19, v106, v118
    v_cvt_pk_bf16_f32 v20, v18, v19
    v_lshlrev_b32 v18, 16, v20
    v_and_b32 v19, 0xffff0000, v20
    ds_read_b64_tr_b16 v[48:49], v14 offset:16384
    ds_read_b64_tr_b16 v[50:51], v14 offset:18432
    ds_read_b64_tr_b16 v[52:53], v15 offset:16384
    ds_read_b64_tr_b16 v[54:55], v15 offset:18432
    ds_read_b64_tr_b16 v[56:57], v16 offset:16384
    ds_read_b64_tr_b16 v[58:59], v16 offset:18432
    ds_read_b64_tr_b16 v[60:61], v17 offset:16384
    ds_read_b64_tr_b16 v[62:63], v17 offset:18432
    ds_read_b128 v[64:67], v9 offset:0
    ds_read_b128 v[68:71], v9 offset:2048
    ds_read_b128 v[72:75], v9 offset:4096
    ds_read_b128 v[76:79], v9 offset:6144
    s_waitcnt lgkmcnt(12)
    s_add_u32 m0, s32, 32768
    s_add_u32 s35, s34, 4194304
    buffer_load_dwordx4 v4, s[12:15], s35 offen lds
    s_add_u32 m0, s32, 33792
    s_add_u32 s35, s34, 4210688
    buffer_load_dwordx4 v5, s[12:15], s35 offen lds
    s_add_u32 m0, s32, 34816
    s_add_u32 s35, s34, 4227072
    buffer_load_dwordx4 v4, s[12:15], s35 offen lds
    s_add_u32 m0, s32, 35840
    s_add_u32 s35, s34, 4243456
    buffer_load_dwordx4 v5, s[12:15], s35 offen lds
    v_mfma_f32_16x16x32_bf16 v[192:195], v[32:35], v[80:83], v[192:195]
    v_mfma_f32_16x16x32_bf16 v[196:199], v[36:39], v[80:83], v[196:199]
    v_mfma_f32_16x16x32_bf16 v[200:203], v[40:43], v[80:83], v[200:203]
    v_mfma_f32_16x16x32_bf16 v[204:207], v[44:47], v[80:83], v[204:207]
    v_mfma_f32_16x16x32_bf16 v[208:211], v[32:35], v[84:87], v[208:211]
    v_mfma_f32_16x16x32_bf16 v[212:215], v[36:39], v[84:87], v[212:215]
    v_mfma_f32_16x16x32_bf16 v[216:219], v[40:43], v[84:87], v[216:219]
    v_mfma_f32_16x16x32_bf16 v[220:223], v[44:47], v[84:87], v[220:223]
    v_mfma_f32_16x16x32_bf16 v[224:227], v[32:35], v[88:91], v[224:227]
    v_mfma_f32_16x16x32_bf16 v[228:231], v[36:39], v[88:91], v[228:231]
    v_mfma_f32_16x16x32_bf16 v[232:235], v[40:43], v[88:91], v[232:235]
    v_mfma_f32_16x16x32_bf16 v[236:239], v[44:47], v[88:91], v[236:239]
    v_mfma_f32_16x16x32_bf16 v[240:243], v[32:35], v[92:95], v[240:243]
    v_mfma_f32_16x16x32_bf16 v[244:247], v[36:39], v[92:95], v[244:247]
    v_mfma_f32_16x16x32_bf16 v[248:251], v[40:43], v[92:95], v[248:251]
    v_mfma_f32_16x16x32_bf16 v[252:255], v[44:47], v[92:95], v[252:255]
    v_add_f32 v21, v21, v18
    v_add_f32 v22, v22, v19
    v_cvt_pk_bf16_f32 v20, v21, v22
    v_lshlrev_b32 v21, 16, v20
    v_and_b32 v22, 0xffff0000, v20
    v_mul_f32 v21, v21, v113
    v_mul_f32 v22, v22, v114
    v_cvt_pk_bf16_f32 v28, v22, v21
    v_lshlrev_b32 v19, 12, v0
    s_lshl_b32 s81, s80, 1
    buffer_store_dwordx4 v[28:31], v19, s[64:67], s81 offen
    ds_read_b128 v[80:83], v9 offset:8192
    ds_read_b128 v[84:87], v9 offset:10240
    ds_read_b128 v[88:91], v9 offset:12288
    ds_read_b128 v[92:95], v9 offset:14336
    s_waitcnt lgkmcnt(4)
    v_mfma_f32_16x16x32_bf16 v[128:131], v[48:51], v[64:67], v[128:131]
    v_mfma_f32_16x16x32_bf16 v[132:135], v[52:55], v[64:67], v[132:135]
    v_mfma_f32_16x16x32_bf16 v[136:139], v[56:59], v[64:67], v[136:139]
    v_mfma_f32_16x16x32_bf16 v[140:143], v[60:63], v[64:67], v[140:143]
    v_mfma_f32_16x16x32_bf16 v[144:147], v[48:51], v[68:71], v[144:147]
    v_mfma_f32_16x16x32_bf16 v[148:151], v[52:55], v[68:71], v[148:151]
    v_mfma_f32_16x16x32_bf16 v[152:155], v[56:59], v[68:71], v[152:155]
    v_mfma_f32_16x16x32_bf16 v[156:159], v[60:63], v[68:71], v[156:159]
    v_mfma_f32_16x16x32_bf16 v[160:163], v[48:51], v[72:75], v[160:163]
    v_mfma_f32_16x16x32_bf16 v[164:167], v[52:55], v[72:75], v[164:167]
    v_mfma_f32_16x16x32_bf16 v[168:171], v[56:59], v[72:75], v[168:171]
    v_mfma_f32_16x16x32_bf16 v[172:175], v[60:63], v[72:75], v[172:175]
    v_mfma_f32_16x16x32_bf16 v[176:179], v[48:51], v[76:79], v[176:179]
    v_mfma_f32_16x16x32_bf16 v[180:183], v[52:55], v[76:79], v[180:183]
    v_mfma_f32_16x16x32_bf16 v[184:187], v[56:59], v[76:79], v[184:187]
    v_mfma_f32_16x16x32_bf16 v[188:191], v[60:63], v[76:79], v[188:191]
    s_waitcnt lgkmcnt(0)
    v_mfma_f32_16x16x32_bf16 v[192:195], v[48:51], v[80:83], v[192:195]
    v_mfma_f32_16x16x32_bf16 v[196:199], v[52:55], v[80:83], v[196:199]
    v_mfma_f32_16x16x32_bf16 v[200:203], v[56:59], v[80:83], v[200:203]
    v_mfma_f32_16x16x32_bf16 v[204:207], v[60:63], v[80:83], v[204:207]
    v_mfma_f32_16x16x32_bf16 v[208:211], v[48:51], v[84:87], v[208:211]
    v_mfma_f32_16x16x32_bf16 v[212:215], v[52:55], v[84:87], v[212:215]
    v_mfma_f32_16x16x32_bf16 v[216:219], v[56:59], v[84:87], v[216:219]
    v_mfma_f32_16x16x32_bf16 v[220:223], v[60:63], v[84:87], v[220:223]
    v_mfma_f32_16x16x32_bf16 v[224:227], v[48:51], v[88:91], v[224:227]
    v_mfma_f32_16x16x32_bf16 v[228:231], v[52:55], v[88:91], v[228:231]
    v_mfma_f32_16x16x32_bf16 v[232:235], v[56:59], v[88:91], v[232:235]
    v_mfma_f32_16x16x32_bf16 v[236:239], v[60:63], v[88:91], v[236:239]
    v_mfma_f32_16x16x32_bf16 v[240:243], v[48:51], v[92:95], v[240:243]
    v_mfma_f32_16x16x32_bf16 v[244:247], v[52:55], v[92:95], v[244:247]
    v_mfma_f32_16x16x32_bf16 v[248:251], v[56:59], v[92:95], v[248:251]
    v_mfma_f32_16x16x32_bf16 v[252:255], v[60:63], v[92:95], v[252:255]
    s_cmp_lg_u32 s30, 7
    s_cbranch_scc1 L_lp_18
    s_add_u32 s35, s83, 1280
    buffer_load_dword v26, v115, s[8:11], s35 offen
    s_add_u32 s35, s88, 5242880
    buffer_load_dword v27, v126, s[12:15], s35 offen
L_lp_18:
    s_cmp_eq_u32 s30, 7
    s_cbranch_scc1 L_lw_19
    s_waitcnt vmcnt(0)
L_lw_19:
    s_waitcnt vmcnt(2)
    s_barrier
    ds_read_b64_tr_b16 v[32:33], v10 offset:0
    ds_read_b64_tr_b16 v[34:35], v10 offset:2048
    ds_read_b64_tr_b16 v[36:37], v11 offset:0
    ds_read_b64_tr_b16 v[38:39], v11 offset:2048
    ds_read_b64_tr_b16 v[40:41], v12 offset:0
    ds_read_b64_tr_b16 v[42:43], v12 offset:2048
    ds_read_b64_tr_b16 v[44:45], v13 offset:0
    ds_read_b64_tr_b16 v[46:47], v13 offset:2048
    ds_read_b128 v[64:67], v6 offset:0
    ds_read_b128 v[68:71], v6 offset:2048
    ds_read_b128 v[72:75], v6 offset:4096
    ds_read_b128 v[76:79], v6 offset:6144
    ds_read_b128 v[80:83], v6 offset:8192
    ds_read_b128 v[84:87], v6 offset:10240
    ds_read_b128 v[88:91], v6 offset:12288
    ds_read_b128 v[92:95], v6 offset:14336
    s_waitcnt lgkmcnt(4)
    s_add_u32 m0, s31, 65536
    s_add_u32 s35, s33, 1152
    buffer_load_dwordx4 v2, s[8:11], s35 offen lds
    s_add_u32 m0, s31, 66560
    s_add_u32 s35, s33, 17536
    buffer_load_dwordx4 v3, s[8:11], s35 offen lds
    s_add_u32 m0, s31, 67584
    s_add_u32 s35, s33, 33920
    buffer_load_dwordx4 v2, s[8:11], s35 offen lds
    s_add_u32 m0, s31, 68608
    s_add_u32 s35, s33, 50304
    buffer_load_dwordx4 v3, s[8:11], s35 offen lds
    v_mfma_f32_16x16x32_bf16 v[128:131], v[32:35], v[64:67], v[128:131]
    v_mfma_f32_16x16x32_bf16 v[132:135], v[36:39], v[64:67], v[132:135]
    v_mfma_f32_16x16x32_bf16 v[136:139], v[40:43], v[64:67], v[136:139]
    v_mfma_f32_16x16x32_bf16 v[140:143], v[44:47], v[64:67], v[140:143]
    v_mfma_f32_16x16x32_bf16 v[144:147], v[32:35], v[68:71], v[144:147]
    v_mfma_f32_16x16x32_bf16 v[148:151], v[36:39], v[68:71], v[148:151]
    v_mfma_f32_16x16x32_bf16 v[152:155], v[40:43], v[68:71], v[152:155]
    v_mfma_f32_16x16x32_bf16 v[156:159], v[44:47], v[68:71], v[156:159]
    v_mfma_f32_16x16x32_bf16 v[160:163], v[32:35], v[72:75], v[160:163]
    v_mfma_f32_16x16x32_bf16 v[164:167], v[36:39], v[72:75], v[164:167]
    v_mfma_f32_16x16x32_bf16 v[168:171], v[40:43], v[72:75], v[168:171]
    v_mfma_f32_16x16x32_bf16 v[172:175], v[44:47], v[72:75], v[172:175]
    v_mfma_f32_16x16x32_bf16 v[176:179], v[32:35], v[76:79], v[176:179]
    v_mfma_f32_16x16x32_bf16 v[180:183], v[36:39], v[76:79], v[180:183]
    v_mfma_f32_16x16x32_bf16 v[184:187], v[40:43], v[76:79], v[184:187]
    v_mfma_f32_16x16x32_bf16 v[188:191], v[44:47], v[76:79], v[188:191]
    ds_read_b64_tr_b16 v[48:49], v10 offset:16384
    ds_read_b64_tr_b16 v[50:51], v10 offset:18432
    ds_read_b64_tr_b16 v[52:53], v11 offset:16384
    ds_read_b64_tr_b16 v[54:55], v11 offset:18432
    ds_read_b64_tr_b16 v[56:57], v12 offset:16384
    ds_read_b64_tr_b16 v[58:59], v12 offset:18432
    ds_read_b64_tr_b16 v[60:61], v13 offset:16384
    ds_read_b64_tr_b16 v[62:63], v13 offset:18432
    ds_read_b128 v[64:67], v7 offset:0
    ds_read_b128 v[68:71], v7 offset:2048
    ds_read_b128 v[72:75], v7 offset:4096
    ds_read_b128 v[76:79], v7 offset:6144
    s_waitcnt lgkmcnt(12)
    s_add_u32 m0, s32, 98304
    s_add_u32 s35, s34, 4718592
    buffer_load_dwordx4 v4, s[12:15], s35 offen lds
    s_add_u32 m0, s32, 99328
    s_add_u32 s35, s34, 4734976
    buffer_load_dwordx4 v5, s[12:15], s35 offen lds
    s_add_u32 m0, s32, 100352
    s_add_u32 s35, s34, 4751360
    buffer_load_dwordx4 v4, s[12:15], s35 offen lds
    s_add_u32 m0, s32, 101376
    s_add_u32 s35, s34, 4767744
    buffer_load_dwordx4 v5, s[12:15], s35 offen lds
    v_mfma_f32_16x16x32_bf16 v[192:195], v[32:35], v[80:83], v[192:195]
    v_mfma_f32_16x16x32_bf16 v[196:199], v[36:39], v[80:83], v[196:199]
    v_mfma_f32_16x16x32_bf16 v[200:203], v[40:43], v[80:83], v[200:203]
    v_mfma_f32_16x16x32_bf16 v[204:207], v[44:47], v[80:83], v[204:207]
    v_mfma_f32_16x16x32_bf16 v[208:211], v[32:35], v[84:87], v[208:211]
    v_mfma_f32_16x16x32_bf16 v[212:215], v[36:39], v[84:87], v[212:215]
    v_mfma_f32_16x16x32_bf16 v[216:219], v[40:43], v[84:87], v[216:219]
    v_mfma_f32_16x16x32_bf16 v[220:223], v[44:47], v[84:87], v[220:223]
    v_mfma_f32_16x16x32_bf16 v[224:227], v[32:35], v[88:91], v[224:227]
    v_mfma_f32_16x16x32_bf16 v[228:231], v[36:39], v[88:91], v[228:231]
    v_mfma_f32_16x16x32_bf16 v[232:235], v[40:43], v[88:91], v[232:235]
    v_mfma_f32_16x16x32_bf16 v[236:239], v[44:47], v[88:91], v[236:239]
    v_mfma_f32_16x16x32_bf16 v[240:243], v[32:35], v[92:95], v[240:243]
    v_mfma_f32_16x16x32_bf16 v[244:247], v[36:39], v[92:95], v[244:247]
    v_mfma_f32_16x16x32_bf16 v[248:251], v[40:43], v[92:95], v[248:251]
    v_mfma_f32_16x16x32_bf16 v[252:255], v[44:47], v[92:95], v[252:255]
    ds_read_b128 v[80:83], v7 offset:8192
    ds_read_b128 v[84:87], v7 offset:10240
    ds_read_b128 v[88:91], v7 offset:12288
    ds_read_b128 v[92:95], v7 offset:14336
    s_waitcnt lgkmcnt(4)
    v_mfma_f32_16x16x32_bf16 v[128:131], v[48:51], v[64:67], v[128:131]
    v_mfma_f32_16x16x32_bf16 v[132:135], v[52:55], v[64:67], v[132:135]
    v_mfma_f32_16x16x32_bf16 v[136:139], v[56:59], v[64:67], v[136:139]
    v_mfma_f32_16x16x32_bf16 v[140:143], v[60:63], v[64:67], v[140:143]
    v_mfma_f32_16x16x32_bf16 v[144:147], v[48:51], v[68:71], v[144:147]
    v_mfma_f32_16x16x32_bf16 v[148:151], v[52:55], v[68:71], v[148:151]
    v_mfma_f32_16x16x32_bf16 v[152:155], v[56:59], v[68:71], v[152:155]
    v_mfma_f32_16x16x32_bf16 v[156:159], v[60:63], v[68:71], v[156:159]
    v_mfma_f32_16x16x32_bf16 v[160:163], v[48:51], v[72:75], v[160:163]
    v_mfma_f32_16x16x32_bf16 v[164:167], v[52:55], v[72:75], v[164:167]
    v_mfma_f32_16x16x32_bf16 v[168:171], v[56:59], v[72:75], v[168:171]
    v_mfma_f32_16x16x32_bf16 v[172:175], v[60:63], v[72:75], v[172:175]
    v_mfma_f32_16x16x32_bf16 v[176:179], v[48:51], v[76:79], v[176:179]
    v_mfma_f32_16x16x32_bf16 v[180:183], v[52:55], v[76:79], v[180:183]
    v_mfma_f32_16x16x32_bf16 v[184:187], v[56:59], v[76:79], v[184:187]
    v_mfma_f32_16x16x32_bf16 v[188:191], v[60:63], v[76:79], v[188:191]
    s_waitcnt lgkmcnt(0)
    v_mfma_f32_16x16x32_bf16 v[192:195], v[48:51], v[80:83], v[192:195]
    v_mfma_f32_16x16x32_bf16 v[196:199], v[52:55], v[80:83], v[196:199]
    v_mfma_f32_16x16x32_bf16 v[200:203], v[56:59], v[80:83], v[200:203]
    v_mfma_f32_16x16x32_bf16 v[204:207], v[60:63], v[80:83], v[204:207]
    v_mfma_f32_16x16x32_bf16 v[208:211], v[48:51], v[84:87], v[208:211]
    v_mfma_f32_16x16x32_bf16 v[212:215], v[52:55], v[84:87], v[212:215]
    v_mfma_f32_16x16x32_bf16 v[216:219], v[56:59], v[84:87], v[216:219]
    v_mfma_f32_16x16x32_bf16 v[220:223], v[60:63], v[84:87], v[220:223]
    v_mfma_f32_16x16x32_bf16 v[224:227], v[48:51], v[88:91], v[224:227]
    v_mfma_f32_16x16x32_bf16 v[228:231], v[52:55], v[88:91], v[228:231]
    v_mfma_f32_16x16x32_bf16 v[232:235], v[56:59], v[88:91], v[232:235]
    v_mfma_f32_16x16x32_bf16 v[236:239], v[60:63], v[88:91], v[236:239]
    v_mfma_f32_16x16x32_bf16 v[240:243], v[48:51], v[92:95], v[240:243]
    v_mfma_f32_16x16x32_bf16 v[244:247], v[52:55], v[92:95], v[244:247]
    v_mfma_f32_16x16x32_bf16 v[248:251], v[56:59], v[92:95], v[248:251]
    v_mfma_f32_16x16x32_bf16 v[252:255], v[60:63], v[92:95], v[252:255]
    s_cmp_lg_u32 s30, 0
    s_cbranch_scc1 L_lp_20
    s_add_u32 s35, s83, 1408
    buffer_load_dword v26, v115, s[8:11], s35 offen
    s_add_u32 s35, s88, 5767168
    buffer_load_dword v27, v126, s[12:15], s35 offen
L_lp_20:
    s_cmp_eq_u32 s30, 0
    s_cbranch_scc1 L_lw_21
    s_waitcnt vmcnt(0)
L_lw_21:
    s_waitcnt vmcnt(2)
    s_barrier
    ds_read_b64_tr_b16 v[32:33], v14 offset:0
    ds_read_b64_tr_b16 v[34:35], v14 offset:2048
    ds_read_b64_tr_b16 v[36:37], v15 offset:0
    ds_read_b64_tr_b16 v[38:39], v15 offset:2048
    ds_read_b64_tr_b16 v[40:41], v16 offset:0
    ds_read_b64_tr_b16 v[42:43], v16 offset:2048
    ds_read_b64_tr_b16 v[44:45], v17 offset:0
    ds_read_b64_tr_b16 v[46:47], v17 offset:2048
    ds_read_b128 v[64:67], v8 offset:0
    ds_read_b128 v[68:71], v8 offset:2048
    ds_read_b128 v[72:75], v8 offset:4096
    ds_read_b128 v[76:79], v8 offset:6144
    ds_read_b128 v[80:83], v8 offset:8192
    ds_read_b128 v[84:87], v8 offset:10240
    ds_read_b128 v[88:91], v8 offset:12288
    ds_read_b128 v[92:95], v8 offset:14336
    s_waitcnt lgkmcnt(4)
    s_add_u32 m0, s31, 0
    s_add_u32 s35, s33, 1280
    buffer_load_dwordx4 v2, s[8:11], s35 offen lds
    s_add_u32 m0, s31, 1024
    s_add_u32 s35, s33, 17664
    buffer_load_dwordx4 v3, s[8:11], s35 offen lds
    s_add_u32 m0, s31, 2048
    s_add_u32 s35, s33, 34048
    buffer_load_dwordx4 v2, s[8:11], s35 offen lds
    s_add_u32 m0, s31, 3072
    s_add_u32 s35, s33, 50432
    buffer_load_dwordx4 v3, s[8:11], s35 offen lds
    v_mfma_f32_16x16x32_bf16 v[128:131], v[32:35], v[64:67], v[128:131]
    v_mfma_f32_16x16x32_bf16 v[132:135], v[36:39], v[64:67], v[132:135]
    v_mfma_f32_16x16x32_bf16 v[136:139], v[40:43], v[64:67], v[136:139]
    v_mfma_f32_16x16x32_bf16 v[140:143], v[44:47], v[64:67], v[140:143]
    v_mfma_f32_16x16x32_bf16 v[144:147], v[32:35], v[68:71], v[144:147]
    v_mfma_f32_16x16x32_bf16 v[148:151], v[36:39], v[68:71], v[148:151]
    v_mfma_f32_16x16x32_bf16 v[152:155], v[40:43], v[68:71], v[152:155]
    v_mfma_f32_16x16x32_bf16 v[156:159], v[44:47], v[68:71], v[156:159]
    v_mfma_f32_16x16x32_bf16 v[160:163], v[32:35], v[72:75], v[160:163]
    v_mfma_f32_16x16x32_bf16 v[164:167], v[36:39], v[72:75], v[164:167]
    v_mfma_f32_16x16x32_bf16 v[168:171], v[40:43], v[72:75], v[168:171]
    v_mfma_f32_16x16x32_bf16 v[172:175], v[44:47], v[72:75], v[172:175]
    v_mfma_f32_16x16x32_bf16 v[176:179], v[32:35], v[76:79], v[176:179]
    v_mfma_f32_16x16x32_bf16 v[180:183], v[36:39], v[76:79], v[180:183]
    v_mfma_f32_16x16x32_bf16 v[184:187], v[40:43], v[76:79], v[184:187]
    v_mfma_f32_16x16x32_bf16 v[188:191], v[44:47], v[76:79], v[188:191]
    ds_read_b64_tr_b16 v[48:49], v14 offset:16384
    ds_read_b64_tr_b16 v[50:51], v14 offset:18432
    ds_read_b64_tr_b16 v[52:53], v15 offset:16384
    ds_read_b64_tr_b16 v[54:55], v15 offset:18432
    ds_read_b64_tr_b16 v[56:57], v16 offset:16384
    ds_read_b64_tr_b16 v[58:59], v16 offset:18432
    ds_read_b64_tr_b16 v[60:61], v17 offset:16384
    ds_read_b64_tr_b16 v[62:63], v17 offset:18432
    ds_read_b128 v[64:67], v9 offset:0
    ds_read_b128 v[68:71], v9 offset:2048
    ds_read_b128 v[72:75], v9 offset:4096
    ds_read_b128 v[76:79], v9 offset:6144
    s_waitcnt lgkmcnt(12)
    s_add_u32 m0, s32, 32768
    s_add_u32 s35, s34, 5242880
    buffer_load_dwordx4 v4, s[12:15], s35 offen lds
    s_add_u32 m0, s32, 33792
    s_add_u32 s35, s34, 5259264
    buffer_load_dwordx4 v5, s[12:15], s35 offen lds
    s_add_u32 m0, s32, 34816
    s_add_u32 s35, s34, 5275648
    buffer_load_dwordx4 v4, s[12:15], s35 offen lds
    s_add_u32 m0, s32, 35840
    s_add_u32 s35, s34, 5292032
    buffer_load_dwordx4 v5, s[12:15], s35 offen lds
    v_mfma_f32_16x16x32_bf16 v[192:195], v[32:35], v[80:83], v[192:195]
    v_mfma_f32_16x16x32_bf16 v[196:199], v[36:39], v[80:83], v[196:199]
    v_mfma_f32_16x16x32_bf16 v[200:203], v[40:43], v[80:83], v[200:203]
    v_mfma_f32_16x16x32_bf16 v[204:207], v[44:47], v[80:83], v[204:207]
    v_mfma_f32_16x16x32_bf16 v[208:211], v[32:35], v[84:87], v[208:211]
    v_mfma_f32_16x16x32_bf16 v[212:215], v[36:39], v[84:87], v[212:215]
    v_mfma_f32_16x16x32_bf16 v[216:219], v[40:43], v[84:87], v[216:219]
    v_mfma_f32_16x16x32_bf16 v[220:223], v[44:47], v[84:87], v[220:223]
    v_mfma_f32_16x16x32_bf16 v[224:227], v[32:35], v[88:91], v[224:227]
    v_mfma_f32_16x16x32_bf16 v[228:231], v[36:39], v[88:91], v[228:231]
    v_mfma_f32_16x16x32_bf16 v[232:235], v[40:43], v[88:91], v[232:235]
    v_mfma_f32_16x16x32_bf16 v[236:239], v[44:47], v[88:91], v[236:239]
    v_mfma_f32_16x16x32_bf16 v[240:243], v[32:35], v[92:95], v[240:243]
    v_mfma_f32_16x16x32_bf16 v[244:247], v[36:39], v[92:95], v[244:247]
    v_mfma_f32_16x16x32_bf16 v[248:251], v[40:43], v[92:95], v[248:251]
    v_mfma_f32_16x16x32_bf16 v[252:255], v[44:47], v[92:95], v[252:255]
    ds_read_b128 v[80:83], v9 offset:8192
    ds_read_b128 v[84:87], v9 offset:10240
    ds_read_b128 v[88:91], v9 offset:12288
    ds_read_b128 v[92:95], v9 offset:14336
    s_waitcnt lgkmcnt(4)
    v_mfma_f32_16x16x32_bf16 v[128:131], v[48:51], v[64:67], v[128:131]
    v_mfma_f32_16x16x32_bf16 v[132:135], v[52:55], v[64:67], v[132:135]
    v_mfma_f32_16x16x32_bf16 v[136:139], v[56:59], v[64:67], v[136:139]
    v_mfma_f32_16x16x32_bf16 v[140:143], v[60:63], v[64:67], v[140:143]
    v_mfma_f32_16x16x32_bf16 v[144:147], v[48:51], v[68:71], v[144:147]
    v_mfma_f32_16x16x32_bf16 v[148:151], v[52:55], v[68:71], v[148:151]
    v_mfma_f32_16x16x32_bf16 v[152:155], v[56:59], v[68:71], v[152:155]
    v_mfma_f32_16x16x32_bf16 v[156:159], v[60:63], v[68:71], v[156:159]
    v_mfma_f32_16x16x32_bf16 v[160:163], v[48:51], v[72:75], v[160:163]
    v_mfma_f32_16x16x32_bf16 v[164:167], v[52:55], v[72:75], v[164:167]
    v_mfma_f32_16x16x32_bf16 v[168:171], v[56:59], v[72:75], v[168:171]
    v_mfma_f32_16x16x32_bf16 v[172:175], v[60:63], v[72:75], v[172:175]
    v_mfma_f32_16x16x32_bf16 v[176:179], v[48:51], v[76:79], v[176:179]
    v_mfma_f32_16x16x32_bf16 v[180:183], v[52:55], v[76:79], v[180:183]
    v_mfma_f32_16x16x32_bf16 v[184:187], v[56:59], v[76:79], v[184:187]
    v_mfma_f32_16x16x32_bf16 v[188:191], v[60:63], v[76:79], v[188:191]
    s_waitcnt lgkmcnt(0)
    v_mfma_f32_16x16x32_bf16 v[192:195], v[48:51], v[80:83], v[192:195]
    v_mfma_f32_16x16x32_bf16 v[196:199], v[52:55], v[80:83], v[196:199]
    v_mfma_f32_16x16x32_bf16 v[200:203], v[56:59], v[80:83], v[200:203]
    v_mfma_f32_16x16x32_bf16 v[204:207], v[60:63], v[80:83], v[204:207]
    v_mfma_f32_16x16x32_bf16 v[208:211], v[48:51], v[84:87], v[208:211]
    v_mfma_f32_16x16x32_bf16 v[212:215], v[52:55], v[84:87], v[212:215]
    v_mfma_f32_16x16x32_bf16 v[216:219], v[56:59], v[84:87], v[216:219]
    v_mfma_f32_16x16x32_bf16 v[220:223], v[60:63], v[84:87], v[220:223]
    v_mfma_f32_16x16x32_bf16 v[224:227], v[48:51], v[88:91], v[224:227]
    v_mfma_f32_16x16x32_bf16 v[228:231], v[52:55], v[88:91], v[228:231]
    v_mfma_f32_16x16x32_bf16 v[232:235], v[56:59], v[88:91], v[232:235]
    v_mfma_f32_16x16x32_bf16 v[236:239], v[60:63], v[88:91], v[236:239]
    v_mfma_f32_16x16x32_bf16 v[240:243], v[48:51], v[92:95], v[240:243]
    v_mfma_f32_16x16x32_bf16 v[244:247], v[52:55], v[92:95], v[244:247]
    v_mfma_f32_16x16x32_bf16 v[248:251], v[56:59], v[92:95], v[248:251]
    v_mfma_f32_16x16x32_bf16 v[252:255], v[60:63], v[92:95], v[252:255]
    s_cmp_lg_u32 s30, 1
    s_cbranch_scc1 L_lp_22
    s_add_u32 s35, s83, 1536
    buffer_load_dword v26, v115, s[8:11], s35 offen
    s_add_u32 s35, s88, 6291456
    buffer_load_dword v27, v126, s[12:15], s35 offen
L_lp_22:
    s_cmp_eq_u32 s30, 1
    s_cbranch_scc1 L_lw_23
    s_waitcnt vmcnt(0)
L_lw_23:
    s_waitcnt vmcnt(2)
    s_barrier
    ds_read_b64_tr_b16 v[32:33], v10 offset:0
    ds_read_b64_tr_b16 v[34:35], v10 offset:2048
    ds_read_b64_tr_b16 v[36:37], v11 offset:0
    ds_read_b64_tr_b16 v[38:39], v11 offset:2048
    ds_read_b64_tr_b16 v[40:41], v12 offset:0
    ds_read_b64_tr_b16 v[42:43], v12 offset:2048
    ds_read_b64_tr_b16 v[44:45], v13 offset:0
    ds_read_b64_tr_b16 v[46:47], v13 offset:2048
    ds_read_b128 v[64:67], v6 offset:0
    ds_read_b128 v[68:71], v6 offset:2048
    ds_read_b128 v[72:75], v6 offset:4096
    ds_read_b128 v[76:79], v6 offset:6144
    ds_read_b128 v[80:83], v6 offset:8192
    ds_read_b128 v[84:87], v6 offset:10240
    ds_read_b128 v[88:91], v6 offset:12288
    ds_read_b128 v[92:95], v6 offset:14336
    s_waitcnt lgkmcnt(4)
    s_add_u32 m0, s31, 65536
    s_add_u32 s35, s33, 1408
    buffer_load_dwordx4 v2, s[8:11], s35 offen lds
    s_add_u32 m0, s31, 66560
    s_add_u32 s35, s33, 17792
    buffer_load_dwordx4 v3, s[8:11], s35 offen lds
    s_add_u32 m0, s31, 67584
    s_add_u32 s35, s33, 34176
    buffer_load_dwordx4 v2, s[8:11], s35 offen lds
    s_add_u32 m0, s31, 68608
    s_add_u32 s35, s33, 50560
    buffer_load_dwordx4 v3, s[8:11], s35 offen lds
    v_mfma_f32_16x16x32_bf16 v[128:131], v[32:35], v[64:67], v[128:131]
    v_mfma_f32_16x16x32_bf16 v[132:135], v[36:39], v[64:67], v[132:135]
    v_mfma_f32_16x16x32_bf16 v[136:139], v[40:43], v[64:67], v[136:139]
    v_mfma_f32_16x16x32_bf16 v[140:143], v[44:47], v[64:67], v[140:143]
    v_mfma_f32_16x16x32_bf16 v[144:147], v[32:35], v[68:71], v[144:147]
    v_mfma_f32_16x16x32_bf16 v[148:151], v[36:39], v[68:71], v[148:151]
    v_mfma_f32_16x16x32_bf16 v[152:155], v[40:43], v[68:71], v[152:155]
    v_mfma_f32_16x16x32_bf16 v[156:159], v[44:47], v[68:71], v[156:159]
    v_mfma_f32_16x16x32_bf16 v[160:163], v[32:35], v[72:75], v[160:163]
    v_mfma_f32_16x16x32_bf16 v[164:167], v[36:39], v[72:75], v[164:167]
    v_mfma_f32_16x16x32_bf16 v[168:171], v[40:43], v[72:75], v[168:171]
    v_mfma_f32_16x16x32_bf16 v[172:175], v[44:47], v[72:75], v[172:175]
    v_mfma_f32_16x16x32_bf16 v[176:179], v[32:35], v[76:79], v[176:179]
    v_mfma_f32_16x16x32_bf16 v[180:183], v[36:39], v[76:79], v[180:183]
    v_mfma_f32_16x16x32_bf16 v[184:187], v[40:43], v[76:79], v[184:187]
    v_mfma_f32_16x16x32_bf16 v[188:191], v[44:47], v[76:79], v[188:191]
    ds_read_b64_tr_b16 v[48:49], v10 offset:16384
    ds_read_b64_tr_b16 v[50:51], v10 offset:18432
    ds_read_b64_tr_b16 v[52:53], v11 offset:16384
    ds_read_b64_tr_b16 v[54:55], v11 offset:18432
    ds_read_b64_tr_b16 v[56:57], v12 offset:16384
    ds_read_b64_tr_b16 v[58:59], v12 offset:18432
    ds_read_b64_tr_b16 v[60:61], v13 offset:16384
    ds_read_b64_tr_b16 v[62:63], v13 offset:18432
    ds_read_b128 v[64:67], v7 offset:0
    ds_read_b128 v[68:71], v7 offset:2048
    ds_read_b128 v[72:75], v7 offset:4096
    ds_read_b128 v[76:79], v7 offset:6144
    s_waitcnt lgkmcnt(12)
    s_add_u32 m0, s32, 98304
    s_add_u32 s35, s34, 5767168
    buffer_load_dwordx4 v4, s[12:15], s35 offen lds
    s_add_u32 m0, s32, 99328
    s_add_u32 s35, s34, 5783552
    buffer_load_dwordx4 v5, s[12:15], s35 offen lds
    s_add_u32 m0, s32, 100352
    s_add_u32 s35, s34, 5799936
    buffer_load_dwordx4 v4, s[12:15], s35 offen lds
    s_add_u32 m0, s32, 101376
    s_add_u32 s35, s34, 5816320
    buffer_load_dwordx4 v5, s[12:15], s35 offen lds
    v_mfma_f32_16x16x32_bf16 v[192:195], v[32:35], v[80:83], v[192:195]
    v_mfma_f32_16x16x32_bf16 v[196:199], v[36:39], v[80:83], v[196:199]
    v_mfma_f32_16x16x32_bf16 v[200:203], v[40:43], v[80:83], v[200:203]
    v_mfma_f32_16x16x32_bf16 v[204:207], v[44:47], v[80:83], v[204:207]
    v_mfma_f32_16x16x32_bf16 v[208:211], v[32:35], v[84:87], v[208:211]
    v_mfma_f32_16x16x32_bf16 v[212:215], v[36:39], v[84:87], v[212:215]
    v_mfma_f32_16x16x32_bf16 v[216:219], v[40:43], v[84:87], v[216:219]
    v_mfma_f32_16x16x32_bf16 v[220:223], v[44:47], v[84:87], v[220:223]
    v_mfma_f32_16x16x32_bf16 v[224:227], v[32:35], v[88:91], v[224:227]
    v_mfma_f32_16x16x32_bf16 v[228:231], v[36:39], v[88:91], v[228:231]
    v_mfma_f32_16x16x32_bf16 v[232:235], v[40:43], v[88:91], v[232:235]
    v_mfma_f32_16x16x32_bf16 v[236:239], v[44:47], v[88:91], v[236:239]
    v_mfma_f32_16x16x32_bf16 v[240:243], v[32:35], v[92:95], v[240:243]
    v_mfma_f32_16x16x32_bf16 v[244:247], v[36:39], v[92:95], v[244:247]
    v_mfma_f32_16x16x32_bf16 v[248:251], v[40:43], v[92:95], v[248:251]
    v_mfma_f32_16x16x32_bf16 v[252:255], v[44:47], v[92:95], v[252:255]
    ds_read_b128 v[80:83], v7 offset:8192
    ds_read_b128 v[84:87], v7 offset:10240
    ds_read_b128 v[88:91], v7 offset:12288
    ds_read_b128 v[92:95], v7 offset:14336
    s_waitcnt lgkmcnt(4)
    v_mfma_f32_16x16x32_bf16 v[128:131], v[48:51], v[64:67], v[128:131]
    v_mfma_f32_16x16x32_bf16 v[132:135], v[52:55], v[64:67], v[132:135]
    v_mfma_f32_16x16x32_bf16 v[136:139], v[56:59], v[64:67], v[136:139]
    v_mfma_f32_16x16x32_bf16 v[140:143], v[60:63], v[64:67], v[140:143]
    v_mfma_f32_16x16x32_bf16 v[144:147], v[48:51], v[68:71], v[144:147]
    v_mfma_f32_16x16x32_bf16 v[148:151], v[52:55], v[68:71], v[148:151]
    v_mfma_f32_16x16x32_bf16 v[152:155], v[56:59], v[68:71], v[152:155]
    v_mfma_f32_16x16x32_bf16 v[156:159], v[60:63], v[68:71], v[156:159]
    v_mfma_f32_16x16x32_bf16 v[160:163], v[48:51], v[72:75], v[160:163]
    v_mfma_f32_16x16x32_bf16 v[164:167], v[52:55], v[72:75], v[164:167]
    v_mfma_f32_16x16x32_bf16 v[168:171], v[56:59], v[72:75], v[168:171]
    v_mfma_f32_16x16x32_bf16 v[172:175], v[60:63], v[72:75], v[172:175]
    v_mfma_f32_16x16x32_bf16 v[176:179], v[48:51], v[76:79], v[176:179]
    v_mfma_f32_16x16x32_bf16 v[180:183], v[52:55], v[76:79], v[180:183]
    v_mfma_f32_16x16x32_bf16 v[184:187], v[56:59], v[76:79], v[184:187]
    v_mfma_f32_16x16x32_bf16 v[188:191], v[60:63], v[76:79], v[188:191]
    s_waitcnt lgkmcnt(0)
    v_mfma_f32_16x16x32_bf16 v[192:195], v[48:51], v[80:83], v[192:195]
    v_mfma_f32_16x16x32_bf16 v[196:199], v[52:55], v[80:83], v[196:199]
    v_mfma_f32_16x16x32_bf16 v[200:203], v[56:59], v[80:83], v[200:203]
    v_mfma_f32_16x16x32_bf16 v[204:207], v[60:63], v[80:83], v[204:207]
    v_mfma_f32_16x16x32_bf16 v[208:211], v[48:51], v[84:87], v[208:211]
    v_mfma_f32_16x16x32_bf16 v[212:215], v[52:55], v[84:87], v[212:215]
    v_mfma_f32_16x16x32_bf16 v[216:219], v[56:59], v[84:87], v[216:219]
    v_mfma_f32_16x16x32_bf16 v[220:223], v[60:63], v[84:87], v[220:223]
    v_mfma_f32_16x16x32_bf16 v[224:227], v[48:51], v[88:91], v[224:227]
    v_mfma_f32_16x16x32_bf16 v[228:231], v[52:55], v[88:91], v[228:231]
    v_mfma_f32_16x16x32_bf16 v[232:235], v[56:59], v[88:91], v[232:235]
    v_mfma_f32_16x16x32_bf16 v[236:239], v[60:63], v[88:91], v[236:239]
    v_mfma_f32_16x16x32_bf16 v[240:243], v[48:51], v[92:95], v[240:243]
    v_mfma_f32_16x16x32_bf16 v[244:247], v[52:55], v[92:95], v[244:247]
    v_mfma_f32_16x16x32_bf16 v[248:251], v[56:59], v[92:95], v[248:251]
    v_mfma_f32_16x16x32_bf16 v[252:255], v[60:63], v[92:95], v[252:255]
    s_cmp_lg_u32 s30, 2
    s_cbranch_scc1 L_lp_24
    s_add_u32 s35, s83, 1664
    buffer_load_dword v26, v115, s[8:11], s35 offen
    s_add_u32 s35, s88, 6815744
    buffer_load_dword v27, v126, s[12:15], s35 offen
L_lp_24:
    s_cmp_eq_u32 s30, 2
    s_cbranch_scc1 L_lw_25
    s_waitcnt vmcnt(0)
L_lw_25:
    s_waitcnt vmcnt(2)
    s_barrier
    s_lshr_b32 s81, s30, 1
    s_cmp_lg_u32 s81, 0
    s_cbranch_scc1 L_qp_26
    s_and_b32 s81, s49, 1
    s_lshl_b32 s81, s81, 6
    s_add_u32 s81, s81, s54
    s_mul_i32 s81, s81, 896
    s_lshl_b32 s82, s30, 7
    s_add_u32 s81, s81, s82
    v_mul_u32_u24 v18, 896, v1
    buffer_load_dword v20, v18, s[44:47], s81 offen
L_qp_26:
    ds_read_b64_tr_b16 v[32:33], v14 offset:0
    ds_read_b64_tr_b16 v[34:35], v14 offset:2048
    ds_read_b64_tr_b16 v[36:37], v15 offset:0
    ds_read_b64_tr_b16 v[38:39], v15 offset:2048
    ds_read_b64_tr_b16 v[40:41], v16 offset:0
    ds_read_b64_tr_b16 v[42:43], v16 offset:2048
    ds_read_b64_tr_b16 v[44:45], v17 offset:0
    ds_read_b64_tr_b16 v[46:47], v17 offset:2048
    ds_read_b128 v[64:67], v8 offset:0
    ds_read_b128 v[68:71], v8 offset:2048
    ds_read_b128 v[72:75], v8 offset:4096
    ds_read_b128 v[76:79], v8 offset:6144
    ds_read_b128 v[80:83], v8 offset:8192
    ds_read_b128 v[84:87], v8 offset:10240
    ds_read_b128 v[88:91], v8 offset:12288
    ds_read_b128 v[92:95], v8 offset:14336
    s_waitcnt lgkmcnt(4)
    s_add_u32 m0, s31, 0
    s_add_u32 s35, s33, 1536
    buffer_load_dwordx4 v2, s[8:11], s35 offen lds
    s_add_u32 m0, s31, 1024
    s_add_u32 s35, s33, 17920
    buffer_load_dwordx4 v3, s[8:11], s35 offen lds
    s_add_u32 m0, s31, 2048
    s_add_u32 s35, s33, 34304
    buffer_load_dwordx4 v2, s[8:11], s35 offen lds
    s_add_u32 m0, s31, 3072
    s_add_u32 s35, s33, 50688
    buffer_load_dwordx4 v3, s[8:11], s35 offen lds
    v_mfma_f32_16x16x32_bf16 v[128:131], v[32:35], v[64:67], v[128:131]
    v_mfma_f32_16x16x32_bf16 v[132:135], v[36:39], v[64:67], v[132:135]
    v_mfma_f32_16x16x32_bf16 v[136:139], v[40:43], v[64:67], v[136:139]
    v_mfma_f32_16x16x32_bf16 v[140:143], v[44:47], v[64:67], v[140:143]
    v_mfma_f32_16x16x32_bf16 v[144:147], v[32:35], v[68:71], v[144:147]
    v_mfma_f32_16x16x32_bf16 v[148:151], v[36:39], v[68:71], v[148:151]
    v_mfma_f32_16x16x32_bf16 v[152:155], v[40:43], v[68:71], v[152:155]
    v_mfma_f32_16x16x32_bf16 v[156:159], v[44:47], v[68:71], v[156:159]
    v_mfma_f32_16x16x32_bf16 v[160:163], v[32:35], v[72:75], v[160:163]
    v_mfma_f32_16x16x32_bf16 v[164:167], v[36:39], v[72:75], v[164:167]
    v_mfma_f32_16x16x32_bf16 v[168:171], v[40:43], v[72:75], v[168:171]
    v_mfma_f32_16x16x32_bf16 v[172:175], v[44:47], v[72:75], v[172:175]
    v_mfma_f32_16x16x32_bf16 v[176:179], v[32:35], v[76:79], v[176:179]
    v_mfma_f32_16x16x32_bf16 v[180:183], v[36:39], v[76:79], v[180:183]
    v_mfma_f32_16x16x32_bf16 v[184:187], v[40:43], v[76:79], v[184:187]
    v_mfma_f32_16x16x32_bf16 v[188:191], v[44:47], v[76:79], v[188:191]
    ds_read_b64_tr_b16 v[48:49], v14 offset:16384
    ds_read_b64_tr_b16 v[50:51], v14 offset:18432
    ds_read_b64_tr_b16 v[52:53], v15 offset:16384
    ds_read_b64_tr_b16 v[54:55], v15 offset:18432
    ds_read_b64_tr_b16 v[56:57], v16 offset:16384
    ds_read_b64_tr_b16 v[58:59], v16 offset:18432
    ds_read_b64_tr_b16 v[60:61], v17 offset:16384
    ds_read_b64_tr_b16 v[62:63], v17 offset:18432
    ds_read_b128 v[64:67], v9 offset:0
    ds_read_b128 v[68:71], v9 offset:2048
    ds_read_b128 v[72:75], v9 offset:4096
    ds_read_b128 v[76:79], v9 offset:6144
    s_waitcnt lgkmcnt(12)
    s_add_u32 m0, s32, 32768
    s_add_u32 s35, s34, 6291456
    buffer_load_dwordx4 v4, s[12:15], s35 offen lds
    s_add_u32 m0, s32, 33792
    s_add_u32 s35, s34, 6307840
    buffer_load_dwordx4 v5, s[12:15], s35 offen lds
    s_add_u32 m0, s32, 34816
    s_add_u32 s35, s34, 6324224
    buffer_load_dwordx4 v4, s[12:15], s35 offen lds
    s_add_u32 m0, s32, 35840
    s_add_u32 s35, s34, 6340608
    buffer_load_dwordx4 v5, s[12:15], s35 offen lds
    v_mfma_f32_16x16x32_bf16 v[192:195], v[32:35], v[80:83], v[192:195]
    v_mfma_f32_16x16x32_bf16 v[196:199], v[36:39], v[80:83], v[196:199]
    v_mfma_f32_16x16x32_bf16 v[200:203], v[40:43], v[80:83], v[200:203]
    v_mfma_f32_16x16x32_bf16 v[204:207], v[44:47], v[80:83], v[204:207]
    v_mfma_f32_16x16x32_bf16 v[208:211], v[32:35], v[84:87], v[208:211]
    v_mfma_f32_16x16x32_bf16 v[212:215], v[36:39], v[84:87], v[212:215]
    v_mfma_f32_16x16x32_bf16 v[216:219], v[40:43], v[84:87], v[216:219]
    v_mfma_f32_16x16x32_bf16 v[220:223], v[44:47], v[84:87], v[220:223]
    v_mfma_f32_16x16x32_bf16 v[224:227], v[32:35], v[88:91], v[224:227]
    v_mfma_f32_16x16x32_bf16 v[228:231], v[36:39], v[88:91], v[228:231]
    v_mfma_f32_16x16x32_bf16 v[232:235], v[40:43], v[88:91], v[232:235]
    v_mfma_f32_16x16x32_bf16 v[236:239], v[44:47], v[88:91], v[236:239]
    v_mfma_f32_16x16x32_bf16 v[240:243], v[32:35], v[92:95], v[240:243]
    v_mfma_f32_16x16x32_bf16 v[244:247], v[36:39], v[92:95], v[244:247]
    v_mfma_f32_16x16x32_bf16 v[248:251], v[40:43], v[92:95], v[248:251]
    v_mfma_f32_16x16x32_bf16 v[252:255], v[44:47], v[92:95], v[252:255]
    ds_read_b128 v[80:83], v9 offset:8192
    ds_read_b128 v[84:87], v9 offset:10240
    ds_read_b128 v[88:91], v9 offset:12288
    ds_read_b128 v[92:95], v9 offset:14336
    s_waitcnt lgkmcnt(4)
    v_mfma_f32_16x16x32_bf16 v[128:131], v[48:51], v[64:67], v[128:131]
    v_mfma_f32_16x16x32_bf16 v[132:135], v[52:55], v[64:67], v[132:135]
    v_mfma_f32_16x16x32_bf16 v[136:139], v[56:59], v[64:67], v[136:139]
    v_mfma_f32_16x16x32_bf16 v[140:143], v[60:63], v[64:67], v[140:143]
    v_mfma_f32_16x16x32_bf16 v[144:147], v[48:51], v[68:71], v[144:147]
    v_mfma_f32_16x16x32_bf16 v[148:151], v[52:55], v[68:71], v[148:151]
    v_mfma_f32_16x16x32_bf16 v[152:155], v[56:59], v[68:71], v[152:155]
    v_mfma_f32_16x16x32_bf16 v[156:159], v[60:63], v[68:71], v[156:159]
    v_mfma_f32_16x16x32_bf16 v[160:163], v[48:51], v[72:75], v[160:163]
    v_mfma_f32_16x16x32_bf16 v[164:167], v[52:55], v[72:75], v[164:167]
    v_mfma_f32_16x16x32_bf16 v[168:171], v[56:59], v[72:75], v[168:171]
    v_mfma_f32_16x16x32_bf16 v[172:175], v[60:63], v[72:75], v[172:175]
    v_mfma_f32_16x16x32_bf16 v[176:179], v[48:51], v[76:79], v[176:179]
    v_mfma_f32_16x16x32_bf16 v[180:183], v[52:55], v[76:79], v[180:183]
    v_mfma_f32_16x16x32_bf16 v[184:187], v[56:59], v[76:79], v[184:187]
    v_mfma_f32_16x16x32_bf16 v[188:191], v[60:63], v[76:79], v[188:191]
    s_waitcnt lgkmcnt(0)
    v_mfma_f32_16x16x32_bf16 v[192:195], v[48:51], v[80:83], v[192:195]
    v_mfma_f32_16x16x32_bf16 v[196:199], v[52:55], v[80:83], v[196:199]
    v_mfma_f32_16x16x32_bf16 v[200:203], v[56:59], v[80:83], v[200:203]
    v_mfma_f32_16x16x32_bf16 v[204:207], v[60:63], v[80:83], v[204:207]
    v_mfma_f32_16x16x32_bf16 v[208:211], v[48:51], v[84:87], v[208:211]
    v_mfma_f32_16x16x32_bf16 v[212:215], v[52:55], v[84:87], v[212:215]
    v_mfma_f32_16x16x32_bf16 v[216:219], v[56:59], v[84:87], v[216:219]
    v_mfma_f32_16x16x32_bf16 v[220:223], v[60:63], v[84:87], v[220:223]
    v_mfma_f32_16x16x32_bf16 v[224:227], v[48:51], v[88:91], v[224:227]
    v_mfma_f32_16x16x32_bf16 v[228:231], v[52:55], v[88:91], v[228:231]
    v_mfma_f32_16x16x32_bf16 v[232:235], v[56:59], v[88:91], v[232:235]
    v_mfma_f32_16x16x32_bf16 v[236:239], v[60:63], v[88:91], v[236:239]
    v_mfma_f32_16x16x32_bf16 v[240:243], v[48:51], v[92:95], v[240:243]
    v_mfma_f32_16x16x32_bf16 v[244:247], v[52:55], v[92:95], v[244:247]
    v_mfma_f32_16x16x32_bf16 v[248:251], v[56:59], v[92:95], v[248:251]
    v_mfma_f32_16x16x32_bf16 v[252:255], v[60:63], v[92:95], v[252:255]
    s_cmp_lg_u32 s30, 3
    s_cbranch_scc1 L_lp_27
    s_add_u32 s35, s83, 1792
    buffer_load_dword v26, v115, s[8:11], s35 offen
    s_add_u32 s35, s88, 7340032
    buffer_load_dword v27, v126, s[12:15], s35 offen
L_lp_27:
    s_cmp_eq_u32 s30, 3
    s_cbranch_scc1 L_lw_28
    s_waitcnt vmcnt(0)
L_lw_28:
    s_waitcnt vmcnt(2)
    s_barrier
    s_lshr_b32 s81, s30, 1
    s_cmp_lg_u32 s81, 1
    s_cbranch_scc1 L_qp_29
    s_and_b32 s81, s49, 1
    s_lshl_b32 s81, s81, 6
    s_add_u32 s81, s81, s54
    s_mul_i32 s81, s81, 896
    s_lshl_b32 s82, s30, 7
    s_add_u32 s81, s81, s82
    v_mul_u32_u24 v18, 896, v1
    buffer_load_dword v20, v18, s[44:47], s81 offen
L_qp_29:
    ds_read_b64_tr_b16 v[32:33], v10 offset:0
    ds_read_b64_tr_b16 v[34:35], v10 offset:2048
    ds_read_b64_tr_b16 v[36:37], v11 offset:0
    ds_read_b64_tr_b16 v[38:39], v11 offset:2048
    ds_read_b64_tr_b16 v[40:41], v12 offset:0
    ds_read_b64_tr_b16 v[42:43], v12 offset:2048
    ds_read_b64_tr_b16 v[44:45], v13 offset:0
    ds_read_b64_tr_b16 v[46:47], v13 offset:2048
    ds_read_b128 v[64:67], v6 offset:0
    ds_read_b128 v[68:71], v6 offset:2048
    ds_read_b128 v[72:75], v6 offset:4096
    ds_read_b128 v[76:79], v6 offset:6144
    ds_read_b128 v[80:83], v6 offset:8192
    ds_read_b128 v[84:87], v6 offset:10240
    ds_read_b128 v[88:91], v6 offset:12288
    ds_read_b128 v[92:95], v6 offset:14336
    s_waitcnt lgkmcnt(4)
    s_add_u32 m0, s31, 65536
    s_add_u32 s35, s33, 1664
    buffer_load_dwordx4 v2, s[8:11], s35 offen lds
    s_add_u32 m0, s31, 66560
    s_add_u32 s35, s33, 18048
    buffer_load_dwordx4 v3, s[8:11], s35 offen lds
    s_add_u32 m0, s31, 67584
    s_add_u32 s35, s33, 34432
    buffer_load_dwordx4 v2, s[8:11], s35 offen lds
    s_add_u32 m0, s31, 68608
    s_add_u32 s35, s33, 50816
    buffer_load_dwordx4 v3, s[8:11], s35 offen lds
    v_mfma_f32_16x16x32_bf16 v[128:131], v[32:35], v[64:67], v[128:131]
    v_mfma_f32_16x16x32_bf16 v[132:135], v[36:39], v[64:67], v[132:135]
    v_mfma_f32_16x16x32_bf16 v[136:139], v[40:43], v[64:67], v[136:139]
    v_mfma_f32_16x16x32_bf16 v[140:143], v[44:47], v[64:67], v[140:143]
    v_mfma_f32_16x16x32_bf16 v[144:147], v[32:35], v[68:71], v[144:147]
    v_mfma_f32_16x16x32_bf16 v[148:151], v[36:39], v[68:71], v[148:151]
    v_mfma_f32_16x16x32_bf16 v[152:155], v[40:43], v[68:71], v[152:155]
    v_mfma_f32_16x16x32_bf16 v[156:159], v[44:47], v[68:71], v[156:159]
    v_mfma_f32_16x16x32_bf16 v[160:163], v[32:35], v[72:75], v[160:163]
    v_mfma_f32_16x16x32_bf16 v[164:167], v[36:39], v[72:75], v[164:167]
    v_mfma_f32_16x16x32_bf16 v[168:171], v[40:43], v[72:75], v[168:171]
    v_mfma_f32_16x16x32_bf16 v[172:175], v[44:47], v[72:75], v[172:175]
    v_mfma_f32_16x16x32_bf16 v[176:179], v[32:35], v[76:79], v[176:179]
    v_mfma_f32_16x16x32_bf16 v[180:183], v[36:39], v[76:79], v[180:183]
    v_mfma_f32_16x16x32_bf16 v[184:187], v[40:43], v[76:79], v[184:187]
    v_mfma_f32_16x16x32_bf16 v[188:191], v[44:47], v[76:79], v[188:191]
    ds_read_b64_tr_b16 v[48:49], v10 offset:16384
    ds_read_b64_tr_b16 v[50:51], v10 offset:18432
    ds_read_b64_tr_b16 v[52:53], v11 offset:16384
    ds_read_b64_tr_b16 v[54:55], v11 offset:18432
    ds_read_b64_tr_b16 v[56:57], v12 offset:16384
    ds_read_b64_tr_b16 v[58:59], v12 offset:18432
    ds_read_b64_tr_b16 v[60:61], v13 offset:16384
    ds_read_b64_tr_b16 v[62:63], v13 offset:18432
    ds_read_b128 v[64:67], v7 offset:0
    ds_read_b128 v[68:71], v7 offset:2048
    ds_read_b128 v[72:75], v7 offset:4096
    ds_read_b128 v[76:79], v7 offset:6144
    s_waitcnt lgkmcnt(12)
    s_add_u32 m0, s32, 98304
    s_add_u32 s35, s34, 6815744
    buffer_load_dwordx4 v4, s[12:15], s35 offen lds
    s_add_u32 m0, s32, 99328
    s_add_u32 s35, s34, 6832128
    buffer_load_dwordx4 v5, s[12:15], s35 offen lds
    s_add_u32 m0, s32, 100352
    s_add_u32 s35, s34, 6848512
    buffer_load_dwordx4 v4, s[12:15], s35 offen lds
    s_add_u32 m0, s32, 101376
    s_add_u32 s35, s34, 6864896
    buffer_load_dwordx4 v5, s[12:15], s35 offen lds
    v_mfma_f32_16x16x32_bf16 v[192:195], v[32:35], v[80:83], v[192:195]
    v_mfma_f32_16x16x32_bf16 v[196:199], v[36:39], v[80:83], v[196:199]
    v_mfma_f32_16x16x32_bf16 v[200:203], v[40:43], v[80:83], v[200:203]
    v_mfma_f32_16x16x32_bf16 v[204:207], v[44:47], v[80:83], v[204:207]
    v_mfma_f32_16x16x32_bf16 v[208:211], v[32:35], v[84:87], v[208:211]
    v_mfma_f32_16x16x32_bf16 v[212:215], v[36:39], v[84:87], v[212:215]
    v_mfma_f32_16x16x32_bf16 v[216:219], v[40:43], v[84:87], v[216:219]
    v_mfma_f32_16x16x32_bf16 v[220:223], v[44:47], v[84:87], v[220:223]
    v_mfma_f32_16x16x32_bf16 v[224:227], v[32:35], v[88:91], v[224:227]
    v_mfma_f32_16x16x32_bf16 v[228:231], v[36:39], v[88:91], v[228:231]
    v_mfma_f32_16x16x32_bf16 v[232:235], v[40:43], v[88:91], v[232:235]
    v_mfma_f32_16x16x32_bf16 v[236:239], v[44:47], v[88:91], v[236:239]
    v_mfma_f32_16x16x32_bf16 v[240:243], v[32:35], v[92:95], v[240:243]
    v_mfma_f32_16x16x32_bf16 v[244:247], v[36:39], v[92:95], v[244:247]
    v_mfma_f32_16x16x32_bf16 v[248:251], v[40:43], v[92:95], v[248:251]
    v_mfma_f32_16x16x32_bf16 v[252:255], v[44:47], v[92:95], v[252:255]
    ds_read_b128 v[80:83], v7 offset:8192
    ds_read_b128 v[84:87], v7 offset:10240
    ds_read_b128 v[88:91], v7 offset:12288
    ds_read_b128 v[92:95], v7 offset:14336
    s_waitcnt lgkmcnt(4)
    v_mfma_f32_16x16x32_bf16 v[128:131], v[48:51], v[64:67], v[128:131]
    v_mfma_f32_16x16x32_bf16 v[132:135], v[52:55], v[64:67], v[132:135]
    v_mfma_f32_16x16x32_bf16 v[136:139], v[56:59], v[64:67], v[136:139]
    v_mfma_f32_16x16x32_bf16 v[140:143], v[60:63], v[64:67], v[140:143]
    v_mfma_f32_16x16x32_bf16 v[144:147], v[48:51], v[68:71], v[144:147]
    v_mfma_f32_16x16x32_bf16 v[148:151], v[52:55], v[68:71], v[148:151]
    v_mfma_f32_16x16x32_bf16 v[152:155], v[56:59], v[68:71], v[152:155]
    v_mfma_f32_16x16x32_bf16 v[156:159], v[60:63], v[68:71], v[156:159]
    v_mfma_f32_16x16x32_bf16 v[160:163], v[48:51], v[72:75], v[160:163]
    v_mfma_f32_16x16x32_bf16 v[164:167], v[52:55], v[72:75], v[164:167]
    v_mfma_f32_16x16x32_bf16 v[168:171], v[56:59], v[72:75], v[168:171]
    v_mfma_f32_16x16x32_bf16 v[172:175], v[60:63], v[72:75], v[172:175]
    v_mfma_f32_16x16x32_bf16 v[176:179], v[48:51], v[76:79], v[176:179]
    v_mfma_f32_16x16x32_bf16 v[180:183], v[52:55], v[76:79], v[180:183]
    v_mfma_f32_16x16x32_bf16 v[184:187], v[56:59], v[76:79], v[184:187]
    v_mfma_f32_16x16x32_bf16 v[188:191], v[60:63], v[76:79], v[188:191]
    s_waitcnt lgkmcnt(0)
    v_mfma_f32_16x16x32_bf16 v[192:195], v[48:51], v[80:83], v[192:195]
    v_mfma_f32_16x16x32_bf16 v[196:199], v[52:55], v[80:83], v[196:199]
    v_mfma_f32_16x16x32_bf16 v[200:203], v[56:59], v[80:83], v[200:203]
    v_mfma_f32_16x16x32_bf16 v[204:207], v[60:63], v[80:83], v[204:207]
    v_mfma_f32_16x16x32_bf16 v[208:211], v[48:51], v[84:87], v[208:211]
    v_mfma_f32_16x16x32_bf16 v[212:215], v[52:55], v[84:87], v[212:215]
    v_mfma_f32_16x16x32_bf16 v[216:219], v[56:59], v[84:87], v[216:219]
    v_mfma_f32_16x16x32_bf16 v[220:223], v[60:63], v[84:87], v[220:223]
    v_mfma_f32_16x16x32_bf16 v[224:227], v[48:51], v[88:91], v[224:227]
    v_mfma_f32_16x16x32_bf16 v[228:231], v[52:55], v[88:91], v[228:231]
    v_mfma_f32_16x16x32_bf16 v[232:235], v[56:59], v[88:91], v[232:235]
    v_mfma_f32_16x16x32_bf16 v[236:239], v[60:63], v[88:91], v[236:239]
    v_mfma_f32_16x16x32_bf16 v[240:243], v[48:51], v[92:95], v[240:243]
    v_mfma_f32_16x16x32_bf16 v[244:247], v[52:55], v[92:95], v[244:247]
    v_mfma_f32_16x16x32_bf16 v[248:251], v[56:59], v[92:95], v[248:251]
    v_mfma_f32_16x16x32_bf16 v[252:255], v[60:63], v[92:95], v[252:255]
    s_cmp_lg_u32 s30, 4
    s_cbranch_scc1 L_lp_30
    s_add_u32 s35, s83, 1920
    buffer_load_dword v26, v115, s[8:11], s35 offen
    s_add_u32 s35, s88, 7864320
    buffer_load_dword v27, v126, s[12:15], s35 offen
L_lp_30:
    s_cmp_eq_u32 s30, 4
    s_cbranch_scc1 L_lw_31
    s_waitcnt vmcnt(0)
L_lw_31:
    s_waitcnt vmcnt(2)
    s_barrier
    s_lshr_b32 s81, s30, 1
    s_cmp_lg_u32 s81, 2
    s_cbranch_scc1 L_qp_32
    s_and_b32 s81, s49, 1
    s_lshl_b32 s81, s81, 6
    s_add_u32 s81, s81, s54
    s_mul_i32 s81, s81, 896
    s_lshl_b32 s82, s30, 7
    s_add_u32 s81, s81, s82
    v_mul_u32_u24 v18, 896, v1
    buffer_load_dword v20, v18, s[44:47], s81 offen
L_qp_32:
    ds_read_b64_tr_b16 v[32:33], v14 offset:0
    ds_read_b64_tr_b16 v[34:35], v14 offset:2048
    ds_read_b64_tr_b16 v[36:37], v15 offset:0
    ds_read_b64_tr_b16 v[38:39], v15 offset:2048
    ds_read_b64_tr_b16 v[40:41], v16 offset:0
    ds_read_b64_tr_b16 v[42:43], v16 offset:2048
    ds_read_b64_tr_b16 v[44:45], v17 offset:0
    ds_read_b64_tr_b16 v[46:47], v17 offset:2048
    ds_read_b128 v[64:67], v8 offset:0
    ds_read_b128 v[68:71], v8 offset:2048
    ds_read_b128 v[72:75], v8 offset:4096
    ds_read_b128 v[76:79], v8 offset:6144
    ds_read_b128 v[80:83], v8 offset:8192
    ds_read_b128 v[84:87], v8 offset:10240
    ds_read_b128 v[88:91], v8 offset:12288
    ds_read_b128 v[92:95], v8 offset:14336
    s_waitcnt lgkmcnt(4)
    s_add_u32 m0, s31, 0
    s_add_u32 s35, s33, 1792
    buffer_load_dwordx4 v2, s[8:11], s35 offen lds
    s_add_u32 m0, s31, 1024
    s_add_u32 s35, s33, 18176
    buffer_load_dwordx4 v3, s[8:11], s35 offen lds
    s_add_u32 m0, s31, 2048
    s_add_u32 s35, s33, 34560
    buffer_load_dwordx4 v2, s[8:11], s35 offen lds
    s_add_u32 m0, s31, 3072
    s_add_u32 s35, s33, 50944
    buffer_load_dwordx4 v3, s[8:11], s35 offen lds
    v_mfma_f32_16x16x32_bf16 v[128:131], v[32:35], v[64:67], v[128:131]
    v_mfma_f32_16x16x32_bf16 v[132:135], v[36:39], v[64:67], v[132:135]
    v_mfma_f32_16x16x32_bf16 v[136:139], v[40:43], v[64:67], v[136:139]
    v_mfma_f32_16x16x32_bf16 v[140:143], v[44:47], v[64:67], v[140:143]
    v_mfma_f32_16x16x32_bf16 v[144:147], v[32:35], v[68:71], v[144:147]
    v_mfma_f32_16x16x32_bf16 v[148:151], v[36:39], v[68:71], v[148:151]
    v_mfma_f32_16x16x32_bf16 v[152:155], v[40:43], v[68:71], v[152:155]
    v_mfma_f32_16x16x32_bf16 v[156:159], v[44:47], v[68:71], v[156:159]
    v_mfma_f32_16x16x32_bf16 v[160:163], v[32:35], v[72:75], v[160:163]
    v_mfma_f32_16x16x32_bf16 v[164:167], v[36:39], v[72:75], v[164:167]
    v_mfma_f32_16x16x32_bf16 v[168:171], v[40:43], v[72:75], v[168:171]
    v_mfma_f32_16x16x32_bf16 v[172:175], v[44:47], v[72:75], v[172:175]
    v_mfma_f32_16x16x32_bf16 v[176:179], v[32:35], v[76:79], v[176:179]
    v_mfma_f32_16x16x32_bf16 v[180:183], v[36:39], v[76:79], v[180:183]
    v_mfma_f32_16x16x32_bf16 v[184:187], v[40:43], v[76:79], v[184:187]
    v_mfma_f32_16x16x32_bf16 v[188:191], v[44:47], v[76:79], v[188:191]
    ds_read_b64_tr_b16 v[48:49], v14 offset:16384
    ds_read_b64_tr_b16 v[50:51], v14 offset:18432
    ds_read_b64_tr_b16 v[52:53], v15 offset:16384
    ds_read_b64_tr_b16 v[54:55], v15 offset:18432
    ds_read_b64_tr_b16 v[56:57], v16 offset:16384
    ds_read_b64_tr_b16 v[58:59], v16 offset:18432
    ds_read_b64_tr_b16 v[60:61], v17 offset:16384
    ds_read_b64_tr_b16 v[62:63], v17 offset:18432
    ds_read_b128 v[64:67], v9 offset:0
    ds_read_b128 v[68:71], v9 offset:2048
    ds_read_b128 v[72:75], v9 offset:4096
    ds_read_b128 v[76:79], v9 offset:6144
    s_waitcnt lgkmcnt(12)
    s_add_u32 m0, s32, 32768
    s_add_u32 s35, s34, 7340032
    buffer_load_dwordx4 v4, s[12:15], s35 offen lds
    s_add_u32 m0, s32, 33792
    s_add_u32 s35, s34, 7356416
    buffer_load_dwordx4 v5, s[12:15], s35 offen lds
    s_add_u32 m0, s32, 34816
    s_add_u32 s35, s34, 7372800
    buffer_load_dwordx4 v4, s[12:15], s35 offen lds
    s_add_u32 m0, s32, 35840
    s_add_u32 s35, s34, 7389184
    buffer_load_dwordx4 v5, s[12:15], s35 offen lds
    v_mfma_f32_16x16x32_bf16 v[192:195], v[32:35], v[80:83], v[192:195]
    v_mfma_f32_16x16x32_bf16 v[196:199], v[36:39], v[80:83], v[196:199]
    v_mfma_f32_16x16x32_bf16 v[200:203], v[40:43], v[80:83], v[200:203]
    v_mfma_f32_16x16x32_bf16 v[204:207], v[44:47], v[80:83], v[204:207]
    v_mfma_f32_16x16x32_bf16 v[208:211], v[32:35], v[84:87], v[208:211]
    v_mfma_f32_16x16x32_bf16 v[212:215], v[36:39], v[84:87], v[212:215]
    v_mfma_f32_16x16x32_bf16 v[216:219], v[40:43], v[84:87], v[216:219]
    v_mfma_f32_16x16x32_bf16 v[220:223], v[44:47], v[84:87], v[220:223]
    v_mfma_f32_16x16x32_bf16 v[224:227], v[32:35], v[88:91], v[224:227]
    v_mfma_f32_16x16x32_bf16 v[228:231], v[36:39], v[88:91], v[228:231]
    v_mfma_f32_16x16x32_bf16 v[232:235], v[40:43], v[88:91], v[232:235]
    v_mfma_f32_16x16x32_bf16 v[236:239], v[44:47], v[88:91], v[236:239]
    v_mfma_f32_16x16x32_bf16 v[240:243], v[32:35], v[92:95], v[240:243]
    v_mfma_f32_16x16x32_bf16 v[244:247], v[36:39], v[92:95], v[244:247]
    v_mfma_f32_16x16x32_bf16 v[248:251], v[40:43], v[92:95], v[248:251]
    v_mfma_f32_16x16x32_bf16 v[252:255], v[44:47], v[92:95], v[252:255]
    ds_read_b128 v[80:83], v9 offset:8192
    ds_read_b128 v[84:87], v9 offset:10240
    ds_read_b128 v[88:91], v9 offset:12288
    ds_read_b128 v[92:95], v9 offset:14336
    s_waitcnt lgkmcnt(4)
    v_mfma_f32_16x16x32_bf16 v[128:131], v[48:51], v[64:67], v[128:131]
    v_mfma_f32_16x16x32_bf16 v[132:135], v[52:55], v[64:67], v[132:135]
    v_mfma_f32_16x16x32_bf16 v[136:139], v[56:59], v[64:67], v[136:139]
    v_mfma_f32_16x16x32_bf16 v[140:143], v[60:63], v[64:67], v[140:143]
    v_mfma_f32_16x16x32_bf16 v[144:147], v[48:51], v[68:71], v[144:147]
    v_mfma_f32_16x16x32_bf16 v[148:151], v[52:55], v[68:71], v[148:151]
    v_mfma_f32_16x16x32_bf16 v[152:155], v[56:59], v[68:71], v[152:155]
    v_mfma_f32_16x16x32_bf16 v[156:159], v[60:63], v[68:71], v[156:159]
    v_mfma_f32_16x16x32_bf16 v[160:163], v[48:51], v[72:75], v[160:163]
    v_mfma_f32_16x16x32_bf16 v[164:167], v[52:55], v[72:75], v[164:167]
    v_mfma_f32_16x16x32_bf16 v[168:171], v[56:59], v[72:75], v[168:171]
    v_mfma_f32_16x16x32_bf16 v[172:175], v[60:63], v[72:75], v[172:175]
    v_mfma_f32_16x16x32_bf16 v[176:179], v[48:51], v[76:79], v[176:179]
    v_mfma_f32_16x16x32_bf16 v[180:183], v[52:55], v[76:79], v[180:183]
    v_mfma_f32_16x16x32_bf16 v[184:187], v[56:59], v[76:79], v[184:187]
    v_mfma_f32_16x16x32_bf16 v[188:191], v[60:63], v[76:79], v[188:191]
    s_waitcnt lgkmcnt(0)
    v_mfma_f32_16x16x32_bf16 v[192:195], v[48:51], v[80:83], v[192:195]
    v_mfma_f32_16x16x32_bf16 v[196:199], v[52:55], v[80:83], v[196:199]
    v_mfma_f32_16x16x32_bf16 v[200:203], v[56:59], v[80:83], v[200:203]
    v_mfma_f32_16x16x32_bf16 v[204:207], v[60:63], v[80:83], v[204:207]
    v_mfma_f32_16x16x32_bf16 v[208:211], v[48:51], v[84:87], v[208:211]
    v_mfma_f32_16x16x32_bf16 v[212:215], v[52:55], v[84:87], v[212:215]
    v_mfma_f32_16x16x32_bf16 v[216:219], v[56:59], v[84:87], v[216:219]
    v_mfma_f32_16x16x32_bf16 v[220:223], v[60:63], v[84:87], v[220:223]
    v_mfma_f32_16x16x32_bf16 v[224:227], v[48:51], v[88:91], v[224:227]
    v_mfma_f32_16x16x32_bf16 v[228:231], v[52:55], v[88:91], v[228:231]
    v_mfma_f32_16x16x32_bf16 v[232:235], v[56:59], v[88:91], v[232:235]
    v_mfma_f32_16x16x32_bf16 v[236:239], v[60:63], v[88:91], v[236:239]
    v_mfma_f32_16x16x32_bf16 v[240:243], v[48:51], v[92:95], v[240:243]
    v_mfma_f32_16x16x32_bf16 v[244:247], v[52:55], v[92:95], v[244:247]
    v_mfma_f32_16x16x32_bf16 v[248:251], v[56:59], v[92:95], v[248:251]
    v_mfma_f32_16x16x32_bf16 v[252:255], v[60:63], v[92:95], v[252:255]
    s_waitcnt vmcnt(0)
    s_barrier
    s_lshr_b32 s81, s30, 1
    s_cmp_lg_u32 s81, 3
    s_cbranch_scc1 L_qp_33
    s_and_b32 s81, s49, 1
    s_lshl_b32 s81, s81, 6
    s_add_u32 s81, s81, s54
    s_mul_i32 s81, s81, 896
    s_lshl_b32 s82, s30, 7
    s_add_u32 s81, s81, s82
    v_mul_u32_u24 v18, 896, v1
    s_cmp_eq_u32 s30, 7
    s_cbranch_scc1 L_qp_33_w
    buffer_load_dword v20, v18, s[44:47], s81 offen
    s_branch L_qp_33
L_qp_33_w:
    s_mov_b32 s72, s20
    s_mov_b32 s73, s21
    s_mov_b32 s74, 3670016
    s_mov_b32 s75, 0x00020000
    s_lshr_b32 s81, s49, 1
    s_mul_i32 s81, s81, 28
    s_lshl_b32 s81, s81, 13
    s_add_u32 s81, s81, s55
    v_lshrrev_b32 v19, 2, v1
    v_lshlrev_b32 v19, 13, v19
    v_and_b32 v21, 3, v1
    v_lshl_add_u32 v19, v21, 7, v19
    buffer_load_dword v21, v19, s[72:75], s81 offen
    s_add_u32 s81, s81, 131072
    buffer_load_dword v20, v19, s[72:75], s81 offen
L_qp_33:
    ds_read_b64_tr_b16 v[32:33], v10 offset:0
    ds_read_b64_tr_b16 v[34:35], v10 offset:2048
    ds_read_b64_tr_b16 v[36:37], v11 offset:0
    ds_read_b64_tr_b16 v[38:39], v11 offset:2048
    ds_read_b64_tr_b16 v[40:41], v12 offset:0
    ds_read_b64_tr_b16 v[42:43], v12 offset:2048
    ds_read_b64_tr_b16 v[44:45], v13 offset:0
    ds_read_b64_tr_b16 v[46:47], v13 offset:2048
    ds_read_b128 v[64:67], v6 offset:0
    ds_read_b128 v[68:71], v6 offset:2048
    ds_read_b128 v[72:75], v6 offset:4096
    ds_read_b128 v[76:79], v6 offset:6144
    ds_read_b128 v[80:83], v6 offset:8192
    ds_read_b128 v[84:87], v6 offset:10240
    ds_read_b128 v[88:91], v6 offset:12288
    ds_read_b128 v[92:95], v6 offset:14336
    s_waitcnt lgkmcnt(4)
    s_add_u32 m0, s31, 65536
    s_add_u32 s35, s33, 1920
    buffer_load_dwordx4 v2, s[8:11], s35 offen lds
    s_add_u32 m0, s31, 66560
    s_add_u32 s35, s33, 18304
    buffer_load_dwordx4 v3, s[8:11], s35 offen lds
    s_add_u32 m0, s31, 67584
    s_add_u32 s35, s33, 34688
    buffer_load_dwordx4 v2, s[8:11], s35 offen lds
    s_add_u32 m0, s31, 68608
    s_add_u32 s35, s33, 51072
    buffer_load_dwordx4 v3, s[8:11], s35 offen lds
    v_mfma_f32_16x16x32_bf16 v[128:131], v[32:35], v[64:67], v[128:131]
    v_mfma_f32_16x16x32_bf16 v[132:135], v[36:39], v[64:67], v[132:135]
    v_mfma_f32_16x16x32_bf16 v[136:139], v[40:43], v[64:67], v[136:139]
    v_mfma_f32_16x16x32_bf16 v[140:143], v[44:47], v[64:67], v[140:143]
    v_mfma_f32_16x16x32_bf16 v[144:147], v[32:35], v[68:71], v[144:147]
    v_mfma_f32_16x16x32_bf16 v[148:151], v[36:39], v[68:71], v[148:151]
    v_mfma_f32_16x16x32_bf16 v[152:155], v[40:43], v[68:71], v[152:155]
    v_mfma_f32_16x16x32_bf16 v[156:159], v[44:47], v[68:71], v[156:159]
    v_mfma_f32_16x16x32_bf16 v[160:163], v[32:35], v[72:75], v[160:163]
    v_mfma_f32_16x16x32_bf16 v[164:167], v[36:39], v[72:75], v[164:167]
    v_mfma_f32_16x16x32_bf16 v[168:171], v[40:43], v[72:75], v[168:171]
    v_mfma_f32_16x16x32_bf16 v[172:175], v[44:47], v[72:75], v[172:175]
    v_mfma_f32_16x16x32_bf16 v[176:179], v[32:35], v[76:79], v[176:179]
    v_mfma_f32_16x16x32_bf16 v[180:183], v[36:39], v[76:79], v[180:183]
    v_mfma_f32_16x16x32_bf16 v[184:187], v[40:43], v[76:79], v[184:187]
    v_mfma_f32_16x16x32_bf16 v[188:191], v[44:47], v[76:79], v[188:191]
    ds_read_b64_tr_b16 v[48:49], v10 offset:16384
    ds_read_b64_tr_b16 v[50:51], v10 offset:18432
    ds_read_b64_tr_b16 v[52:53], v11 offset:16384
    ds_read_b64_tr_b16 v[54:55], v11 offset:18432
    ds_read_b64_tr_b16 v[56:57], v12 offset:16384
    ds_read_b64_tr_b16 v[58:59], v12 offset:18432
    ds_read_b64_tr_b16 v[60:61], v13 offset:16384
    ds_read_b64_tr_b16 v[62:63], v13 offset:18432
    ds_read_b128 v[64:67], v7 offset:0
    ds_read_b128 v[68:71], v7 offset:2048
    ds_read_b128 v[72:75], v7 offset:4096
    ds_read_b128 v[76:79], v7 offset:6144
    s_waitcnt lgkmcnt(12)
    s_add_u32 m0, s32, 98304
    s_add_u32 s35, s34, 7864320
    buffer_load_dwordx4 v4, s[12:15], s35 offen lds
    s_add_u32 m0, s32, 99328
    s_add_u32 s35, s34, 7880704
    buffer_load_dwordx4 v5, s[12:15], s35 offen lds
    s_add_u32 m0, s32, 100352
    s_add_u32 s35, s34, 7897088
    buffer_load_dwordx4 v4, s[12:15], s35 offen lds
    s_add_u32 m0, s32, 101376
    s_add_u32 s35, s34, 7913472
    buffer_load_dwordx4 v5, s[12:15], s35 offen lds
    v_mfma_f32_16x16x32_bf16 v[192:195], v[32:35], v[80:83], v[192:195]
    v_mfma_f32_16x16x32_bf16 v[196:199], v[36:39], v[80:83], v[196:199]
    v_mfma_f32_16x16x32_bf16 v[200:203], v[40:43], v[80:83], v[200:203]
    v_mfma_f32_16x16x32_bf16 v[204:207], v[44:47], v[80:83], v[204:207]
    v_mfma_f32_16x16x32_bf16 v[208:211], v[32:35], v[84:87], v[208:211]
    v_mfma_f32_16x16x32_bf16 v[212:215], v[36:39], v[84:87], v[212:215]
    v_mfma_f32_16x16x32_bf16 v[216:219], v[40:43], v[84:87], v[216:219]
    v_mfma_f32_16x16x32_bf16 v[220:223], v[44:47], v[84:87], v[220:223]
    v_mfma_f32_16x16x32_bf16 v[224:227], v[32:35], v[88:91], v[224:227]
    v_mfma_f32_16x16x32_bf16 v[228:231], v[36:39], v[88:91], v[228:231]
    v_mfma_f32_16x16x32_bf16 v[232:235], v[40:43], v[88:91], v[232:235]
    v_mfma_f32_16x16x32_bf16 v[236:239], v[44:47], v[88:91], v[236:239]
    v_mfma_f32_16x16x32_bf16 v[240:243], v[32:35], v[92:95], v[240:243]
    v_mfma_f32_16x16x32_bf16 v[244:247], v[36:39], v[92:95], v[244:247]
    v_mfma_f32_16x16x32_bf16 v[248:251], v[40:43], v[92:95], v[248:251]
    v_mfma_f32_16x16x32_bf16 v[252:255], v[44:47], v[92:95], v[252:255]
    ds_read_b128 v[80:83], v7 offset:8192
    ds_read_b128 v[84:87], v7 offset:10240
    ds_read_b128 v[88:91], v7 offset:12288
    ds_read_b128 v[92:95], v7 offset:14336
    s_waitcnt lgkmcnt(4)
    v_mfma_f32_16x16x32_bf16 v[128:131], v[48:51], v[64:67], v[128:131]
    v_mfma_f32_16x16x32_bf16 v[132:135], v[52:55], v[64:67], v[132:135]
    v_mfma_f32_16x16x32_bf16 v[136:139], v[56:59], v[64:67], v[136:139]
    v_mfma_f32_16x16x32_bf16 v[140:143], v[60:63], v[64:67], v[140:143]
    v_mfma_f32_16x16x32_bf16 v[144:147], v[48:51], v[68:71], v[144:147]
    v_mfma_f32_16x16x32_bf16 v[148:151], v[52:55], v[68:71], v[148:151]
    v_mfma_f32_16x16x32_bf16 v[152:155], v[56:59], v[68:71], v[152:155]
    v_mfma_f32_16x16x32_bf16 v[156:159], v[60:63], v[68:71], v[156:159]
    v_mfma_f32_16x16x32_bf16 v[160:163], v[48:51], v[72:75], v[160:163]
    v_mfma_f32_16x16x32_bf16 v[164:167], v[52:55], v[72:75], v[164:167]
    v_mfma_f32_16x16x32_bf16 v[168:171], v[56:59], v[72:75], v[168:171]
    v_mfma_f32_16x16x32_bf16 v[172:175], v[60:63], v[72:75], v[172:175]
    v_mfma_f32_16x16x32_bf16 v[176:179], v[48:51], v[76:79], v[176:179]
    v_mfma_f32_16x16x32_bf16 v[180:183], v[52:55], v[76:79], v[180:183]
    v_mfma_f32_16x16x32_bf16 v[184:187], v[56:59], v[76:79], v[184:187]
    v_mfma_f32_16x16x32_bf16 v[188:191], v[60:63], v[76:79], v[188:191]
    s_waitcnt lgkmcnt(0)
    v_mfma_f32_16x16x32_bf16 v[192:195], v[48:51], v[80:83], v[192:195]
    v_mfma_f32_16x16x32_bf16 v[196:199], v[52:55], v[80:83], v[196:199]
    v_mfma_f32_16x16x32_bf16 v[200:203], v[56:59], v[80:83], v[200:203]
    v_mfma_f32_16x16x32_bf16 v[204:207], v[60:63], v[80:83], v[204:207]
    v_mfma_f32_16x16x32_bf16 v[208:211], v[48:51], v[84:87], v[208:211]
    v_mfma_f32_16x16x32_bf16 v[212:215], v[52:55], v[84:87], v[212:215]
    v_mfma_f32_16x16x32_bf16 v[216:219], v[56:59], v[84:87], v[216:219]
    v_mfma_f32_16x16x32_bf16 v[220:223], v[60:63], v[84:87], v[220:223]
    v_mfma_f32_16x16x32_bf16 v[224:227], v[48:51], v[88:91], v[224:227]
    v_mfma_f32_16x16x32_bf16 v[228:231], v[52:55], v[88:91], v[228:231]
    v_mfma_f32_16x16x32_bf16 v[232:235], v[56:59], v[88:91], v[232:235]
    v_mfma_f32_16x16x32_bf16 v[236:239], v[60:63], v[88:91], v[236:239]
    v_mfma_f32_16x16x32_bf16 v[240:243], v[48:51], v[92:95], v[240:243]
    v_mfma_f32_16x16x32_bf16 v[244:247], v[52:55], v[92:95], v[244:247]
    v_mfma_f32_16x16x32_bf16 v[248:251], v[56:59], v[92:95], v[248:251]
    v_mfma_f32_16x16x32_bf16 v[252:255], v[60:63], v[92:95], v[252:255]
    s_waitcnt vmcnt(0)
    s_barrier
    ds_read_b64_tr_b16 v[32:33], v14 offset:0
    ds_read_b64_tr_b16 v[34:35], v14 offset:2048
    ds_read_b64_tr_b16 v[36:37], v15 offset:0
    ds_read_b64_tr_b16 v[38:39], v15 offset:2048
    ds_read_b64_tr_b16 v[40:41], v16 offset:0
    ds_read_b64_tr_b16 v[42:43], v16 offset:2048
    ds_read_b64_tr_b16 v[44:45], v17 offset:0
    ds_read_b64_tr_b16 v[46:47], v17 offset:2048
    ds_read_b128 v[64:67], v8 offset:0
    ds_read_b128 v[68:71], v8 offset:2048
    ds_read_b128 v[72:75], v8 offset:4096
    ds_read_b128 v[76:79], v8 offset:6144
    ds_read_b128 v[80:83], v8 offset:8192
    ds_read_b128 v[84:87], v8 offset:10240
    ds_read_b128 v[88:91], v8 offset:12288
    ds_read_b128 v[92:95], v8 offset:14336
    s_waitcnt lgkmcnt(4)
    v_mfma_f32_16x16x32_bf16 v[128:131], v[32:35], v[64:67], v[128:131]
    v_mfma_f32_16x16x32_bf16 v[132:135], v[36:39], v[64:67], v[132:135]
    v_mfma_f32_16x16x32_bf16 v[136:139], v[40:43], v[64:67], v[136:139]
    v_mfma_f32_16x16x32_bf16 v[140:143], v[44:47], v[64:67], v[140:143]
    v_mfma_f32_16x16x32_bf16 v[144:147], v[32:35], v[68:71], v[144:147]
    v_mfma_f32_16x16x32_bf16 v[148:151], v[36:39], v[68:71], v[148:151]
    v_mfma_f32_16x16x32_bf16 v[152:155], v[40:43], v[68:71], v[152:155]
    v_mfma_f32_16x16x32_bf16 v[156:159], v[44:47], v[68:71], v[156:159]
    v_mfma_f32_16x16x32_bf16 v[160:163], v[32:35], v[72:75], v[160:163]
    v_mfma_f32_16x16x32_bf16 v[164:167], v[36:39], v[72:75], v[164:167]
    v_mfma_f32_16x16x32_bf16 v[168:171], v[40:43], v[72:75], v[168:171]
    v_mfma_f32_16x16x32_bf16 v[172:175], v[44:47], v[72:75], v[172:175]
    v_mfma_f32_16x16x32_bf16 v[176:179], v[32:35], v[76:79], v[176:179]
    v_mfma_f32_16x16x32_bf16 v[180:183], v[36:39], v[76:79], v[180:183]
    v_mfma_f32_16x16x32_bf16 v[184:187], v[40:43], v[76:79], v[184:187]
    v_mfma_f32_16x16x32_bf16 v[188:191], v[44:47], v[76:79], v[188:191]
    ds_read_b64_tr_b16 v[48:49], v14 offset:16384
    ds_read_b64_tr_b16 v[50:51], v14 offset:18432
    ds_read_b64_tr_b16 v[52:53], v15 offset:16384
    ds_read_b64_tr_b16 v[54:55], v15 offset:18432
    ds_read_b64_tr_b16 v[56:57], v16 offset:16384
    ds_read_b64_tr_b16 v[58:59], v16 offset:18432
    ds_read_b64_tr_b16 v[60:61], v17 offset:16384
    ds_read_b64_tr_b16 v[62:63], v17 offset:18432
    ds_read_b128 v[64:67], v9 offset:0
    ds_read_b128 v[68:71], v9 offset:2048
    ds_read_b128 v[72:75], v9 offset:4096
    ds_read_b128 v[76:79], v9 offset:6144
    s_waitcnt lgkmcnt(12)
    v_mfma_f32_16x16x32_bf16 v[192:195], v[32:35], v[80:83], v[192:195]
    v_mfma_f32_16x16x32_bf16 v[196:199], v[36:39], v[80:83], v[196:199]
    v_mfma_f32_16x16x32_bf16 v[200:203], v[40:43], v[80:83], v[200:203]
    v_mfma_f32_16x16x32_bf16 v[204:207], v[44:47], v[80:83], v[204:207]
    v_mfma_f32_16x16x32_bf16 v[208:211], v[32:35], v[84:87], v[208:211]
    v_mfma_f32_16x16x32_bf16 v[212:215], v[36:39], v[84:87], v[212:215]
    v_mfma_f32_16x16x32_bf16 v[216:219], v[40:43], v[84:87], v[216:219]
    v_mfma_f32_16x16x32_bf16 v[220:223], v[44:47], v[84:87], v[220:223]
    v_mfma_f32_16x16x32_bf16 v[224:227], v[32:35], v[88:91], v[224:227]
    v_mfma_f32_16x16x32_bf16 v[228:231], v[36:39], v[88:91], v[228:231]
    v_mfma_f32_16x16x32_bf16 v[232:235], v[40:43], v[88:91], v[232:235]
    v_mfma_f32_16x16x32_bf16 v[236:239], v[44:47], v[88:91], v[236:239]
    v_mfma_f32_16x16x32_bf16 v[240:243], v[32:35], v[92:95], v[240:243]
    v_mfma_f32_16x16x32_bf16 v[244:247], v[36:39], v[92:95], v[244:247]
    v_mfma_f32_16x16x32_bf16 v[248:251], v[40:43], v[92:95], v[248:251]
    v_mfma_f32_16x16x32_bf16 v[252:255], v[44:47], v[92:95], v[252:255]
    ds_read_b128 v[80:83], v9 offset:8192
    ds_read_b128 v[84:87], v9 offset:10240
    ds_read_b128 v[88:91], v9 offset:12288
    ds_read_b128 v[92:95], v9 offset:14336
    s_waitcnt lgkmcnt(4)
    v_mfma_f32_16x16x32_bf16 v[128:131], v[48:51], v[64:67], v[128:131]
    v_mfma_f32_16x16x32_bf16 v[132:135], v[52:55], v[64:67], v[132:135]
    v_mfma_f32_16x16x32_bf16 v[136:139], v[56:59], v[64:67], v[136:139]
    v_mfma_f32_16x16x32_bf16 v[140:143], v[60:63], v[64:67], v[140:143]
    v_mfma_f32_16x16x32_bf16 v[144:147], v[48:51], v[68:71], v[144:147]
    v_mfma_f32_16x16x32_bf16 v[148:151], v[52:55], v[68:71], v[148:151]
    v_mfma_f32_16x16x32_bf16 v[152:155], v[56:59], v[68:71], v[152:155]
    v_mfma_f32_16x16x32_bf16 v[156:159], v[60:63], v[68:71], v[156:159]
    v_mfma_f32_16x16x32_bf16 v[160:163], v[48:51], v[72:75], v[160:163]
    v_mfma_f32_16x16x32_bf16 v[164:167], v[52:55], v[72:75], v[164:167]
    v_mfma_f32_16x16x32_bf16 v[168:171], v[56:59], v[72:75], v[168:171]
    v_mfma_f32_16x16x32_bf16 v[172:175], v[60:63], v[72:75], v[172:175]
    v_mfma_f32_16x16x32_bf16 v[176:179], v[48:51], v[76:79], v[176:179]
    v_mfma_f32_16x16x32_bf16 v[180:183], v[52:55], v[76:79], v[180:183]
    v_mfma_f32_16x16x32_bf16 v[184:187], v[56:59], v[76:79], v[184:187]
    v_mfma_f32_16x16x32_bf16 v[188:191], v[60:63], v[76:79], v[188:191]
    s_waitcnt lgkmcnt(0)
    v_mfma_f32_16x16x32_bf16 v[192:195], v[48:51], v[80:83], v[192:195]
    v_mfma_f32_16x16x32_bf16 v[196:199], v[52:55], v[80:83], v[196:199]
    v_mfma_f32_16x16x32_bf16 v[200:203], v[56:59], v[80:83], v[200:203]
    v_mfma_f32_16x16x32_bf16 v[204:207], v[60:63], v[80:83], v[204:207]
    v_mfma_f32_16x16x32_bf16 v[208:211], v[48:51], v[84:87], v[208:211]
    v_mfma_f32_16x16x32_bf16 v[212:215], v[52:55], v[84:87], v[212:215]
    v_mfma_f32_16x16x32_bf16 v[216:219], v[56:59], v[84:87], v[216:219]
    v_mfma_f32_16x16x32_bf16 v[220:223], v[60:63], v[84:87], v[220:223]
    v_mfma_f32_16x16x32_bf16 v[224:227], v[48:51], v[88:91], v[224:227]
    v_mfma_f32_16x16x32_bf16 v[228:231], v[52:55], v[88:91], v[228:231]
    v_mfma_f32_16x16x32_bf16 v[232:235], v[56:59], v[88:91], v[232:235]
    v_mfma_f32_16x16x32_bf16 v[236:239], v[60:63], v[88:91], v[236:239]
    v_mfma_f32_16x16x32_bf16 v[240:243], v[48:51], v[92:95], v[240:243]
    v_mfma_f32_16x16x32_bf16 v[244:247], v[52:55], v[92:95], v[244:247]
    v_mfma_f32_16x16x32_bf16 v[248:251], v[56:59], v[92:95], v[248:251]
    v_mfma_f32_16x16x32_bf16 v[252:255], v[60:63], v[92:95], v[252:255]
    s_barrier
    s_mov_b32 s8, s4
    s_mov_b32 s9, s5
    s_mov_b32 s10, 1835008
    s_mov_b32 s11, 0x00020000
    s_mov_b32 s12, s20
    s_mov_b32 s13, s21
    s_mov_b32 s14, 3670016
    s_mov_b32 s15, 0x00020000
    v_lshrrev_b32 v18, 3, v1
    v_mul_u32_u24 v19, 896, v18
    v_lshrrev_b32 v20, 4, v1
    v_and_b32 v21, 7, v1
    v_xor_b32 v22, v21, v20
    v_lshl_add_u32 v2, v22, 4, v19
    v_xor_b32 v22, 4, v22
    v_lshl_add_u32 v3, v22, 4, v19
    s_mul_i32 s31, s30, 2048
    s_mul_i32 s33, s30, 16
    s_add_u32 s33, s33, s54
    s_mul_i32 s33, s33, 896
    s_lshl_b32 s34, s30, 16
    s_add_u32 s34, s34, s55
    s_add_u32 m0, s31, 0
    s_add_u32 s35, s33, 0
    buffer_load_dwordx4 v2, s[8:11], s35 offen lds
    s_add_u32 m0, s31, 1024
    s_add_u32 s35, s33, 7168
    buffer_load_dwordx4 v3, s[8:11], s35 offen lds
    s_add_u32 m0, s32, 32768
    s_add_u32 s35, s34, 0
    buffer_load_dwordx4 v4, s[12:15], s35 offen lds
    s_add_u32 m0, s32, 33792
    s_add_u32 s35, s34, 16384
    buffer_load_dwordx4 v5, s[12:15], s35 offen lds
    s_add_u32 m0, s32, 34816
    s_add_u32 s35, s34, 32768
    buffer_load_dwordx4 v4, s[12:15], s35 offen lds
    s_add_u32 m0, s32, 35840
    s_add_u32 s35, s34, 49152
    buffer_load_dwordx4 v5, s[12:15], s35 offen lds
    s_add_u32 m0, s31, 65536
    s_add_u32 s35, s33, 128
    buffer_load_dwordx4 v2, s[8:11], s35 offen lds
    s_add_u32 m0, s31, 66560
    s_add_u32 s35, s33, 7296
    buffer_load_dwordx4 v3, s[8:11], s35 offen lds
    s_add_u32 m0, s32, 98304
    s_add_u32 s35, s34, 524288
    buffer_load_dwordx4 v4, s[12:15], s35 offen lds
    s_add_u32 m0, s32, 99328
    s_add_u32 s35, s34, 540672
    buffer_load_dwordx4 v5, s[12:15], s35 offen lds
    s_add_u32 m0, s32, 100352
    s_add_u32 s35, s34, 557056
    buffer_load_dwordx4 v4, s[12:15], s35 offen lds
    s_add_u32 m0, s32, 101376
    s_add_u32 s35, s34, 573440
    buffer_load_dwordx4 v5, s[12:15], s35 offen lds
    s_lshl_b32 s42, s52, 20
    s_lshl_b32 s35, s37, 7
    s_add_u32 s35, s35, s40
    s_lshl_b32 s35, s35, 9
    s_add_u32 s42, s42, s35
    s_lshl_b32 s35, s38, 12
    s_add_u32 s42, s42, s35
    s_add_u32 s56, s42, 0
    s_add_u32 s57, s42, 2048
    s_add_u32 s58, s42, 256
    s_add_u32 s59, s42, 2304
    s_add_u32 s60, s42, 16384
    s_add_u32 s61, s42, 18432
    s_add_u32 s62, s42, 16640
    s_add_u32 s63, s42, 18688
    s_add_u32 s64, s42, 32768
    s_add_u32 s65, s42, 34816
    s_add_u32 s66, s42, 33024
    s_add_u32 s67, s42, 35072
    s_add_u32 s68, s42, 49152
    s_add_u32 s69, s42, 51200
    s_add_u32 s70, s42, 49408
    s_add_u32 s71, s42, 51456
    v_cvt_pk_bf16_f32 v255, v254, v255
    v_cvt_pk_bf16_f32 v254, v252, v253
    v_cvt_pk_bf16_f32 v253, v250, v251
    v_cvt_pk_bf16_f32 v252, v248, v249
    v_cvt_pk_bf16_f32 v251, v246, v247
    v_cvt_pk_bf16_f32 v250, v244, v245
    v_cvt_pk_bf16_f32 v249, v242, v243
    v_cvt_pk_bf16_f32 v248, v240, v241
    v_cvt_pk_bf16_f32 v247, v238, v239
    v_cvt_pk_bf16_f32 v246, v236, v237
    v_cvt_pk_bf16_f32 v245, v234, v235
    v_cvt_pk_bf16_f32 v244, v232, v233
    v_cvt_pk_bf16_f32 v243, v230, v231
    v_cvt_pk_bf16_f32 v242, v228, v229
    v_cvt_pk_bf16_f32 v241, v226, v227
    v_cvt_pk_bf16_f32 v240, v224, v225
    v_cvt_pk_bf16_f32 v239, v222, v223
    v_cvt_pk_bf16_f32 v238, v220, v221
    v_cvt_pk_bf16_f32 v237, v218, v219
    v_cvt_pk_bf16_f32 v236, v216, v217
    v_cvt_pk_bf16_f32 v235, v214, v215
    v_cvt_pk_bf16_f32 v234, v212, v213
    v_cvt_pk_bf16_f32 v233, v210, v211
    v_cvt_pk_bf16_f32 v232, v208, v209
    v_cvt_pk_bf16_f32 v231, v206, v207
    v_cvt_pk_bf16_f32 v230, v204, v205
    v_cvt_pk_bf16_f32 v229, v202, v203
    v_cvt_pk_bf16_f32 v228, v200, v201
    v_cvt_pk_bf16_f32 v227, v198, v199
    v_cvt_pk_bf16_f32 v226, v196, v197
    v_cvt_pk_bf16_f32 v225, v194, v195
    v_cvt_pk_bf16_f32 v224, v192, v193
    v_cvt_pk_bf16_f32 v223, v190, v191
    v_cvt_pk_bf16_f32 v222, v188, v189
    v_cvt_pk_bf16_f32 v221, v186, v187
    v_cvt_pk_bf16_f32 v220, v184, v185
    v_cvt_pk_bf16_f32 v219, v182, v183
    v_cvt_pk_bf16_f32 v218, v180, v181
    v_cvt_pk_bf16_f32 v217, v178, v179
    v_cvt_pk_bf16_f32 v216, v176, v177
    v_cvt_pk_bf16_f32 v215, v174, v175
    v_cvt_pk_bf16_f32 v214, v172, v173
    v_cvt_pk_bf16_f32 v213, v170, v171
    v_cvt_pk_bf16_f32 v212, v168, v169
    v_cvt_pk_bf16_f32 v211, v166, v167
    v_cvt_pk_bf16_f32 v210, v164, v165
    v_cvt_pk_bf16_f32 v209, v162, v163
    v_cvt_pk_bf16_f32 v208, v160, v161
    v_cvt_pk_bf16_f32 v207, v158, v159
    v_cvt_pk_bf16_f32 v206, v156, v157
    v_cvt_pk_bf16_f32 v205, v154, v155
    v_cvt_pk_bf16_f32 v204, v152, v153
    v_cvt_pk_bf16_f32 v203, v150, v151
    v_cvt_pk_bf16_f32 v202, v148, v149
    v_cvt_pk_bf16_f32 v201, v146, v147
    v_cvt_pk_bf16_f32 v200, v144, v145
    v_cvt_pk_bf16_f32 v199, v142, v143
    v_cvt_pk_bf16_f32 v198, v140, v141
    v_cvt_pk_bf16_f32 v197, v138, v139
    v_cvt_pk_bf16_f32 v196, v136, v137
    v_cvt_pk_bf16_f32 v195, v134, v135
    v_cvt_pk_bf16_f32 v194, v132, v133
    v_cvt_pk_bf16_f32 v193, v130, v131
    v_cvt_pk_bf16_f32 v192, v128, v129
    v_and_b32 v28, 15, v1
    v_lshlrev_b32 v28, 4, v28
    v_bfe_u32 v29, v1, 4, 1
    v_lshl_add_u32 v28, v29, 9, v28
    v_lshrrev_b32 v29, 5, v1
    v_lshl_add_u32 v28, v29, 10, v28
    s_branch L_proj_q
L_proj_v:
    s_mov_b32 s12, s24
    s_mov_b32 s13, s25
    s_mov_b32 s14, 8388608
    s_mov_b32 s15, 0x00020000
    s_add_u32 s16, s26, 33554432
    s_addc_u32 s17, s27, 0
    s_mov_b32 s18, 16777216
    s_mov_b32 s19, 0x00020000
    v_lshrrev_b32 v18, 3, v1
    v_mul_u32_u24 v19, 2048, v18
    v_lshrrev_b32 v20, 4, v1
    v_and_b32 v21, 7, v1
    v_xor_b32 v22, v21, v20
    v_lshl_add_u32 v2, v22, 4, v19
    v_xor_b32 v22, 4, v22
    v_lshl_add_u32 v3, v22, 4, v19
    s_mul_i32 s31, s30, 4096
    s_mul_i32 s33, s30, 32
    s_add_u32 s33, s33, s40
    s_mul_i32 s33, s33, 2048
    s_lshl_b32 s34, s30, 16
    s_add_u32 s34, s34, s41
    s_add_u32 m0, s31, 0
    s_add_u32 s35, s33, 0
    buffer_load_dwordx4 v2, s[8:11], s35 offen lds
    s_add_u32 m0, s31, 1024
    s_add_u32 s35, s33, 16384
    buffer_load_dwordx4 v3, s[8:11], s35 offen lds
    s_add_u32 m0, s31, 2048
    s_add_u32 s35, s33, 32768
    buffer_load_dwordx4 v2, s[8:11], s35 offen lds
    s_add_u32 m0, s31, 3072
    s_add_u32 s35, s33, 49152
    buffer_load_dwordx4 v3, s[8:11], s35 offen lds
    s_add_u32 m0, s32, 32768
    s_add_u32 s35, s34, 0
    buffer_load_dwordx4 v4, s[12:15], s35 offen lds
    s_add_u32 m0, s32, 33792
    s_add_u32 s35, s34, 16384
    buffer_load_dwordx4 v5, s[12:15], s35 offen lds
    s_add_u32 m0, s32, 34816
    s_add_u32 s35, s34, 32768
    buffer_load_dwordx4 v4, s[12:15], s35 offen lds
    s_add_u32 m0, s32, 35840
    s_add_u32 s35, s34, 49152
    buffer_load_dwordx4 v5, s[12:15], s35 offen lds
    s_lshl_b32 s80, s2, 3
    s_mov_b32 s64, s56
    s_mov_b32 s65, s57
    s_mov_b32 s66, 1835008
    s_mov_b32 s67, 0x00020000
    s_mov_b32 s68, s58
    s_mov_b32 s69, s59
    s_mov_b32 s70, 1835008
    s_mov_b32 s71, 0x00020000
    s_mov_b32 s72, s60
    s_mov_b32 s73, s61
    s_mov_b32 s74, 3584
    s_mov_b32 s75, 0x00020000
    s_mov_b32 s76, s62
    s_mov_b32 s77, s63
    s_mov_b32 s78, 896
    s_mov_b32 s79, 0x00020000
    s_mov_b32 s84, s86
    s_mov_b32 s85, s87
    s_mov_b32 s86, 3670016
    s_mov_b32 s87, 0x00020000
    s_mov_b32 s44, s4
    s_mov_b32 s45, s5
    s_mov_b32 s46, 1835008
    s_mov_b32 s47, 0x00020000
    v_lshlrev_b32 v18, 4, v1
    s_mul_i32 s81, s2, 14336
    s_lshl_b32 s82, s30, 10
    s_add_u32 s81, s81, s82
    s_add_u32 m0, s82, 131072
    s_nop 0
    buffer_load_dwordx4 v18, s[84:87], s81 offen lds
    s_cmp_ge_u32 s30, 6
    s_cbranch_scc1 L_sd_now2_33
    s_add_u32 m0, s82, 139264
    s_add_u32 s81, s81, 8192
    buffer_load_dwordx4 v18, s[84:87], s81 offen lds
L_sd_now2_33:
    s_add_u32 s81, s80, s30
    s_mul_i32 s81, s81, 896
    v_cmp_gt_u32 vcc, 56, v1
    v_mov_b32 v19, 0x7f000000
    s_nop 0
    v_cndmask_b32 v19, v19, v18, vcc
    buffer_load_dwordx4 v[118:121], v19, s[44:47], s81 offen
    buffer_load_dwordx4 v[122:125], v19, s[76:79], 0 offen
    s_mul_i32 s81, s80, 896
    s_sub_u32 s82, s81, 2688
    v_lshlrev_b32 v18, 1, v0
    v_add_u32 v19, s82, v18
    buffer_load_ushort v96, v19, s[64:67], 0 offen
    v_add_u32 v19, 896, v19
    buffer_load_ushort v97, v19, s[64:67], 0 offen
    v_add_u32 v19, 896, v19
    buffer_load_ushort v98, v19, s[64:67], 0 offen
    v_add_u32 v19, 896, v19
    buffer_load_ushort v99, v19, s[64:67], 0 offen
    v_add_u32 v19, 896, v19
    buffer_load_ushort v100, v19, s[64:67], 0 offen
    v_add_u32 v19, 896, v19
    buffer_load_ushort v101, v19, s[64:67], 0 offen
    v_add_u32 v19, 896, v19
    buffer_load_ushort v102, v19, s[64:67], 0 offen
    v_add_u32 v19, 896, v19
    buffer_load_ushort v103, v19, s[64:67], 0 offen
    v_add_u32 v19, 896, v19
    buffer_load_ushort v104, v19, s[64:67], 0 offen
    v_add_u32 v19, 896, v19
    buffer_load_ushort v105, v19, s[64:67], 0 offen
    v_add_u32 v19, 896, v19
    buffer_load_ushort v106, v19, s[64:67], 0 offen
    v_add_u32 v19, s81, v18
    buffer_load_ushort v107, v19, s[68:71], 0 offen
    v_add_u32 v19, 896, v19
    buffer_load_ushort v108, v19, s[68:71], 0 offen
    v_add_u32 v19, 896, v19
    buffer_load_ushort v109, v19, s[68:71], 0 offen
    v_add_u32 v19, 896, v19
    buffer_load_ushort v110, v19, s[68:71], 0 offen
    v_add_u32 v19, 896, v19
    buffer_load_ushort v111, v19, s[68:71], 0 offen
    v_add_u32 v19, 896, v19
    buffer_load_ushort v112, v19, s[68:71], 0 offen
    v_add_u32 v19, 896, v19
    buffer_load_ushort v113, v19, s[68:71], 0 offen
    v_add_u32 v19, 896, v19
    buffer_load_ushort v114, v19, s[68:71], 0 offen
    v_lshlrev_b32 v20, 3, v0
    buffer_load_dwordx2 v[116:117], v20, s[72:75], 0 offen
    v_and_b32 v18, 15, v1
    v_lshrrev_b32 v19, 4, v1
    v_bfe_u32 v20, v1, 1, 3
    v_xor_b32 v20, v20, v19
    s_mul_i32 s35, s37, 16384
    v_lshlrev_b32 v21, 7, v18
    v_add_u32 v21, s35, v21
    v_lshl_add_u32 v6, v20, 4, v21
    v_xor_b32 v7, 64, v6
    v_add_u32 v8, 0x10000, v6
    v_add_u32 v9, 0x10000, v7
    s_and_b32 s83, s49, 3
    s_lshl_b32 s83, s83, 6
    s_add_u32 s83, s83, s40
    s_lshl_b32 s83, s83, 11
    s_lshr_b32 s88, s49, 2
    s_lshl_b32 s88, s88, 16
    s_add_u32 s88, s88, s41
    v_lshlrev_b32 v115, 11, v1
    v_bfe_u32 v126, v1, 2, 3
    v_lshlrev_b32 v126, 13, v126
    v_and_b32 v127, 3, v1
    v_lshl_add_u32 v126, v127, 7, v126
    s_cmp_lg_u32 s30, 7
    s_cbranch_scc1 L_lp_35
    s_add_u32 s35, s83, 256
    buffer_load_dword v26, v115, s[8:11], s35 offen
    s_add_u32 s35, s88, 1048576
    buffer_load_dword v27, v126, s[12:15], s35 offen
L_lp_35:
    s_cmp_eq_u32 s30, 7
    s_cbranch_scc1 L_lw_36
    s_waitcnt vmcnt(23)
L_lw_36:
    s_waitcnt vmcnt(25)
    s_barrier
    ds_read_b64_tr_b16 v[32:33], v10 offset:0
    ds_read_b64_tr_b16 v[34:35], v10 offset:2048
    ds_read_b64_tr_b16 v[36:37], v11 offset:0
    ds_read_b64_tr_b16 v[38:39], v11 offset:2048
    ds_read_b64_tr_b16 v[40:41], v12 offset:0
    ds_read_b64_tr_b16 v[42:43], v12 offset:2048
    ds_read_b64_tr_b16 v[44:45], v13 offset:0
    ds_read_b64_tr_b16 v[46:47], v13 offset:2048
    ds_read_b128 v[64:67], v6 offset:0
    ds_read_b128 v[68:71], v6 offset:2048
    ds_read_b128 v[72:75], v6 offset:4096
    ds_read_b128 v[76:79], v6 offset:6144
    ds_read_b128 v[80:83], v6 offset:8192
    ds_read_b128 v[84:87], v6 offset:10240
    ds_read_b128 v[88:91], v6 offset:12288
    ds_read_b128 v[92:95], v6 offset:14336
    s_waitcnt lgkmcnt(4)
    s_add_u32 m0, s31, 65536
    s_add_u32 s35, s33, 128
    buffer_load_dwordx4 v2, s[8:11], s35 offen lds
    s_add_u32 m0, s31, 66560
    s_add_u32 s35, s33, 16512
    buffer_load_dwordx4 v3, s[8:11], s35 offen lds
    s_add_u32 m0, s31, 67584
    s_add_u32 s35, s33, 32896
    buffer_load_dwordx4 v2, s[8:11], s35 offen lds
    s_add_u32 m0, s31, 68608
    s_add_u32 s35, s33, 49280
    buffer_load_dwordx4 v3, s[8:11], s35 offen lds
    v_mfma_f32_16x16x32_bf16 v[128:131], v[64:67], v[32:35], 0
    v_mfma_f32_16x16x32_bf16 v[132:135], v[64:67], v[36:39], 0
    v_mfma_f32_16x16x32_bf16 v[136:139], v[64:67], v[40:43], 0
    v_mfma_f32_16x16x32_bf16 v[140:143], v[64:67], v[44:47], 0
    v_mfma_f32_16x16x32_bf16 v[144:147], v[68:71], v[32:35], 0
    v_mfma_f32_16x16x32_bf16 v[148:151], v[68:71], v[36:39], 0
    v_mfma_f32_16x16x32_bf16 v[152:155], v[68:71], v[40:43], 0
    v_mfma_f32_16x16x32_bf16 v[156:159], v[68:71], v[44:47], 0
    v_mfma_f32_16x16x32_bf16 v[160:163], v[72:75], v[32:35], 0
    v_mfma_f32_16x16x32_bf16 v[164:167], v[72:75], v[36:39], 0
    v_mfma_f32_16x16x32_bf16 v[168:171], v[72:75], v[40:43], 0
    v_mfma_f32_16x16x32_bf16 v[172:175], v[72:75], v[44:47], 0
    v_mfma_f32_16x16x32_bf16 v[176:179], v[76:79], v[32:35], 0
    v_mfma_f32_16x16x32_bf16 v[180:183], v[76:79], v[36:39], 0
    v_mfma_f32_16x16x32_bf16 v[184:187], v[76:79], v[40:43], 0
    v_mfma_f32_16x16x32_bf16 v[188:191], v[76:79], v[44:47], 0
    ds_read_b64_tr_b16 v[48:49], v10 offset:16384
    ds_read_b64_tr_b16 v[50:51], v10 offset:18432
    ds_read_b64_tr_b16 v[52:53], v11 offset:16384
    ds_read_b64_tr_b16 v[54:55], v11 offset:18432
    ds_read_b64_tr_b16 v[56:57], v12 offset:16384
    ds_read_b64_tr_b16 v[58:59], v12 offset:18432
    ds_read_b64_tr_b16 v[60:61], v13 offset:16384
    ds_read_b64_tr_b16 v[62:63], v13 offset:18432
    ds_read_b128 v[64:67], v7 offset:0
    ds_read_b128 v[68:71], v7 offset:2048
    ds_read_b128 v[72:75], v7 offset:4096
    ds_read_b128 v[76:79], v7 offset:6144
    s_waitcnt lgkmcnt(12)
    s_add_u32 m0, s32, 98304
    s_add_u32 s35, s34, 524288
    buffer_load_dwordx4 v4, s[12:15], s35 offen lds
    s_add_u32 m0, s32, 99328
    s_add_u32 s35, s34, 540672
    buffer_load_dwordx4 v5, s[12:15], s35 offen lds
    s_add_u32 m0, s32, 100352
    s_add_u32 s35, s34, 557056
    buffer_load_dwordx4 v4, s[12:15], s35 offen lds
    s_add_u32 m0, s32, 101376
    s_add_u32 s35, s34, 573440
    buffer_load_dwordx4 v5, s[12:15], s35 offen lds
    v_mfma_f32_16x16x32_bf16 v[192:195], v[80:83], v[32:35], 0
    v_mfma_f32_16x16x32_bf16 v[196:199], v[80:83], v[36:39], 0
    v_mfma_f32_16x16x32_bf16 v[200:203], v[80:83], v[40:43], 0
    v_mfma_f32_16x16x32_bf16 v[204:207], v[80:83], v[44:47], 0
    v_mfma_f32_16x16x32_bf16 v[208:211], v[84:87], v[32:35], 0
    v_mfma_f32_16x16x32_bf16 v[212:215], v[84:87], v[36:39], 0
    v_mfma_f32_16x16x32_bf16 v[216:219], v[84:87], v[40:43], 0
    v_mfma_f32_16x16x32_bf16 v[220:223], v[84:87], v[44:47], 0
    v_mfma_f32_16x16x32_bf16 v[224:227], v[88:91], v[32:35], 0
    v_mfma_f32_16x16x32_bf16 v[228:231], v[88:91], v[36:39], 0
    v_mfma_f32_16x16x32_bf16 v[232:235], v[88:91], v[40:43], 0
    v_mfma_f32_16x16x32_bf16 v[236:239], v[88:91], v[44:47], 0
    v_mfma_f32_16x16x32_bf16 v[240:243], v[92:95], v[32:35], 0
    v_mfma_f32_16x16x32_bf16 v[244:247], v[92:95], v[36:39], 0
    v_mfma_f32_16x16x32_bf16 v[248:251], v[92:95], v[40:43], 0
    v_mfma_f32_16x16x32_bf16 v[252:255], v[92:95], v[44:47], 0
    ds_read_b128 v[80:83], v7 offset:8192
    ds_read_b128 v[84:87], v7 offset:10240
    ds_read_b128 v[88:91], v7 offset:12288
    ds_read_b128 v[92:95], v7 offset:14336
    s_waitcnt lgkmcnt(4)
    v_mfma_f32_16x16x32_bf16 v[128:131], v[64:67], v[48:51], v[128:131]
    v_mfma_f32_16x16x32_bf16 v[132:135], v[64:67], v[52:55], v[132:135]
    v_mfma_f32_16x16x32_bf16 v[136:139], v[64:67], v[56:59], v[136:139]
    v_mfma_f32_16x16x32_bf16 v[140:143], v[64:67], v[60:63], v[140:143]
    v_mfma_f32_16x16x32_bf16 v[144:147], v[68:71], v[48:51], v[144:147]
    v_mfma_f32_16x16x32_bf16 v[148:151], v[68:71], v[52:55], v[148:151]
    v_mfma_f32_16x16x32_bf16 v[152:155], v[68:71], v[56:59], v[152:155]
    v_mfma_f32_16x16x32_bf16 v[156:159], v[68:71], v[60:63], v[156:159]
    v_mfma_f32_16x16x32_bf16 v[160:163], v[72:75], v[48:51], v[160:163]
    v_mfma_f32_16x16x32_bf16 v[164:167], v[72:75], v[52:55], v[164:167]
    v_mfma_f32_16x16x32_bf16 v[168:171], v[72:75], v[56:59], v[168:171]
    v_mfma_f32_16x16x32_bf16 v[172:175], v[72:75], v[60:63], v[172:175]
    v_mfma_f32_16x16x32_bf16 v[176:179], v[76:79], v[48:51], v[176:179]
    v_mfma_f32_16x16x32_bf16 v[180:183], v[76:79], v[52:55], v[180:183]
    v_mfma_f32_16x16x32_bf16 v[184:187], v[76:79], v[56:59], v[184:187]
    v_mfma_f32_16x16x32_bf16 v[188:191], v[76:79], v[60:63], v[188:191]
    s_waitcnt lgkmcnt(0)
    v_mfma_f32_16x16x32_bf16 v[192:195], v[80:83], v[48:51], v[192:195]
    v_mfma_f32_16x16x32_bf16 v[196:199], v[80:83], v[52:55], v[196:199]
    v_mfma_f32_16x16x32_bf16 v[200:203], v[80:83], v[56:59], v[200:203]
    v_mfma_f32_16x16x32_bf16 v[204:207], v[80:83], v[60:63], v[204:207]
    v_mfma_f32_16x16x32_bf16 v[208:211], v[84:87], v[48:51], v[208:211]
    v_mfma_f32_16x16x32_bf16 v[212:215], v[84:87], v[52:55], v[212:215]
    v_mfma_f32_16x16x32_bf16 v[216:219], v[84:87], v[56:59], v[216:219]
    v_mfma_f32_16x16x32_bf16 v[220:223], v[84:87], v[60:63], v[220:223]
    v_mfma_f32_16x16x32_bf16 v[224:227], v[88:91], v[48:51], v[224:227]
    v_mfma_f32_16x16x32_bf16 v[228:231], v[88:91], v[52:55], v[228:231]
    v_mfma_f32_16x16x32_bf16 v[232:235], v[88:91], v[56:59], v[232:235]
    v_mfma_f32_16x16x32_bf16 v[236:239], v[88:91], v[60:63], v[236:239]
    v_mfma_f32_16x16x32_bf16 v[240:243], v[92:95], v[48:51], v[240:243]
    v_mfma_f32_16x16x32_bf16 v[244:247], v[92:95], v[52:55], v[244:247]
    v_mfma_f32_16x16x32_bf16 v[248:251], v[92:95], v[56:59], v[248:251]
    v_mfma_f32_16x16x32_bf16 v[252:255], v[92:95], v[60:63], v[252:255]
    s_cmp_lg_u32 s30, 0
    s_cbranch_scc1 L_lp_37
    s_add_u32 s35, s83, 384
    buffer_load_dword v26, v115, s[8:11], s35 offen
    s_add_u32 s35, s88, 1572864
    buffer_load_dword v27, v126, s[12:15], s35 offen
L_lp_37:
    s_cmp_eq_u32 s30, 0
    s_cbranch_scc1 L_lw_38
    s_waitcnt vmcnt(0)
L_lw_38:
    s_waitcnt vmcnt(2)
    s_barrier
    ds_read_b64_tr_b16 v[32:33], v14 offset:0
    ds_read_b64_tr_b16 v[34:35], v14 offset:2048
    ds_read_b64_tr_b16 v[36:37], v15 offset:0
    ds_read_b64_tr_b16 v[38:39], v15 offset:2048
    ds_read_b64_tr_b16 v[40:41], v16 offset:0
    ds_read_b64_tr_b16 v[42:43], v16 offset:2048
    ds_read_b64_tr_b16 v[44:45], v17 offset:0
    ds_read_b64_tr_b16 v[46:47], v17 offset:2048
    ds_read_b128 v[64:67], v8 offset:0
    ds_read_b128 v[68:71], v8 offset:2048
    ds_read_b128 v[72:75], v8 offset:4096
    ds_read_b128 v[76:79], v8 offset:6144
    ds_read_b128 v[80:83], v8 offset:8192
    ds_read_b128 v[84:87], v8 offset:10240
    ds_read_b128 v[88:91], v8 offset:12288
    ds_read_b128 v[92:95], v8 offset:14336
    s_waitcnt lgkmcnt(4)
    s_add_u32 m0, s31, 0
    s_add_u32 s35, s33, 256
    buffer_load_dwordx4 v2, s[8:11], s35 offen lds
    s_add_u32 m0, s31, 1024
    s_add_u32 s35, s33, 16640
    buffer_load_dwordx4 v3, s[8:11], s35 offen lds
    s_add_u32 m0, s31, 2048
    s_add_u32 s35, s33, 33024
    buffer_load_dwordx4 v2, s[8:11], s35 offen lds
    s_add_u32 m0, s31, 3072
    s_add_u32 s35, s33, 49408
    buffer_load_dwordx4 v3, s[8:11], s35 offen lds
    v_mfma_f32_16x16x32_bf16 v[128:131], v[64:67], v[32:35], v[128:131]
    v_mfma_f32_16x16x32_bf16 v[132:135], v[64:67], v[36:39], v[132:135]
    v_mfma_f32_16x16x32_bf16 v[136:139], v[64:67], v[40:43], v[136:139]
    v_mfma_f32_16x16x32_bf16 v[140:143], v[64:67], v[44:47], v[140:143]
    v_mfma_f32_16x16x32_bf16 v[144:147], v[68:71], v[32:35], v[144:147]
    v_mfma_f32_16x16x32_bf16 v[148:151], v[68:71], v[36:39], v[148:151]
    v_mfma_f32_16x16x32_bf16 v[152:155], v[68:71], v[40:43], v[152:155]
    v_mfma_f32_16x16x32_bf16 v[156:159], v[68:71], v[44:47], v[156:159]
    v_mfma_f32_16x16x32_bf16 v[160:163], v[72:75], v[32:35], v[160:163]
    v_mfma_f32_16x16x32_bf16 v[164:167], v[72:75], v[36:39], v[164:167]
    v_mfma_f32_16x16x32_bf16 v[168:171], v[72:75], v[40:43], v[168:171]
    v_mfma_f32_16x16x32_bf16 v[172:175], v[72:75], v[44:47], v[172:175]
    v_mfma_f32_16x16x32_bf16 v[176:179], v[76:79], v[32:35], v[176:179]
    v_mfma_f32_16x16x32_bf16 v[180:183], v[76:79], v[36:39], v[180:183]
    v_mfma_f32_16x16x32_bf16 v[184:187], v[76:79], v[40:43], v[184:187]
    v_mfma_f32_16x16x32_bf16 v[188:191], v[76:79], v[44:47], v[188:191]
    s_add_u32 s64, s26, 69206016
    s_addc_u32 s65, s27, 0
    s_mov_b32 s66, 1835008
    s_mov_b32 s67, 0x00020000
    s_add_u32 s68, s26, 71303168
    s_addc_u32 s69, s27, 0
    s_mov_b32 s70, 8192
    s_mov_b32 s71, 0x00020000
    s_add_u32 s72, s26, 72351744
    s_addc_u32 s73, s27, 0
    s_mov_b32 s74, 3670016
    s_mov_b32 s75, 0x00020000
    v_lshrrev_b32 v18, 5, v1
    ds_read_b64_tr_b16 v[48:49], v14 offset:16384
    ds_read_b64_tr_b16 v[50:51], v14 offset:18432
    ds_read_b64_tr_b16 v[52:53], v15 offset:16384
    ds_read_b64_tr_b16 v[54:55], v15 offset:18432
    ds_read_b64_tr_b16 v[56:57], v16 offset:16384
    ds_read_b64_tr_b16 v[58:59], v16 offset:18432
    ds_read_b64_tr_b16 v[60:61], v17 offset:16384
    ds_read_b64_tr_b16 v[62:63], v17 offset:18432
    ds_read_b128 v[64:67], v9 offset:0
    ds_read_b128 v[68:71], v9 offset:2048
    ds_read_b128 v[72:75], v9 offset:4096
    ds_read_b128 v[76:79], v9 offset:6144
    s_waitcnt lgkmcnt(12)
    s_add_u32 m0, s32, 32768
    s_add_u32 s35, s34, 1048576
    buffer_load_dwordx4 v4, s[12:15], s35 offen lds
    s_add_u32 m0, s32, 33792
    s_add_u32 s35, s34, 1064960
    buffer_load_dwordx4 v5, s[12:15], s35 offen lds
    s_add_u32 m0, s32, 34816
    s_add_u32 s35, s34, 1081344
    buffer_load_dwordx4 v4, s[12:15], s35 offen lds
    s_add_u32 m0, s32, 35840
    s_add_u32 s35, s34, 1097728
    buffer_load_dwordx4 v5, s[12:15], s35 offen lds
    v_mfma_f32_16x16x32_bf16 v[192:195], v[80:83], v[32:35], v[192:195]
    v_mfma_f32_16x16x32_bf16 v[196:199], v[80:83], v[36:39], v[196:199]
    v_mfma_f32_16x16x32_bf16 v[200:203], v[80:83], v[40:43], v[200:203]
    v_mfma_f32_16x16x32_bf16 v[204:207], v[80:83], v[44:47], v[204:207]
    v_mfma_f32_16x16x32_bf16 v[208:211], v[84:87], v[32:35], v[208:211]
    v_mfma_f32_16x16x32_bf16 v[212:215], v[84:87], v[36:39], v[212:215]
    v_mfma_f32_16x16x32_bf16 v[216:219], v[84:87], v[40:43], v[216:219]
    v_mfma_f32_16x16x32_bf16 v[220:223], v[84:87], v[44:47], v[220:223]
    v_mfma_f32_16x16x32_bf16 v[224:227], v[88:91], v[32:35], v[224:227]
    v_mfma_f32_16x16x32_bf16 v[228:231], v[88:91], v[36:39], v[228:231]
    v_mfma_f32_16x16x32_bf16 v[232:235], v[88:91], v[40:43], v[232:235]
    v_mfma_f32_16x16x32_bf16 v[236:239], v[88:91], v[44:47], v[236:239]
    v_mfma_f32_16x16x32_bf16 v[240:243], v[92:95], v[32:35], v[240:243]
    v_mfma_f32_16x16x32_bf16 v[244:247], v[92:95], v[36:39], v[244:247]
    v_mfma_f32_16x16x32_bf16 v[248:251], v[92:95], v[40:43], v[248:251]
    v_mfma_f32_16x16x32_bf16 v[252:255], v[92:95], v[44:47], v[252:255]
    v_bfe_u32 v19, v1, 2, 2
    v_lshl_add_u32 v18, v18, 2, v19
    v_mul_u32_u24 v18, 896, v18
    v_bfe_u32 v19, v1, 4, 1
    v_lshl_add_u32 v18, v19, 5, v18
    v_and_b32 v19, 3, v1
    v_lshl_add_u32 v18, v19, 3, v18
    s_lshl_b32 s81, s30, 6
    s_add_u32 s81, s81, 131072
    v_add_u32 v18, s81, v18
    ds_read_b64_tr_b16 v[28:29], v18
    ds_read_b64_tr_b16 v[30:31], v18 offset:7168
    ds_read_b64_tr_b16 v[22:23], v18 offset:512
    ds_read_b64_tr_b16 v[24:25], v18 offset:7680
    v_lshlrev_b32 v19, 4, v1
    ds_read_b128 v[80:83], v9 offset:8192
    ds_read_b128 v[84:87], v9 offset:10240
    ds_read_b128 v[88:91], v9 offset:12288
    ds_read_b128 v[92:95], v9 offset:14336
    s_waitcnt lgkmcnt(4)
    v_mfma_f32_16x16x32_bf16 v[128:131], v[64:67], v[48:51], v[128:131]
    v_mfma_f32_16x16x32_bf16 v[132:135], v[64:67], v[52:55], v[132:135]
    v_mfma_f32_16x16x32_bf16 v[136:139], v[64:67], v[56:59], v[136:139]
    v_mfma_f32_16x16x32_bf16 v[140:143], v[64:67], v[60:63], v[140:143]
    v_mfma_f32_16x16x32_bf16 v[144:147], v[68:71], v[48:51], v[144:147]
    v_mfma_f32_16x16x32_bf16 v[148:151], v[68:71], v[52:55], v[148:151]
    v_mfma_f32_16x16x32_bf16 v[152:155], v[68:71], v[56:59], v[152:155]
    v_mfma_f32_16x16x32_bf16 v[156:159], v[68:71], v[60:63], v[156:159]
    v_mfma_f32_16x16x32_bf16 v[160:163], v[72:75], v[48:51], v[160:163]
    v_mfma_f32_16x16x32_bf16 v[164:167], v[72:75], v[52:55], v[164:167]
    v_mfma_f32_16x16x32_bf16 v[168:171], v[72:75], v[56:59], v[168:171]
    v_mfma_f32_16x16x32_bf16 v[172:175], v[72:75], v[60:63], v[172:175]
    v_mfma_f32_16x16x32_bf16 v[176:179], v[76:79], v[48:51], v[176:179]
    v_mfma_f32_16x16x32_bf16 v[180:183], v[76:79], v[52:55], v[180:183]
    v_mfma_f32_16x16x32_bf16 v[184:187], v[76:79], v[56:59], v[184:187]
    v_mfma_f32_16x16x32_bf16 v[188:191], v[76:79], v[60:63], v[188:191]
    s_lshl_b32 s81, s30, 18
    s_lshl_b32 s82, s2, 10
    s_add_u32 s81, s81, s82
    s_waitcnt lgkmcnt(0)
    buffer_store_dwordx4 v[28:31], v19, s[72:75], s81 offen
    s_add_u32 s81, s81, 2097152
    buffer_store_dwordx4 v[22:25], v19, s[72:75], s81 offen
    s_nop 1
    v_mov_b32 v21, 0
    v_lshlrev_b32 v22, 16, v118
    v_lshlrev_b32 v23, 16, v122
    s_waitcnt lgkmcnt(0)
    v_mfma_f32_16x16x32_bf16 v[192:195], v[80:83], v[48:51], v[192:195]
    v_mfma_f32_16x16x32_bf16 v[196:199], v[80:83], v[52:55], v[196:199]
    v_mfma_f32_16x16x32_bf16 v[200:203], v[80:83], v[56:59], v[200:203]
    v_mfma_f32_16x16x32_bf16 v[204:207], v[80:83], v[60:63], v[204:207]
    v_mfma_f32_16x16x32_bf16 v[208:211], v[84:87], v[48:51], v[208:211]
    v_mfma_f32_16x16x32_bf16 v[212:215], v[84:87], v[52:55], v[212:215]
    v_mfma_f32_16x16x32_bf16 v[216:219], v[84:87], v[56:59], v[216:219]
    v_mfma_f32_16x16x32_bf16 v[220:223], v[84:87], v[60:63], v[220:223]
    v_mfma_f32_16x16x32_bf16 v[224:227], v[88:91], v[48:51], v[224:227]
    v_mfma_f32_16x16x32_bf16 v[228:231], v[88:91], v[52:55], v[228:231]
    v_mfma_f32_16x16x32_bf16 v[232:235], v[88:91], v[56:59], v[232:235]
    v_mfma_f32_16x16x32_bf16 v[236:239], v[88:91], v[60:63], v[236:239]
    v_mfma_f32_16x16x32_bf16 v[240:243], v[92:95], v[48:51], v[240:243]
    v_mfma_f32_16x16x32_bf16 v[244:247], v[92:95], v[52:55], v[244:247]
    v_mfma_f32_16x16x32_bf16 v[248:251], v[92:95], v[56:59], v[248:251]
    v_mfma_f32_16x16x32_bf16 v[252:255], v[92:95], v[60:63], v[252:255]
    v_and_b32 v24, 0xffff0000, v118
    v_and_b32 v25, 0xffff0000, v122
    v_mul_f32 v22, v22, v23
    v_mul_f32 v24, v24, v25
    v_cvt_pk_bf16_f32 v22, v22, v24
    v_lshlrev_b32 v23, 16, v22
    v_and_b32 v24, 0xffff0000, v22
    v_add_f32 v21, v21, v23
    v_add_f32 v21, v21, v24
    v_lshlrev_b32 v22, 16, v119
    v_lshlrev_b32 v23, 16, v123
    s_cmp_lg_u32 s30, 1
    s_cbranch_scc1 L_lp_39
    s_add_u32 s35, s83, 512
    buffer_load_dword v26, v115, s[8:11], s35 offen
    s_add_u32 s35, s88, 2097152
    buffer_load_dword v27, v126, s[12:15], s35 offen
L_lp_39:
    s_cmp_eq_u32 s30, 1
    s_cbranch_scc1 L_lw_40
    s_waitcnt vmcnt(0)
L_lw_40:
    s_waitcnt vmcnt(2)
    s_barrier
    ds_read_b64_tr_b16 v[32:33], v10 offset:0
    ds_read_b64_tr_b16 v[34:35], v10 offset:2048
    ds_read_b64_tr_b16 v[36:37], v11 offset:0
    ds_read_b64_tr_b16 v[38:39], v11 offset:2048
    ds_read_b64_tr_b16 v[40:41], v12 offset:0
    ds_read_b64_tr_b16 v[42:43], v12 offset:2048
    ds_read_b64_tr_b16 v[44:45], v13 offset:0
    ds_read_b64_tr_b16 v[46:47], v13 offset:2048
    ds_read_b128 v[64:67], v6 offset:0
    ds_read_b128 v[68:71], v6 offset:2048
    ds_read_b128 v[72:75], v6 offset:4096
    ds_read_b128 v[76:79], v6 offset:6144
    ds_read_b128 v[80:83], v6 offset:8192
    ds_read_b128 v[84:87], v6 offset:10240
    ds_read_b128 v[88:91], v6 offset:12288
    ds_read_b128 v[92:95], v6 offset:14336
    s_waitcnt lgkmcnt(4)
    s_add_u32 m0, s31, 65536
    s_add_u32 s35, s33, 384
    buffer_load_dwordx4 v2, s[8:11], s35 offen lds
    s_add_u32 m0, s31, 66560
    s_add_u32 s35, s33, 16768
    buffer_load_dwordx4 v3, s[8:11], s35 offen lds
    s_add_u32 m0, s31, 67584
    s_add_u32 s35, s33, 33152
    buffer_load_dwordx4 v2, s[8:11], s35 offen lds
    s_add_u32 m0, s31, 68608
    s_add_u32 s35, s33, 49536
    buffer_load_dwordx4 v3, s[8:11], s35 offen lds
    v_mfma_f32_16x16x32_bf16 v[128:131], v[64:67], v[32:35], v[128:131]
    v_mfma_f32_16x16x32_bf16 v[132:135], v[64:67], v[36:39], v[132:135]
    v_mfma_f32_16x16x32_bf16 v[136:139], v[64:67], v[40:43], v[136:139]
    v_mfma_f32_16x16x32_bf16 v[140:143], v[64:67], v[44:47], v[140:143]
    v_mfma_f32_16x16x32_bf16 v[144:147], v[68:71], v[32:35], v[144:147]
    v_mfma_f32_16x16x32_bf16 v[148:151], v[68:71], v[36:39], v[148:151]
    v_mfma_f32_16x16x32_bf16 v[152:155], v[68:71], v[40:43], v[152:155]
    v_mfma_f32_16x16x32_bf16 v[156:159], v[68:71], v[44:47], v[156:159]
    v_mfma_f32_16x16x32_bf16 v[160:163], v[72:75], v[32:35], v[160:163]
    v_mfma_f32_16x16x32_bf16 v[164:167], v[72:75], v[36:39], v[164:167]
    v_mfma_f32_16x16x32_bf16 v[168:171], v[72:75], v[40:43], v[168:171]
    v_mfma_f32_16x16x32_bf16 v[172:175], v[72:75], v[44:47], v[172:175]
    v_mfma_f32_16x16x32_bf16 v[176:179], v[76:79], v[32:35], v[176:179]
    v_mfma_f32_16x16x32_bf16 v[180:183], v[76:79], v[36:39], v[180:183]
    v_mfma_f32_16x16x32_bf16 v[184:187], v[76:79], v[40:43], v[184:187]
    v_mfma_f32_16x16x32_bf16 v[188:191], v[76:79], v[44:47], v[188:191]
    v_and_b32 v24, 0xffff0000, v119
    v_and_b32 v25, 0xffff0000, v123
    v_mul_f32 v22, v22, v23
    v_mul_f32 v24, v24, v25
    v_cvt_pk_bf16_f32 v22, v22, v24
    v_lshlrev_b32 v23, 16, v22
    v_and_b32 v24, 0xffff0000, v22
    v_add_f32 v21, v21, v23
    v_add_f32 v21, v21, v24
    v_lshlrev_b32 v22, 16, v120
    v_lshlrev_b32 v23, 16, v124
    ds_read_b64_tr_b16 v[48:49], v10 offset:16384
    ds_read_b64_tr_b16 v[50:51], v10 offset:18432
    ds_read_b64_tr_b16 v[52:53], v11 offset:16384
    ds_read_b64_tr_b16 v[54:55], v11 offset:18432
    ds_read_b64_tr_b16 v[56:57], v12 offset:16384
    ds_read_b64_tr_b16 v[58:59], v12 offset:18432
    ds_read_b64_tr_b16 v[60:61], v13 offset:16384
    ds_read_b64_tr_b16 v[62:63], v13 offset:18432
    ds_read_b128 v[64:67], v7 offset:0
    ds_read_b128 v[68:71], v7 offset:2048
    ds_read_b128 v[72:75], v7 offset:4096
    ds_read_b128 v[76:79], v7 offset:6144
    s_waitcnt lgkmcnt(12)
    s_add_u32 m0, s32, 98304
    s_add_u32 s35, s34, 1572864
    buffer_load_dwordx4 v4, s[12:15], s35 offen lds
    s_add_u32 m0, s32, 99328
    s_add_u32 s35, s34, 1589248
    buffer_load_dwordx4 v5, s[12:15], s35 offen lds
    s_add_u32 m0, s32, 100352
    s_add_u32 s35, s34, 1605632
    buffer_load_dwordx4 v4, s[12:15], s35 offen lds
    s_add_u32 m0, s32, 101376
    s_add_u32 s35, s34, 1622016
    buffer_load_dwordx4 v5, s[12:15], s35 offen lds
    v_mfma_f32_16x16x32_bf16 v[192:195], v[80:83], v[32:35], v[192:195]
    v_mfma_f32_16x16x32_bf16 v[196:199], v[80:83], v[36:39], v[196:199]
    v_mfma_f32_16x16x32_bf16 v[200:203], v[80:83], v[40:43], v[200:203]
    v_mfma_f32_16x16x32_bf16 v[204:207], v[80:83], v[44:47], v[204:207]
    v_mfma_f32_16x16x32_bf16 v[208:211], v[84:87], v[32:35], v[208:211]
    v_mfma_f32_16x16x32_bf16 v[212:215], v[84:87], v[36:39], v[212:215]
    v_mfma_f32_16x16x32_bf16 v[216:219], v[84:87], v[40:43], v[216:219]
    v_mfma_f32_16x16x32_bf16 v[220:223], v[84:87], v[44:47], v[220:223]
    v_mfma_f32_16x16x32_bf16 v[224:227], v[88:91], v[32:35], v[224:227]
    v_mfma_f32_16x16x32_bf16 v[228:231], v[88:91], v[36:39], v[228:231]
    v_mfma_f32_16x16x32_bf16 v[232:235], v[88:91], v[40:43], v[232:235]
    v_mfma_f32_16x16x32_bf16 v[236:239], v[88:91], v[44:47], v[236:239]
    v_mfma_f32_16x16x32_bf16 v[240:243], v[92:95], v[32:35], v[240:243]
    v_mfma_f32_16x16x32_bf16 v[244:247], v[92:95], v[36:39], v[244:247]
    v_mfma_f32_16x16x32_bf16 v[248:251], v[92:95], v[40:43], v[248:251]
    v_mfma_f32_16x16x32_bf16 v[252:255], v[92:95], v[44:47], v[252:255]
    v_and_b32 v24, 0xffff0000, v120
    v_and_b32 v25, 0xffff0000, v124
    v_mul_f32 v22, v22, v23
    v_mul_f32 v24, v24, v25
    v_cvt_pk_bf16_f32 v22, v22, v24
    v_lshlrev_b32 v23, 16, v22
    v_and_b32 v24, 0xffff0000, v22
    v_add_f32 v21, v21, v23
    v_add_f32 v21, v21, v24
    v_lshlrev_b32 v22, 16, v121
    v_lshlrev_b32 v23, 16, v125
    ds_read_b128 v[80:83], v7 offset:8192
    ds_read_b128 v[84:87], v7 offset:10240
    ds_read_b128 v[88:91], v7 offset:12288
    ds_read_b128 v[92:95], v7 offset:14336
    s_waitcnt lgkmcnt(4)
    v_mfma_f32_16x16x32_bf16 v[128:131], v[64:67], v[48:51], v[128:131]
    v_mfma_f32_16x16x32_bf16 v[132:135], v[64:67], v[52:55], v[132:135]
    v_mfma_f32_16x16x32_bf16 v[136:139], v[64:67], v[56:59], v[136:139]
    v_mfma_f32_16x16x32_bf16 v[140:143], v[64:67], v[60:63], v[140:143]
    v_mfma_f32_16x16x32_bf16 v[144:147], v[68:71], v[48:51], v[144:147]
    v_mfma_f32_16x16x32_bf16 v[148:151], v[68:71], v[52:55], v[148:151]
    v_mfma_f32_16x16x32_bf16 v[152:155], v[68:71], v[56:59], v[152:155]
    v_mfma_f32_16x16x32_bf16 v[156:159], v[68:71], v[60:63], v[156:159]
    v_mfma_f32_16x16x32_bf16 v[160:163], v[72:75], v[48:51], v[160:163]
    v_mfma_f32_16x16x32_bf16 v[164:167], v[72:75], v[52:55], v[164:167]
    v_mfma_f32_16x16x32_bf16 v[168:171], v[72:75], v[56:59], v[168:171]
    v_mfma_f32_16x16x32_bf16 v[172:175], v[72:75], v[60:63], v[172:175]
    v_mfma_f32_16x16x32_bf16 v[176:179], v[76:79], v[48:51], v[176:179]
    v_mfma_f32_16x16x32_bf16 v[180:183], v[76:79], v[52:55], v[180:183]
    v_mfma_f32_16x16x32_bf16 v[184:187], v[76:79], v[56:59], v[184:187]
    v_mfma_f32_16x16x32_bf16 v[188:191], v[76:79], v[60:63], v[188:191]
    v_and_b32 v24, 0xffff0000, v121
    v_and_b32 v25, 0xffff0000, v125
    v_mul_f32 v22, v22, v23
    v_mul_f32 v24, v24, v25
    v_cvt_pk_bf16_f32 v22, v22, v24
    v_lshlrev_b32 v23, 16, v22
    v_and_b32 v24, 0xffff0000, v22
    v_add_f32 v21, v21, v23
    v_add_f32 v21, v21, v24
    ds_swizzle_b32 v22, v21 offset:1055
    s_waitcnt lgkmcnt(0)
    s_waitcnt lgkmcnt(0)
    v_mfma_f32_16x16x32_bf16 v[192:195], v[80:83], v[48:51], v[192:195]
    v_mfma_f32_16x16x32_bf16 v[196:199], v[80:83], v[52:55], v[196:199]
    v_mfma_f32_16x16x32_bf16 v[200:203], v[80:83], v[56:59], v[200:203]
    v_mfma_f32_16x16x32_bf16 v[204:207], v[80:83], v[60:63], v[204:207]
    v_mfma_f32_16x16x32_bf16 v[208:211], v[84:87], v[48:51], v[208:211]
    v_mfma_f32_16x16x32_bf16 v[212:215], v[84:87], v[52:55], v[212:215]
    v_mfma_f32_16x16x32_bf16 v[216:219], v[84:87], v[56:59], v[216:219]
    v_mfma_f32_16x16x32_bf16 v[220:223], v[84:87], v[60:63], v[220:223]
    v_mfma_f32_16x16x32_bf16 v[224:227], v[88:91], v[48:51], v[224:227]
    v_mfma_f32_16x16x32_bf16 v[228:231], v[88:91], v[52:55], v[228:231]
    v_mfma_f32_16x16x32_bf16 v[232:235], v[88:91], v[56:59], v[232:235]
    v_mfma_f32_16x16x32_bf16 v[236:239], v[88:91], v[60:63], v[236:239]
    v_mfma_f32_16x16x32_bf16 v[240:243], v[92:95], v[48:51], v[240:243]
    v_mfma_f32_16x16x32_bf16 v[244:247], v[92:95], v[52:55], v[244:247]
    v_mfma_f32_16x16x32_bf16 v[248:251], v[92:95], v[56:59], v[248:251]
    v_mfma_f32_16x16x32_bf16 v[252:255], v[92:95], v[60:63], v[252:255]
    v_add_f32 v21, v21, v22
    ds_swizzle_b32 v22, v21 offset:2079
    s_waitcnt lgkmcnt(0)
    v_add_f32 v21, v21, v22
    ds_swizzle_b32 v22, v21 offset:4127
    s_waitcnt lgkmcnt(0)
    v_add_f32 v21, v21, v22
    ds_swizzle_b32 v22, v21 offset:8223
    s_waitcnt lgkmcnt(0)
    v_add_f32 v21, v21, v22
    ds_swizzle_b32 v22, v21 offset:16415
    s_waitcnt lgkmcnt(0)
    s_cmp_lg_u32 s30, 2
    s_cbranch_scc1 L_lp_41
    s_add_u32 s35, s83, 640
    buffer_load_dword v26, v115, s[8:11], s35 offen
    s_add_u32 s35, s88, 2621440
    buffer_load_dword v27, v126, s[12:15], s35 offen
L_lp_41:
    s_cmp_eq_u32 s30, 2
    s_cbranch_scc1 L_lw_42
    s_waitcnt vmcnt(0)
L_lw_42:
    s_waitcnt vmcnt(2)
    s_barrier
    ds_read_b64_tr_b16 v[32:33], v14 offset:0
    ds_read_b64_tr_b16 v[34:35], v14 offset:2048
    ds_read_b64_tr_b16 v[36:37], v15 offset:0
    ds_read_b64_tr_b16 v[38:39], v15 offset:2048
    ds_read_b64_tr_b16 v[40:41], v16 offset:0
    ds_read_b64_tr_b16 v[42:43], v16 offset:2048
    ds_read_b64_tr_b16 v[44:45], v17 offset:0
    ds_read_b64_tr_b16 v[46:47], v17 offset:2048
    ds_read_b128 v[64:67], v8 offset:0
    ds_read_b128 v[68:71], v8 offset:2048
    ds_read_b128 v[72:75], v8 offset:4096
    ds_read_b128 v[76:79], v8 offset:6144
    ds_read_b128 v[80:83], v8 offset:8192
    ds_read_b128 v[84:87], v8 offset:10240
    ds_read_b128 v[88:91], v8 offset:12288
    ds_read_b128 v[92:95], v8 offset:14336
    s_waitcnt lgkmcnt(4)
    s_add_u32 m0, s31, 0
    s_add_u32 s35, s33, 512
    buffer_load_dwordx4 v2, s[8:11], s35 offen lds
    s_add_u32 m0, s31, 1024
    s_add_u32 s35, s33, 16896
    buffer_load_dwordx4 v3, s[8:11], s35 offen lds
    s_add_u32 m0, s31, 2048
    s_add_u32 s35, s33, 33280
    buffer_load_dwordx4 v2, s[8:11], s35 offen lds
    s_add_u32 m0, s31, 3072
    s_add_u32 s35, s33, 49664
    buffer_load_dwordx4 v3, s[8:11], s35 offen lds
    v_mfma_f32_16x16x32_bf16 v[128:131], v[64:67], v[32:35], v[128:131]
    v_mfma_f32_16x16x32_bf16 v[132:135], v[64:67], v[36:39], v[132:135]
    v_mfma_f32_16x16x32_bf16 v[136:139], v[64:67], v[40:43], v[136:139]
    v_mfma_f32_16x16x32_bf16 v[140:143], v[64:67], v[44:47], v[140:143]
    v_mfma_f32_16x16x32_bf16 v[144:147], v[68:71], v[32:35], v[144:147]
    v_mfma_f32_16x16x32_bf16 v[148:151], v[68:71], v[36:39], v[148:151]
    v_mfma_f32_16x16x32_bf16 v[152:155], v[68:71], v[40:43], v[152:155]
    v_mfma_f32_16x16x32_bf16 v[156:159], v[68:71], v[44:47], v[156:159]
    v_mfma_f32_16x16x32_bf16 v[160:163], v[72:75], v[32:35], v[160:163]
    v_mfma_f32_16x16x32_bf16 v[164:167], v[72:75], v[36:39], v[164:167]
    v_mfma_f32_16x16x32_bf16 v[168:171], v[72:75], v[40:43], v[168:171]
    v_mfma_f32_16x16x32_bf16 v[172:175], v[72:75], v[44:47], v[172:175]
    v_mfma_f32_16x16x32_bf16 v[176:179], v[76:79], v[32:35], v[176:179]
    v_mfma_f32_16x16x32_bf16 v[180:183], v[76:79], v[36:39], v[180:183]
    v_mfma_f32_16x16x32_bf16 v[184:187], v[76:79], v[40:43], v[184:187]
    v_mfma_f32_16x16x32_bf16 v[188:191], v[76:79], v[44:47], v[188:191]
    v_add_f32 v21, v21, v22
    v_mov_b32 v22, v21
    s_nop 1
    v_permlane32_swap_b32 v21, v22
    v_add_f32 v21, v21, v22
    v_cvt_pk_bf16_f32 v21, v21, v21
    v_lshlrev_b32 v21, 16, v21
    v_mul_f32 v21, 0xbfb8aa3b, v21
    v_exp_f32 v21, v21
    s_nop 0
    v_add_f32 v21, 1.0, v21
    ds_read_b64_tr_b16 v[48:49], v14 offset:16384
    ds_read_b64_tr_b16 v[50:51], v14 offset:18432
    ds_read_b64_tr_b16 v[52:53], v15 offset:16384
    ds_read_b64_tr_b16 v[54:55], v15 offset:18432
    ds_read_b64_tr_b16 v[56:57], v16 offset:16384
    ds_read_b64_tr_b16 v[58:59], v16 offset:18432
    ds_read_b64_tr_b16 v[60:61], v17 offset:16384
    ds_read_b64_tr_b16 v[62:63], v17 offset:18432
    ds_read_b128 v[64:67], v9 offset:0
    ds_read_b128 v[68:71], v9 offset:2048
    ds_read_b128 v[72:75], v9 offset:4096
    ds_read_b128 v[76:79], v9 offset:6144
    s_waitcnt lgkmcnt(12)
    s_add_u32 m0, s32, 32768
    s_add_u32 s35, s34, 2097152
    buffer_load_dwordx4 v4, s[12:15], s35 offen lds
    s_add_u32 m0, s32, 33792
    s_add_u32 s35, s34, 2113536
    buffer_load_dwordx4 v5, s[12:15], s35 offen lds
    s_add_u32 m0, s32, 34816
    s_add_u32 s35, s34, 2129920
    buffer_load_dwordx4 v4, s[12:15], s35 offen lds
    s_add_u32 m0, s32, 35840
    s_add_u32 s35, s34, 2146304
    buffer_load_dwordx4 v5, s[12:15], s35 offen lds
    v_mfma_f32_16x16x32_bf16 v[192:195], v[80:83], v[32:35], v[192:195]
    v_mfma_f32_16x16x32_bf16 v[196:199], v[80:83], v[36:39], v[196:199]
    v_mfma_f32_16x16x32_bf16 v[200:203], v[80:83], v[40:43], v[200:203]
    v_mfma_f32_16x16x32_bf16 v[204:207], v[80:83], v[44:47], v[204:207]
    v_mfma_f32_16x16x32_bf16 v[208:211], v[84:87], v[32:35], v[208:211]
    v_mfma_f32_16x16x32_bf16 v[212:215], v[84:87], v[36:39], v[212:215]
    v_mfma_f32_16x16x32_bf16 v[216:219], v[84:87], v[40:43], v[216:219]
    v_mfma_f32_16x16x32_bf16 v[220:223], v[84:87], v[44:47], v[220:223]
    v_mfma_f32_16x16x32_bf16 v[224:227], v[88:91], v[32:35], v[224:227]
    v_mfma_f32_16x16x32_bf16 v[228:231], v[88:91], v[36:39], v[228:231]
    v_mfma_f32_16x16x32_bf16 v[232:235], v[88:91], v[40:43], v[232:235]
    v_mfma_f32_16x16x32_bf16 v[236:239], v[88:91], v[44:47], v[236:239]
    v_mfma_f32_16x16x32_bf16 v[240:243], v[92:95], v[32:35], v[240:243]
    v_mfma_f32_16x16x32_bf16 v[244:247], v[92:95], v[36:39], v[244:247]
    v_mfma_f32_16x16x32_bf16 v[248:251], v[92:95], v[40:43], v[248:251]
    v_mfma_f32_16x16x32_bf16 v[252:255], v[92:95], v[44:47], v[252:255]
    v_rcp_f32 v21, v21
    s_nop 0
    v_cvt_pk_bf16_f32 v21, v21, v21
    v_lshlrev_b32 v21, 16, v21
    s_add_u32 s81, s80, s30
    s_lshl_b32 s81, s81, 2
    v_mov_b32 v22, s81
    buffer_store_dword v21, v22, s[68:71], 0 offen
    v_lshlrev_b32 v96, 16, v96
    v_lshlrev_b32 v97, 16, v97
    v_lshlrev_b32 v98, 16, v98
    ds_read_b128 v[80:83], v9 offset:8192
    ds_read_b128 v[84:87], v9 offset:10240
    ds_read_b128 v[88:91], v9 offset:12288
    ds_read_b128 v[92:95], v9 offset:14336
    s_waitcnt lgkmcnt(4)
    v_mfma_f32_16x16x32_bf16 v[128:131], v[64:67], v[48:51], v[128:131]
    v_mfma_f32_16x16x32_bf16 v[132:135], v[64:67], v[52:55], v[132:135]
    v_mfma_f32_16x16x32_bf16 v[136:139], v[64:67], v[56:59], v[136:139]
    v_mfma_f32_16x16x32_bf16 v[140:143], v[64:67], v[60:63], v[140:143]
    v_mfma_f32_16x16x32_bf16 v[144:147], v[68:71], v[48:51], v[144:147]
    v_mfma_f32_16x16x32_bf16 v[148:151], v[68:71], v[52:55], v[148:151]
    v_mfma_f32_16x16x32_bf16 v[152:155], v[68:71], v[56:59], v[152:155]
    v_mfma_f32_16x16x32_bf16 v[156:159], v[68:71], v[60:63], v[156:159]
    v_mfma_f32_16x16x32_bf16 v[160:163], v[72:75], v[48:51], v[160:163]
    v_mfma_f32_16x16x32_bf16 v[164:167], v[72:75], v[52:55], v[164:167]
    v_mfma_f32_16x16x32_bf16 v[168:171], v[72:75], v[56:59], v[168:171]
    v_mfma_f32_16x16x32_bf16 v[172:175], v[72:75], v[60:63], v[172:175]
    v_mfma_f32_16x16x32_bf16 v[176:179], v[76:79], v[48:51], v[176:179]
    v_mfma_f32_16x16x32_bf16 v[180:183], v[76:79], v[52:55], v[180:183]
    v_mfma_f32_16x16x32_bf16 v[184:187], v[76:79], v[56:59], v[184:187]
    v_mfma_f32_16x16x32_bf16 v[188:191], v[76:79], v[60:63], v[188:191]
    v_lshlrev_b32 v99, 16, v99
    v_lshlrev_b32 v100, 16, v100
    v_lshlrev_b32 v101, 16, v101
    v_lshlrev_b32 v102, 16, v102
    v_lshlrev_b32 v103, 16, v103
    v_lshlrev_b32 v104, 16, v104
    v_lshlrev_b32 v105, 16, v105
    v_lshlrev_b32 v106, 16, v106
    v_lshlrev_b32 v107, 16, v107
    v_lshlrev_b32 v108, 16, v108
    v_lshlrev_b32 v109, 16, v109
    s_waitcnt lgkmcnt(0)
    v_mfma_f32_16x16x32_bf16 v[192:195], v[80:83], v[48:51], v[192:195]
    v_mfma_f32_16x16x32_bf16 v[196:199], v[80:83], v[52:55], v[196:199]
    v_mfma_f32_16x16x32_bf16 v[200:203], v[80:83], v[56:59], v[200:203]
    v_mfma_f32_16x16x32_bf16 v[204:207], v[80:83], v[60:63], v[204:207]
    v_mfma_f32_16x16x32_bf16 v[208:211], v[84:87], v[48:51], v[208:211]
    v_mfma_f32_16x16x32_bf16 v[212:215], v[84:87], v[52:55], v[212:215]
    v_mfma_f32_16x16x32_bf16 v[216:219], v[84:87], v[56:59], v[216:219]
    v_mfma_f32_16x16x32_bf16 v[220:223], v[84:87], v[60:63], v[220:223]
    v_mfma_f32_16x16x32_bf16 v[224:227], v[88:91], v[48:51], v[224:227]
    v_mfma_f32_16x16x32_bf16 v[228:231], v[88:91], v[52:55], v[228:231]
    v_mfma_f32_16x16x32_bf16 v[232:235], v[88:91], v[56:59], v[232:235]
    v_mfma_f32_16x16x32_bf16 v[236:239], v[88:91], v[60:63], v[236:239]
    v_mfma_f32_16x16x32_bf16 v[240:243], v[92:95], v[48:51], v[240:243]
    v_mfma_f32_16x16x32_bf16 v[244:247], v[92:95], v[52:55], v[244:247]
    v_mfma_f32_16x16x32_bf16 v[248:251], v[92:95], v[56:59], v[248:251]
    v_mfma_f32_16x16x32_bf16 v[252:255], v[92:95], v[60:63], v[252:255]
    v_lshlrev_b32 v110, 16, v110
    v_lshlrev_b32 v111, 16, v111
    v_lshlrev_b32 v112, 16, v112
    v_lshlrev_b32 v113, 16, v113
    v_lshlrev_b32 v114, 16, v114
    s_nop 0
    v_lshlrev_b32 v118, 16, v116
    v_and_b32 v119, 0xffff0000, v116
    v_lshlrev_b32 v120, 16, v117
    v_and_b32 v121, 0xffff0000, v117
    v_mul_f32 v18, v96, v121
    s_cmp_lg_u32 s30, 3
    s_cbranch_scc1 L_lp_43
    s_add_u32 s35, s83, 768
    buffer_load_dword v26, v115, s[8:11], s35 offen
    s_add_u32 s35, s88, 3145728
    buffer_load_dword v27, v126, s[12:15], s35 offen
L_lp_43:
    s_cmp_eq_u32 s30, 3
    s_cbranch_scc1 L_lw_44
    s_waitcnt vmcnt(0)
L_lw_44:
    s_waitcnt vmcnt(2)
    s_barrier
    ds_read_b64_tr_b16 v[32:33], v10 offset:0
    ds_read_b64_tr_b16 v[34:35], v10 offset:2048
    ds_read_b64_tr_b16 v[36:37], v11 offset:0
    ds_read_b64_tr_b16 v[38:39], v11 offset:2048
    ds_read_b64_tr_b16 v[40:41], v12 offset:0
    ds_read_b64_tr_b16 v[42:43], v12 offset:2048
    ds_read_b64_tr_b16 v[44:45], v13 offset:0
    ds_read_b64_tr_b16 v[46:47], v13 offset:2048
    ds_read_b128 v[64:67], v6 offset:0
    ds_read_b128 v[68:71], v6 offset:2048
    ds_read_b128 v[72:75], v6 offset:4096
    ds_read_b128 v[76:79], v6 offset:6144
    ds_read_b128 v[80:83], v6 offset:8192
    ds_read_b128 v[84:87], v6 offset:10240
    ds_read_b128 v[88:91], v6 offset:12288
    ds_read_b128 v[92:95], v6 offset:14336
    s_waitcnt lgkmcnt(4)
    s_add_u32 m0, s31, 65536
    s_add_u32 s35, s33, 640
    buffer_load_dwordx4 v2, s[8:11], s35 offen lds
    s_add_u32 m0, s31, 66560
    s_add_u32 s35, s33, 17024
    buffer_load_dwordx4 v3, s[8:11], s35 offen lds
    s_add_u32 m0, s31, 67584
    s_add_u32 s35, s33, 33408
    buffer_load_dwordx4 v2, s[8:11], s35 offen lds
    s_add_u32 m0, s31, 68608
    s_add_u32 s35, s33, 49792
    buffer_load_dwordx4 v3, s[8:11], s35 offen lds
    v_mfma_f32_16x16x32_bf16 v[128:131], v[64:67], v[32:35], v[128:131]
    v_mfma_f32_16x16x32_bf16 v[132:135], v[64:67], v[36:39], v[132:135]
    v_mfma_f32_16x16x32_bf16 v[136:139], v[64:67], v[40:43], v[136:139]
    v_mfma_f32_16x16x32_bf16 v[140:143], v[64:67], v[44:47], v[140:143]
    v_mfma_f32_16x16x32_bf16 v[144:147], v[68:71], v[32:35], v[144:147]
    v_mfma_f32_16x16x32_bf16 v[148:151], v[68:71], v[36:39], v[148:151]
    v_mfma_f32_16x16x32_bf16 v[152:155], v[68:71], v[40:43], v[152:155]
    v_mfma_f32_16x16x32_bf16 v[156:159], v[68:71], v[44:47], v[156:159]
    v_mfma_f32_16x16x32_bf16 v[160:163], v[72:75], v[32:35], v[160:163]
    v_mfma_f32_16x16x32_bf16 v[164:167], v[72:75], v[36:39], v[164:167]
    v_mfma_f32_16x16x32_bf16 v[168:171], v[72:75], v[40:43], v[168:171]
    v_mfma_f32_16x16x32_bf16 v[172:175], v[72:75], v[44:47], v[172:175]
    v_mfma_f32_16x16x32_bf16 v[176:179], v[76:79], v[32:35], v[176:179]
    v_mfma_f32_16x16x32_bf16 v[180:183], v[76:79], v[36:39], v[180:183]
    v_mfma_f32_16x16x32_bf16 v[184:187], v[76:79], v[40:43], v[184:187]
    v_mfma_f32_16x16x32_bf16 v[188:191], v[76:79], v[44:47], v[188:191]
    v_mul_f32 v19, v97, v121
    v_cvt_pk_bf16_f32 v20, v18, v19
    v_lshlrev_b32 v21, 16, v20
    v_and_b32 v22, 0xffff0000, v20
    v_mul_f32 v18, v97, v120
    v_mul_f32 v19, v98, v120
    v_cvt_pk_bf16_f32 v20, v18, v19
    v_lshlrev_b32 v18, 16, v20
    v_and_b32 v19, 0xffff0000, v20
    v_add_f32 v21, v21, v18
    v_add_f32 v22, v22, v19
    ds_read_b64_tr_b16 v[48:49], v10 offset:16384
    ds_read_b64_tr_b16 v[50:51], v10 offset:18432
    ds_read_b64_tr_b16 v[52:53], v11 offset:16384
    ds_read_b64_tr_b16 v[54:55], v11 offset:18432
    ds_read_b64_tr_b16 v[56:57], v12 offset:16384
    ds_read_b64_tr_b16 v[58:59], v12 offset:18432
    ds_read_b64_tr_b16 v[60:61], v13 offset:16384
    ds_read_b64_tr_b16 v[62:63], v13 offset:18432
    ds_read_b128 v[64:67], v7 offset:0
    ds_read_b128 v[68:71], v7 offset:2048
    ds_read_b128 v[72:75], v7 offset:4096
    ds_read_b128 v[76:79], v7 offset:6144
    s_waitcnt lgkmcnt(12)
    s_add_u32 m0, s32, 98304
    s_add_u32 s35, s34, 2621440
    buffer_load_dwordx4 v4, s[12:15], s35 offen lds
    s_add_u32 m0, s32, 99328
    s_add_u32 s35, s34, 2637824
    buffer_load_dwordx4 v5, s[12:15], s35 offen lds
    s_add_u32 m0, s32, 100352
    s_add_u32 s35, s34, 2654208
    buffer_load_dwordx4 v4, s[12:15], s35 offen lds
    s_add_u32 m0, s32, 101376
    s_add_u32 s35, s34, 2670592
    buffer_load_dwordx4 v5, s[12:15], s35 offen lds
    v_mfma_f32_16x16x32_bf16 v[192:195], v[80:83], v[32:35], v[192:195]
    v_mfma_f32_16x16x32_bf16 v[196:199], v[80:83], v[36:39], v[196:199]
    v_mfma_f32_16x16x32_bf16 v[200:203], v[80:83], v[40:43], v[200:203]
    v_mfma_f32_16x16x32_bf16 v[204:207], v[80:83], v[44:47], v[204:207]
    v_mfma_f32_16x16x32_bf16 v[208:211], v[84:87], v[32:35], v[208:211]
    v_mfma_f32_16x16x32_bf16 v[212:215], v[84:87], v[36:39], v[212:215]
    v_mfma_f32_16x16x32_bf16 v[216:219], v[84:87], v[40:43], v[216:219]
    v_mfma_f32_16x16x32_bf16 v[220:223], v[84:87], v[44:47], v[220:223]
    v_mfma_f32_16x16x32_bf16 v[224:227], v[88:91], v[32:35], v[224:227]
    v_mfma_f32_16x16x32_bf16 v[228:231], v[88:91], v[36:39], v[228:231]
    v_mfma_f32_16x16x32_bf16 v[232:235], v[88:91], v[40:43], v[232:235]
    v_mfma_f32_16x16x32_bf16 v[236:239], v[88:91], v[44:47], v[236:239]
    v_mfma_f32_16x16x32_bf16 v[240:243], v[92:95], v[32:35], v[240:243]
    v_mfma_f32_16x16x32_bf16 v[244:247], v[92:95], v[36:39], v[244:247]
    v_mfma_f32_16x16x32_bf16 v[248:251], v[92:95], v[40:43], v[248:251]
    v_mfma_f32_16x16x32_bf16 v[252:255], v[92:95], v[44:47], v[252:255]
    v_cvt_pk_bf16_f32 v20, v21, v22
    v_lshlrev_b32 v21, 16, v20
    v_and_b32 v22, 0xffff0000, v20
    v_mul_f32 v18, v98, v119
    v_mul_f32 v19, v99, v119
    v_cvt_pk_bf16_f32 v20, v18, v19
    v_lshlrev_b32 v18, 16, v20
    v_and_b32 v19, 0xffff0000, v20
    v_add_f32 v21, v21, v18
    v_add_f32 v22, v22, v19
    v_cvt_pk_bf16_f32 v20, v21, v22
    ds_read_b128 v[80:83], v7 offset:8192
    ds_read_b128 v[84:87], v7 offset:10240
    ds_read_b128 v[88:91], v7 offset:12288
    ds_read_b128 v[92:95], v7 offset:14336
    s_waitcnt lgkmcnt(4)
    v_mfma_f32_16x16x32_bf16 v[128:131], v[64:67], v[48:51], v[128:131]
    v_mfma_f32_16x16x32_bf16 v[132:135], v[64:67], v[52:55], v[132:135]
    v_mfma_f32_16x16x32_bf16 v[136:139], v[64:67], v[56:59], v[136:139]
    v_mfma_f32_16x16x32_bf16 v[140:143], v[64:67], v[60:63], v[140:143]
    v_mfma_f32_16x16x32_bf16 v[144:147], v[68:71], v[48:51], v[144:147]
    v_mfma_f32_16x16x32_bf16 v[148:151], v[68:71], v[52:55], v[148:151]
    v_mfma_f32_16x16x32_bf16 v[152:155], v[68:71], v[56:59], v[152:155]
    v_mfma_f32_16x16x32_bf16 v[156:159], v[68:71], v[60:63], v[156:159]
    v_mfma_f32_16x16x32_bf16 v[160:163], v[72:75], v[48:51], v[160:163]
    v_mfma_f32_16x16x32_bf16 v[164:167], v[72:75], v[52:55], v[164:167]
    v_mfma_f32_16x16x32_bf16 v[168:171], v[72:75], v[56:59], v[168:171]
    v_mfma_f32_16x16x32_bf16 v[172:175], v[72:75], v[60:63], v[172:175]
    v_mfma_f32_16x16x32_bf16 v[176:179], v[76:79], v[48:51], v[176:179]
    v_mfma_f32_16x16x32_bf16 v[180:183], v[76:79], v[52:55], v[180:183]
    v_mfma_f32_16x16x32_bf16 v[184:187], v[76:79], v[56:59], v[184:187]
    v_mfma_f32_16x16x32_bf16 v[188:191], v[76:79], v[60:63], v[188:191]
    v_lshlrev_b32 v21, 16, v20
    v_and_b32 v22, 0xffff0000, v20
    v_mul_f32 v18, v99, v118
    v_mul_f32 v19, v100, v118
    v_cvt_pk_bf16_f32 v20, v18, v19
    v_lshlrev_b32 v18, 16, v20
    v_and_b32 v19, 0xffff0000, v20
    v_add_f32 v21, v21, v18
    v_add_f32 v22, v22, v19
    v_cvt_pk_bf16_f32 v20, v21, v22
    v_lshlrev_b32 v21, 16, v20
    s_waitcnt lgkmcnt(0)
    v_mfma_f32_16x16x32_bf16 v[192:195], v[80:83], v[48:51], v[192:195]
    v_mfma_f32_16x16x32_bf16 v[196:199], v[80:83], v[52:55], v[196:199]
    v_mfma_f32_16x16x32_bf16 v[200:203], v[80:83], v[56:59], v[200:203]
    v_mfma_f32_16x16x32_bf16 v[204:207], v[80:83], v[60:63], v[204:207]
    v_mfma_f32_16x16x32_bf16 v[208:211], v[84:87], v[48:51], v[208:211]
    v_mfma_f32_16x16x32_bf16 v[212:215], v[84:87], v[52:55], v[212:215]
    v_mfma_f32_16x16x32_bf16 v[216:219], v[84:87], v[56:59], v[216:219]
    v_mfma_f32_16x16x32_bf16 v[220:223], v[84:87], v[60:63], v[220:223]
    v_mfma_f32_16x16x32_bf16 v[224:227], v[88:91], v[48:51], v[224:227]
    v_mfma_f32_16x16x32_bf16 v[228:231], v[88:91], v[52:55], v[228:231]
    v_mfma_f32_16x16x32_bf16 v[232:235], v[88:91], v[56:59], v[232:235]
    v_mfma_f32_16x16x32_bf16 v[236:239], v[88:91], v[60:63], v[236:239]
    v_mfma_f32_16x16x32_bf16 v[240:243], v[92:95], v[48:51], v[240:243]
    v_mfma_f32_16x16x32_bf16 v[244:247], v[92:95], v[52:55], v[244:247]
    v_mfma_f32_16x16x32_bf16 v[248:251], v[92:95], v[56:59], v[248:251]
    v_mfma_f32_16x16x32_bf16 v[252:255], v[92:95], v[60:63], v[252:255]
    v_and_b32 v22, 0xffff0000, v20
    v_mul_f32 v21, v21, v107
    v_mul_f32 v22, v22, v108
    v_cvt_pk_bf16_f32 v31, v22, v21
    v_mul_f32 v18, v98, v121
    v_mul_f32 v19, v99, v121
    v_cvt_pk_bf16_f32 v20, v18, v19
    v_lshlrev_b32 v21, 16, v20
    v_and_b32 v22, 0xffff0000, v20
    v_mul_f32 v18, v99, v120
    v_mul_f32 v19, v100, v120
    s_cmp_lg_u32 s30, 4
    s_cbranch_scc1 L_lp_45
    s_add_u32 s35, s83, 896
    buffer_load_dword v26, v115, s[8:11], s35 offen
    s_add_u32 s35, s88, 3670016
    buffer_load_dword v27, v126, s[12:15], s35 offen
L_lp_45:
    s_cmp_eq_u32 s30, 4
    s_cbranch_scc1 L_lw_46
    s_waitcnt vmcnt(0)
L_lw_46:
    s_waitcnt vmcnt(2)
    s_barrier
    ds_read_b64_tr_b16 v[32:33], v14 offset:0
    ds_read_b64_tr_b16 v[34:35], v14 offset:2048
    ds_read_b64_tr_b16 v[36:37], v15 offset:0
    ds_read_b64_tr_b16 v[38:39], v15 offset:2048
    ds_read_b64_tr_b16 v[40:41], v16 offset:0
    ds_read_b64_tr_b16 v[42:43], v16 offset:2048
    ds_read_b64_tr_b16 v[44:45], v17 offset:0
    ds_read_b64_tr_b16 v[46:47], v17 offset:2048
    ds_read_b128 v[64:67], v8 offset:0
    ds_read_b128 v[68:71], v8 offset:2048
    ds_read_b128 v[72:75], v8 offset:4096
    ds_read_b128 v[76:79], v8 offset:6144
    ds_read_b128 v[80:83], v8 offset:8192
    ds_read_b128 v[84:87], v8 offset:10240
    ds_read_b128 v[88:91], v8 offset:12288
    ds_read_b128 v[92:95], v8 offset:14336
    s_waitcnt lgkmcnt(4)
    s_add_u32 m0, s31, 0
    s_add_u32 s35, s33, 768
    buffer_load_dwordx4 v2, s[8:11], s35 offen lds
    s_add_u32 m0, s31, 1024
    s_add_u32 s35, s33, 17152
    buffer_load_dwordx4 v3, s[8:11], s35 offen lds
    s_add_u32 m0, s31, 2048
    s_add_u32 s35, s33, 33536
    buffer_load_dwordx4 v2, s[8:11], s35 offen lds
    s_add_u32 m0, s31, 3072
    s_add_u32 s35, s33, 49920
    buffer_load_dwordx4 v3, s[8:11], s35 offen lds
    v_mfma_f32_16x16x32_bf16 v[128:131], v[64:67], v[32:35], v[128:131]
    v_mfma_f32_16x16x32_bf16 v[132:135], v[64:67], v[36:39], v[132:135]
    v_mfma_f32_16x16x32_bf16 v[136:139], v[64:67], v[40:43], v[136:139]
    v_mfma_f32_16x16x32_bf16 v[140:143], v[64:67], v[44:47], v[140:143]
    v_mfma_f32_16x16x32_bf16 v[144:147], v[68:71], v[32:35], v[144:147]
    v_mfma_f32_16x16x32_bf16 v[148:151], v[68:71], v[36:39], v[148:151]
    v_mfma_f32_16x16x32_bf16 v[152:155], v[68:71], v[40:43], v[152:155]
    v_mfma_f32_16x16x32_bf16 v[156:159], v[68:71], v[44:47], v[156:159]
    v_mfma_f32_16x16x32_bf16 v[160:163], v[72:75], v[32:35], v[160:163]
    v_mfma_f32_16x16x32_bf16 v[164:167], v[72:75], v[36:39], v[164:167]
    v_mfma_f32_16x16x32_bf16 v[168:171], v[72:75], v[40:43], v[168:171]
    v_mfma_f32_16x16x32_bf16 v[172:175], v[72:75], v[44:47], v[172:175]
    v_mfma_f32_16x16x32_bf16 v[176:179], v[76:79], v[32:35], v[176:179]
    v_mfma_f32_16x16x32_bf16 v[180:183], v[76:79], v[36:39], v[180:183]
    v_mfma_f32_16x16x32_bf16 v[184:187], v[76:79], v[40:43], v[184:187]
    v_mfma_f32_16x16x32_bf16 v[188:191], v[76:79], v[44:47], v[188:191]
    v_cvt_pk_bf16_f32 v20, v18, v19
    v_lshlrev_b32 v18, 16, v20
    v_and_b32 v19, 0xffff0000, v20
    v_add_f32 v21, v21, v18
    v_add_f32 v22, v22, v19
    v_cvt_pk_bf16_f32 v20, v21, v22
    v_lshlrev_b32 v21, 16, v20
    v_and_b32 v22, 0xffff0000, v20
    v_mul_f32 v18, v100, v119
    v_mul_f32 v19, v101, v119
    v_cvt_pk_bf16_f32 v20, v18, v19
    ds_read_b64_tr_b16 v[48:49], v14 offset:16384
    ds_read_b64_tr_b16 v[50:51], v14 offset:18432
    ds_read_b64_tr_b16 v[52:53], v15 offset:16384
    ds_read_b64_tr_b16 v[54:55], v15 offset:18432
    ds_read_b64_tr_b16 v[56:57], v16 offset:16384
    ds_read_b64_tr_b16 v[58:59], v16 offset:18432
    ds_read_b64_tr_b16 v[60:61], v17 offset:16384
    ds_read_b64_tr_b16 v[62:63], v17 offset:18432
    ds_read_b128 v[64:67], v9 offset:0
    ds_read_b128 v[68:71], v9 offset:2048
    ds_read_b128 v[72:75], v9 offset:4096
    ds_read_b128 v[76:79], v9 offset:6144
    s_waitcnt lgkmcnt(12)
    s_add_u32 m0, s32, 32768
    s_add_u32 s35, s34, 3145728
    buffer_load_dwordx4 v4, s[12:15], s35 offen lds
    s_add_u32 m0, s32, 33792
    s_add_u32 s35, s34, 3162112
    buffer_load_dwordx4 v5, s[12:15], s35 offen lds
    s_add_u32 m0, s32, 34816
    s_add_u32 s35, s34, 3178496
    buffer_load_dwordx4 v4, s[12:15], s35 offen lds
    s_add_u32 m0, s32, 35840
    s_add_u32 s35, s34, 3194880
    buffer_load_dwordx4 v5, s[12:15], s35 offen lds
    v_mfma_f32_16x16x32_bf16 v[192:195], v[80:83], v[32:35], v[192:195]
    v_mfma_f32_16x16x32_bf16 v[196:199], v[80:83], v[36:39], v[196:199]
    v_mfma_f32_16x16x32_bf16 v[200:203], v[80:83], v[40:43], v[200:203]
    v_mfma_f32_16x16x32_bf16 v[204:207], v[80:83], v[44:47], v[204:207]
    v_mfma_f32_16x16x32_bf16 v[208:211], v[84:87], v[32:35], v[208:211]
    v_mfma_f32_16x16x32_bf16 v[212:215], v[84:87], v[36:39], v[212:215]
    v_mfma_f32_16x16x32_bf16 v[216:219], v[84:87], v[40:43], v[216:219]
    v_mfma_f32_16x16x32_bf16 v[220:223], v[84:87], v[44:47], v[220:223]
    v_mfma_f32_16x16x32_bf16 v[224:227], v[88:91], v[32:35], v[224:227]
    v_mfma_f32_16x16x32_bf16 v[228:231], v[88:91], v[36:39], v[228:231]
    v_mfma_f32_16x16x32_bf16 v[232:235], v[88:91], v[40:43], v[232:235]
    v_mfma_f32_16x16x32_bf16 v[236:239], v[88:91], v[44:47], v[236:239]
    v_mfma_f32_16x16x32_bf16 v[240:243], v[92:95], v[32:35], v[240:243]
    v_mfma_f32_16x16x32_bf16 v[244:247], v[92:95], v[36:39], v[244:247]
    v_mfma_f32_16x16x32_bf16 v[248:251], v[92:95], v[40:43], v[248:251]
    v_mfma_f32_16x16x32_bf16 v[252:255], v[92:95], v[44:47], v[252:255]
    v_lshlrev_b32 v18, 16, v20
    v_and_b32 v19, 0xffff0000, v20
    v_add_f32 v21, v21, v18
    v_add_f32 v22, v22, v19
    v_cvt_pk_bf16_f32 v20, v21, v22
    v_lshlrev_b32 v21, 16, v20
    v_and_b32 v22, 0xffff0000, v20
    v_mul_f32 v18, v101, v118
    v_mul_f32 v19, v102, v118
    v_cvt_pk_bf16_f32 v20, v18, v19
    v_lshlrev_b32 v18, 16, v20
    ds_read_b128 v[80:83], v9 offset:8192
    ds_read_b128 v[84:87], v9 offset:10240
    ds_read_b128 v[88:91], v9 offset:12288
    ds_read_b128 v[92:95], v9 offset:14336
    s_waitcnt lgkmcnt(4)
    v_mfma_f32_16x16x32_bf16 v[128:131], v[64:67], v[48:51], v[128:131]
    v_mfma_f32_16x16x32_bf16 v[132:135], v[64:67], v[52:55], v[132:135]
    v_mfma_f32_16x16x32_bf16 v[136:139], v[64:67], v[56:59], v[136:139]
    v_mfma_f32_16x16x32_bf16 v[140:143], v[64:67], v[60:63], v[140:143]
    v_mfma_f32_16x16x32_bf16 v[144:147], v[68:71], v[48:51], v[144:147]
    v_mfma_f32_16x16x32_bf16 v[148:151], v[68:71], v[52:55], v[148:151]
    v_mfma_f32_16x16x32_bf16 v[152:155], v[68:71], v[56:59], v[152:155]
    v_mfma_f32_16x16x32_bf16 v[156:159], v[68:71], v[60:63], v[156:159]
    v_mfma_f32_16x16x32_bf16 v[160:163], v[72:75], v[48:51], v[160:163]
    v_mfma_f32_16x16x32_bf16 v[164:167], v[72:75], v[52:55], v[164:167]
    v_mfma_f32_16x16x32_bf16 v[168:171], v[72:75], v[56:59], v[168:171]
    v_mfma_f32_16x16x32_bf16 v[172:175], v[72:75], v[60:63], v[172:175]
    v_mfma_f32_16x16x32_bf16 v[176:179], v[76:79], v[48:51], v[176:179]
    v_mfma_f32_16x16x32_bf16 v[180:183], v[76:79], v[52:55], v[180:183]
    v_mfma_f32_16x16x32_bf16 v[184:187], v[76:79], v[56:59], v[184:187]
    v_mfma_f32_16x16x32_bf16 v[188:191], v[76:79], v[60:63], v[188:191]
    v_and_b32 v19, 0xffff0000, v20
    v_add_f32 v21, v21, v18
    v_add_f32 v22, v22, v19
    v_cvt_pk_bf16_f32 v20, v21, v22
    v_lshlrev_b32 v21, 16, v20
    v_and_b32 v22, 0xffff0000, v20
    v_mul_f32 v21, v21, v109
    v_mul_f32 v22, v22, v110
    v_cvt_pk_bf16_f32 v30, v22, v21
    v_mul_f32 v18, v100, v121
    v_mul_f32 v19, v101, v121
    s_waitcnt lgkmcnt(0)
    v_mfma_f32_16x16x32_bf16 v[192:195], v[80:83], v[48:51], v[192:195]
    v_mfma_f32_16x16x32_bf16 v[196:199], v[80:83], v[52:55], v[196:199]
    v_mfma_f32_16x16x32_bf16 v[200:203], v[80:83], v[56:59], v[200:203]
    v_mfma_f32_16x16x32_bf16 v[204:207], v[80:83], v[60:63], v[204:207]
    v_mfma_f32_16x16x32_bf16 v[208:211], v[84:87], v[48:51], v[208:211]
    v_mfma_f32_16x16x32_bf16 v[212:215], v[84:87], v[52:55], v[212:215]
    v_mfma_f32_16x16x32_bf16 v[216:219], v[84:87], v[56:59], v[216:219]
    v_mfma_f32_16x16x32_bf16 v[220:223], v[84:87], v[60:63], v[220:223]
    v_mfma_f32_16x16x32_bf16 v[224:227], v[88:91], v[48:51], v[224:227]
    v_mfma_f32_16x16x32_bf16 v[228:231], v[88:91], v[52:55], v[228:231]
    v_mfma_f32_16x16x32_bf16 v[232:235], v[88:91], v[56:59], v[232:235]
    v_mfma_f32_16x16x32_bf16 v[236:239], v[88:91], v[60:63], v[236:239]
    v_mfma_f32_16x16x32_bf16 v[240:243], v[92:95], v[48:51], v[240:243]
    v_mfma_f32_16x16x32_bf16 v[244:247], v[92:95], v[52:55], v[244:247]
    v_mfma_f32_16x16x32_bf16 v[248:251], v[92:95], v[56:59], v[248:251]
    v_mfma_f32_16x16x32_bf16 v[252:255], v[92:95], v[60:63], v[252:255]
    v_cvt_pk_bf16_f32 v20, v18, v19
    v_lshlrev_b32 v21, 16, v20
    v_and_b32 v22, 0xffff0000, v20
    v_mul_f32 v18, v101, v120
    v_mul_f32 v19, v102, v120
    v_cvt_pk_bf16_f32 v20, v18, v19
    v_lshlrev_b32 v18, 16, v20
    v_and_b32 v19, 0xffff0000, v20
    v_add_f32 v21, v21, v18
    v_add_f32 v22, v22, v19
    v_cvt_pk_bf16_f32 v20, v21, v22
    s_cmp_lg_u32 s30, 5
    s_cbranch_scc1 L_lp_47
    s_add_u32 s35, s83, 1024
    buffer_load_dword v26, v115, s[8:11], s35 offen
    s_add_u32 s35, s88, 4194304
    buffer_load_dword v27, v126, s[12:15], s35 offen
L_lp_47:
    s_cmp_eq_u32 s30, 5
    s_cbranch_scc1 L_lw_48
    s_waitcnt vmcnt(0)
L_lw_48:
    s_waitcnt vmcnt(2)
    s_barrier
    ds_read_b64_tr_b16 v[32:33], v10 offset:0
    ds_read_b64_tr_b16 v[34:35], v10 offset:2048
    ds_read_b64_tr_b16 v[36:37], v11 offset:0
    ds_read_b64_tr_b16 v[38:39], v11 offset:2048
    ds_read_b64_tr_b16 v[40:41], v12 offset:0
    ds_read_b64_tr_b16 v[42:43], v12 offset:2048
    ds_read_b64_tr_b16 v[44:45], v13 offset:0
    ds_read_b64_tr_b16 v[46:47], v13 offset:2048
    ds_read_b128 v[64:67], v6 offset:0
    ds_read_b128 v[68:71], v6 offset:2048
    ds_read_b128 v[72:75], v6 offset:4096
    ds_read_b128 v[76:79], v6 offset:6144
    ds_read_b128 v[80:83], v6 offset:8192
    ds_read_b128 v[84:87], v6 offset:10240
    ds_read_b128 v[88:91], v6 offset:12288
    ds_read_b128 v[92:95], v6 offset:14336
    s_waitcnt lgkmcnt(4)
    s_add_u32 m0, s31, 65536
    s_add_u32 s35, s33, 896
    buffer_load_dwordx4 v2, s[8:11], s35 offen lds
    s_add_u32 m0, s31, 66560
    s_add_u32 s35, s33, 17280
    buffer_load_dwordx4 v3, s[8:11], s35 offen lds
    s_add_u32 m0, s31, 67584
    s_add_u32 s35, s33, 33664
    buffer_load_dwordx4 v2, s[8:11], s35 offen lds
    s_add_u32 m0, s31, 68608
    s_add_u32 s35, s33, 50048
    buffer_load_dwordx4 v3, s[8:11], s35 offen lds
    v_mfma_f32_16x16x32_bf16 v[128:131], v[64:67], v[32:35], v[128:131]
    v_mfma_f32_16x16x32_bf16 v[132:135], v[64:67], v[36:39], v[132:135]
    v_mfma_f32_16x16x32_bf16 v[136:139], v[64:67], v[40:43], v[136:139]
    v_mfma_f32_16x16x32_bf16 v[140:143], v[64:67], v[44:47], v[140:143]
    v_mfma_f32_16x16x32_bf16 v[144:147], v[68:71], v[32:35], v[144:147]
    v_mfma_f32_16x16x32_bf16 v[148:151], v[68:71], v[36:39], v[148:151]
    v_mfma_f32_16x16x32_bf16 v[152:155], v[68:71], v[40:43], v[152:155]
    v_mfma_f32_16x16x32_bf16 v[156:159], v[68:71], v[44:47], v[156:159]
    v_mfma_f32_16x16x32_bf16 v[160:163], v[72:75], v[32:35], v[160:163]
    v_mfma_f32_16x16x32_bf16 v[164:167], v[72:75], v[36:39], v[164:167]
    v_mfma_f32_16x16x32_bf16 v[168:171], v[72:75], v[40:43], v[168:171]
    v_mfma_f32_16x16x32_bf16 v[172:175], v[72:75], v[44:47], v[172:175]
    v_mfma_f32_16x16x32_bf16 v[176:179], v[76:79], v[32:35], v[176:179]
    v_mfma_f32_16x16x32_bf16 v[180:183], v[76:79], v[36:39], v[180:183]
    v_mfma_f32_16x16x32_bf16 v[184:187], v[76:79], v[40:43], v[184:187]
    v_mfma_f32_16x16x32_bf16 v[188:191], v[76:79], v[44:47], v[188:191]
    v_lshlrev_b32 v21, 16, v20
    v_and_b32 v22, 0xffff0000, v20
    v_mul_f32 v18, v102, v119
    v_mul_f32 v19, v103, v119
    v_cvt_pk_bf16_f32 v20, v18, v19
    v_lshlrev_b32 v18, 16, v20
    v_and_b32 v19, 0xffff0000, v20
    v_add_f32 v21, v21, v18
    v_add_f32 v22, v22, v19
    v_cvt_pk_bf16_f32 v20, v21, v22
    v_lshlrev_b32 v21, 16, v20
    ds_read_b64_tr_b16 v[48:49], v10 offset:16384
    ds_read_b64_tr_b16 v[50:51], v10 offset:18432
    ds_read_b64_tr_b16 v[52:53], v11 offset:16384
    ds_read_b64_tr_b16 v[54:55], v11 offset:18432
    ds_read_b64_tr_b16 v[56:57], v12 offset:16384
    ds_read_b64_tr_b16 v[58:59], v12 offset:18432
    ds_read_b64_tr_b16 v[60:61], v13 offset:16384
    ds_read_b64_tr_b16 v[62:63], v13 offset:18432
    ds_read_b128 v[64:67], v7 offset:0
    ds_read_b128 v[68:71], v7 offset:2048
    ds_read_b128 v[72:75], v7 offset:4096
    ds_read_b128 v[76:79], v7 offset:6144
    s_waitcnt lgkmcnt(12)
    s_add_u32 m0, s32, 98304
    s_add_u32 s35, s34, 3670016
    buffer_load_dwordx4 v4, s[12:15], s35 offen lds
    s_add_u32 m0, s32, 99328
    s_add_u32 s35, s34, 3686400
    buffer_load_dwordx4 v5, s[12:15], s35 offen lds
    s_add_u32 m0, s32, 100352
    s_add_u32 s35, s34, 3702784
    buffer_load_dwordx4 v4, s[12:15], s35 offen lds
    s_add_u32 m0, s32, 101376
    s_add_u32 s35, s34, 3719168
    buffer_load_dwordx4 v5, s[12:15], s35 offen lds
    v_mfma_f32_16x16x32_bf16 v[192:195], v[80:83], v[32:35], v[192:195]
    v_mfma_f32_16x16x32_bf16 v[196:199], v[80:83], v[36:39], v[196:199]
    v_mfma_f32_16x16x32_bf16 v[200:203], v[80:83], v[40:43], v[200:203]
    v_mfma_f32_16x16x32_bf16 v[204:207], v[80:83], v[44:47], v[204:207]
    v_mfma_f32_16x16x32_bf16 v[208:211], v[84:87], v[32:35], v[208:211]
    v_mfma_f32_16x16x32_bf16 v[212:215], v[84:87], v[36:39], v[212:215]
    v_mfma_f32_16x16x32_bf16 v[216:219], v[84:87], v[40:43], v[216:219]
    v_mfma_f32_16x16x32_bf16 v[220:223], v[84:87], v[44:47], v[220:223]
    v_mfma_f32_16x16x32_bf16 v[224:227], v[88:91], v[32:35], v[224:227]
    v_mfma_f32_16x16x32_bf16 v[228:231], v[88:91], v[36:39], v[228:231]
    v_mfma_f32_16x16x32_bf16 v[232:235], v[88:91], v[40:43], v[232:235]
    v_mfma_f32_16x16x32_bf16 v[236:239], v[88:91], v[44:47], v[236:239]
    v_mfma_f32_16x16x32_bf16 v[240:243], v[92:95], v[32:35], v[240:243]
    v_mfma_f32_16x16x32_bf16 v[244:247], v[92:95], v[36:39], v[244:247]
    v_mfma_f32_16x16x32_bf16 v[248:251], v[92:95], v[40:43], v[248:251]
    v_mfma_f32_16x16x32_bf16 v[252:255], v[92:95], v[44:47], v[252:255]
    v_and_b32 v22, 0xffff0000, v20
    v_mul_f32 v18, v103, v118
    v_mul_f32 v19, v104, v118
    v_cvt_pk_bf16_f32 v20, v18, v19
    v_lshlrev_b32 v18, 16, v20
    v_and_b32 v19, 0xffff0000, v20
    v_add_f32 v21, v21, v18
    v_add_f32 v22, v22, v19
    v_cvt_pk_bf16_f32 v20, v21, v22
    v_lshlrev_b32 v21, 16, v20
    v_and_b32 v22, 0xffff0000, v20
    ds_read_b128 v[80:83], v7 offset:8192
    ds_read_b128 v[84:87], v7 offset:10240
    ds_read_b128 v[88:91], v7 offset:12288
    ds_read_b128 v[92:95], v7 offset:14336
    s_waitcnt lgkmcnt(4)
    v_mfma_f32_16x16x32_bf16 v[128:131], v[64:67], v[48:51], v[128:131]
    v_mfma_f32_16x16x32_bf16 v[132:135], v[64:67], v[52:55], v[132:135]
    v_mfma_f32_16x16x32_bf16 v[136:139], v[64:67], v[56:59], v[136:139]
    v_mfma_f32_16x16x32_bf16 v[140:143], v[64:67], v[60:63], v[140:143]
    v_mfma_f32_16x16x32_bf16 v[144:147], v[68:71], v[48:51], v[144:147]
    v_mfma_f32_16x16x32_bf16 v[148:151], v[68:71], v[52:55], v[148:151]
    v_mfma_f32_16x16x32_bf16 v[152:155], v[68:71], v[56:59], v[152:155]
    v_mfma_f32_16x16x32_bf16 v[156:159], v[68:71], v[60:63], v[156:159]
    v_mfma_f32_16x16x32_bf16 v[160:163], v[72:75], v[48:51], v[160:163]
    v_mfma_f32_16x16x32_bf16 v[164:167], v[72:75], v[52:55], v[164:167]
    v_mfma_f32_16x16x32_bf16 v[168:171], v[72:75], v[56:59], v[168:171]
    v_mfma_f32_16x16x32_bf16 v[172:175], v[72:75], v[60:63], v[172:175]
    v_mfma_f32_16x16x32_bf16 v[176:179], v[76:79], v[48:51], v[176:179]
    v_mfma_f32_16x16x32_bf16 v[180:183], v[76:79], v[52:55], v[180:183]
    v_mfma_f32_16x16x32_bf16 v[184:187], v[76:79], v[56:59], v[184:187]
    v_mfma_f32_16x16x32_bf16 v[188:191], v[76:79], v[60:63], v[188:191]
    v_mul_f32 v21, v21, v111
    v_mul_f32 v22, v22, v112
    v_cvt_pk_bf16_f32 v29, v22, v21
    v_mul_f32 v18, v102, v121
    v_mul_f32 v19, v103, v121
    v_cvt_pk_bf16_f32 v20, v18, v19
    v_lshlrev_b32 v21, 16, v20
    v_and_b32 v22, 0xffff0000, v20
    v_mul_f32 v18, v103, v120
    v_mul_f32 v19, v104, v120
    v_cvt_pk_bf16_f32 v20, v18, v19
    s_waitcnt lgkmcnt(0)
    v_mfma_f32_16x16x32_bf16 v[192:195], v[80:83], v[48:51], v[192:195]
    v_mfma_f32_16x16x32_bf16 v[196:199], v[80:83], v[52:55], v[196:199]
    v_mfma_f32_16x16x32_bf16 v[200:203], v[80:83], v[56:59], v[200:203]
    v_mfma_f32_16x16x32_bf16 v[204:207], v[80:83], v[60:63], v[204:207]
    v_mfma_f32_16x16x32_bf16 v[208:211], v[84:87], v[48:51], v[208:211]
    v_mfma_f32_16x16x32_bf16 v[212:215], v[84:87], v[52:55], v[212:215]
    v_mfma_f32_16x16x32_bf16 v[216:219], v[84:87], v[56:59], v[216:219]
    v_mfma_f32_16x16x32_bf16 v[220:223], v[84:87], v[60:63], v[220:223]
    v_mfma_f32_16x16x32_bf16 v[224:227], v[88:91], v[48:51], v[224:227]
    v_mfma_f32_16x16x32_bf16 v[228:231], v[88:91], v[52:55], v[228:231]
    v_mfma_f32_16x16x32_bf16 v[232:235], v[88:91], v[56:59], v[232:235]
    v_mfma_f32_16x16x32_bf16 v[236:239], v[88:91], v[60:63], v[236:239]
    v_mfma_f32_16x16x32_bf16 v[240:243], v[92:95], v[48:51], v[240:243]
    v_mfma_f32_16x16x32_bf16 v[244:247], v[92:95], v[52:55], v[244:247]
    v_mfma_f32_16x16x32_bf16 v[248:251], v[92:95], v[56:59], v[248:251]
    v_mfma_f32_16x16x32_bf16 v[252:255], v[92:95], v[60:63], v[252:255]
    v_lshlrev_b32 v18, 16, v20
    v_and_b32 v19, 0xffff0000, v20
    v_add_f32 v21, v21, v18
    v_add_f32 v22, v22, v19
    v_cvt_pk_bf16_f32 v20, v21, v22
    v_lshlrev_b32 v21, 16, v20
    v_and_b32 v22, 0xffff0000, v20
    v_mul_f32 v18, v104, v119
    v_mul_f32 v19, v105, v119
    v_cvt_pk_bf16_f32 v20, v18, v19
    v_lshlrev_b32 v18, 16, v20
    s_cmp_lg_u32 s30, 6
    s_cbranch_scc1 L_lp_49
    s_add_u32 s35, s83, 1152
    buffer_load_dword v26, v115, s[8:11], s35 offen
    s_add_u32 s35, s88, 4718592
    buffer_load_dword v27, v126, s[12:15], s35 offen
L_lp_49:
    s_cmp_eq_u32 s30, 6
    s_cbranch_scc1 L_lw_50
    s_waitcnt vmcnt(0)
L_lw_50:
    s_waitcnt vmcnt(2)
    s_barrier
    ds_read_b64_tr_b16 v[32:33], v14 offset:0
    ds_read_b64_tr_b16 v[34:35], v14 offset:2048
    ds_read_b64_tr_b16 v[36:37], v15 offset:0
    ds_read_b64_tr_b16 v[38:39], v15 offset:2048
    ds_read_b64_tr_b16 v[40:41], v16 offset:0
    ds_read_b64_tr_b16 v[42:43], v16 offset:2048
    ds_read_b64_tr_b16 v[44:45], v17 offset:0
    ds_read_b64_tr_b16 v[46:47], v17 offset:2048
    ds_read_b128 v[64:67], v8 offset:0
    ds_read_b128 v[68:71], v8 offset:2048
    ds_read_b128 v[72:75], v8 offset:4096
    ds_read_b128 v[76:79], v8 offset:6144
    ds_read_b128 v[80:83], v8 offset:8192
    ds_read_b128 v[84:87], v8 offset:10240
    ds_read_b128 v[88:91], v8 offset:12288
    ds_read_b128 v[92:95], v8 offset:14336
    s_waitcnt lgkmcnt(4)
    s_add_u32 m0, s31, 0
    s_add_u32 s35, s33, 1024
    buffer_load_dwordx4 v2, s[8:11], s35 offen lds
    s_add_u32 m0, s31, 1024
    s_add_u32 s35, s33, 17408
    buffer_load_dwordx4 v3, s[8:11], s35 offen lds
    s_add_u32 m0, s31, 2048
    s_add_u32 s35, s33, 33792
    buffer_load_dwordx4 v2, s[8:11], s35 offen lds
    s_add_u32 m0, s31, 3072
    s_add_u32 s35, s33, 50176
    buffer_load_dwordx4 v3, s[8:11], s35 offen lds
    v_mfma_f32_16x16x32_bf16 v[128:131], v[64:67], v[32:35], v[128:131]
    v_mfma_f32_16x16x32_bf16 v[132:135], v[64:67], v[36:39], v[132:135]
    v_mfma_f32_16x16x32_bf16 v[136:139], v[64:67], v[40:43], v[136:139]
    v_mfma_f32_16x16x32_bf16 v[140:143], v[64:67], v[44:47], v[140:143]
    v_mfma_f32_16x16x32_bf16 v[144:147], v[68:71], v[32:35], v[144:147]
    v_mfma_f32_16x16x32_bf16 v[148:151], v[68:71], v[36:39], v[148:151]
    v_mfma_f32_16x16x32_bf16 v[152:155], v[68:71], v[40:43], v[152:155]
    v_mfma_f32_16x16x32_bf16 v[156:159], v[68:71], v[44:47], v[156:159]
    v_mfma_f32_16x16x32_bf16 v[160:163], v[72:75], v[32:35], v[160:163]
    v_mfma_f32_16x16x32_bf16 v[164:167], v[72:75], v[36:39], v[164:167]
    v_mfma_f32_16x16x32_bf16 v[168:171], v[72:75], v[40:43], v[168:171]
    v_mfma_f32_16x16x32_bf16 v[172:175], v[72:75], v[44:47], v[172:175]
    v_mfma_f32_16x16x32_bf16 v[176:179], v[76:79], v[32:35], v[176:179]
    v_mfma_f32_16x16x32_bf16 v[180:183], v[76:79], v[36:39], v[180:183]
    v_mfma_f32_16x16x32_bf16 v[184:187], v[76:79], v[40:43], v[184:187]
    v_mfma_f32_16x16x32_bf16 v[188:191], v[76:79], v[44:47], v[188:191]
    v_and_b32 v19, 0xffff0000, v20
    v_add_f32 v21, v21, v18
    v_add_f32 v22, v22, v19
    v_cvt_pk_bf16_f32 v20, v21, v22
    v_lshlrev_b32 v21, 16, v20
    v_and_b32 v22, 0xffff0000, v20
    v_mul_f32 v18, v105, v118
    v_mul_f32 v19, v106, v118
    v_cvt_pk_bf16_f32 v20, v18, v19
    v_lshlrev_b32 v18, 16, v20
    v_and_b32 v19, 0xffff0000, v20
    ds_read_b64_tr_b16 v[48:49], v14 offset:16384
    ds_read_b64_tr_b16 v[50:51], v14 offset:18432
    ds_read_b64_tr_b16 v[52:53], v15 offset:16384
    ds_read_b64_tr_b16 v[54:55], v15 offset:18432
    ds_read_b64_tr_b16 v[56:57], v16 offset:16384
    ds_read_b64_tr_b16 v[58:59], v16 offset:18432
    ds_read_b64_tr_b16 v[60:61], v17 offset:16384
    ds_read_b64_tr_b16 v[62:63], v17 offset:18432
    ds_read_b128 v[64:67], v9 offset:0
    ds_read_b128 v[68:71], v9 offset:2048
    ds_read_b128 v[72:75], v9 offset:4096
    ds_read_b128 v[76:79], v9 offset:6144
    s_waitcnt lgkmcnt(12)
    s_add_u32 m0, s32, 32768
    s_add_u32 s35, s34, 4194304
    buffer_load_dwordx4 v4, s[12:15], s35 offen lds
    s_add_u32 m0, s32, 33792
    s_add_u32 s35, s34, 4210688
    buffer_load_dwordx4 v5, s[12:15], s35 offen lds
    s_add_u32 m0, s32, 34816
    s_add_u32 s35, s34, 4227072
    buffer_load_dwordx4 v4, s[12:15], s35 offen lds
    s_add_u32 m0, s32, 35840
    s_add_u32 s35, s34, 4243456
    buffer_load_dwordx4 v5, s[12:15], s35 offen lds
    v_mfma_f32_16x16x32_bf16 v[192:195], v[80:83], v[32:35], v[192:195]
    v_mfma_f32_16x16x32_bf16 v[196:199], v[80:83], v[36:39], v[196:199]
    v_mfma_f32_16x16x32_bf16 v[200:203], v[80:83], v[40:43], v[200:203]
    v_mfma_f32_16x16x32_bf16 v[204:207], v[80:83], v[44:47], v[204:207]
    v_mfma_f32_16x16x32_bf16 v[208:211], v[84:87], v[32:35], v[208:211]
    v_mfma_f32_16x16x32_bf16 v[212:215], v[84:87], v[36:39], v[212:215]
    v_mfma_f32_16x16x32_bf16 v[216:219], v[84:87], v[40:43], v[216:219]
    v_mfma_f32_16x16x32_bf16 v[220:223], v[84:87], v[44:47], v[220:223]
    v_mfma_f32_16x16x32_bf16 v[224:227], v[88:91], v[32:35], v[224:227]
    v_mfma_f32_16x16x32_bf16 v[228:231], v[88:91], v[36:39], v[228:231]
    v_mfma_f32_16x16x32_bf16 v[232:235], v[88:91], v[40:43], v[232:235]
    v_mfma_f32_16x16x32_bf16 v[236:239], v[88:91], v[44:47], v[236:239]
    v_mfma_f32_16x16x32_bf16 v[240:243], v[92:95], v[32:35], v[240:243]
    v_mfma_f32_16x16x32_bf16 v[244:247], v[92:95], v[36:39], v[244:247]
    v_mfma_f32_16x16x32_bf16 v[248:251], v[92:95], v[40:43], v[248:251]
    v_mfma_f32_16x16x32_bf16 v[252:255], v[92:95], v[44:47], v[252:255]
    v_add_f32 v21, v21, v18
    v_add_f32 v22, v22, v19
    v_cvt_pk_bf16_f32 v20, v21, v22
    v_lshlrev_b32 v21, 16, v20
    v_and_b32 v22, 0xffff0000, v20
    v_mul_f32 v21, v21, v113
    v_mul_f32 v22, v22, v114
    v_cvt_pk_bf16_f32 v28, v22, v21
    v_lshlrev_b32 v19, 12, v0
    s_lshl_b32 s81, s80, 1
    buffer_store_dwordx4 v[28:31], v19, s[64:67], s81 offen
    ds_read_b128 v[80:83], v9 offset:8192
    ds_read_b128 v[84:87], v9 offset:10240
    ds_read_b128 v[88:91], v9 offset:12288
    ds_read_b128 v[92:95], v9 offset:14336
    s_waitcnt lgkmcnt(4)
    v_mfma_f32_16x16x32_bf16 v[128:131], v[64:67], v[48:51], v[128:131]
    v_mfma_f32_16x16x32_bf16 v[132:135], v[64:67], v[52:55], v[132:135]
    v_mfma_f32_16x16x32_bf16 v[136:139], v[64:67], v[56:59], v[136:139]
    v_mfma_f32_16x16x32_bf16 v[140:143], v[64:67], v[60:63], v[140:143]
    v_mfma_f32_16x16x32_bf16 v[144:147], v[68:71], v[48:51], v[144:147]
    v_mfma_f32_16x16x32_bf16 v[148:151], v[68:71], v[52:55], v[148:151]
    v_mfma_f32_16x16x32_bf16 v[152:155], v[68:71], v[56:59], v[152:155]
    v_mfma_f32_16x16x32_bf16 v[156:159], v[68:71], v[60:63], v[156:159]
    v_mfma_f32_16x16x32_bf16 v[160:163], v[72:75], v[48:51], v[160:163]
    v_mfma_f32_16x16x32_bf16 v[164:167], v[72:75], v[52:55], v[164:167]
    v_mfma_f32_16x16x32_bf16 v[168:171], v[72:75], v[56:59], v[168:171]
    v_mfma_f32_16x16x32_bf16 v[172:175], v[72:75], v[60:63], v[172:175]
    v_mfma_f32_16x16x32_bf16 v[176:179], v[76:79], v[48:51], v[176:179]
    v_mfma_f32_16x16x32_bf16 v[180:183], v[76:79], v[52:55], v[180:183]
    v_mfma_f32_16x16x32_bf16 v[184:187], v[76:79], v[56:59], v[184:187]
    v_mfma_f32_16x16x32_bf16 v[188:191], v[76:79], v[60:63], v[188:191]
    s_waitcnt lgkmcnt(0)
    v_mfma_f32_16x16x32_bf16 v[192:195], v[80:83], v[48:51], v[192:195]
    v_mfma_f32_16x16x32_bf16 v[196:199], v[80:83], v[52:55], v[196:199]
    v_mfma_f32_16x16x32_bf16 v[200:203], v[80:83], v[56:59], v[200:203]
    v_mfma_f32_16x16x32_bf16 v[204:207], v[80:83], v[60:63], v[204:207]
    v_mfma_f32_16x16x32_bf16 v[208:211], v[84:87], v[48:51], v[208:211]
    v_mfma_f32_16x16x32_bf16 v[212:215], v[84:87], v[52:55], v[212:215]
    v_mfma_f32_16x16x32_bf16 v[216:219], v[84:87], v[56:59], v[216:219]
    v_mfma_f32_16x16x32_bf16 v[220:223], v[84:87], v[60:63], v[220:223]
    v_mfma_f32_16x16x32_bf16 v[224:227], v[88:91], v[48:51], v[224:227]
    v_mfma_f32_16x16x32_bf16 v[228:231], v[88:91], v[52:55], v[228:231]
    v_mfma_f32_16x16x32_bf16 v[232:235], v[88:91], v[56:59], v[232:235]
    v_mfma_f32_16x16x32_bf16 v[236:239], v[88:91], v[60:63], v[236:239]
    v_mfma_f32_16x16x32_bf16 v[240:243], v[92:95], v[48:51], v[240:243]
    v_mfma_f32_16x16x32_bf16 v[244:247], v[92:95], v[52:55], v[244:247]
    v_mfma_f32_16x16x32_bf16 v[248:251], v[92:95], v[56:59], v[248:251]
    v_mfma_f32_16x16x32_bf16 v[252:255], v[92:95], v[60:63], v[252:255]
    s_cmp_lg_u32 s30, 7
    s_cbranch_scc1 L_lp_51
    s_add_u32 s35, s83, 1280
    buffer_load_dword v26, v115, s[8:11], s35 offen
    s_add_u32 s35, s88, 5242880
    buffer_load_dword v27, v126, s[12:15], s35 offen
L_lp_51:
    s_cmp_eq_u32 s30, 7
    s_cbranch_scc1 L_lw_52
    s_waitcnt vmcnt(0)
L_lw_52:
    s_waitcnt vmcnt(2)
    s_barrier
    ds_read_b64_tr_b16 v[32:33], v10 offset:0
    ds_read_b64_tr_b16 v[34:35], v10 offset:2048
    ds_read_b64_tr_b16 v[36:37], v11 offset:0
    ds_read_b64_tr_b16 v[38:39], v11 offset:2048
    ds_read_b64_tr_b16 v[40:41], v12 offset:0
    ds_read_b64_tr_b16 v[42:43], v12 offset:2048
    ds_read_b64_tr_b16 v[44:45], v13 offset:0
    ds_read_b64_tr_b16 v[46:47], v13 offset:2048
    ds_read_b128 v[64:67], v6 offset:0
    ds_read_b128 v[68:71], v6 offset:2048
    ds_read_b128 v[72:75], v6 offset:4096
    ds_read_b128 v[76:79], v6 offset:6144
    ds_read_b128 v[80:83], v6 offset:8192
    ds_read_b128 v[84:87], v6 offset:10240
    ds_read_b128 v[88:91], v6 offset:12288
    ds_read_b128 v[92:95], v6 offset:14336
    s_waitcnt lgkmcnt(4)
    s_add_u32 m0, s31, 65536
    s_add_u32 s35, s33, 1152
    buffer_load_dwordx4 v2, s[8:11], s35 offen lds
    s_add_u32 m0, s31, 66560
    s_add_u32 s35, s33, 17536
    buffer_load_dwordx4 v3, s[8:11], s35 offen lds
    s_add_u32 m0, s31, 67584
    s_add_u32 s35, s33, 33920
    buffer_load_dwordx4 v2, s[8:11], s35 offen lds
    s_add_u32 m0, s31, 68608
    s_add_u32 s35, s33, 50304
    buffer_load_dwordx4 v3, s[8:11], s35 offen lds
    v_mfma_f32_16x16x32_bf16 v[128:131], v[64:67], v[32:35], v[128:131]
    v_mfma_f32_16x16x32_bf16 v[132:135], v[64:67], v[36:39], v[132:135]
    v_mfma_f32_16x16x32_bf16 v[136:139], v[64:67], v[40:43], v[136:139]
    v_mfma_f32_16x16x32_bf16 v[140:143], v[64:67], v[44:47], v[140:143]
    v_mfma_f32_16x16x32_bf16 v[144:147], v[68:71], v[32:35], v[144:147]
    v_mfma_f32_16x16x32_bf16 v[148:151], v[68:71], v[36:39], v[148:151]
    v_mfma_f32_16x16x32_bf16 v[152:155], v[68:71], v[40:43], v[152:155]
    v_mfma_f32_16x16x32_bf16 v[156:159], v[68:71], v[44:47], v[156:159]
    v_mfma_f32_16x16x32_bf16 v[160:163], v[72:75], v[32:35], v[160:163]
    v_mfma_f32_16x16x32_bf16 v[164:167], v[72:75], v[36:39], v[164:167]
    v_mfma_f32_16x16x32_bf16 v[168:171], v[72:75], v[40:43], v[168:171]
    v_mfma_f32_16x16x32_bf16 v[172:175], v[72:75], v[44:47], v[172:175]
    v_mfma_f32_16x16x32_bf16 v[176:179], v[76:79], v[32:35], v[176:179]
    v_mfma_f32_16x16x32_bf16 v[180:183], v[76:79], v[36:39], v[180:183]
    v_mfma_f32_16x16x32_bf16 v[184:187], v[76:79], v[40:43], v[184:187]
    v_mfma_f32_16x16x32_bf16 v[188:191], v[76:79], v[44:47], v[188:191]
    ds_read_b64_tr_b16 v[48:49], v10 offset:16384
    ds_read_b64_tr_b16 v[50:51], v10 offset:18432
    ds_read_b64_tr_b16 v[52:53], v11 offset:16384
    ds_read_b64_tr_b16 v[54:55], v11 offset:18432
    ds_read_b64_tr_b16 v[56:57], v12 offset:16384
    ds_read_b64_tr_b16 v[58:59], v12 offset:18432
    ds_read_b64_tr_b16 v[60:61], v13 offset:16384
    ds_read_b64_tr_b16 v[62:63], v13 offset:18432
    ds_read_b128 v[64:67], v7 offset:0
    ds_read_b128 v[68:71], v7 offset:2048
    ds_read_b128 v[72:75], v7 offset:4096
    ds_read_b128 v[76:79], v7 offset:6144
    s_waitcnt lgkmcnt(12)
    s_add_u32 m0, s32, 98304
    s_add_u32 s35, s34, 4718592
    buffer_load_dwordx4 v4, s[12:15], s35 offen lds
    s_add_u32 m0, s32, 99328
    s_add_u32 s35, s34, 4734976
    buffer_load_dwordx4 v5, s[12:15], s35 offen lds
    s_add_u32 m0, s32, 100352
    s_add_u32 s35, s34, 4751360
    buffer_load_dwordx4 v4, s[12:15], s35 offen lds
    s_add_u32 m0, s32, 101376
    s_add_u32 s35, s34, 4767744
    buffer_load_dwordx4 v5, s[12:15], s35 offen lds
    v_mfma_f32_16x16x32_bf16 v[192:195], v[80:83], v[32:35], v[192:195]
    v_mfma_f32_16x16x32_bf16 v[196:199], v[80:83], v[36:39], v[196:199]
    v_mfma_f32_16x16x32_bf16 v[200:203], v[80:83], v[40:43], v[200:203]
    v_mfma_f32_16x16x32_bf16 v[204:207], v[80:83], v[44:47], v[204:207]
    v_mfma_f32_16x16x32_bf16 v[208:211], v[84:87], v[32:35], v[208:211]
    v_mfma_f32_16x16x32_bf16 v[212:215], v[84:87], v[36:39], v[212:215]
    v_mfma_f32_16x16x32_bf16 v[216:219], v[84:87], v[40:43], v[216:219]
    v_mfma_f32_16x16x32_bf16 v[220:223], v[84:87], v[44:47], v[220:223]
    v_mfma_f32_16x16x32_bf16 v[224:227], v[88:91], v[32:35], v[224:227]
    v_mfma_f32_16x16x32_bf16 v[228:231], v[88:91], v[36:39], v[228:231]
    v_mfma_f32_16x16x32_bf16 v[232:235], v[88:91], v[40:43], v[232:235]
    v_mfma_f32_16x16x32_bf16 v[236:239], v[88:91], v[44:47], v[236:239]
    v_mfma_f32_16x16x32_bf16 v[240:243], v[92:95], v[32:35], v[240:243]
    v_mfma_f32_16x16x32_bf16 v[244:247], v[92:95], v[36:39], v[244:247]
    v_mfma_f32_16x16x32_bf16 v[248:251], v[92:95], v[40:43], v[248:251]
    v_mfma_f32_16x16x32_bf16 v[252:255], v[92:95], v[44:47], v[252:255]
    ds_read_b128 v[80:83], v7 offset:8192
    ds_read_b128 v[84:87], v7 offset:10240
    ds_read_b128 v[88:91], v7 offset:12288
    ds_read_b128 v[92:95], v7 offset:14336
    s_waitcnt lgkmcnt(4)
    v_mfma_f32_16x16x32_bf16 v[128:131], v[64:67], v[48:51], v[128:131]
    v_mfma_f32_16x16x32_bf16 v[132:135], v[64:67], v[52:55], v[132:135]
    v_mfma_f32_16x16x32_bf16 v[136:139], v[64:67], v[56:59], v[136:139]
    v_mfma_f32_16x16x32_bf16 v[140:143], v[64:67], v[60:63], v[140:143]
    v_mfma_f32_16x16x32_bf16 v[144:147], v[68:71], v[48:51], v[144:147]
    v_mfma_f32_16x16x32_bf16 v[148:151], v[68:71], v[52:55], v[148:151]
    v_mfma_f32_16x16x32_bf16 v[152:155], v[68:71], v[56:59], v[152:155]
    v_mfma_f32_16x16x32_bf16 v[156:159], v[68:71], v[60:63], v[156:159]
    v_mfma_f32_16x16x32_bf16 v[160:163], v[72:75], v[48:51], v[160:163]
    v_mfma_f32_16x16x32_bf16 v[164:167], v[72:75], v[52:55], v[164:167]
    v_mfma_f32_16x16x32_bf16 v[168:171], v[72:75], v[56:59], v[168:171]
    v_mfma_f32_16x16x32_bf16 v[172:175], v[72:75], v[60:63], v[172:175]
    v_mfma_f32_16x16x32_bf16 v[176:179], v[76:79], v[48:51], v[176:179]
    v_mfma_f32_16x16x32_bf16 v[180:183], v[76:79], v[52:55], v[180:183]
    v_mfma_f32_16x16x32_bf16 v[184:187], v[76:79], v[56:59], v[184:187]
    v_mfma_f32_16x16x32_bf16 v[188:191], v[76:79], v[60:63], v[188:191]
    s_waitcnt lgkmcnt(0)
    v_mfma_f32_16x16x32_bf16 v[192:195], v[80:83], v[48:51], v[192:195]
    v_mfma_f32_16x16x32_bf16 v[196:199], v[80:83], v[52:55], v[196:199]
    v_mfma_f32_16x16x32_bf16 v[200:203], v[80:83], v[56:59], v[200:203]
    v_mfma_f32_16x16x32_bf16 v[204:207], v[80:83], v[60:63], v[204:207]
    v_mfma_f32_16x16x32_bf16 v[208:211], v[84:87], v[48:51], v[208:211]
    v_mfma_f32_16x16x32_bf16 v[212:215], v[84:87], v[52:55], v[212:215]
    v_mfma_f32_16x16x32_bf16 v[216:219], v[84:87], v[56:59], v[216:219]
    v_mfma_f32_16x16x32_bf16 v[220:223], v[84:87], v[60:63], v[220:223]
    v_mfma_f32_16x16x32_bf16 v[224:227], v[88:91], v[48:51], v[224:227]
    v_mfma_f32_16x16x32_bf16 v[228:231], v[88:91], v[52:55], v[228:231]
    v_mfma_f32_16x16x32_bf16 v[232:235], v[88:91], v[56:59], v[232:235]
    v_mfma_f32_16x16x32_bf16 v[236:239], v[88:91], v[60:63], v[236:239]
    v_mfma_f32_16x16x32_bf16 v[240:243], v[92:95], v[48:51], v[240:243]
    v_mfma_f32_16x16x32_bf16 v[244:247], v[92:95], v[52:55], v[244:247]
    v_mfma_f32_16x16x32_bf16 v[248:251], v[92:95], v[56:59], v[248:251]
    v_mfma_f32_16x16x32_bf16 v[252:255], v[92:95], v[60:63], v[252:255]
    s_cmp_lg_u32 s30, 0
    s_cbranch_scc1 L_lp_53
    s_add_u32 s35, s83, 1408
    buffer_load_dword v26, v115, s[8:11], s35 offen
    s_add_u32 s35, s88, 5767168
    buffer_load_dword v27, v126, s[12:15], s35 offen
L_lp_53:
    s_cmp_eq_u32 s30, 0
    s_cbranch_scc1 L_lw_54
    s_waitcnt vmcnt(0)
L_lw_54:
    s_waitcnt vmcnt(2)
    s_barrier
    ds_read_b64_tr_b16 v[32:33], v14 offset:0
    ds_read_b64_tr_b16 v[34:35], v14 offset:2048
    ds_read_b64_tr_b16 v[36:37], v15 offset:0
    ds_read_b64_tr_b16 v[38:39], v15 offset:2048
    ds_read_b64_tr_b16 v[40:41], v16 offset:0
    ds_read_b64_tr_b16 v[42:43], v16 offset:2048
    ds_read_b64_tr_b16 v[44:45], v17 offset:0
    ds_read_b64_tr_b16 v[46:47], v17 offset:2048
    ds_read_b128 v[64:67], v8 offset:0
    ds_read_b128 v[68:71], v8 offset:2048
    ds_read_b128 v[72:75], v8 offset:4096
    ds_read_b128 v[76:79], v8 offset:6144
    ds_read_b128 v[80:83], v8 offset:8192
    ds_read_b128 v[84:87], v8 offset:10240
    ds_read_b128 v[88:91], v8 offset:12288
    ds_read_b128 v[92:95], v8 offset:14336
    s_waitcnt lgkmcnt(4)
    s_add_u32 m0, s31, 0
    s_add_u32 s35, s33, 1280
    buffer_load_dwordx4 v2, s[8:11], s35 offen lds
    s_add_u32 m0, s31, 1024
    s_add_u32 s35, s33, 17664
    buffer_load_dwordx4 v3, s[8:11], s35 offen lds
    s_add_u32 m0, s31, 2048
    s_add_u32 s35, s33, 34048
    buffer_load_dwordx4 v2, s[8:11], s35 offen lds
    s_add_u32 m0, s31, 3072
    s_add_u32 s35, s33, 50432
    buffer_load_dwordx4 v3, s[8:11], s35 offen lds
    v_mfma_f32_16x16x32_bf16 v[128:131], v[64:67], v[32:35], v[128:131]
    v_mfma_f32_16x16x32_bf16 v[132:135], v[64:67], v[36:39], v[132:135]
    v_mfma_f32_16x16x32_bf16 v[136:139], v[64:67], v[40:43], v[136:139]
    v_mfma_f32_16x16x32_bf16 v[140:143], v[64:67], v[44:47], v[140:143]
    v_mfma_f32_16x16x32_bf16 v[144:147], v[68:71], v[32:35], v[144:147]
    v_mfma_f32_16x16x32_bf16 v[148:151], v[68:71], v[36:39], v[148:151]
    v_mfma_f32_16x16x32_bf16 v[152:155], v[68:71], v[40:43], v[152:155]
    v_mfma_f32_16x16x32_bf16 v[156:159], v[68:71], v[44:47], v[156:159]
    v_mfma_f32_16x16x32_bf16 v[160:163], v[72:75], v[32:35], v[160:163]
    v_mfma_f32_16x16x32_bf16 v[164:167], v[72:75], v[36:39], v[164:167]
    v_mfma_f32_16x16x32_bf16 v[168:171], v[72:75], v[40:43], v[168:171]
    v_mfma_f32_16x16x32_bf16 v[172:175], v[72:75], v[44:47], v[172:175]
    v_mfma_f32_16x16x32_bf16 v[176:179], v[76:79], v[32:35], v[176:179]
    v_mfma_f32_16x16x32_bf16 v[180:183], v[76:79], v[36:39], v[180:183]
    v_mfma_f32_16x16x32_bf16 v[184:187], v[76:79], v[40:43], v[184:187]
    v_mfma_f32_16x16x32_bf16 v[188:191], v[76:79], v[44:47], v[188:191]
    ds_read_b64_tr_b16 v[48:49], v14 offset:16384
    ds_read_b64_tr_b16 v[50:51], v14 offset:18432
    ds_read_b64_tr_b16 v[52:53], v15 offset:16384
    ds_read_b64_tr_b16 v[54:55], v15 offset:18432
    ds_read_b64_tr_b16 v[56:57], v16 offset:16384
    ds_read_b64_tr_b16 v[58:59], v16 offset:18432
    ds_read_b64_tr_b16 v[60:61], v17 offset:16384
    ds_read_b64_tr_b16 v[62:63], v17 offset:18432
    ds_read_b128 v[64:67], v9 offset:0
    ds_read_b128 v[68:71], v9 offset:2048
    ds_read_b128 v[72:75], v9 offset:4096
    ds_read_b128 v[76:79], v9 offset:6144
    s_waitcnt lgkmcnt(12)
    s_add_u32 m0, s32, 32768
    s_add_u32 s35, s34, 5242880
    buffer_load_dwordx4 v4, s[12:15], s35 offen lds
    s_add_u32 m0, s32, 33792
    s_add_u32 s35, s34, 5259264
    buffer_load_dwordx4 v5, s[12:15], s35 offen lds
    s_add_u32 m0, s32, 34816
    s_add_u32 s35, s34, 5275648
    buffer_load_dwordx4 v4, s[12:15], s35 offen lds
    s_add_u32 m0, s32, 35840
    s_add_u32 s35, s34, 5292032
    buffer_load_dwordx4 v5, s[12:15], s35 offen lds
    v_mfma_f32_16x16x32_bf16 v[192:195], v[80:83], v[32:35], v[192:195]
    v_mfma_f32_16x16x32_bf16 v[196:199], v[80:83], v[36:39], v[196:199]
    v_mfma_f32_16x16x32_bf16 v[200:203], v[80:83], v[40:43], v[200:203]
    v_mfma_f32_16x16x32_bf16 v[204:207], v[80:83], v[44:47], v[204:207]
    v_mfma_f32_16x16x32_bf16 v[208:211], v[84:87], v[32:35], v[208:211]
    v_mfma_f32_16x16x32_bf16 v[212:215], v[84:87], v[36:39], v[212:215]
    v_mfma_f32_16x16x32_bf16 v[216:219], v[84:87], v[40:43], v[216:219]
    v_mfma_f32_16x16x32_bf16 v[220:223], v[84:87], v[44:47], v[220:223]
    v_mfma_f32_16x16x32_bf16 v[224:227], v[88:91], v[32:35], v[224:227]
    v_mfma_f32_16x16x32_bf16 v[228:231], v[88:91], v[36:39], v[228:231]
    v_mfma_f32_16x16x32_bf16 v[232:235], v[88:91], v[40:43], v[232:235]
    v_mfma_f32_16x16x32_bf16 v[236:239], v[88:91], v[44:47], v[236:239]
    v_mfma_f32_16x16x32_bf16 v[240:243], v[92:95], v[32:35], v[240:243]
    v_mfma_f32_16x16x32_bf16 v[244:247], v[92:95], v[36:39], v[244:247]
    v_mfma_f32_16x16x32_bf16 v[248:251], v[92:95], v[40:43], v[248:251]
    v_mfma_f32_16x16x32_bf16 v[252:255], v[92:95], v[44:47], v[252:255]
    ds_read_b128 v[80:83], v9 offset:8192
    ds_read_b128 v[84:87], v9 offset:10240
    ds_read_b128 v[88:91], v9 offset:12288
    ds_read_b128 v[92:95], v9 offset:14336
    s_waitcnt lgkmcnt(4)
    v_mfma_f32_16x16x32_bf16 v[128:131], v[64:67], v[48:51], v[128:131]
    v_mfma_f32_16x16x32_bf16 v[132:135], v[64:67], v[52:55], v[132:135]
    v_mfma_f32_16x16x32_bf16 v[136:139], v[64:67], v[56:59], v[136:139]
    v_mfma_f32_16x16x32_bf16 v[140:143], v[64:67], v[60:63], v[140:143]
    v_mfma_f32_16x16x32_bf16 v[144:147], v[68:71], v[48:51], v[144:147]
    v_mfma_f32_16x16x32_bf16 v[148:151], v[68:71], v[52:55], v[148:151]
    v_mfma_f32_16x16x32_bf16 v[152:155], v[68:71], v[56:59], v[152:155]
    v_mfma_f32_16x16x32_bf16 v[156:159], v[68:71], v[60:63], v[156:159]
    v_mfma_f32_16x16x32_bf16 v[160:163], v[72:75], v[48:51], v[160:163]
    v_mfma_f32_16x16x32_bf16 v[164:167], v[72:75], v[52:55], v[164:167]
    v_mfma_f32_16x16x32_bf16 v[168:171], v[72:75], v[56:59], v[168:171]
    v_mfma_f32_16x16x32_bf16 v[172:175], v[72:75], v[60:63], v[172:175]
    v_mfma_f32_16x16x32_bf16 v[176:179], v[76:79], v[48:51], v[176:179]
    v_mfma_f32_16x16x32_bf16 v[180:183], v[76:79], v[52:55], v[180:183]
    v_mfma_f32_16x16x32_bf16 v[184:187], v[76:79], v[56:59], v[184:187]
    v_mfma_f32_16x16x32_bf16 v[188:191], v[76:79], v[60:63], v[188:191]
    s_waitcnt lgkmcnt(0)
    v_mfma_f32_16x16x32_bf16 v[192:195], v[80:83], v[48:51], v[192:195]
    v_mfma_f32_16x16x32_bf16 v[196:199], v[80:83], v[52:55], v[196:199]
    v_mfma_f32_16x16x32_bf16 v[200:203], v[80:83], v[56:59], v[200:203]
    v_mfma_f32_16x16x32_bf16 v[204:207], v[80:83], v[60:63], v[204:207]
    v_mfma_f32_16x16x32_bf16 v[208:211], v[84:87], v[48:51], v[208:211]
    v_mfma_f32_16x16x32_bf16 v[212:215], v[84:87], v[52:55], v[212:215]
    v_mfma_f32_16x16x32_bf16 v[216:219], v[84:87], v[56:59], v[216:219]
    v_mfma_f32_16x16x32_bf16 v[220:223], v[84:87], v[60:63], v[220:223]
    v_mfma_f32_16x16x32_bf16 v[224:227], v[88:91], v[48:51], v[224:227]
    v_mfma_f32_16x16x32_bf16 v[228:231], v[88:91], v[52:55], v[228:231]
    v_mfma_f32_16x16x32_bf16 v[232:235], v[88:91], v[56:59], v[232:235]
    v_mfma_f32_16x16x32_bf16 v[236:239], v[88:91], v[60:63], v[236:239]
    v_mfma_f32_16x16x32_bf16 v[240:243], v[92:95], v[48:51], v[240:243]
    v_mfma_f32_16x16x32_bf16 v[244:247], v[92:95], v[52:55], v[244:247]
    v_mfma_f32_16x16x32_bf16 v[248:251], v[92:95], v[56:59], v[248:251]
    v_mfma_f32_16x16x32_bf16 v[252:255], v[92:95], v[60:63], v[252:255]
    s_cmp_lg_u32 s30, 1
    s_cbranch_scc1 L_lp_55
    s_add_u32 s35, s83, 1536
    buffer_load_dword v26, v115, s[8:11], s35 offen
    s_add_u32 s35, s88, 6291456
    buffer_load_dword v27, v126, s[12:15], s35 offen
L_lp_55:
    s_cmp_eq_u32 s30, 1
    s_cbranch_scc1 L_lw_56
    s_waitcnt vmcnt(0)
L_lw_56:
    s_waitcnt vmcnt(2)
    s_barrier
    ds_read_b64_tr_b16 v[32:33], v10 offset:0
    ds_read_b64_tr_b16 v[34:35], v10 offset:2048
    ds_read_b64_tr_b16 v[36:37], v11 offset:0
    ds_read_b64_tr_b16 v[38:39], v11 offset:2048
    ds_read_b64_tr_b16 v[40:41], v12 offset:0
    ds_read_b64_tr_b16 v[42:43], v12 offset:2048
    ds_read_b64_tr_b16 v[44:45], v13 offset:0
    ds_read_b64_tr_b16 v[46:47], v13 offset:2048
    ds_read_b128 v[64:67], v6 offset:0
    ds_read_b128 v[68:71], v6 offset:2048
    ds_read_b128 v[72:75], v6 offset:4096
    ds_read_b128 v[76:79], v6 offset:6144
    ds_read_b128 v[80:83], v6 offset:8192
    ds_read_b128 v[84:87], v6 offset:10240
    ds_read_b128 v[88:91], v6 offset:12288
    ds_read_b128 v[92:95], v6 offset:14336
    s_waitcnt lgkmcnt(4)
    s_add_u32 m0, s31, 65536
    s_add_u32 s35, s33, 1408
    buffer_load_dwordx4 v2, s[8:11], s35 offen lds
    s_add_u32 m0, s31, 66560
    s_add_u32 s35, s33, 17792
    buffer_load_dwordx4 v3, s[8:11], s35 offen lds
    s_add_u32 m0, s31, 67584
    s_add_u32 s35, s33, 34176
    buffer_load_dwordx4 v2, s[8:11], s35 offen lds
    s_add_u32 m0, s31, 68608
    s_add_u32 s35, s33, 50560
    buffer_load_dwordx4 v3, s[8:11], s35 offen lds
    v_mfma_f32_16x16x32_bf16 v[128:131], v[64:67], v[32:35], v[128:131]
    v_mfma_f32_16x16x32_bf16 v[132:135], v[64:67], v[36:39], v[132:135]
    v_mfma_f32_16x16x32_bf16 v[136:139], v[64:67], v[40:43], v[136:139]
    v_mfma_f32_16x16x32_bf16 v[140:143], v[64:67], v[44:47], v[140:143]
    v_mfma_f32_16x16x32_bf16 v[144:147], v[68:71], v[32:35], v[144:147]
    v_mfma_f32_16x16x32_bf16 v[148:151], v[68:71], v[36:39], v[148:151]
    v_mfma_f32_16x16x32_bf16 v[152:155], v[68:71], v[40:43], v[152:155]
    v_mfma_f32_16x16x32_bf16 v[156:159], v[68:71], v[44:47], v[156:159]
    v_mfma_f32_16x16x32_bf16 v[160:163], v[72:75], v[32:35], v[160:163]
    v_mfma_f32_16x16x32_bf16 v[164:167], v[72:75], v[36:39], v[164:167]
    v_mfma_f32_16x16x32_bf16 v[168:171], v[72:75], v[40:43], v[168:171]
    v_mfma_f32_16x16x32_bf16 v[172:175], v[72:75], v[44:47], v[172:175]
    v_mfma_f32_16x16x32_bf16 v[176:179], v[76:79], v[32:35], v[176:179]
    v_mfma_f32_16x16x32_bf16 v[180:183], v[76:79], v[36:39], v[180:183]
    v_mfma_f32_16x16x32_bf16 v[184:187], v[76:79], v[40:43], v[184:187]
    v_mfma_f32_16x16x32_bf16 v[188:191], v[76:79], v[44:47], v[188:191]
    ds_read_b64_tr_b16 v[48:49], v10 offset:16384
    ds_read_b64_tr_b16 v[50:51], v10 offset:18432
    ds_read_b64_tr_b16 v[52:53], v11 offset:16384
    ds_read_b64_tr_b16 v[54:55], v11 offset:18432
    ds_read_b64_tr_b16 v[56:57], v12 offset:16384
    ds_read_b64_tr_b16 v[58:59], v12 offset:18432
    ds_read_b64_tr_b16 v[60:61], v13 offset:16384
    ds_read_b64_tr_b16 v[62:63], v13 offset:18432
    ds_read_b128 v[64:67], v7 offset:0
    ds_read_b128 v[68:71], v7 offset:2048
    ds_read_b128 v[72:75], v7 offset:4096
    ds_read_b128 v[76:79], v7 offset:6144
    s_waitcnt lgkmcnt(12)
    s_add_u32 m0, s32, 98304
    s_add_u32 s35, s34, 5767168
    buffer_load_dwordx4 v4, s[12:15], s35 offen lds
    s_add_u32 m0, s32, 99328
    s_add_u32 s35, s34, 5783552
    buffer_load_dwordx4 v5, s[12:15], s35 offen lds
    s_add_u32 m0, s32, 100352
    s_add_u32 s35, s34, 5799936
    buffer_load_dwordx4 v4, s[12:15], s35 offen lds
    s_add_u32 m0, s32, 101376
    s_add_u32 s35, s34, 5816320
    buffer_load_dwordx4 v5, s[12:15], s35 offen lds
    v_mfma_f32_16x16x32_bf16 v[192:195], v[80:83], v[32:35], v[192:195]
    v_mfma_f32_16x16x32_bf16 v[196:199], v[80:83], v[36:39], v[196:199]
    v_mfma_f32_16x16x32_bf16 v[200:203], v[80:83], v[40:43], v[200:203]
    v_mfma_f32_16x16x32_bf16 v[204:207], v[80:83], v[44:47], v[204:207]
    v_mfma_f32_16x16x32_bf16 v[208:211], v[84:87], v[32:35], v[208:211]
    v_mfma_f32_16x16x32_bf16 v[212:215], v[84:87], v[36:39], v[212:215]
    v_mfma_f32_16x16x32_bf16 v[216:219], v[84:87], v[40:43], v[216:219]
    v_mfma_f32_16x16x32_bf16 v[220:223], v[84:87], v[44:47], v[220:223]
    v_mfma_f32_16x16x32_bf16 v[224:227], v[88:91], v[32:35], v[224:227]
    v_mfma_f32_16x16x32_bf16 v[228:231], v[88:91], v[36:39], v[228:231]
    v_mfma_f32_16x16x32_bf16 v[232:235], v[88:91], v[40:43], v[232:235]
    v_mfma_f32_16x16x32_bf16 v[236:239], v[88:91], v[44:47], v[236:239]
    v_mfma_f32_16x16x32_bf16 v[240:243], v[92:95], v[32:35], v[240:243]
    v_mfma_f32_16x16x32_bf16 v[244:247], v[92:95], v[36:39], v[244:247]
    v_mfma_f32_16x16x32_bf16 v[248:251], v[92:95], v[40:43], v[248:251]
    v_mfma_f32_16x16x32_bf16 v[252:255], v[92:95], v[44:47], v[252:255]
    ds_read_b128 v[80:83], v7 offset:8192
    ds_read_b128 v[84:87], v7 offset:10240
    ds_read_b128 v[88:91], v7 offset:12288
    ds_read_b128 v[92:95], v7 offset:14336
    s_waitcnt lgkmcnt(4)
    v_mfma_f32_16x16x32_bf16 v[128:131], v[64:67], v[48:51], v[128:131]
    v_mfma_f32_16x16x32_bf16 v[132:135], v[64:67], v[52:55], v[132:135]
    v_mfma_f32_16x16x32_bf16 v[136:139], v[64:67], v[56:59], v[136:139]
    v_mfma_f32_16x16x32_bf16 v[140:143], v[64:67], v[60:63], v[140:143]
    v_mfma_f32_16x16x32_bf16 v[144:147], v[68:71], v[48:51], v[144:147]
    v_mfma_f32_16x16x32_bf16 v[148:151], v[68:71], v[52:55], v[148:151]
    v_mfma_f32_16x16x32_bf16 v[152:155], v[68:71], v[56:59], v[152:155]
    v_mfma_f32_16x16x32_bf16 v[156:159], v[68:71], v[60:63], v[156:159]
    v_mfma_f32_16x16x32_bf16 v[160:163], v[72:75], v[48:51], v[160:163]
    v_mfma_f32_16x16x32_bf16 v[164:167], v[72:75], v[52:55], v[164:167]
    v_mfma_f32_16x16x32_bf16 v[168:171], v[72:75], v[56:59], v[168:171]
    v_mfma_f32_16x16x32_bf16 v[172:175], v[72:75], v[60:63], v[172:175]
    v_mfma_f32_16x16x32_bf16 v[176:179], v[76:79], v[48:51], v[176:179]
    v_mfma_f32_16x16x32_bf16 v[180:183], v[76:79], v[52:55], v[180:183]
    v_mfma_f32_16x16x32_bf16 v[184:187], v[76:79], v[56:59], v[184:187]
    v_mfma_f32_16x16x32_bf16 v[188:191], v[76:79], v[60:63], v[188:191]
    s_waitcnt lgkmcnt(0)
    v_mfma_f32_16x16x32_bf16 v[192:195], v[80:83], v[48:51], v[192:195]
    v_mfma_f32_16x16x32_bf16 v[196:199], v[80:83], v[52:55], v[196:199]
    v_mfma_f32_16x16x32_bf16 v[200:203], v[80:83], v[56:59], v[200:203]
    v_mfma_f32_16x16x32_bf16 v[204:207], v[80:83], v[60:63], v[204:207]
    v_mfma_f32_16x16x32_bf16 v[208:211], v[84:87], v[48:51], v[208:211]
    v_mfma_f32_16x16x32_bf16 v[212:215], v[84:87], v[52:55], v[212:215]
    v_mfma_f32_16x16x32_bf16 v[216:219], v[84:87], v[56:59], v[216:219]
    v_mfma_f32_16x16x32_bf16 v[220:223], v[84:87], v[60:63], v[220:223]
    v_mfma_f32_16x16x32_bf16 v[224:227], v[88:91], v[48:51], v[224:227]
    v_mfma_f32_16x16x32_bf16 v[228:231], v[88:91], v[52:55], v[228:231]
    v_mfma_f32_16x16x32_bf16 v[232:235], v[88:91], v[56:59], v[232:235]
    v_mfma_f32_16x16x32_bf16 v[236:239], v[88:91], v[60:63], v[236:239]
    v_mfma_f32_16x16x32_bf16 v[240:243], v[92:95], v[48:51], v[240:243]
    v_mfma_f32_16x16x32_bf16 v[244:247], v[92:95], v[52:55], v[244:247]
    v_mfma_f32_16x16x32_bf16 v[248:251], v[92:95], v[56:59], v[248:251]
    v_mfma_f32_16x16x32_bf16 v[252:255], v[92:95], v[60:63], v[252:255]
    s_cmp_lg_u32 s30, 2
    s_cbranch_scc1 L_lp_57
    s_add_u32 s35, s83, 1664
    buffer_load_dword v26, v115, s[8:11], s35 offen
    s_add_u32 s35, s88, 6815744
    buffer_load_dword v27, v126, s[12:15], s35 offen
L_lp_57:
    s_cmp_eq_u32 s30, 2
    s_cbranch_scc1 L_lw_58
    s_waitcnt vmcnt(0)
L_lw_58:
    s_waitcnt vmcnt(2)
    s_barrier
    s_lshr_b32 s81, s30, 1
    s_cmp_lg_u32 s81, 0
    s_cbranch_scc1 L_qp_59
    s_and_b32 s81, s49, 1
    s_lshl_b32 s81, s81, 6
    s_add_u32 s81, s81, s54
    s_mul_i32 s81, s81, 896
    s_lshl_b32 s82, s30, 7
    s_add_u32 s81, s81, s82
    v_mul_u32_u24 v18, 896, v1
    buffer_load_dword v20, v18, s[44:47], s81 offen
L_qp_59:
    ds_read_b64_tr_b16 v[32:33], v14 offset:0
    ds_read_b64_tr_b16 v[34:35], v14 offset:2048
    ds_read_b64_tr_b16 v[36:37], v15 offset:0
    ds_read_b64_tr_b16 v[38:39], v15 offset:2048
    ds_read_b64_tr_b16 v[40:41], v16 offset:0
    ds_read_b64_tr_b16 v[42:43], v16 offset:2048
    ds_read_b64_tr_b16 v[44:45], v17 offset:0
    ds_read_b64_tr_b16 v[46:47], v17 offset:2048
    ds_read_b128 v[64:67], v8 offset:0
    ds_read_b128 v[68:71], v8 offset:2048
    ds_read_b128 v[72:75], v8 offset:4096
    ds_read_b128 v[76:79], v8 offset:6144
    ds_read_b128 v[80:83], v8 offset:8192
    ds_read_b128 v[84:87], v8 offset:10240
    ds_read_b128 v[88:91], v8 offset:12288
    ds_read_b128 v[92:95], v8 offset:14336
    s_waitcnt lgkmcnt(4)
    s_add_u32 m0, s31, 0
    s_add_u32 s35, s33, 1536
    buffer_load_dwordx4 v2, s[8:11], s35 offen lds
    s_add_u32 m0, s31, 1024
    s_add_u32 s35, s33, 17920
    buffer_load_dwordx4 v3, s[8:11], s35 offen lds
    s_add_u32 m0, s31, 2048
    s_add_u32 s35, s33, 34304
    buffer_load_dwordx4 v2, s[8:11], s35 offen lds
    s_add_u32 m0, s31, 3072
    s_add_u32 s35, s33, 50688
    buffer_load_dwordx4 v3, s[8:11], s35 offen lds
    v_mfma_f32_16x16x32_bf16 v[128:131], v[64:67], v[32:35], v[128:131]
    v_mfma_f32_16x16x32_bf16 v[132:135], v[64:67], v[36:39], v[132:135]
    v_mfma_f32_16x16x32_bf16 v[136:139], v[64:67], v[40:43], v[136:139]
    v_mfma_f32_16x16x32_bf16 v[140:143], v[64:67], v[44:47], v[140:143]
    v_mfma_f32_16x16x32_bf16 v[144:147], v[68:71], v[32:35], v[144:147]
    v_mfma_f32_16x16x32_bf16 v[148:151], v[68:71], v[36:39], v[148:151]
    v_mfma_f32_16x16x32_bf16 v[152:155], v[68:71], v[40:43], v[152:155]
    v_mfma_f32_16x16x32_bf16 v[156:159], v[68:71], v[44:47], v[156:159]
    v_mfma_f32_16x16x32_bf16 v[160:163], v[72:75], v[32:35], v[160:163]
    v_mfma_f32_16x16x32_bf16 v[164:167], v[72:75], v[36:39], v[164:167]
    v_mfma_f32_16x16x32_bf16 v[168:171], v[72:75], v[40:43], v[168:171]
    v_mfma_f32_16x16x32_bf16 v[172:175], v[72:75], v[44:47], v[172:175]
    v_mfma_f32_16x16x32_bf16 v[176:179], v[76:79], v[32:35], v[176:179]
    v_mfma_f32_16x16x32_bf16 v[180:183], v[76:79], v[36:39], v[180:183]
    v_mfma_f32_16x16x32_bf16 v[184:187], v[76:79], v[40:43], v[184:187]
    v_mfma_f32_16x16x32_bf16 v[188:191], v[76:79], v[44:47], v[188:191]
    ds_read_b64_tr_b16 v[48:49], v14 offset:16384
    ds_read_b64_tr_b16 v[50:51], v14 offset:18432
    ds_read_b64_tr_b16 v[52:53], v15 offset:16384
    ds_read_b64_tr_b16 v[54:55], v15 offset:18432
    ds_read_b64_tr_b16 v[56:57], v16 offset:16384
    ds_read_b64_tr_b16 v[58:59], v16 offset:18432
    ds_read_b64_tr_b16 v[60:61], v17 offset:16384
    ds_read_b64_tr_b16 v[62:63], v17 offset:18432
    ds_read_b128 v[64:67], v9 offset:0
    ds_read_b128 v[68:71], v9 offset:2048
    ds_read_b128 v[72:75], v9 offset:4096
    ds_read_b128 v[76:79], v9 offset:6144
    s_waitcnt lgkmcnt(12)
    s_add_u32 m0, s32, 32768
    s_add_u32 s35, s34, 6291456
    buffer_load_dwordx4 v4, s[12:15], s35 offen lds
    s_add_u32 m0, s32, 33792
    s_add_u32 s35, s34, 6307840
    buffer_load_dwordx4 v5, s[12:15], s35 offen lds
    s_add_u32 m0, s32, 34816
    s_add_u32 s35, s34, 6324224
    buffer_load_dwordx4 v4, s[12:15], s35 offen lds
    s_add_u32 m0, s32, 35840
    s_add_u32 s35, s34, 6340608
    buffer_load_dwordx4 v5, s[12:15], s35 offen lds
    v_mfma_f32_16x16x32_bf16 v[192:195], v[80:83], v[32:35], v[192:195]
    v_mfma_f32_16x16x32_bf16 v[196:199], v[80:83], v[36:39], v[196:199]
    v_mfma_f32_16x16x32_bf16 v[200:203], v[80:83], v[40:43], v[200:203]
    v_mfma_f32_16x16x32_bf16 v[204:207], v[80:83], v[44:47], v[204:207]
    v_mfma_f32_16x16x32_bf16 v[208:211], v[84:87], v[32:35], v[208:211]
    v_mfma_f32_16x16x32_bf16 v[212:215], v[84:87], v[36:39], v[212:215]
    v_mfma_f32_16x16x32_bf16 v[216:219], v[84:87], v[40:43], v[216:219]
    v_mfma_f32_16x16x32_bf16 v[220:223], v[84:87], v[44:47], v[220:223]
    v_mfma_f32_16x16x32_bf16 v[224:227], v[88:91], v[32:35], v[224:227]
    v_mfma_f32_16x16x32_bf16 v[228:231], v[88:91], v[36:39], v[228:231]
    v_mfma_f32_16x16x32_bf16 v[232:235], v[88:91], v[40:43], v[232:235]
    v_mfma_f32_16x16x32_bf16 v[236:239], v[88:91], v[44:47], v[236:239]
    v_mfma_f32_16x16x32_bf16 v[240:243], v[92:95], v[32:35], v[240:243]
    v_mfma_f32_16x16x32_bf16 v[244:247], v[92:95], v[36:39], v[244:247]
    v_mfma_f32_16x16x32_bf16 v[248:251], v[92:95], v[40:43], v[248:251]
    v_mfma_f32_16x16x32_bf16 v[252:255], v[92:95], v[44:47], v[252:255]
    ds_read_b128 v[80:83], v9 offset:8192
    ds_read_b128 v[84:87], v9 offset:10240
    ds_read_b128 v[88:91], v9 offset:12288
    ds_read_b128 v[92:95], v9 offset:14336
    s_waitcnt lgkmcnt(4)
    v_mfma_f32_16x16x32_bf16 v[128:131], v[64:67], v[48:51], v[128:131]
    v_mfma_f32_16x16x32_bf16 v[132:135], v[64:67], v[52:55], v[132:135]
    v_mfma_f32_16x16x32_bf16 v[136:139], v[64:67], v[56:59], v[136:139]
    v_mfma_f32_16x16x32_bf16 v[140:143], v[64:67], v[60:63], v[140:143]
    v_mfma_f32_16x16x32_bf16 v[144:147], v[68:71], v[48:51], v[144:147]
    v_mfma_f32_16x16x32_bf16 v[148:151], v[68:71], v[52:55], v[148:151]
    v_mfma_f32_16x16x32_bf16 v[152:155], v[68:71], v[56:59], v[152:155]
    v_mfma_f32_16x16x32_bf16 v[156:159], v[68:71], v[60:63], v[156:159]
    v_mfma_f32_16x16x32_bf16 v[160:163], v[72:75], v[48:51], v[160:163]
    v_mfma_f32_16x16x32_bf16 v[164:167], v[72:75], v[52:55], v[164:167]
    v_mfma_f32_16x16x32_bf16 v[168:171], v[72:75], v[56:59], v[168:171]
    v_mfma_f32_16x16x32_bf16 v[172:175], v[72:75], v[60:63], v[172:175]
    v_mfma_f32_16x16x32_bf16 v[176:179], v[76:79], v[48:51], v[176:179]
    v_mfma_f32_16x16x32_bf16 v[180:183], v[76:79], v[52:55], v[180:183]
    v_mfma_f32_16x16x32_bf16 v[184:187], v[76:79], v[56:59], v[184:187]
    v_mfma_f32_16x16x32_bf16 v[188:191], v[76:79], v[60:63], v[188:191]
    s_waitcnt lgkmcnt(0)
    v_mfma_f32_16x16x32_bf16 v[192:195], v[80:83], v[48:51], v[192:195]
    v_mfma_f32_16x16x32_bf16 v[196:199], v[80:83], v[52:55], v[196:199]
    v_mfma_f32_16x16x32_bf16 v[200:203], v[80:83], v[56:59], v[200:203]
    v_mfma_f32_16x16x32_bf16 v[204:207], v[80:83], v[60:63], v[204:207]
    v_mfma_f32_16x16x32_bf16 v[208:211], v[84:87], v[48:51], v[208:211]
    v_mfma_f32_16x16x32_bf16 v[212:215], v[84:87], v[52:55], v[212:215]
    v_mfma_f32_16x16x32_bf16 v[216:219], v[84:87], v[56:59], v[216:219]
    v_mfma_f32_16x16x32_bf16 v[220:223], v[84:87], v[60:63], v[220:223]
    v_mfma_f32_16x16x32_bf16 v[224:227], v[88:91], v[48:51], v[224:227]
    v_mfma_f32_16x16x32_bf16 v[228:231], v[88:91], v[52:55], v[228:231]
    v_mfma_f32_16x16x32_bf16 v[232:235], v[88:91], v[56:59], v[232:235]
    v_mfma_f32_16x16x32_bf16 v[236:239], v[88:91], v[60:63], v[236:239]
    v_mfma_f32_16x16x32_bf16 v[240:243], v[92:95], v[48:51], v[240:243]
    v_mfma_f32_16x16x32_bf16 v[244:247], v[92:95], v[52:55], v[244:247]
    v_mfma_f32_16x16x32_bf16 v[248:251], v[92:95], v[56:59], v[248:251]
    v_mfma_f32_16x16x32_bf16 v[252:255], v[92:95], v[60:63], v[252:255]
    s_cmp_lg_u32 s30, 3
    s_cbranch_scc1 L_lp_60
    s_add_u32 s35, s83, 1792
    buffer_load_dword v26, v115, s[8:11], s35 offen
    s_add_u32 s35, s88, 7340032
    buffer_load_dword v27, v126, s[12:15], s35 offen
L_lp_60:
    s_cmp_eq_u32 s30, 3
    s_cbranch_scc1 L_lw_61
    s_waitcnt vmcnt(0)
L_lw_61:
    s_waitcnt vmcnt(2)
    s_barrier
    s_lshr_b32 s81, s30, 1
    s_cmp_lg_u32 s81, 1
    s_cbranch_scc1 L_qp_62
    s_and_b32 s81, s49, 1
    s_lshl_b32 s81, s81, 6
    s_add_u32 s81, s81, s54
    s_mul_i32 s81, s81, 896
    s_lshl_b32 s82, s30, 7
    s_add_u32 s81, s81, s82
    v_mul_u32_u24 v18, 896, v1
    buffer_load_dword v20, v18, s[44:47], s81 offen
L_qp_62:
    ds_read_b64_tr_b16 v[32:33], v10 offset:0
    ds_read_b64_tr_b16 v[34:35], v10 offset:2048
    ds_read_b64_tr_b16 v[36:37], v11 offset:0
    ds_read_b64_tr_b16 v[38:39], v11 offset:2048
    ds_read_b64_tr_b16 v[40:41], v12 offset:0
    ds_read_b64_tr_b16 v[42:43], v12 offset:2048
    ds_read_b64_tr_b16 v[44:45], v13 offset:0
    ds_read_b64_tr_b16 v[46:47], v13 offset:2048
    ds_read_b128 v[64:67], v6 offset:0
    ds_read_b128 v[68:71], v6 offset:2048
    ds_read_b128 v[72:75], v6 offset:4096
    ds_read_b128 v[76:79], v6 offset:6144
    ds_read_b128 v[80:83], v6 offset:8192
    ds_read_b128 v[84:87], v6 offset:10240
    ds_read_b128 v[88:91], v6 offset:12288
    ds_read_b128 v[92:95], v6 offset:14336
    s_waitcnt lgkmcnt(4)
    s_add_u32 m0, s31, 65536
    s_add_u32 s35, s33, 1664
    buffer_load_dwordx4 v2, s[8:11], s35 offen lds
    s_add_u32 m0, s31, 66560
    s_add_u32 s35, s33, 18048
    buffer_load_dwordx4 v3, s[8:11], s35 offen lds
    s_add_u32 m0, s31, 67584
    s_add_u32 s35, s33, 34432
    buffer_load_dwordx4 v2, s[8:11], s35 offen lds
    s_add_u32 m0, s31, 68608
    s_add_u32 s35, s33, 50816
    buffer_load_dwordx4 v3, s[8:11], s35 offen lds
    v_mfma_f32_16x16x32_bf16 v[128:131], v[64:67], v[32:35], v[128:131]
    v_mfma_f32_16x16x32_bf16 v[132:135], v[64:67], v[36:39], v[132:135]
    v_mfma_f32_16x16x32_bf16 v[136:139], v[64:67], v[40:43], v[136:139]
    v_mfma_f32_16x16x32_bf16 v[140:143], v[64:67], v[44:47], v[140:143]
    v_mfma_f32_16x16x32_bf16 v[144:147], v[68:71], v[32:35], v[144:147]
    v_mfma_f32_16x16x32_bf16 v[148:151], v[68:71], v[36:39], v[148:151]
    v_mfma_f32_16x16x32_bf16 v[152:155], v[68:71], v[40:43], v[152:155]
    v_mfma_f32_16x16x32_bf16 v[156:159], v[68:71], v[44:47], v[156:159]
    v_mfma_f32_16x16x32_bf16 v[160:163], v[72:75], v[32:35], v[160:163]
    v_mfma_f32_16x16x32_bf16 v[164:167], v[72:75], v[36:39], v[164:167]
    v_mfma_f32_16x16x32_bf16 v[168:171], v[72:75], v[40:43], v[168:171]
    v_mfma_f32_16x16x32_bf16 v[172:175], v[72:75], v[44:47], v[172:175]
    v_mfma_f32_16x16x32_bf16 v[176:179], v[76:79], v[32:35], v[176:179]
    v_mfma_f32_16x16x32_bf16 v[180:183], v[76:79], v[36:39], v[180:183]
    v_mfma_f32_16x16x32_bf16 v[184:187], v[76:79], v[40:43], v[184:187]
    v_mfma_f32_16x16x32_bf16 v[188:191], v[76:79], v[44:47], v[188:191]
    ds_read_b64_tr_b16 v[48:49], v10 offset:16384
    ds_read_b64_tr_b16 v[50:51], v10 offset:18432
    ds_read_b64_tr_b16 v[52:53], v11 offset:16384
    ds_read_b64_tr_b16 v[54:55], v11 offset:18432
    ds_read_b64_tr_b16 v[56:57], v12 offset:16384
    ds_read_b64_tr_b16 v[58:59], v12 offset:18432
    ds_read_b64_tr_b16 v[60:61], v13 offset:16384
    ds_read_b64_tr_b16 v[62:63], v13 offset:18432
    ds_read_b128 v[64:67], v7 offset:0
    ds_read_b128 v[68:71], v7 offset:2048
    ds_read_b128 v[72:75], v7 offset:4096
    ds_read_b128 v[76:79], v7 offset:6144
    s_waitcnt lgkmcnt(12)
    s_add_u32 m0, s32, 98304
    s_add_u32 s35, s34, 6815744
    buffer_load_dwordx4 v4, s[12:15], s35 offen lds
    s_add_u32 m0, s32, 99328
    s_add_u32 s35, s34, 6832128
    buffer_load_dwordx4 v5, s[12:15], s35 offen lds
    s_add_u32 m0, s32, 100352
    s_add_u32 s35, s34, 6848512
    buffer_load_dwordx4 v4, s[12:15], s35 offen lds
    s_add_u32 m0, s32, 101376
    s_add_u32 s35, s34, 6864896
    buffer_load_dwordx4 v5, s[12:15], s35 offen lds
    v_mfma_f32_16x16x32_bf16 v[192:195], v[80:83], v[32:35], v[192:195]
    v_mfma_f32_16x16x32_bf16 v[196:199], v[80:83], v[36:39], v[196:199]
    v_mfma_f32_16x16x32_bf16 v[200:203], v[80:83], v[40:43], v[200:203]
    v_mfma_f32_16x16x32_bf16 v[204:207], v[80:83], v[44:47], v[204:207]
    v_mfma_f32_16x16x32_bf16 v[208:211], v[84:87], v[32:35], v[208:211]
    v_mfma_f32_16x16x32_bf16 v[212:215], v[84:87], v[36:39], v[212:215]
    v_mfma_f32_16x16x32_bf16 v[216:219], v[84:87], v[40:43], v[216:219]
    v_mfma_f32_16x16x32_bf16 v[220:223], v[84:87], v[44:47], v[220:223]
    v_mfma_f32_16x16x32_bf16 v[224:227], v[88:91], v[32:35], v[224:227]
    v_mfma_f32_16x16x32_bf16 v[228:231], v[88:91], v[36:39], v[228:231]
    v_mfma_f32_16x16x32_bf16 v[232:235], v[88:91], v[40:43], v[232:235]
    v_mfma_f32_16x16x32_bf16 v[236:239], v[88:91], v[44:47], v[236:239]
    v_mfma_f32_16x16x32_bf16 v[240:243], v[92:95], v[32:35], v[240:243]
    v_mfma_f32_16x16x32_bf16 v[244:247], v[92:95], v[36:39], v[244:247]
    v_mfma_f32_16x16x32_bf16 v[248:251], v[92:95], v[40:43], v[248:251]
    v_mfma_f32_16x16x32_bf16 v[252:255], v[92:95], v[44:47], v[252:255]
    ds_read_b128 v[80:83], v7 offset:8192
    ds_read_b128 v[84:87], v7 offset:10240
    ds_read_b128 v[88:91], v7 offset:12288
    ds_read_b128 v[92:95], v7 offset:14336
    s_waitcnt lgkmcnt(4)
    v_mfma_f32_16x16x32_bf16 v[128:131], v[64:67], v[48:51], v[128:131]
    v_mfma_f32_16x16x32_bf16 v[132:135], v[64:67], v[52:55], v[132:135]
    v_mfma_f32_16x16x32_bf16 v[136:139], v[64:67], v[56:59], v[136:139]
    v_mfma_f32_16x16x32_bf16 v[140:143], v[64:67], v[60:63], v[140:143]
    v_mfma_f32_16x16x32_bf16 v[144:147], v[68:71], v[48:51], v[144:147]
    v_mfma_f32_16x16x32_bf16 v[148:151], v[68:71], v[52:55], v[148:151]
    v_mfma_f32_16x16x32_bf16 v[152:155], v[68:71], v[56:59], v[152:155]
    v_mfma_f32_16x16x32_bf16 v[156:159], v[68:71], v[60:63], v[156:159]
    v_mfma_f32_16x16x32_bf16 v[160:163], v[72:75], v[48:51], v[160:163]
    v_mfma_f32_16x16x32_bf16 v[164:167], v[72:75], v[52:55], v[164:167]
    v_mfma_f32_16x16x32_bf16 v[168:171], v[72:75], v[56:59], v[168:171]
    v_mfma_f32_16x16x32_bf16 v[172:175], v[72:75], v[60:63], v[172:175]
    v_mfma_f32_16x16x32_bf16 v[176:179], v[76:79], v[48:51], v[176:179]
    v_mfma_f32_16x16x32_bf16 v[180:183], v[76:79], v[52:55], v[180:183]
    v_mfma_f32_16x16x32_bf16 v[184:187], v[76:79], v[56:59], v[184:187]
    v_mfma_f32_16x16x32_bf16 v[188:191], v[76:79], v[60:63], v[188:191]
    s_waitcnt lgkmcnt(0)
    v_mfma_f32_16x16x32_bf16 v[192:195], v[80:83], v[48:51], v[192:195]
    v_mfma_f32_16x16x32_bf16 v[196:199], v[80:83], v[52:55], v[196:199]
    v_mfma_f32_16x16x32_bf16 v[200:203], v[80:83], v[56:59], v[200:203]
    v_mfma_f32_16x16x32_bf16 v[204:207], v[80:83], v[60:63], v[204:207]
    v_mfma_f32_16x16x32_bf16 v[208:211], v[84:87], v[48:51], v[208:211]
    v_mfma_f32_16x16x32_bf16 v[212:215], v[84:87], v[52:55], v[212:215]
    v_mfma_f32_16x16x32_bf16 v[216:219], v[84:87], v[56:59], v[216:219]
    v_mfma_f32_16x16x32_bf16 v[220:223], v[84:87], v[60:63], v[220:223]
    v_mfma_f32_16x16x32_bf16 v[224:227], v[88:91], v[48:51], v[224:227]
    v_mfma_f32_16x16x32_bf16 v[228:231], v[88:91], v[52:55], v[228:231]
    v_mfma_f32_16x16x32_bf16 v[232:235], v[88:91], v[56:59], v[232:235]
    v_mfma_f32_16x16x32_bf16 v[236:239], v[88:91], v[60:63], v[236:239]
    v_mfma_f32_16x16x32_bf16 v[240:243], v[92:95], v[48:51], v[240:243]
    v_mfma_f32_16x16x32_bf16 v[244:247], v[92:95], v[52:55], v[244:247]
    v_mfma_f32_16x16x32_bf16 v[248:251], v[92:95], v[56:59], v[248:251]
    v_mfma_f32_16x16x32_bf16 v[252:255], v[92:95], v[60:63], v[252:255]
    s_cmp_lg_u32 s30, 4
    s_cbranch_scc1 L_lp_63
    s_add_u32 s35, s83, 1920
    buffer_load_dword v26, v115, s[8:11], s35 offen
    s_add_u32 s35, s88, 7864320
    buffer_load_dword v27, v126, s[12:15], s35 offen
L_lp_63:
    s_cmp_eq_u32 s30, 4
    s_cbranch_scc1 L_lw_64
    s_waitcnt vmcnt(0)
L_lw_64:
    s_waitcnt vmcnt(2)
    s_barrier
    s_lshr_b32 s81, s30, 1
    s_cmp_lg_u32 s81, 2
    s_cbranch_scc1 L_qp_65
    s_and_b32 s81, s49, 1
    s_lshl_b32 s81, s81, 6
    s_add_u32 s81, s81, s54
    s_mul_i32 s81, s81, 896
    s_lshl_b32 s82, s30, 7
    s_add_u32 s81, s81, s82
    v_mul_u32_u24 v18, 896, v1
    buffer_load_dword v20, v18, s[44:47], s81 offen
L_qp_65:
    ds_read_b64_tr_b16 v[32:33], v14 offset:0
    ds_read_b64_tr_b16 v[34:35], v14 offset:2048
    ds_read_b64_tr_b16 v[36:37], v15 offset:0
    ds_read_b64_tr_b16 v[38:39], v15 offset:2048
    ds_read_b64_tr_b16 v[40:41], v16 offset:0
    ds_read_b64_tr_b16 v[42:43], v16 offset:2048
    ds_read_b64_tr_b16 v[44:45], v17 offset:0
    ds_read_b64_tr_b16 v[46:47], v17 offset:2048
    ds_read_b128 v[64:67], v8 offset:0
    ds_read_b128 v[68:71], v8 offset:2048
    ds_read_b128 v[72:75], v8 offset:4096
    ds_read_b128 v[76:79], v8 offset:6144
    ds_read_b128 v[80:83], v8 offset:8192
    ds_read_b128 v[84:87], v8 offset:10240
    ds_read_b128 v[88:91], v8 offset:12288
    ds_read_b128 v[92:95], v8 offset:14336
    s_waitcnt lgkmcnt(4)
    s_add_u32 m0, s31, 0
    s_add_u32 s35, s33, 1792
    buffer_load_dwordx4 v2, s[8:11], s35 offen lds
    s_add_u32 m0, s31, 1024
    s_add_u32 s35, s33, 18176
    buffer_load_dwordx4 v3, s[8:11], s35 offen lds
    s_add_u32 m0, s31, 2048
    s_add_u32 s35, s33, 34560
    buffer_load_dwordx4 v2, s[8:11], s35 offen lds
    s_add_u32 m0, s31, 3072
    s_add_u32 s35, s33, 50944
    buffer_load_dwordx4 v3, s[8:11], s35 offen lds
    v_mfma_f32_16x16x32_bf16 v[128:131], v[64:67], v[32:35], v[128:131]
    v_mfma_f32_16x16x32_bf16 v[132:135], v[64:67], v[36:39], v[132:135]
    v_mfma_f32_16x16x32_bf16 v[136:139], v[64:67], v[40:43], v[136:139]
    v_mfma_f32_16x16x32_bf16 v[140:143], v[64:67], v[44:47], v[140:143]
    v_mfma_f32_16x16x32_bf16 v[144:147], v[68:71], v[32:35], v[144:147]
    v_mfma_f32_16x16x32_bf16 v[148:151], v[68:71], v[36:39], v[148:151]
    v_mfma_f32_16x16x32_bf16 v[152:155], v[68:71], v[40:43], v[152:155]
    v_mfma_f32_16x16x32_bf16 v[156:159], v[68:71], v[44:47], v[156:159]
    v_mfma_f32_16x16x32_bf16 v[160:163], v[72:75], v[32:35], v[160:163]
    v_mfma_f32_16x16x32_bf16 v[164:167], v[72:75], v[36:39], v[164:167]
    v_mfma_f32_16x16x32_bf16 v[168:171], v[72:75], v[40:43], v[168:171]
    v_mfma_f32_16x16x32_bf16 v[172:175], v[72:75], v[44:47], v[172:175]
    v_mfma_f32_16x16x32_bf16 v[176:179], v[76:79], v[32:35], v[176:179]
    v_mfma_f32_16x16x32_bf16 v[180:183], v[76:79], v[36:39], v[180:183]
    v_mfma_f32_16x16x32_bf16 v[184:187], v[76:79], v[40:43], v[184:187]
    v_mfma_f32_16x16x32_bf16 v[188:191], v[76:79], v[44:47], v[188:191]
    ds_read_b64_tr_b16 v[48:49], v14 offset:16384
    ds_read_b64_tr_b16 v[50:51], v14 offset:18432
    ds_read_b64_tr_b16 v[52:53], v15 offset:16384
    ds_read_b64_tr_b16 v[54:55], v15 offset:18432
    ds_read_b64_tr_b16 v[56:57], v16 offset:16384
    ds_read_b64_tr_b16 v[58:59], v16 offset:18432
    ds_read_b64_tr_b16 v[60:61], v17 offset:16384
    ds_read_b64_tr_b16 v[62:63], v17 offset:18432
    ds_read_b128 v[64:67], v9 offset:0
    ds_read_b128 v[68:71], v9 offset:2048
    ds_read_b128 v[72:75], v9 offset:4096
    ds_read_b128 v[76:79], v9 offset:6144
    s_waitcnt lgkmcnt(12)
    s_add_u32 m0, s32, 32768
    s_add_u32 s35, s34, 7340032
    buffer_load_dwordx4 v4, s[12:15], s35 offen lds
    s_add_u32 m0, s32, 33792
    s_add_u32 s35, s34, 7356416
    buffer_load_dwordx4 v5, s[12:15], s35 offen lds
    s_add_u32 m0, s32, 34816
    s_add_u32 s35, s34, 7372800
    buffer_load_dwordx4 v4, s[12:15], s35 offen lds
    s_add_u32 m0, s32, 35840
    s_add_u32 s35, s34, 7389184
    buffer_load_dwordx4 v5, s[12:15], s35 offen lds
    v_mfma_f32_16x16x32_bf16 v[192:195], v[80:83], v[32:35], v[192:195]
    v_mfma_f32_16x16x32_bf16 v[196:199], v[80:83], v[36:39], v[196:199]
    v_mfma_f32_16x16x32_bf16 v[200:203], v[80:83], v[40:43], v[200:203]
    v_mfma_f32_16x16x32_bf16 v[204:207], v[80:83], v[44:47], v[204:207]
    v_mfma_f32_16x16x32_bf16 v[208:211], v[84:87], v[32:35], v[208:211]
    v_mfma_f32_16x16x32_bf16 v[212:215], v[84:87], v[36:39], v[212:215]
    v_mfma_f32_16x16x32_bf16 v[216:219], v[84:87], v[40:43], v[216:219]
    v_mfma_f32_16x16x32_bf16 v[220:223], v[84:87], v[44:47], v[220:223]
    v_mfma_f32_16x16x32_bf16 v[224:227], v[88:91], v[32:35], v[224:227]
    v_mfma_f32_16x16x32_bf16 v[228:231], v[88:91], v[36:39], v[228:231]
    v_mfma_f32_16x16x32_bf16 v[232:235], v[88:91], v[40:43], v[232:235]
    v_mfma_f32_16x16x32_bf16 v[236:239], v[88:91], v[44:47], v[236:239]
    v_mfma_f32_16x16x32_bf16 v[240:243], v[92:95], v[32:35], v[240:243]
    v_mfma_f32_16x16x32_bf16 v[244:247], v[92:95], v[36:39], v[244:247]
    v_mfma_f32_16x16x32_bf16 v[248:251], v[92:95], v[40:43], v[248:251]
    v_mfma_f32_16x16x32_bf16 v[252:255], v[92:95], v[44:47], v[252:255]
    ds_read_b128 v[80:83], v9 offset:8192
    ds_read_b128 v[84:87], v9 offset:10240
    ds_read_b128 v[88:91], v9 offset:12288
    ds_read_b128 v[92:95], v9 offset:14336
    s_waitcnt lgkmcnt(4)
    v_mfma_f32_16x16x32_bf16 v[128:131], v[64:67], v[48:51], v[128:131]
    v_mfma_f32_16x16x32_bf16 v[132:135], v[64:67], v[52:55], v[132:135]
    v_mfma_f32_16x16x32_bf16 v[136:139], v[64:67], v[56:59], v[136:139]
    v_mfma_f32_16x16x32_bf16 v[140:143], v[64:67], v[60:63], v[140:143]
    v_mfma_f32_16x16x32_bf16 v[144:147], v[68:71], v[48:51], v[144:147]
    v_mfma_f32_16x16x32_bf16 v[148:151], v[68:71], v[52:55], v[148:151]
    v_mfma_f32_16x16x32_bf16 v[152:155], v[68:71], v[56:59], v[152:155]
    v_mfma_f32_16x16x32_bf16 v[156:159], v[68:71], v[60:63], v[156:159]
    v_mfma_f32_16x16x32_bf16 v[160:163], v[72:75], v[48:51], v[160:163]
    v_mfma_f32_16x16x32_bf16 v[164:167], v[72:75], v[52:55], v[164:167]
    v_mfma_f32_16x16x32_bf16 v[168:171], v[72:75], v[56:59], v[168:171]
    v_mfma_f32_16x16x32_bf16 v[172:175], v[72:75], v[60:63], v[172:175]
    v_mfma_f32_16x16x32_bf16 v[176:179], v[76:79], v[48:51], v[176:179]
    v_mfma_f32_16x16x32_bf16 v[180:183], v[76:79], v[52:55], v[180:183]
    v_mfma_f32_16x16x32_bf16 v[184:187], v[76:79], v[56:59], v[184:187]
    v_mfma_f32_16x16x32_bf16 v[188:191], v[76:79], v[60:63], v[188:191]
    s_waitcnt lgkmcnt(0)
    v_mfma_f32_16x16x32_bf16 v[192:195], v[80:83], v[48:51], v[192:195]
    v_mfma_f32_16x16x32_bf16 v[196:199], v[80:83], v[52:55], v[196:199]
    v_mfma_f32_16x16x32_bf16 v[200:203], v[80:83], v[56:59], v[200:203]
    v_mfma_f32_16x16x32_bf16 v[204:207], v[80:83], v[60:63], v[204:207]
    v_mfma_f32_16x16x32_bf16 v[208:211], v[84:87], v[48:51], v[208:211]
    v_mfma_f32_16x16x32_bf16 v[212:215], v[84:87], v[52:55], v[212:215]
    v_mfma_f32_16x16x32_bf16 v[216:219], v[84:87], v[56:59], v[216:219]
    v_mfma_f32_16x16x32_bf16 v[220:223], v[84:87], v[60:63], v[220:223]
    v_mfma_f32_16x16x32_bf16 v[224:227], v[88:91], v[48:51], v[224:227]
    v_mfma_f32_16x16x32_bf16 v[228:231], v[88:91], v[52:55], v[228:231]
    v_mfma_f32_16x16x32_bf16 v[232:235], v[88:91], v[56:59], v[232:235]
    v_mfma_f32_16x16x32_bf16 v[236:239], v[88:91], v[60:63], v[236:239]
    v_mfma_f32_16x16x32_bf16 v[240:243], v[92:95], v[48:51], v[240:243]
    v_mfma_f32_16x16x32_bf16 v[244:247], v[92:95], v[52:55], v[244:247]
    v_mfma_f32_16x16x32_bf16 v[248:251], v[92:95], v[56:59], v[248:251]
    v_mfma_f32_16x16x32_bf16 v[252:255], v[92:95], v[60:63], v[252:255]
    s_waitcnt vmcnt(0)
    s_barrier
    s_lshr_b32 s81, s30, 1
    s_cmp_lg_u32 s81, 3
    s_cbranch_scc1 L_qp_66
    s_and_b32 s81, s49, 1
    s_lshl_b32 s81, s81, 6
    s_add_u32 s81, s81, s54
    s_mul_i32 s81, s81, 896
    s_lshl_b32 s82, s30, 7
    s_add_u32 s81, s81, s82
    v_mul_u32_u24 v18, 896, v1
    s_cmp_eq_u32 s30, 7
    s_cbranch_scc1 L_qp_66_w
    buffer_load_dword v20, v18, s[44:47], s81 offen
    s_branch L_qp_66
L_qp_66_w:
    s_mov_b32 s72, s20
    s_mov_b32 s73, s21
    s_mov_b32 s74, 3670016
    s_mov_b32 s75, 0x00020000
    s_lshr_b32 s81, s49, 1
    s_mul_i32 s81, s81, 28
    s_lshl_b32 s81, s81, 13
    s_add_u32 s81, s81, s55
    v_lshrrev_b32 v19, 2, v1
    v_lshlrev_b32 v19, 13, v19
    v_and_b32 v21, 3, v1
    v_lshl_add_u32 v19, v21, 7, v19
    buffer_load_dword v21, v19, s[72:75], s81 offen
    s_add_u32 s81, s81, 131072
    buffer_load_dword v20, v19, s[72:75], s81 offen
L_qp_66:
    ds_read_b64_tr_b16 v[32:33], v10 offset:0
    ds_read_b64_tr_b16 v[34:35], v10 offset:2048
    ds_read_b64_tr_b16 v[36:37], v11 offset:0
    ds_read_b64_tr_b16 v[38:39], v11 offset:2048
    ds_read_b64_tr_b16 v[40:41], v12 offset:0
    ds_read_b64_tr_b16 v[42:43], v12 offset:2048
    ds_read_b64_tr_b16 v[44:45], v13 offset:0
    ds_read_b64_tr_b16 v[46:47], v13 offset:2048
    ds_read_b128 v[64:67], v6 offset:0
    ds_read_b128 v[68:71], v6 offset:2048
    ds_read_b128 v[72:75], v6 offset:4096
    ds_read_b128 v[76:79], v6 offset:6144
    ds_read_b128 v[80:83], v6 offset:8192
    ds_read_b128 v[84:87], v6 offset:10240
    ds_read_b128 v[88:91], v6 offset:12288
    ds_read_b128 v[92:95], v6 offset:14336
    s_waitcnt lgkmcnt(4)
    s_add_u32 m0, s31, 65536
    s_add_u32 s35, s33, 1920
    buffer_load_dwordx4 v2, s[8:11], s35 offen lds
    s_add_u32 m0, s31, 66560
    s_add_u32 s35, s33, 18304
    buffer_load_dwordx4 v3, s[8:11], s35 offen lds
    s_add_u32 m0, s31, 67584
    s_add_u32 s35, s33, 34688
    buffer_load_dwordx4 v2, s[8:11], s35 offen lds
    s_add_u32 m0, s31, 68608
    s_add_u32 s35, s33, 51072
    buffer_load_dwordx4 v3, s[8:11], s35 offen lds
    v_mfma_f32_16x16x32_bf16 v[128:131], v[64:67], v[32:35], v[128:131]
    v_mfma_f32_16x16x32_bf16 v[132:135], v[64:67], v[36:39], v[132:135]
    v_mfma_f32_16x16x32_bf16 v[136:139], v[64:67], v[40:43], v[136:139]
    v_mfma_f32_16x16x32_bf16 v[140:143], v[64:67], v[44:47], v[140:143]
    v_mfma_f32_16x16x32_bf16 v[144:147], v[68:71], v[32:35], v[144:147]
    v_mfma_f32_16x16x32_bf16 v[148:151], v[68:71], v[36:39], v[148:151]
    v_mfma_f32_16x16x32_bf16 v[152:155], v[68:71], v[40:43], v[152:155]
    v_mfma_f32_16x16x32_bf16 v[156:159], v[68:71], v[44:47], v[156:159]
    v_mfma_f32_16x16x32_bf16 v[160:163], v[72:75], v[32:35], v[160:163]
    v_mfma_f32_16x16x32_bf16 v[164:167], v[72:75], v[36:39], v[164:167]
    v_mfma_f32_16x16x32_bf16 v[168:171], v[72:75], v[40:43], v[168:171]
    v_mfma_f32_16x16x32_bf16 v[172:175], v[72:75], v[44:47], v[172:175]
    v_mfma_f32_16x16x32_bf16 v[176:179], v[76:79], v[32:35], v[176:179]
    v_mfma_f32_16x16x32_bf16 v[180:183], v[76:79], v[36:39], v[180:183]
    v_mfma_f32_16x16x32_bf16 v[184:187], v[76:79], v[40:43], v[184:187]
    v_mfma_f32_16x16x32_bf16 v[188:191], v[76:79], v[44:47], v[188:191]
    ds_read_b64_tr_b16 v[48:49], v10 offset:16384
    ds_read_b64_tr_b16 v[50:51], v10 offset:18432
    ds_read_b64_tr_b16 v[52:53], v11 offset:16384
    ds_read_b64_tr_b16 v[54:55], v11 offset:18432
    ds_read_b64_tr_b16 v[56:57], v12 offset:16384
    ds_read_b64_tr_b16 v[58:59], v12 offset:18432
    ds_read_b64_tr_b16 v[60:61], v13 offset:16384
    ds_read_b64_tr_b16 v[62:63], v13 offset:18432
    ds_read_b128 v[64:67], v7 offset:0
    ds_read_b128 v[68:71], v7 offset:2048
    ds_read_b128 v[72:75], v7 offset:4096
    ds_read_b128 v[76:79], v7 offset:6144
    s_waitcnt lgkmcnt(12)
    s_add_u32 m0, s32, 98304
    s_add_u32 s35, s34, 7864320
    buffer_load_dwordx4 v4, s[12:15], s35 offen lds
    s_add_u32 m0, s32, 99328
    s_add_u32 s35, s34, 7880704
    buffer_load_dwordx4 v5, s[12:15], s35 offen lds
    s_add_u32 m0, s32, 100352
    s_add_u32 s35, s34, 7897088
    buffer_load_dwordx4 v4, s[12:15], s35 offen lds
    s_add_u32 m0, s32, 101376
    s_add_u32 s35, s34, 7913472
    buffer_load_dwordx4 v5, s[12:15], s35 offen lds
    v_mfma_f32_16x16x32_bf16 v[192:195], v[80:83], v[32:35], v[192:195]
    v_mfma_f32_16x16x32_bf16 v[196:199], v[80:83], v[36:39], v[196:199]
    v_mfma_f32_16x16x32_bf16 v[200:203], v[80:83], v[40:43], v[200:203]
    v_mfma_f32_16x16x32_bf16 v[204:207], v[80:83], v[44:47], v[204:207]
    v_mfma_f32_16x16x32_bf16 v[208:211], v[84:87], v[32:35], v[208:211]
    v_mfma_f32_16x16x32_bf16 v[212:215], v[84:87], v[36:39], v[212:215]
    v_mfma_f32_16x16x32_bf16 v[216:219], v[84:87], v[40:43], v[216:219]
    v_mfma_f32_16x16x32_bf16 v[220:223], v[84:87], v[44:47], v[220:223]
    v_mfma_f32_16x16x32_bf16 v[224:227], v[88:91], v[32:35], v[224:227]
    v_mfma_f32_16x16x32_bf16 v[228:231], v[88:91], v[36:39], v[228:231]
    v_mfma_f32_16x16x32_bf16 v[232:235], v[88:91], v[40:43], v[232:235]
    v_mfma_f32_16x16x32_bf16 v[236:239], v[88:91], v[44:47], v[236:239]
    v_mfma_f32_16x16x32_bf16 v[240:243], v[92:95], v[32:35], v[240:243]
    v_mfma_f32_16x16x32_bf16 v[244:247], v[92:95], v[36:39], v[244:247]
    v_mfma_f32_16x16x32_bf16 v[248:251], v[92:95], v[40:43], v[248:251]
    v_mfma_f32_16x16x32_bf16 v[252:255], v[92:95], v[44:47], v[252:255]
    ds_read_b128 v[80:83], v7 offset:8192
    ds_read_b128 v[84:87], v7 offset:10240
    ds_read_b128 v[88:91], v7 offset:12288
    ds_read_b128 v[92:95], v7 offset:14336
    s_waitcnt lgkmcnt(4)
    v_mfma_f32_16x16x32_bf16 v[128:131], v[64:67], v[48:51], v[128:131]
    v_mfma_f32_16x16x32_bf16 v[132:135], v[64:67], v[52:55], v[132:135]
    v_mfma_f32_16x16x32_bf16 v[136:139], v[64:67], v[56:59], v[136:139]
    v_mfma_f32_16x16x32_bf16 v[140:143], v[64:67], v[60:63], v[140:143]
    v_mfma_f32_16x16x32_bf16 v[144:147], v[68:71], v[48:51], v[144:147]
    v_mfma_f32_16x16x32_bf16 v[148:151], v[68:71], v[52:55], v[148:151]
    v_mfma_f32_16x16x32_bf16 v[152:155], v[68:71], v[56:59], v[152:155]
    v_mfma_f32_16x16x32_bf16 v[156:159], v[68:71], v[60:63], v[156:159]
    v_mfma_f32_16x16x32_bf16 v[160:163], v[72:75], v[48:51], v[160:163]
    v_mfma_f32_16x16x32_bf16 v[164:167], v[72:75], v[52:55], v[164:167]
    v_mfma_f32_16x16x32_bf16 v[168:171], v[72:75], v[56:59], v[168:171]
    v_mfma_f32_16x16x32_bf16 v[172:175], v[72:75], v[60:63], v[172:175]
    v_mfma_f32_16x16x32_bf16 v[176:179], v[76:79], v[48:51], v[176:179]
    v_mfma_f32_16x16x32_bf16 v[180:183], v[76:79], v[52:55], v[180:183]
    v_mfma_f32_16x16x32_bf16 v[184:187], v[76:79], v[56:59], v[184:187]
    v_mfma_f32_16x16x32_bf16 v[188:191], v[76:79], v[60:63], v[188:191]
    s_waitcnt lgkmcnt(0)
    v_mfma_f32_16x16x32_bf16 v[192:195], v[80:83], v[48:51], v[192:195]
    v_mfma_f32_16x16x32_bf16 v[196:199], v[80:83], v[52:55], v[196:199]
    v_mfma_f32_16x16x32_bf16 v[200:203], v[80:83], v[56:59], v[200:203]
    v_mfma_f32_16x16x32_bf16 v[204:207], v[80:83], v[60:63], v[204:207]
    v_mfma_f32_16x16x32_bf16 v[208:211], v[84:87], v[48:51], v[208:211]
    v_mfma_f32_16x16x32_bf16 v[212:215], v[84:87], v[52:55], v[212:215]
    v_mfma_f32_16x16x32_bf16 v[216:219], v[84:87], v[56:59], v[216:219]
    v_mfma_f32_16x16x32_bf16 v[220:223], v[84:87], v[60:63], v[220:223]
    v_mfma_f32_16x16x32_bf16 v[224:227], v[88:91], v[48:51], v[224:227]
    v_mfma_f32_16x16x32_bf16 v[228:231], v[88:91], v[52:55], v[228:231]
    v_mfma_f32_16x16x32_bf16 v[232:235], v[88:91], v[56:59], v[232:235]
    v_mfma_f32_16x16x32_bf16 v[236:239], v[88:91], v[60:63], v[236:239]
    v_mfma_f32_16x16x32_bf16 v[240:243], v[92:95], v[48:51], v[240:243]
    v_mfma_f32_16x16x32_bf16 v[244:247], v[92:95], v[52:55], v[244:247]
    v_mfma_f32_16x16x32_bf16 v[248:251], v[92:95], v[56:59], v[248:251]
    v_mfma_f32_16x16x32_bf16 v[252:255], v[92:95], v[60:63], v[252:255]
    s_waitcnt vmcnt(0)
    s_barrier
    ds_read_b64_tr_b16 v[32:33], v14 offset:0
    ds_read_b64_tr_b16 v[34:35], v14 offset:2048
    ds_read_b64_tr_b16 v[36:37], v15 offset:0
    ds_read_b64_tr_b16 v[38:39], v15 offset:2048
    ds_read_b64_tr_b16 v[40:41], v16 offset:0
    ds_read_b64_tr_b16 v[42:43], v16 offset:2048
    ds_read_b64_tr_b16 v[44:45], v17 offset:0
    ds_read_b64_tr_b16 v[46:47], v17 offset:2048
    ds_read_b128 v[64:67], v8 offset:0
    ds_read_b128 v[68:71], v8 offset:2048
    ds_read_b128 v[72:75], v8 offset:4096
    ds_read_b128 v[76:79], v8 offset:6144
    ds_read_b128 v[80:83], v8 offset:8192
    ds_read_b128 v[84:87], v8 offset:10240
    ds_read_b128 v[88:91], v8 offset:12288
    ds_read_b128 v[92:95], v8 offset:14336
    s_waitcnt lgkmcnt(4)
    v_mfma_f32_16x16x32_bf16 v[128:131], v[64:67], v[32:35], v[128:131]
    v_mfma_f32_16x16x32_bf16 v[132:135], v[64:67], v[36:39], v[132:135]
    v_mfma_f32_16x16x32_bf16 v[136:139], v[64:67], v[40:43], v[136:139]
    v_mfma_f32_16x16x32_bf16 v[140:143], v[64:67], v[44:47], v[140:143]
    v_mfma_f32_16x16x32_bf16 v[144:147], v[68:71], v[32:35], v[144:147]
    v_mfma_f32_16x16x32_bf16 v[148:151], v[68:71], v[36:39], v[148:151]
    v_mfma_f32_16x16x32_bf16 v[152:155], v[68:71], v[40:43], v[152:155]
    v_mfma_f32_16x16x32_bf16 v[156:159], v[68:71], v[44:47], v[156:159]
    v_mfma_f32_16x16x32_bf16 v[160:163], v[72:75], v[32:35], v[160:163]
    v_mfma_f32_16x16x32_bf16 v[164:167], v[72:75], v[36:39], v[164:167]
    v_mfma_f32_16x16x32_bf16 v[168:171], v[72:75], v[40:43], v[168:171]
    v_mfma_f32_16x16x32_bf16 v[172:175], v[72:75], v[44:47], v[172:175]
    v_mfma_f32_16x16x32_bf16 v[176:179], v[76:79], v[32:35], v[176:179]
    v_mfma_f32_16x16x32_bf16 v[180:183], v[76:79], v[36:39], v[180:183]
    v_mfma_f32_16x16x32_bf16 v[184:187], v[76:79], v[40:43], v[184:187]
    v_mfma_f32_16x16x32_bf16 v[188:191], v[76:79], v[44:47], v[188:191]
    ds_read_b64_tr_b16 v[48:49], v14 offset:16384
    ds_read_b64_tr_b16 v[50:51], v14 offset:18432
    ds_read_b64_tr_b16 v[52:53], v15 offset:16384
    ds_read_b64_tr_b16 v[54:55], v15 offset:18432
    ds_read_b64_tr_b16 v[56:57], v16 offset:16384
    ds_read_b64_tr_b16 v[58:59], v16 offset:18432
    ds_read_b64_tr_b16 v[60:61], v17 offset:16384
    ds_read_b64_tr_b16 v[62:63], v17 offset:18432
    ds_read_b128 v[64:67], v9 offset:0
    ds_read_b128 v[68:71], v9 offset:2048
    ds_read_b128 v[72:75], v9 offset:4096
    ds_read_b128 v[76:79], v9 offset:6144
    s_waitcnt lgkmcnt(12)
    v_mfma_f32_16x16x32_bf16 v[192:195], v[80:83], v[32:35], v[192:195]
    v_mfma_f32_16x16x32_bf16 v[196:199], v[80:83], v[36:39], v[196:199]
    v_mfma_f32_16x16x32_bf16 v[200:203], v[80:83], v[40:43], v[200:203]
    v_mfma_f32_16x16x32_bf16 v[204:207], v[80:83], v[44:47], v[204:207]
    v_mfma_f32_16x16x32_bf16 v[208:211], v[84:87], v[32:35], v[208:211]
    v_mfma_f32_16x16x32_bf16 v[212:215], v[84:87], v[36:39], v[212:215]
    v_mfma_f32_16x16x32_bf16 v[216:219], v[84:87], v[40:43], v[216:219]
    v_mfma_f32_16x16x32_bf16 v[220:223], v[84:87], v[44:47], v[220:223]
    v_mfma_f32_16x16x32_bf16 v[224:227], v[88:91], v[32:35], v[224:227]
    v_mfma_f32_16x16x32_bf16 v[228:231], v[88:91], v[36:39], v[228:231]
    v_mfma_f32_16x16x32_bf16 v[232:235], v[88:91], v[40:43], v[232:235]
    v_mfma_f32_16x16x32_bf16 v[236:239], v[88:91], v[44:47], v[236:239]
    v_mfma_f32_16x16x32_bf16 v[240:243], v[92:95], v[32:35], v[240:243]
    v_mfma_f32_16x16x32_bf16 v[244:247], v[92:95], v[36:39], v[244:247]
    v_mfma_f32_16x16x32_bf16 v[248:251], v[92:95], v[40:43], v[248:251]
    v_mfma_f32_16x16x32_bf16 v[252:255], v[92:95], v[44:47], v[252:255]
    ds_read_b128 v[80:83], v9 offset:8192
    ds_read_b128 v[84:87], v9 offset:10240
    ds_read_b128 v[88:91], v9 offset:12288
    ds_read_b128 v[92:95], v9 offset:14336
    s_waitcnt lgkmcnt(4)
    v_mfma_f32_16x16x32_bf16 v[128:131], v[64:67], v[48:51], v[128:131]
    v_mfma_f32_16x16x32_bf16 v[132:135], v[64:67], v[52:55], v[132:135]
    v_mfma_f32_16x16x32_bf16 v[136:139], v[64:67], v[56:59], v[136:139]
    v_mfma_f32_16x16x32_bf16 v[140:143], v[64:67], v[60:63], v[140:143]
    v_mfma_f32_16x16x32_bf16 v[144:147], v[68:71], v[48:51], v[144:147]
    v_mfma_f32_16x16x32_bf16 v[148:151], v[68:71], v[52:55], v[148:151]
    v_mfma_f32_16x16x32_bf16 v[152:155], v[68:71], v[56:59], v[152:155]
    v_mfma_f32_16x16x32_bf16 v[156:159], v[68:71], v[60:63], v[156:159]
    v_mfma_f32_16x16x32_bf16 v[160:163], v[72:75], v[48:51], v[160:163]
    v_mfma_f32_16x16x32_bf16 v[164:167], v[72:75], v[52:55], v[164:167]
    v_mfma_f32_16x16x32_bf16 v[168:171], v[72:75], v[56:59], v[168:171]
    v_mfma_f32_16x16x32_bf16 v[172:175], v[72:75], v[60:63], v[172:175]
    v_mfma_f32_16x16x32_bf16 v[176:179], v[76:79], v[48:51], v[176:179]
    v_mfma_f32_16x16x32_bf16 v[180:183], v[76:79], v[52:55], v[180:183]
    v_mfma_f32_16x16x32_bf16 v[184:187], v[76:79], v[56:59], v[184:187]
    v_mfma_f32_16x16x32_bf16 v[188:191], v[76:79], v[60:63], v[188:191]
    s_waitcnt lgkmcnt(0)
    v_mfma_f32_16x16x32_bf16 v[192:195], v[80:83], v[48:51], v[192:195]
    v_mfma_f32_16x16x32_bf16 v[196:199], v[80:83], v[52:55], v[196:199]
    v_mfma_f32_16x16x32_bf16 v[200:203], v[80:83], v[56:59], v[200:203]
    v_mfma_f32_16x16x32_bf16 v[204:207], v[80:83], v[60:63], v[204:207]
    v_mfma_f32_16x16x32_bf16 v[208:211], v[84:87], v[48:51], v[208:211]
    v_mfma_f32_16x16x32_bf16 v[212:215], v[84:87], v[52:55], v[212:215]
    v_mfma_f32_16x16x32_bf16 v[216:219], v[84:87], v[56:59], v[216:219]
    v_mfma_f32_16x16x32_bf16 v[220:223], v[84:87], v[60:63], v[220:223]
    v_mfma_f32_16x16x32_bf16 v[224:227], v[88:91], v[48:51], v[224:227]
    v_mfma_f32_16x16x32_bf16 v[228:231], v[88:91], v[52:55], v[228:231]
    v_mfma_f32_16x16x32_bf16 v[232:235], v[88:91], v[56:59], v[232:235]
    v_mfma_f32_16x16x32_bf16 v[236:239], v[88:91], v[60:63], v[236:239]
    v_mfma_f32_16x16x32_bf16 v[240:243], v[92:95], v[48:51], v[240:243]
    v_mfma_f32_16x16x32_bf16 v[244:247], v[92:95], v[52:55], v[244:247]
    v_mfma_f32_16x16x32_bf16 v[248:251], v[92:95], v[56:59], v[248:251]
    v_mfma_f32_16x16x32_bf16 v[252:255], v[92:95], v[60:63], v[252:255]
    s_barrier
    s_mov_b32 s8, s4
    s_mov_b32 s9, s5
    s_mov_b32 s10, 1835008
    s_mov_b32 s11, 0x00020000
    s_mov_b32 s12, s20
    s_mov_b32 s13, s21
    s_mov_b32 s14, 3670016
    s_mov_b32 s15, 0x00020000
    v_lshrrev_b32 v18, 3, v1
    v_mul_u32_u24 v19, 896, v18
    v_lshrrev_b32 v20, 4, v1
    v_and_b32 v21, 7, v1
    v_xor_b32 v22, v21, v20
    v_lshl_add_u32 v2, v22, 4, v19
    v_xor_b32 v22, 4, v22
    v_lshl_add_u32 v3, v22, 4, v19
    s_mul_i32 s31, s30, 2048
    s_mul_i32 s33, s30, 16
    s_add_u32 s33, s33, s54
    s_mul_i32 s33, s33, 896
    s_lshl_b32 s34, s30, 16
    s_add_u32 s34, s34, s55
    s_add_u32 m0, s31, 0
    s_add_u32 s35, s33, 0
    buffer_load_dwordx4 v2, s[8:11], s35 offen lds
    s_add_u32 m0, s31, 1024
    s_add_u32 s35, s33, 7168
    buffer_load_dwordx4 v3, s[8:11], s35 offen lds
    s_add_u32 m0, s32, 32768
    s_add_u32 s35, s34, 0
    buffer_load_dwordx4 v4, s[12:15], s35 offen lds
    s_add_u32 m0, s32, 33792
    s_add_u32 s35, s34, 16384
    buffer_load_dwordx4 v5, s[12:15], s35 offen lds
    s_add_u32 m0, s32, 34816
    s_add_u32 s35, s34, 32768
    buffer_load_dwordx4 v4, s[12:15], s35 offen lds
    s_add_u32 m0, s32, 35840
    s_add_u32 s35, s34, 49152
    buffer_load_dwordx4 v5, s[12:15], s35 offen lds
    s_add_u32 m0, s31, 65536
    s_add_u32 s35, s33, 128
    buffer_load_dwordx4 v2, s[8:11], s35 offen lds
    s_add_u32 m0, s31, 66560
    s_add_u32 s35, s33, 7296
    buffer_load_dwordx4 v3, s[8:11], s35 offen lds
    s_add_u32 m0, s32, 98304
    s_add_u32 s35, s34, 524288
    buffer_load_dwordx4 v4, s[12:15], s35 offen lds
    s_add_u32 m0, s32, 99328
    s_add_u32 s35, s34, 540672
    buffer_load_dwordx4 v5, s[12:15], s35 offen lds
    s_add_u32 m0, s32, 100352
    s_add_u32 s35, s34, 557056
    buffer_load_dwordx4 v4, s[12:15], s35 offen lds
    s_add_u32 m0, s32, 101376
    s_add_u32 s35, s34, 573440
    buffer_load_dwordx4 v5, s[12:15], s35 offen lds
    s_lshl_b32 s42, s52, 20
    s_lshl_b32 s35, s37, 7
    s_add_u32 s35, s35, s40
    s_lshl_b32 s35, s35, 9
    s_add_u32 s42, s42, s35
    s_lshl_b32 s35, s38, 13
    s_add_u32 s42, s42, s35
    s_add_u32 s56, s42, 0
    s_add_u32 s57, s42, 4096
    s_add_u32 s58, s42, 1024
    s_add_u32 s59, s42, 5120
    s_add_u32 s60, s42, 2048
    s_add_u32 s61, s42, 6144
    s_add_u32 s62, s42, 3072
    s_add_u32 s63, s42, 7168
    s_add_u32 s64, s42, 32768
    s_add_u32 s65, s42, 36864
    s_add_u32 s66, s42, 33792
    s_add_u32 s67, s42, 37888
    s_add_u32 s68, s42, 34816
    s_add_u32 s69, s42, 38912
    s_add_u32 s70, s42, 35840
    s_add_u32 s71, s42, 39936
    v_cvt_pk_bf16_f32 v255, v254, v255
    v_cvt_pk_bf16_f32 v254, v252, v253
    v_cvt_pk_bf16_f32 v253, v250, v251
    v_cvt_pk_bf16_f32 v252, v248, v249
    v_cvt_pk_bf16_f32 v251, v246, v247
    v_cvt_pk_bf16_f32 v250, v244, v245
    v_cvt_pk_bf16_f32 v249, v242, v243
    v_cvt_pk_bf16_f32 v248, v240, v241
    v_cvt_pk_bf16_f32 v247, v238, v239
    v_cvt_pk_bf16_f32 v246, v236, v237
    v_cvt_pk_bf16_f32 v245, v234, v235
    v_cvt_pk_bf16_f32 v244, v232, v233
    v_cvt_pk_bf16_f32 v243, v230, v231
    v_cvt_pk_bf16_f32 v242, v228, v229
    v_cvt_pk_bf16_f32 v241, v226, v227
    v_cvt_pk_bf16_f32 v240, v224, v225
    v_cvt_pk_bf16_f32 v239, v222, v223
    v_cvt_pk_bf16_f32 v238, v220, v221
    v_cvt_pk_bf16_f32 v237, v218, v219
    v_cvt_pk_bf16_f32 v236, v216, v217
    v_cvt_pk_bf16_f32 v235, v214, v215
    v_cvt_pk_bf16_f32 v234, v212, v213
    v_cvt_pk_bf16_f32 v233, v210, v211
    v_cvt_pk_bf16_f32 v232, v208, v209
    v_cvt_pk_bf16_f32 v231, v206, v207
    v_cvt_pk_bf16_f32 v230, v204, v205
    v_cvt_pk_bf16_f32 v229, v202, v203
    v_cvt_pk_bf16_f32 v228, v200, v201
    v_cvt_pk_bf16_f32 v227, v198, v199
    v_cvt_pk_bf16_f32 v226, v196, v197
    v_cvt_pk_bf16_f32 v225, v194, v195
    v_cvt_pk_bf16_f32 v224, v192, v193
    v_cvt_pk_bf16_f32 v223, v190, v191
    v_cvt_pk_bf16_f32 v222, v188, v189
    v_cvt_pk_bf16_f32 v221, v186, v187
    v_cvt_pk_bf16_f32 v220, v184, v185
    v_cvt_pk_bf16_f32 v219, v182, v183
    v_cvt_pk_bf16_f32 v218, v180, v181
    v_cvt_pk_bf16_f32 v217, v178, v179
    v_cvt_pk_bf16_f32 v216, v176, v177
    v_cvt_pk_bf16_f32 v215, v174, v175
    v_cvt_pk_bf16_f32 v214, v172, v173
    v_cvt_pk_bf16_f32 v213, v170, v171
    v_cvt_pk_bf16_f32 v212, v168, v169
    v_cvt_pk_bf16_f32 v211, v166, v167
    v_cvt_pk_bf16_f32 v210, v164, v165
    v_cvt_pk_bf16_f32 v209, v162, v163
    v_cvt_pk_bf16_f32 v208, v160, v161
    v_cvt_pk_bf16_f32 v207, v158, v159
    v_cvt_pk_bf16_f32 v206, v156, v157
    v_cvt_pk_bf16_f32 v205, v154, v155
    v_cvt_pk_bf16_f32 v204, v152, v153
    v_cvt_pk_bf16_f32 v203, v150, v151
    v_cvt_pk_bf16_f32 v202, v148, v149
    v_cvt_pk_bf16_f32 v201, v146, v147
    v_cvt_pk_bf16_f32 v200, v144, v145
    v_cvt_pk_bf16_f32 v199, v142, v143
    v_cvt_pk_bf16_f32 v198, v140, v141
    v_cvt_pk_bf16_f32 v197, v138, v139
    v_cvt_pk_bf16_f32 v196, v136, v137
    v_cvt_pk_bf16_f32 v195, v134, v135
    v_cvt_pk_bf16_f32 v194, v132, v133
    v_cvt_pk_bf16_f32 v193, v130, v131
    v_cvt_pk_bf16_f32 v192, v128, v129
    s_nop 1
    v_permlane32_swap_b32 v192, v194
    v_permlane32_swap_b32 v193, v195
    v_permlane32_swap_b32 v196, v198
    v_permlane32_swap_b32 v197, v199
    v_permlane32_swap_b32 v200, v202
    v_permlane32_swap_b32 v201, v203
    v_permlane32_swap_b32 v204, v206
    v_permlane32_swap_b32 v205, v207
    v_permlane32_swap_b32 v208, v210
    v_permlane32_swap_b32 v209, v211
    v_permlane32_swap_b32 v212, v214
    v_permlane32_swap_b32 v213, v215
    v_permlane32_swap_b32 v216, v218
    v_permlane32_swap_b32 v217, v219
    v_permlane32_swap_b32 v220, v222
    v_permlane32_swap_b32 v221, v223
    v_permlane32_swap_b32 v224, v226
    v_permlane32_swap_b32 v225, v227
    v_permlane32_swap_b32 v228, v230
    v_permlane32_swap_b32 v229, v231
    v_permlane32_swap_b32 v232, v234
    v_permlane32_swap_b32 v233, v235
    v_permlane32_swap_b32 v236, v238
    v_permlane32_swap_b32 v237, v239
    v_permlane32_swap_b32 v240, v242
    v_permlane32_swap_b32 v241, v243
    v_permlane32_swap_b32 v244, v246
    v_permlane32_swap_b32 v245, v247
    v_permlane32_swap_b32 v248, v250
    v_permlane32_swap_b32 v249, v251
    v_permlane32_swap_b32 v252, v254
    v_permlane32_swap_b32 v253, v255
    v_and_b32 v28, 15, v1
    v_lshlrev_b32 v28, 4, v28
    v_bfe_u32 v29, v1, 4, 1
    v_lshl_add_u32 v28, v29, 9, v28
    v_lshrrev_b32 v29, 5, v1
    v_lshl_add_u32 v28, v29, 8, v28
L_proj_q:
    v_and_b32 v18, 15, v1
    v_lshrrev_b32 v19, 4, v1
    v_bfe_u32 v20, v1, 1, 3
    v_xor_b32 v20, v20, v19
    s_mul_i32 s35, s37, 8192
    v_lshlrev_b32 v21, 7, v18
    v_add_u32 v21, s35, v21
    v_lshl_add_u32 v6, v20, 4, v21
    v_xor_b32 v7, 64, v6
    v_add_u32 v8, 0x10000, v6
    v_add_u32 v9, 0x10000, v7
    s_waitcnt vmcnt(6)
    s_barrier
    ds_read_b64_tr_b16 v[32:33], v10 offset:0
    ds_read_b64_tr_b16 v[34:35], v10 offset:2048
    ds_read_b64_tr_b16 v[36:37], v11 offset:0
    ds_read_b64_tr_b16 v[38:39], v11 offset:2048
    ds_read_b64_tr_b16 v[40:41], v12 offset:0
    ds_read_b64_tr_b16 v[42:43], v12 offset:2048
    ds_read_b64_tr_b16 v[44:45], v13 offset:0
    ds_read_b64_tr_b16 v[46:47], v13 offset:2048
    ds_read_b128 v[64:67], v6 offset:0
    ds_read_b128 v[68:71], v6 offset:2048
    ds_read_b128 v[72:75], v6 offset:4096
    ds_read_b128 v[76:79], v6 offset:6144
    ds_read_b64_tr_b16 v[48:49], v10 offset:16384
    ds_read_b64_tr_b16 v[50:51], v10 offset:18432
    ds_read_b64_tr_b16 v[52:53], v11 offset:16384
    ds_read_b64_tr_b16 v[54:55], v11 offset:18432
    ds_read_b64_tr_b16 v[56:57], v12 offset:16384
    ds_read_b64_tr_b16 v[58:59], v12 offset:18432
    ds_read_b64_tr_b16 v[60:61], v13 offset:16384
    ds_read_b64_tr_b16 v[62:63], v13 offset:18432
    ds_read_b128 v[80:83], v7 offset:0
    ds_read_b128 v[84:87], v7 offset:2048
    ds_read_b128 v[88:91], v7 offset:4096
    ds_read_b128 v[92:95], v7 offset:6144
    s_waitcnt lgkmcnt(12)
    v_mfma_f32_16x16x32_bf16 v[128:131], v[32:35], v[64:67], 0
    v_mfma_f32_16x16x32_bf16 v[132:135], v[36:39], v[64:67], 0
    v_mfma_f32_16x16x32_bf16 v[136:139], v[40:43], v[64:67], 0
    v_mfma_f32_16x16x32_bf16 v[140:143], v[44:47], v[64:67], 0
    v_mfma_f32_16x16x32_bf16 v[144:147], v[32:35], v[68:71], 0
    v_mfma_f32_16x16x32_bf16 v[148:151], v[36:39], v[68:71], 0
    v_mfma_f32_16x16x32_bf16 v[152:155], v[40:43], v[68:71], 0
    v_mfma_f32_16x16x32_bf16 v[156:159], v[44:47], v[68:71], 0
    v_mfma_f32_16x16x32_bf16 v[160:163], v[32:35], v[72:75], 0
    v_mfma_f32_16x16x32_bf16 v[164:167], v[36:39], v[72:75], 0
    v_mfma_f32_16x16x32_bf16 v[168:171], v[40:43], v[72:75], 0
    v_mfma_f32_16x16x32_bf16 v[172:175], v[44:47], v[72:75], 0
    v_mfma_f32_16x16x32_bf16 v[176:179], v[32:35], v[76:79], 0
    v_mfma_f32_16x16x32_bf16 v[180:183], v[36:39], v[76:79], 0
    v_mfma_f32_16x16x32_bf16 v[184:187], v[40:43], v[76:79], 0
    v_mfma_f32_16x16x32_bf16 v[188:191], v[44:47], v[76:79], 0
    buffer_store_dwordx4 v[192:195], v28, s[16:19], s56 offen sc1
    buffer_store_dwordx4 v[196:199], v28, s[16:19], s57 offen sc1
    s_waitcnt lgkmcnt(0)
    v_mfma_f32_16x16x32_bf16 v[128:131], v[48:51], v[80:83], v[128:131]
    v_mfma_f32_16x16x32_bf16 v[132:135], v[52:55], v[80:83], v[132:135]
    v_mfma_f32_16x16x32_bf16 v[136:139], v[56:59], v[80:83], v[136:139]
    v_mfma_f32_16x16x32_bf16 v[140:143], v[60:63], v[80:83], v[140:143]
    v_mfma_f32_16x16x32_bf16 v[144:147], v[48:51], v[84:87], v[144:147]
    v_mfma_f32_16x16x32_bf16 v[148:151], v[52:55], v[84:87], v[148:151]
    v_mfma_f32_16x16x32_bf16 v[152:155], v[56:59], v[84:87], v[152:155]
    v_mfma_f32_16x16x32_bf16 v[156:159], v[60:63], v[84:87], v[156:159]
    v_mfma_f32_16x16x32_bf16 v[160:163], v[48:51], v[88:91], v[160:163]
    v_mfma_f32_16x16x32_bf16 v[164:167], v[52:55], v[88:91], v[164:167]
    v_mfma_f32_16x16x32_bf16 v[168:171], v[56:59], v[88:91], v[168:171]
    v_mfma_f32_16x16x32_bf16 v[172:175], v[60:63], v[88:91], v[172:175]
    v_mfma_f32_16x16x32_bf16 v[176:179], v[48:51], v[92:95], v[176:179]
    v_mfma_f32_16x16x32_bf16 v[180:183], v[52:55], v[92:95], v[180:183]
    v_mfma_f32_16x16x32_bf16 v[184:187], v[56:59], v[92:95], v[184:187]
    v_mfma_f32_16x16x32_bf16 v[188:191], v[60:63], v[92:95], v[188:191]
    buffer_store_dwordx4 v[200:203], v28, s[16:19], s58 offen sc1
    s_nop 0
    s_waitcnt vmcnt(3)
    s_barrier
    s_add_u32 m0, s31, 0
    s_add_u32 s35, s33, 256
    buffer_load_dwordx4 v2, s[8:11], s35 offen lds
    s_add_u32 m0, s31, 1024
    s_add_u32 s35, s33, 7424
    buffer_load_dwordx4 v3, s[8:11], s35 offen lds
    s_add_u32 m0, s32, 32768
    s_add_u32 s35, s34, 1048576
    buffer_load_dwordx4 v4, s[12:15], s35 offen lds
    s_add_u32 m0, s32, 33792
    s_add_u32 s35, s34, 1064960
    buffer_load_dwordx4 v5, s[12:15], s35 offen lds
    s_add_u32 m0, s32, 34816
    s_add_u32 s35, s34, 1081344
    buffer_load_dwordx4 v4, s[12:15], s35 offen lds
    s_add_u32 m0, s32, 35840
    s_add_u32 s35, s34, 1097728
    buffer_load_dwordx4 v5, s[12:15], s35 offen lds
    ds_read_b64_tr_b16 v[32:33], v14 offset:0
    ds_read_b64_tr_b16 v[34:35], v14 offset:2048
    ds_read_b64_tr_b16 v[36:37], v15 offset:0
    ds_read_b64_tr_b16 v[38:39], v15 offset:2048
    ds_read_b64_tr_b16 v[40:41], v16 offset:0
    ds_read_b64_tr_b16 v[42:43], v16 offset:2048
    ds_read_b64_tr_b16 v[44:45], v17 offset:0
    ds_read_b64_tr_b16 v[46:47], v17 offset:2048
    ds_read_b128 v[64:67], v8 offset:0
    ds_read_b128 v[68:71], v8 offset:2048
    ds_read_b128 v[72:75], v8 offset:4096
    ds_read_b128 v[76:79], v8 offset:6144
    ds_read_b64_tr_b16 v[48:49], v14 offset:16384
    ds_read_b64_tr_b16 v[50:51], v14 offset:18432
    ds_read_b64_tr_b16 v[52:53], v15 offset:16384
    ds_read_b64_tr_b16 v[54:55], v15 offset:18432
    ds_read_b64_tr_b16 v[56:57], v16 offset:16384
    ds_read_b64_tr_b16 v[58:59], v16 offset:18432
    ds_read_b64_tr_b16 v[60:61], v17 offset:16384
    ds_read_b64_tr_b16 v[62:63], v17 offset:18432
    ds_read_b128 v[80:83], v9 offset:0
    ds_read_b128 v[84:87], v9 offset:2048
    ds_read_b128 v[88:91], v9 offset:4096
    ds_read_b128 v[92:95], v9 offset:6144
    s_waitcnt lgkmcnt(12)
    v_mfma_f32_16x16x32_bf16 v[128:131], v[32:35], v[64:67], v[128:131]
    v_mfma_f32_16x16x32_bf16 v[132:135], v[36:39], v[64:67], v[132:135]
    v_mfma_f32_16x16x32_bf16 v[136:139], v[40:43], v[64:67], v[136:139]
    v_mfma_f32_16x16x32_bf16 v[140:143], v[44:47], v[64:67], v[140:143]
    v_mfma_f32_16x16x32_bf16 v[144:147], v[32:35], v[68:71], v[144:147]
    v_mfma_f32_16x16x32_bf16 v[148:151], v[36:39], v[68:71], v[148:151]
    v_mfma_f32_16x16x32_bf16 v[152:155], v[40:43], v[68:71], v[152:155]
    v_mfma_f32_16x16x32_bf16 v[156:159], v[44:47], v[68:71], v[156:159]
    v_mfma_f32_16x16x32_bf16 v[160:163], v[32:35], v[72:75], v[160:163]
    v_mfma_f32_16x16x32_bf16 v[164:167], v[36:39], v[72:75], v[164:167]
    v_mfma_f32_16x16x32_bf16 v[168:171], v[40:43], v[72:75], v[168:171]
    v_mfma_f32_16x16x32_bf16 v[172:175], v[44:47], v[72:75], v[172:175]
    v_mfma_f32_16x16x32_bf16 v[176:179], v[32:35], v[76:79], v[176:179]
    v_mfma_f32_16x16x32_bf16 v[180:183], v[36:39], v[76:79], v[180:183]
    v_mfma_f32_16x16x32_bf16 v[184:187], v[40:43], v[76:79], v[184:187]
    v_mfma_f32_16x16x32_bf16 v[188:191], v[44:47], v[76:79], v[188:191]
    buffer_store_dwordx4 v[204:207], v28, s[16:19], s59 offen sc1
    buffer_store_dwordx4 v[208:211], v28, s[16:19], s60 offen sc1
    s_waitcnt lgkmcnt(0)
    v_mfma_f32_16x16x32_bf16 v[128:131], v[48:51], v[80:83], v[128:131]
    v_mfma_f32_16x16x32_bf16 v[132:135], v[52:55], v[80:83], v[132:135]
    v_mfma_f32_16x16x32_bf16 v[136:139], v[56:59], v[80:83], v[136:139]
    v_mfma_f32_16x16x32_bf16 v[140:143], v[60:63], v[80:83], v[140:143]
    v_mfma_f32_16x16x32_bf16 v[144:147], v[48:51], v[84:87], v[144:147]
    v_mfma_f32_16x16x32_bf16 v[148:151], v[52:55], v[84:87], v[148:151]
    v_mfma_f32_16x16x32_bf16 v[152:155], v[56:59], v[84:87], v[152:155]
    v_mfma_f32_16x16x32_bf16 v[156:159], v[60:63], v[84:87], v[156:159]
    v_mfma_f32_16x16x32_bf16 v[160:163], v[48:51], v[88:91], v[160:163]
    v_mfma_f32_16x16x32_bf16 v[164:167], v[52:55], v[88:91], v[164:167]
    v_mfma_f32_16x16x32_bf16 v[168:171], v[56:59], v[88:91], v[168:171]
    v_mfma_f32_16x16x32_bf16 v[172:175], v[60:63], v[88:91], v[172:175]
    v_mfma_f32_16x16x32_bf16 v[176:179], v[48:51], v[92:95], v[176:179]
    v_mfma_f32_16x16x32_bf16 v[180:183], v[52:55], v[92:95], v[180:183]
    v_mfma_f32_16x16x32_bf16 v[184:187], v[56:59], v[92:95], v[184:187]
    v_mfma_f32_16x16x32_bf16 v[188:191], v[60:63], v[92:95], v[188:191]
    buffer_store_dwordx4 v[212:215], v28, s[16:19], s61 offen sc1
    s_nop 0
    s_waitcnt vmcnt(3)
    s_barrier
    s_add_u32 m0, s31, 65536
    s_add_u32 s35, s33, 384
    buffer_load_dwordx4 v2, s[8:11], s35 offen lds
    s_add_u32 m0, s31, 66560
    s_add_u32 s35, s33, 7552
    buffer_load_dwordx4 v3, s[8:11], s35 offen lds
    s_add_u32 m0, s32, 98304
    s_add_u32 s35, s34, 1572864
    buffer_load_dwordx4 v4, s[12:15], s35 offen lds
    s_add_u32 m0, s32, 99328
    s_add_u32 s35, s34, 1589248
    buffer_load_dwordx4 v5, s[12:15], s35 offen lds
    s_add_u32 m0, s32, 100352
    s_add_u32 s35, s34, 1605632
    buffer_load_dwordx4 v4, s[12:15], s35 offen lds
    s_add_u32 m0, s32, 101376
    s_add_u32 s35, s34, 1622016
    buffer_load_dwordx4 v5, s[12:15], s35 offen lds
    ds_read_b64_tr_b16 v[32:33], v10 offset:0
    ds_read_b64_tr_b16 v[34:35], v10 offset:2048
    ds_read_b64_tr_b16 v[36:37], v11 offset:0
    ds_read_b64_tr_b16 v[38:39], v11 offset:2048
    ds_read_b64_tr_b16 v[40:41], v12 offset:0
    ds_read_b64_tr_b16 v[42:43], v12 offset:2048
    ds_read_b64_tr_b16 v[44:45], v13 offset:0
    ds_read_b64_tr_b16 v[46:47], v13 offset:2048
    ds_read_b128 v[64:67], v6 offset:0
    ds_read_b128 v[68:71], v6 offset:2048
    ds_read_b128 v[72:75], v6 offset:4096
    ds_read_b128 v[76:79], v6 offset:6144
    ds_read_b64_tr_b16 v[48:49], v10 offset:16384
    ds_read_b64_tr_b16 v[50:51], v10 offset:18432
    ds_read_b64_tr_b16 v[52:53], v11 offset:16384
    ds_read_b64_tr_b16 v[54:55], v11 offset:18432
    ds_read_b64_tr_b16 v[56:57], v12 offset:16384
    ds_read_b64_tr_b16 v[58:59], v12 offset:18432
    ds_read_b64_tr_b16 v[60:61], v13 offset:16384
    ds_read_b64_tr_b16 v[62:63], v13 offset:18432
    ds_read_b128 v[80:83], v7 offset:0
    ds_read_b128 v[84:87], v7 offset:2048
    ds_read_b128 v[88:91], v7 offset:4096
    ds_read_b128 v[92:95], v7 offset:6144
    s_waitcnt lgkmcnt(12)
    v_mfma_f32_16x16x32_bf16 v[128:131], v[32:35], v[64:67], v[128:131]
    v_mfma_f32_16x16x32_bf16 v[132:135], v[36:39], v[64:67], v[132:135]
    v_mfma_f32_16x16x32_bf16 v[136:139], v[40:43], v[64:67], v[136:139]
    v_mfma_f32_16x16x32_bf16 v[140:143], v[44:47], v[64:67], v[140:143]
    v_mfma_f32_16x16x32_bf16 v[144:147], v[32:35], v[68:71], v[144:147]
    v_mfma_f32_16x16x32_bf16 v[148:151], v[36:39], v[68:71], v[148:151]
    v_mfma_f32_16x16x32_bf16 v[152:155], v[40:43], v[68:71], v[152:155]
    v_mfma_f32_16x16x32_bf16 v[156:159], v[44:47], v[68:71], v[156:159]
    v_mfma_f32_16x16x32_bf16 v[160:163], v[32:35], v[72:75], v[160:163]
    v_mfma_f32_16x16x32_bf16 v[164:167], v[36:39], v[72:75], v[164:167]
    v_mfma_f32_16x16x32_bf16 v[168:171], v[40:43], v[72:75], v[168:171]
    v_mfma_f32_16x16x32_bf16 v[172:175], v[44:47], v[72:75], v[172:175]
    v_mfma_f32_16x16x32_bf16 v[176:179], v[32:35], v[76:79], v[176:179]
    v_mfma_f32_16x16x32_bf16 v[180:183], v[36:39], v[76:79], v[180:183]
    v_mfma_f32_16x16x32_bf16 v[184:187], v[40:43], v[76:79], v[184:187]
    v_mfma_f32_16x16x32_bf16 v[188:191], v[44:47], v[76:79], v[188:191]
    buffer_store_dwordx4 v[216:219], v28, s[16:19], s62 offen sc1
    buffer_store_dwordx4 v[220:223], v28, s[16:19], s63 offen sc1
    s_waitcnt lgkmcnt(0)
    v_mfma_f32_16x16x32_bf16 v[128:131], v[48:51], v[80:83], v[128:131]
    v_mfma_f32_16x16x32_bf16 v[132:135], v[52:55], v[80:83], v[132:135]
    v_mfma_f32_16x16x32_bf16 v[136:139], v[56:59], v[80:83], v[136:139]
    v_mfma_f32_16x16x32_bf16 v[140:143], v[60:63], v[80:83], v[140:143]
    v_mfma_f32_16x16x32_bf16 v[144:147], v[48:51], v[84:87], v[144:147]
    v_mfma_f32_16x16x32_bf16 v[148:151], v[52:55], v[84:87], v[148:151]
    v_mfma_f32_16x16x32_bf16 v[152:155], v[56:59], v[84:87], v[152:155]
    v_mfma_f32_16x16x32_bf16 v[156:159], v[60:63], v[84:87], v[156:159]
    v_mfma_f32_16x16x32_bf16 v[160:163], v[48:51], v[88:91], v[160:163]
    v_mfma_f32_16x16x32_bf16 v[164:167], v[52:55], v[88:91], v[164:167]
    v_mfma_f32_16x16x32_bf16 v[168:171], v[56:59], v[88:91], v[168:171]
    v_mfma_f32_16x16x32_bf16 v[172:175], v[60:63], v[88:91], v[172:175]
    v_mfma_f32_16x16x32_bf16 v[176:179], v[48:51], v[92:95], v[176:179]
    v_mfma_f32_16x16x32_bf16 v[180:183], v[52:55], v[92:95], v[180:183]
    v_mfma_f32_16x16x32_bf16 v[184:187], v[56:59], v[92:95], v[184:187]
    v_mfma_f32_16x16x32_bf16 v[188:191], v[60:63], v[92:95], v[188:191]
    buffer_store_dwordx4 v[224:227], v28, s[16:19], s64 offen sc1
    s_nop 0
    s_waitcnt vmcnt(3)
    s_barrier
    s_add_u32 m0, s31, 0
    s_add_u32 s35, s33, 512
    buffer_load_dwordx4 v2, s[8:11], s35 offen lds
    s_add_u32 m0, s31, 1024
    s_add_u32 s35, s33, 7680
    buffer_load_dwordx4 v3, s[8:11], s35 offen lds
    s_add_u32 m0, s32, 32768
    s_add_u32 s35, s34, 2097152
    buffer_load_dwordx4 v4, s[12:15], s35 offen lds
    s_add_u32 m0, s32, 33792
    s_add_u32 s35, s34, 2113536
    buffer_load_dwordx4 v5, s[12:15], s35 offen lds
    s_add_u32 m0, s32, 34816
    s_add_u32 s35, s34, 2129920
    buffer_load_dwordx4 v4, s[12:15], s35 offen lds
    s_add_u32 m0, s32, 35840
    s_add_u32 s35, s34, 2146304
    buffer_load_dwordx4 v5, s[12:15], s35 offen lds
    ds_read_b64_tr_b16 v[32:33], v14 offset:0
    ds_read_b64_tr_b16 v[34:35], v14 offset:2048
    ds_read_b64_tr_b16 v[36:37], v15 offset:0
    ds_read_b64_tr_b16 v[38:39], v15 offset:2048
    ds_read_b64_tr_b16 v[40:41], v16 offset:0
    ds_read_b64_tr_b16 v[42:43], v16 offset:2048
    ds_read_b64_tr_b16 v[44:45], v17 offset:0
    ds_read_b64_tr_b16 v[46:47], v17 offset:2048
    ds_read_b128 v[64:67], v8 offset:0
    ds_read_b128 v[68:71], v8 offset:2048
    ds_read_b128 v[72:75], v8 offset:4096
    ds_read_b128 v[76:79], v8 offset:6144
    ds_read_b64_tr_b16 v[48:49], v14 offset:16384
    ds_read_b64_tr_b16 v[50:51], v14 offset:18432
    ds_read_b64_tr_b16 v[52:53], v15 offset:16384
    ds_read_b64_tr_b16 v[54:55], v15 offset:18432
    ds_read_b64_tr_b16 v[56:57], v16 offset:16384
    ds_read_b64_tr_b16 v[58:59], v16 offset:18432
    ds_read_b64_tr_b16 v[60:61], v17 offset:16384
    ds_read_b64_tr_b16 v[62:63], v17 offset:18432
    ds_read_b128 v[80:83], v9 offset:0
    ds_read_b128 v[84:87], v9 offset:2048
    ds_read_b128 v[88:91], v9 offset:4096
    ds_read_b128 v[92:95], v9 offset:6144
    s_waitcnt lgkmcnt(12)
    v_mfma_f32_16x16x32_bf16 v[128:131], v[32:35], v[64:67], v[128:131]
    v_mfma_f32_16x16x32_bf16 v[132:135], v[36:39], v[64:67], v[132:135]
    v_mfma_f32_16x16x32_bf16 v[136:139], v[40:43], v[64:67], v[136:139]
    v_mfma_f32_16x16x32_bf16 v[140:143], v[44:47], v[64:67], v[140:143]
    v_mfma_f32_16x16x32_bf16 v[144:147], v[32:35], v[68:71], v[144:147]
    v_mfma_f32_16x16x32_bf16 v[148:151], v[36:39], v[68:71], v[148:151]
    v_mfma_f32_16x16x32_bf16 v[152:155], v[40:43], v[68:71], v[152:155]
    v_mfma_f32_16x16x32_bf16 v[156:159], v[44:47], v[68:71], v[156:159]
    v_mfma_f32_16x16x32_bf16 v[160:163], v[32:35], v[72:75], v[160:163]
    v_mfma_f32_16x16x32_bf16 v[164:167], v[36:39], v[72:75], v[164:167]
    v_mfma_f32_16x16x32_bf16 v[168:171], v[40:43], v[72:75], v[168:171]
    v_mfma_f32_16x16x32_bf16 v[172:175], v[44:47], v[72:75], v[172:175]
    v_mfma_f32_16x16x32_bf16 v[176:179], v[32:35], v[76:79], v[176:179]
    v_mfma_f32_16x16x32_bf16 v[180:183], v[36:39], v[76:79], v[180:183]
    v_mfma_f32_16x16x32_bf16 v[184:187], v[40:43], v[76:79], v[184:187]
    v_mfma_f32_16x16x32_bf16 v[188:191], v[44:47], v[76:79], v[188:191]
    buffer_store_dwordx4 v[228:231], v28, s[16:19], s65 offen sc1
    buffer_store_dwordx4 v[232:235], v28, s[16:19], s66 offen sc1
    s_waitcnt lgkmcnt(0)
    v_mfma_f32_16x16x32_bf16 v[128:131], v[48:51], v[80:83], v[128:131]
    v_mfma_f32_16x16x32_bf16 v[132:135], v[52:55], v[80:83], v[132:135]
    v_mfma_f32_16x16x32_bf16 v[136:139], v[56:59], v[80:83], v[136:139]
    v_mfma_f32_16x16x32_bf16 v[140:143], v[60:63], v[80:83], v[140:143]
    v_mfma_f32_16x16x32_bf16 v[144:147], v[48:51], v[84:87], v[144:147]
    v_mfma_f32_16x16x32_bf16 v[148:151], v[52:55], v[84:87], v[148:151]
    v_mfma_f32_16x16x32_bf16 v[152:155], v[56:59], v[84:87], v[152:155]
    v_mfma_f32_16x16x32_bf16 v[156:159], v[60:63], v[84:87], v[156:159]
    v_mfma_f32_16x16x32_bf16 v[160:163], v[48:51], v[88:91], v[160:163]
    v_mfma_f32_16x16x32_bf16 v[164:167], v[52:55], v[88:91], v[164:167]
    v_mfma_f32_16x16x32_bf16 v[168:171], v[56:59], v[88:91], v[168:171]
    v_mfma_f32_16x16x32_bf16 v[172:175], v[60:63], v[88:91], v[172:175]
    v_mfma_f32_16x16x32_bf16 v[176:179], v[48:51], v[92:95], v[176:179]
    v_mfma_f32_16x16x32_bf16 v[180:183], v[52:55], v[92:95], v[180:183]
    v_mfma_f32_16x16x32_bf16 v[184:187], v[56:59], v[92:95], v[184:187]
    v_mfma_f32_16x16x32_bf16 v[188:191], v[60:63], v[92:95], v[188:191]
    buffer_store_dwordx4 v[236:239], v28, s[16:19], s67 offen sc1
    s_nop 0
    s_waitcnt vmcnt(3)
    s_barrier
    s_add_u32 m0, s31, 65536
    s_add_u32 s35, s33, 640
    buffer_load_dwordx4 v2, s[8:11], s35 offen lds
    s_add_u32 m0, s31, 66560
    s_add_u32 s35, s33, 7808
    buffer_load_dwordx4 v3, s[8:11], s35 offen lds
    s_add_u32 m0, s32, 98304
    s_add_u32 s35, s34, 2621440
    buffer_load_dwordx4 v4, s[12:15], s35 offen lds
    s_add_u32 m0, s32, 99328
    s_add_u32 s35, s34, 2637824
    buffer_load_dwordx4 v5, s[12:15], s35 offen lds
    s_add_u32 m0, s32, 100352
    s_add_u32 s35, s34, 2654208
    buffer_load_dwordx4 v4, s[12:15], s35 offen lds
    s_add_u32 m0, s32, 101376
    s_add_u32 s35, s34, 2670592
    buffer_load_dwordx4 v5, s[12:15], s35 offen lds
    ds_read_b64_tr_b16 v[32:33], v10 offset:0
    ds_read_b64_tr_b16 v[34:35], v10 offset:2048
    ds_read_b64_tr_b16 v[36:37], v11 offset:0
    ds_read_b64_tr_b16 v[38:39], v11 offset:2048
    ds_read_b64_tr_b16 v[40:41], v12 offset:0
    ds_read_b64_tr_b16 v[42:43], v12 offset:2048
    ds_read_b64_tr_b16 v[44:45], v13 offset:0
    ds_read_b64_tr_b16 v[46:47], v13 offset:2048
    ds_read_b128 v[64:67], v6 offset:0
    ds_read_b128 v[68:71], v6 offset:2048
    ds_read_b128 v[72:75], v6 offset:4096
    ds_read_b128 v[76:79], v6 offset:6144
    ds_read_b64_tr_b16 v[48:49], v10 offset:16384
    ds_read_b64_tr_b16 v[50:51], v10 offset:18432
    ds_read_b64_tr_b16 v[52:53], v11 offset:16384
    ds_read_b64_tr_b16 v[54:55], v11 offset:18432
    ds_read_b64_tr_b16 v[56:57], v12 offset:16384
    ds_read_b64_tr_b16 v[58:59], v12 offset:18432
    ds_read_b64_tr_b16 v[60:61], v13 offset:16384
    ds_read_b64_tr_b16 v[62:63], v13 offset:18432
    ds_read_b128 v[80:83], v7 offset:0
    ds_read_b128 v[84:87], v7 offset:2048
    ds_read_b128 v[88:91], v7 offset:4096
    ds_read_b128 v[92:95], v7 offset:6144
    s_waitcnt lgkmcnt(12)
    v_mfma_f32_16x16x32_bf16 v[128:131], v[32:35], v[64:67], v[128:131]
    v_mfma_f32_16x16x32_bf16 v[132:135], v[36:39], v[64:67], v[132:135]
    v_mfma_f32_16x16x32_bf16 v[136:139], v[40:43], v[64:67], v[136:139]
    v_mfma_f32_16x16x32_bf16 v[140:143], v[44:47], v[64:67], v[140:143]
    v_mfma_f32_16x16x32_bf16 v[144:147], v[32:35], v[68:71], v[144:147]
    v_mfma_f32_16x16x32_bf16 v[148:151], v[36:39], v[68:71], v[148:151]
    v_mfma_f32_16x16x32_bf16 v[152:155], v[40:43], v[68:71], v[152:155]
    v_mfma_f32_16x16x32_bf16 v[156:159], v[44:47], v[68:71], v[156:159]
    v_mfma_f32_16x16x32_bf16 v[160:163], v[32:35], v[72:75], v[160:163]
    v_mfma_f32_16x16x32_bf16 v[164:167], v[36:39], v[72:75], v[164:167]
    v_mfma_f32_16x16x32_bf16 v[168:171], v[40:43], v[72:75], v[168:171]
    v_mfma_f32_16x16x32_bf16 v[172:175], v[44:47], v[72:75], v[172:175]
    v_mfma_f32_16x16x32_bf16 v[176:179], v[32:35], v[76:79], v[176:179]
    v_mfma_f32_16x16x32_bf16 v[180:183], v[36:39], v[76:79], v[180:183]
    v_mfma_f32_16x16x32_bf16 v[184:187], v[40:43], v[76:79], v[184:187]
    v_mfma_f32_16x16x32_bf16 v[188:191], v[44:47], v[76:79], v[188:191]
    buffer_store_dwordx4 v[240:243], v28, s[16:19], s68 offen sc1
    buffer_store_dwordx4 v[244:247], v28, s[16:19], s69 offen sc1
    s_waitcnt lgkmcnt(0)
    v_mfma_f32_16x16x32_bf16 v[128:131], v[48:51], v[80:83], v[128:131]
    v_mfma_f32_16x16x32_bf16 v[132:135], v[52:55], v[80:83], v[132:135]
    v_mfma_f32_16x16x32_bf16 v[136:139], v[56:59], v[80:83], v[136:139]
    v_mfma_f32_16x16x32_bf16 v[140:143], v[60:63], v[80:83], v[140:143]
    v_mfma_f32_16x16x32_bf16 v[144:147], v[48:51], v[84:87], v[144:147]
    v_mfma_f32_16x16x32_bf16 v[148:151], v[52:55], v[84:87], v[148:151]
    v_mfma_f32_16x16x32_bf16 v[152:155], v[56:59], v[84:87], v[152:155]
    v_mfma_f32_16x16x32_bf16 v[156:159], v[60:63], v[84:87], v[156:159]
    v_mfma_f32_16x16x32_bf16 v[160:163], v[48:51], v[88:91], v[160:163]
    v_mfma_f32_16x16x32_bf16 v[164:167], v[52:55], v[88:91], v[164:167]
    v_mfma_f32_16x16x32_bf16 v[168:171], v[56:59], v[88:91], v[168:171]
    v_mfma_f32_16x16x32_bf16 v[172:175], v[60:63], v[88:91], v[172:175]
    v_mfma_f32_16x16x32_bf16 v[176:179], v[48:51], v[92:95], v[176:179]
    v_mfma_f32_16x16x32_bf16 v[180:183], v[52:55], v[92:95], v[180:183]
    v_mfma_f32_16x16x32_bf16 v[184:187], v[56:59], v[92:95], v[184:187]
    v_mfma_f32_16x16x32_bf16 v[188:191], v[60:63], v[92:95], v[188:191]
    s_nop 0
    s_nop 0
    s_waitcnt vmcnt(2)
    s_barrier
    s_add_u32 m0, s31, 0
    s_add_u32 s35, s33, 768
    buffer_load_dwordx4 v2, s[8:11], s35 offen lds
    s_add_u32 m0, s31, 1024
    s_add_u32 s35, s33, 7936
    buffer_load_dwordx4 v3, s[8:11], s35 offen lds
    s_add_u32 m0, s32, 32768
    s_add_u32 s35, s34, 3145728
    buffer_load_dwordx4 v4, s[12:15], s35 offen lds
    s_add_u32 m0, s32, 33792
    s_add_u32 s35, s34, 3162112
    buffer_load_dwordx4 v5, s[12:15], s35 offen lds
    s_add_u32 m0, s32, 34816
    s_add_u32 s35, s34, 3178496
    buffer_load_dwordx4 v4, s[12:15], s35 offen lds
    s_add_u32 m0, s32, 35840
    s_add_u32 s35, s34, 3194880
    buffer_load_dwordx4 v5, s[12:15], s35 offen lds
    ds_read_b64_tr_b16 v[32:33], v14 offset:0
    ds_read_b64_tr_b16 v[34:35], v14 offset:2048
    ds_read_b64_tr_b16 v[36:37], v15 offset:0
    ds_read_b64_tr_b16 v[38:39], v15 offset:2048
    ds_read_b64_tr_b16 v[40:41], v16 offset:0
    ds_read_b64_tr_b16 v[42:43], v16 offset:2048
    ds_read_b64_tr_b16 v[44:45], v17 offset:0
    ds_read_b64_tr_b16 v[46:47], v17 offset:2048
    ds_read_b128 v[64:67], v8 offset:0
    ds_read_b128 v[68:71], v8 offset:2048
    ds_read_b128 v[72:75], v8 offset:4096
    ds_read_b128 v[76:79], v8 offset:6144
    ds_read_b64_tr_b16 v[48:49], v14 offset:16384
    ds_read_b64_tr_b16 v[50:51], v14 offset:18432
    ds_read_b64_tr_b16 v[52:53], v15 offset:16384
    ds_read_b64_tr_b16 v[54:55], v15 offset:18432
    ds_read_b64_tr_b16 v[56:57], v16 offset:16384
    ds_read_b64_tr_b16 v[58:59], v16 offset:18432
    ds_read_b64_tr_b16 v[60:61], v17 offset:16384
    ds_read_b64_tr_b16 v[62:63], v17 offset:18432
    ds_read_b128 v[80:83], v9 offset:0
    ds_read_b128 v[84:87], v9 offset:2048
    ds_read_b128 v[88:91], v9 offset:4096
    ds_read_b128 v[92:95], v9 offset:6144
    s_waitcnt lgkmcnt(12)
    v_mfma_f32_16x16x32_bf16 v[128:131], v[32:35], v[64:67], v[128:131]
    v_mfma_f32_16x16x32_bf16 v[132:135], v[36:39], v[64:67], v[132:135]
    v_mfma_f32_16x16x32_bf16 v[136:139], v[40:43], v[64:67], v[136:139]
    v_mfma_f32_16x16x32_bf16 v[140:143], v[44:47], v[64:67], v[140:143]
    v_mfma_f32_16x16x32_bf16 v[144:147], v[32:35], v[68:71], v[144:147]
    v_mfma_f32_16x16x32_bf16 v[148:151], v[36:39], v[68:71], v[148:151]
    v_mfma_f32_16x16x32_bf16 v[152:155], v[40:43], v[68:71], v[152:155]
    v_mfma_f32_16x16x32_bf16 v[156:159], v[44:47], v[68:71], v[156:159]
    v_mfma_f32_16x16x32_bf16 v[160:163], v[32:35], v[72:75], v[160:163]
    v_mfma_f32_16x16x32_bf16 v[164:167], v[36:39], v[72:75], v[164:167]
    v_mfma_f32_16x16x32_bf16 v[168:171], v[40:43], v[72:75], v[168:171]
    v_mfma_f32_16x16x32_bf16 v[172:175], v[44:47], v[72:75], v[172:175]
    v_mfma_f32_16x16x32_bf16 v[176:179], v[32:35], v[76:79], v[176:179]
    v_mfma_f32_16x16x32_bf16 v[180:183], v[36:39], v[76:79], v[180:183]
    v_mfma_f32_16x16x32_bf16 v[184:187], v[40:43], v[76:79], v[184:187]
    v_mfma_f32_16x16x32_bf16 v[188:191], v[44:47], v[76:79], v[188:191]
    buffer_store_dwordx4 v[248:251], v28, s[16:19], s70 offen sc1
    buffer_store_dwordx4 v[252:255], v28, s[16:19], s71 offen sc1
    s_waitcnt lgkmcnt(0)
    v_mfma_f32_16x16x32_bf16 v[128:131], v[48:51], v[80:83], v[128:131]
    v_mfma_f32_16x16x32_bf16 v[132:135], v[52:55], v[80:83], v[132:135]
    v_mfma_f32_16x16x32_bf16 v[136:139], v[56:59], v[80:83], v[136:139]
    v_mfma_f32_16x16x32_bf16 v[140:143], v[60:63], v[80:83], v[140:143]
    v_mfma_f32_16x16x32_bf16 v[144:147], v[48:51], v[84:87], v[144:147]
    v_mfma_f32_16x16x32_bf16 v[148:151], v[52:55], v[84:87], v[148:151]
    v_mfma_f32_16x16x32_bf16 v[152:155], v[56:59], v[84:87], v[152:155]
    v_mfma_f32_16x16x32_bf16 v[156:159], v[60:63], v[84:87], v[156:159]
    v_mfma_f32_16x16x32_bf16 v[160:163], v[48:51], v[88:91], v[160:163]
    v_mfma_f32_16x16x32_bf16 v[164:167], v[52:55], v[88:91], v[164:167]
    v_mfma_f32_16x16x32_bf16 v[168:171], v[56:59], v[88:91], v[168:171]
    v_mfma_f32_16x16x32_bf16 v[172:175], v[60:63], v[88:91], v[172:175]
    v_mfma_f32_16x16x32_bf16 v[176:179], v[48:51], v[92:95], v[176:179]
    v_mfma_f32_16x16x32_bf16 v[180:183], v[52:55], v[92:95], v[180:183]
    v_mfma_f32_16x16x32_bf16 v[184:187], v[56:59], v[92:95], v[184:187]
    v_mfma_f32_16x16x32_bf16 v[188:191], v[60:63], v[92:95], v[188:191]
    s_nop 0
    s_nop 0
    s_waitcnt vmcnt(2)
    s_barrier
    ds_read_b64_tr_b16 v[32:33], v10 offset:0
    ds_read_b64_tr_b16 v[34:35], v10 offset:2048
    ds_read_b64_tr_b16 v[36:37], v11 offset:0
    ds_read_b64_tr_b16 v[38:39], v11 offset:2048
    ds_read_b64_tr_b16 v[40:41], v12 offset:0
    ds_read_b64_tr_b16 v[42:43], v12 offset:2048
    ds_read_b64_tr_b16 v[44:45], v13 offset:0
    ds_read_b64_tr_b16 v[46:47], v13 offset:2048
    ds_read_b128 v[64:67], v6 offset:0
    ds_read_b128 v[68:71], v6 offset:2048
    ds_read_b128 v[72:75], v6 offset:4096
    ds_read_b128 v[76:79], v6 offset:6144
    ds_read_b64_tr_b16 v[48:49], v10 offset:16384
    ds_read_b64_tr_b16 v[50:51], v10 offset:18432
    ds_read_b64_tr_b16 v[52:53], v11 offset:16384
    ds_read_b64_tr_b16 v[54:55], v11 offset:18432
    ds_read_b64_tr_b16 v[56:57], v12 offset:16384
    ds_read_b64_tr_b16 v[58:59], v12 offset:18432
    ds_read_b64_tr_b16 v[60:61], v13 offset:16384
    ds_read_b64_tr_b16 v[62:63], v13 offset:18432
    ds_read_b128 v[80:83], v7 offset:0
    ds_read_b128 v[84:87], v7 offset:2048
    ds_read_b128 v[88:91], v7 offset:4096
    ds_read_b128 v[92:95], v7 offset:6144
    s_waitcnt lgkmcnt(12)
    v_mfma_f32_16x16x32_bf16 v[128:131], v[32:35], v[64:67], v[128:131]
    v_mfma_f32_16x16x32_bf16 v[132:135], v[36:39], v[64:67], v[132:135]
    v_mfma_f32_16x16x32_bf16 v[136:139], v[40:43], v[64:67], v[136:139]
    v_mfma_f32_16x16x32_bf16 v[140:143], v[44:47], v[64:67], v[140:143]
    v_mfma_f32_16x16x32_bf16 v[144:147], v[32:35], v[68:71], v[144:147]
    v_mfma_f32_16x16x32_bf16 v[148:151], v[36:39], v[68:71], v[148:151]
    v_mfma_f32_16x16x32_bf16 v[152:155], v[40:43], v[68:71], v[152:155]
    v_mfma_f32_16x16x32_bf16 v[156:159], v[44:47], v[68:71], v[156:159]
    v_mfma_f32_16x16x32_bf16 v[160:163], v[32:35], v[72:75], v[160:163]
    v_mfma_f32_16x16x32_bf16 v[164:167], v[36:39], v[72:75], v[164:167]
    v_mfma_f32_16x16x32_bf16 v[168:171], v[40:43], v[72:75], v[168:171]
    v_mfma_f32_16x16x32_bf16 v[172:175], v[44:47], v[72:75], v[172:175]
    v_mfma_f32_16x16x32_bf16 v[176:179], v[32:35], v[76:79], v[176:179]
    v_mfma_f32_16x16x32_bf16 v[180:183], v[36:39], v[76:79], v[180:183]
    v_mfma_f32_16x16x32_bf16 v[184:187], v[40:43], v[76:79], v[184:187]
    v_mfma_f32_16x16x32_bf16 v[188:191], v[44:47], v[76:79], v[188:191]
    s_nop 0
    s_nop 0
    s_waitcnt lgkmcnt(0)
    v_mfma_f32_16x16x32_bf16 v[128:131], v[48:51], v[80:83], v[128:131]
    v_mfma_f32_16x16x32_bf16 v[132:135], v[52:55], v[80:83], v[132:135]
    v_mfma_f32_16x16x32_bf16 v[136:139], v[56:59], v[80:83], v[136:139]
    v_mfma_f32_16x16x32_bf16 v[140:143], v[60:63], v[80:83], v[140:143]
    v_mfma_f32_16x16x32_bf16 v[144:147], v[48:51], v[84:87], v[144:147]
    v_mfma_f32_16x16x32_bf16 v[148:151], v[52:55], v[84:87], v[148:151]
    v_mfma_f32_16x16x32_bf16 v[152:155], v[56:59], v[84:87], v[152:155]
    v_mfma_f32_16x16x32_bf16 v[156:159], v[60:63], v[84:87], v[156:159]
    v_mfma_f32_16x16x32_bf16 v[160:163], v[48:51], v[88:91], v[160:163]
    v_mfma_f32_16x16x32_bf16 v[164:167], v[52:55], v[88:91], v[164:167]
    v_mfma_f32_16x16x32_bf16 v[168:171], v[56:59], v[88:91], v[168:171]
    v_mfma_f32_16x16x32_bf16 v[172:175], v[60:63], v[88:91], v[172:175]
    v_mfma_f32_16x16x32_bf16 v[176:179], v[48:51], v[92:95], v[176:179]
    v_mfma_f32_16x16x32_bf16 v[180:183], v[52:55], v[92:95], v[180:183]
    v_mfma_f32_16x16x32_bf16 v[184:187], v[56:59], v[92:95], v[184:187]
    v_mfma_f32_16x16x32_bf16 v[188:191], v[60:63], v[92:95], v[188:191]
    s_nop 0
    s_nop 0
    s_mov_b32 s16, s26
    s_mov_b32 s17, s27
    s_mov_b32 s18, 16777216
    s_mov_b32 s19, 0x00020000
    s_lshl_b32 s42, s53, 20
    s_lshl_b32 s35, s37, 6
    s_add_u32 s35, s35, s54
    s_lshl_b32 s35, s35, 9
    s_add_u32 s42, s42, s35
    s_lshl_b32 s35, s38, 12
    s_add_u32 s42, s42, s35
    s_nop 7
    v_and_b32 v18, 15, v1
    v_lshlrev_b32 v18, 4, v18
    v_bfe_u32 v19, v1, 4, 1
    v_lshl_add_u32 v18, v19, 9, v18
    v_lshrrev_b32 v19, 5, v1
    v_lshl_add_u32 v18, v19, 10, v18
    v_cvt_pk_bf16_f32 v32, v128, v129
    v_cvt_pk_bf16_f32 v33, v130, v131
    v_cvt_pk_bf16_f32 v34, v132, v133
    v_cvt_pk_bf16_f32 v35, v134, v135
    s_add_u32 s35, s42, 0
    buffer_store_dwordx4 v[32:35], v18, s[16:19], s35 offen sc1
    v_cvt_pk_bf16_f32 v36, v136, v137
    v_cvt_pk_bf16_f32 v37, v138, v139
    v_cvt_pk_bf16_f32 v38, v140, v141
    v_cvt_pk_bf16_f32 v39, v142, v143
    s_add_u32 s35, s42, 2048
    buffer_store_dwordx4 v[36:39], v18, s[16:19], s35 offen sc1
    v_cvt_pk_bf16_f32 v40, v144, v145
    v_cvt_pk_bf16_f32 v41, v146, v147
    v_cvt_pk_bf16_f32 v42, v148, v149
    v_cvt_pk_bf16_f32 v43, v150, v151
    s_add_u32 s35, s42, 256
    buffer_store_dwordx4 v[40:43], v18, s[16:19], s35 offen sc1
    v_cvt_pk_bf16_f32 v44, v152, v153
    v_cvt_pk_bf16_f32 v45, v154, v155
    v_cvt_pk_bf16_f32 v46, v156, v157
    v_cvt_pk_bf16_f32 v47, v158, v159
    s_add_u32 s35, s42, 2304
    buffer_store_dwordx4 v[44:47], v18, s[16:19], s35 offen sc1
    v_cvt_pk_bf16_f32 v48, v160, v161
    v_cvt_pk_bf16_f32 v49, v162, v163
    v_cvt_pk_bf16_f32 v50, v164, v165
    v_cvt_pk_bf16_f32 v51, v166, v167
    s_add_u32 s35, s42, 16384
    buffer_store_dwordx4 v[48:51], v18, s[16:19], s35 offen sc1
    v_cvt_pk_bf16_f32 v52, v168, v169
    v_cvt_pk_bf16_f32 v53, v170, v171
    v_cvt_pk_bf16_f32 v54, v172, v173
    v_cvt_pk_bf16_f32 v55, v174, v175
    s_add_u32 s35, s42, 18432
    buffer_store_dwordx4 v[52:55], v18, s[16:19], s35 offen sc1
    v_cvt_pk_bf16_f32 v56, v176, v177
    v_cvt_pk_bf16_f32 v57, v178, v179
    v_cvt_pk_bf16_f32 v58, v180, v181
    v_cvt_pk_bf16_f32 v59, v182, v183
    s_add_u32 s35, s42, 16640
    buffer_store_dwordx4 v[56:59], v18, s[16:19], s35 offen sc1
    v_cvt_pk_bf16_f32 v60, v184, v185
    v_cvt_pk_bf16_f32 v61, v186, v187
    v_cvt_pk_bf16_f32 v62, v188, v189
    v_cvt_pk_bf16_f32 v63, v190, v191
    s_add_u32 s35, s42, 18688
    buffer_store_dwordx4 v[60:63], v18, s[16:19], s35 offen sc1
L_proj_end:
    s_endpgm
.globl attn_kernel
.p2align 8
.type attn_kernel,@function
attn_kernel:
    s_cmp_ge_u32 s2, 256
    s_cbranch_scc1 L_attn_end
    s_load_dwordx2 s[4:5], s[0:1], 120
    s_load_dwordx2 s[6:7], s[0:1], 112
    s_load_dwordx2 s[82:83], s[0:1], 32
    s_load_dwordx2 s[84:85], s[0:1], 40
    v_lshrrev_b32 v30, 6, v0
    v_and_b32 v1, 63, v0
    v_readfirstlane_b32 s32, v30
    s_and_b32 s70, s2, 7
    s_lshr_b32 s71, s2, 3
    s_and_b32 s41, s71, 1
    s_lshl_b32 s70, s70, 1
    s_add_u32 s41, s41, s70
    s_lshr_b32 s72, s71, 1
    s_and_b32 s72, s72, 7
    s_lshr_b32 s40, s71, 4
    s_mov_b32 s43, 1035512379
    s_mov_b32 s44, 0x41000000
    s_mov_b32 s46, 4048155338
    s_lshl_b32 s38, s32, 13
    s_lshl_b32 s56, s32, 13
    s_lshl_b32 s42, s41, 3
    s_add_u32 s42, s42, s72
    s_mov_b32 s58, s42
    s_lshl_b32 s73, s41, 20
    s_sub_u32 s39, 15, s72
    s_lshl_b32 s74, s72, 1
    s_sub_u32 s77, 15, s74
    s_add_u32 s78, s74, 2
    s_cmp_eq_u32 s40, 0
    s_cselect_b32 s53, s72, s39
    s_cselect_b32 s33, s77, 17
    s_cselect_b32 s59, s78, 17
    s_cselect_b32 s37, 0, s77
    s_mov_b32 s49, s33
    s_mov_b32 s50, s33
    s_mov_b32 s51, 17
    s_mov_b32 s52, 17
    s_mov_b32 s54, 0
    s_mov_b32 s69, 0
    s_mov_b32 s34, 0
    s_lshl_b32 s48, s32, 13
    s_mov_b32 s47, s48
    s_lshl_b32 s37, s37, 15
    s_add_u32 s35, s47, s37
    s_mov_b32 s36, s35
    v_lshlrev_b32 v2, 4, v1
    v_mov_b32 v12, v2
    v_add_u32 v20, 98304, v2
    s_waitcnt lgkmcnt(0)
    s_add_u32 s8, s4, 16777216
    s_addc_u32 s9, s5, 0
    s_add_u32 s8, s8, s73
    s_addc_u32 s9, s9, 0
    s_mov_b32 s10, 1048576
    s_mov_b32 s11, 0x00020000
    s_add_u32 s12, s4, 33554432
    s_addc_u32 s13, s5, 0
    s_add_u32 s12, s12, s73
    s_addc_u32 s13, s13, 0
    s_mov_b32 s14, 1048576
    s_mov_b32 s15, 0x00020000
    s_add_u32 s16, s4, 0
    s_addc_u32 s17, s5, 0
    s_add_u32 s16, s16, s73
    s_addc_u32 s17, s17, 0
    s_mov_b32 s18, 1048576
    s_mov_b32 s19, 0x00020000
    s_cmp_ge_u32 s2, 224
    s_cbranch_scc1 L_noconv1
    s_mov_b32 s20, s82
    s_mov_b32 s21, s83
    s_mov_b32 s22, 1835008
    s_mov_b32 s23, 0x00020000
    s_add_u32 s24, s4, 69206016
    s_addc_u32 s25, s5, 0
    s_mov_b32 s26, 1835008
    s_mov_b32 s27, 0x00020000
    s_mov_b32 s76, s84
    s_mov_b32 s77, s85
    s_mov_b32 s78, 896
    s_mov_b32 s79, 0x00020000
    v_lshlrev_b32 v132, 4, v0
    s_lshl_b32 s80, s2, 1
    s_add_u32 s80, s80, 0
    s_lshl_b32 s81, s80, 12
    buffer_load_dwordx4 v[140:143], v132, s[20:23], s81 offen
    buffer_load_dwordx4 v[144:147], v132, s[24:27], s81 offen
    buffer_load_dword v149, v132, s[20:23], s81 offen offset:16
    s_lshl_b32 s81, s80, 1
    v_mov_b32 v133, s81
    buffer_load_ushort v148, v133, s[76:79], 0 offen
    s_lshl_b32 s80, s2, 1
    s_add_u32 s80, s80, 1
    s_lshl_b32 s81, s80, 12
    buffer_load_dwordx4 v[150:153], v132, s[20:23], s81 offen
    buffer_load_dwordx4 v[154:157], v132, s[24:27], s81 offen
    buffer_load_dword v159, v132, s[20:23], s81 offen offset:16
    s_lshl_b32 s81, s80, 1
    v_mov_b32 v133, s81
    buffer_load_ushort v158, v133, s[76:79], 0 offen
    s_waitcnt vmcnt(0)
L_noconv1:
    s_add_u32 m0, s38, 0
    s_add_u32 s68, s35, 0
    buffer_load_dwordx4 v2, s[8:11], s68 offen offset:0 lds
    buffer_load_dwordx4 v2, s[8:11], s68 offen offset:1024 lds
    buffer_load_dwordx4 v2, s[8:11], s68 offen offset:2048 lds
    buffer_load_dwordx4 v2, s[8:11], s68 offen offset:3072 lds
    s_add_u32 m0, s38, 4096
    s_add_u32 s68, s35, 4096
    buffer_load_dwordx4 v2, s[8:11], s68 offen offset:0 lds
    buffer_load_dwordx4 v2, s[8:11], s68 offen offset:1024 lds
    buffer_load_dwordx4 v2, s[8:11], s68 offen offset:2048 lds
    buffer_load_dwordx4 v2, s[8:11], s68 offen offset:3072 lds
    s_add_u32 s35, s35, 32768
    s_sub_u32 s49, s49, 1
    s_cmp_eq_u32 s49, 0
    s_cselect_b32 s35, s47, s35
    s_sub_u32 s51, s51, 1
    s_cmp_eq_u32 s51, 0
    s_cselect_b32 s35, 0x80000000, s35
    s_cselect_b32 s47, 0x80000000, s47
    s_add_u32 s38, s38, 32768
    s_cmp_ge_u32 s38, 98304
    s_cselect_b32 s68, 98304, 0
    s_sub_u32 s38, s38, s68
    v_and_b32 v30, 31, v1
    v_lshrrev_b32 v31, 5, v1
    s_lshl_b32 s45, s32, 5
    v_add_u32 v32, s45, v30
    s_lshl_b32 s76, s32, 14
    s_lshl_b32 s75, s39, 16
    s_add_u32 s75, s75, s76
    buffer_load_dwordx4 a[0:3], v2, s[16:19], s75 offen offset:0
    buffer_load_dwordx4 a[4:7], v2, s[16:19], s75 offen offset:1024
    buffer_load_dwordx4 a[8:11], v2, s[16:19], s75 offen offset:2048
    buffer_load_dwordx4 a[12:15], v2, s[16:19], s75 offen offset:3072
    s_add_u32 s75, s75, 4096
    buffer_load_dwordx4 a[16:19], v2, s[16:19], s75 offen offset:0
    buffer_load_dwordx4 a[20:23], v2, s[16:19], s75 offen offset:1024
    buffer_load_dwordx4 a[24:27], v2, s[16:19], s75 offen offset:2048
    buffer_load_dwordx4 a[28:31], v2, s[16:19], s75 offen offset:3072
    s_add_u32 s75, s75, 4096
    buffer_load_dwordx4 a[32:35], v2, s[16:19], s75 offen offset:0
    buffer_load_dwordx4 a[36:39], v2, s[16:19], s75 offen offset:1024
    buffer_load_dwordx4 a[40:43], v2, s[16:19], s75 offen offset:2048
    buffer_load_dwordx4 a[44:47], v2, s[16:19], s75 offen offset:3072
    s_add_u32 s75, s75, 4096
    buffer_load_dwordx4 a[48:51], v2, s[16:19], s75 offen offset:0
    buffer_load_dwordx4 a[52:55], v2, s[16:19], s75 offen offset:1024
    buffer_load_dwordx4 a[56:59], v2, s[16:19], s75 offen offset:2048
    buffer_load_dwordx4 a[60:63], v2, s[16:19], s75 offen offset:3072
    s_add_u32 m0, s56, 98304
    s_add_u32 s68, s36, 0
    buffer_load_dwordx4 v2, s[12:15], s68 offen offset:0 lds
    buffer_load_dwordx4 v2, s[12:15], s68 offen offset:1024 lds
    buffer_load_dwordx4 v2, s[12:15], s68 offen offset:2048 lds
    buffer_load_dwordx4 v2, s[12:15], s68 offen offset:3072 lds
    s_add_u32 m0, s56, 102400
    s_add_u32 s68, s36, 4096
    buffer_load_dwordx4 v2, s[12:15], s68 offen offset:0 lds
    buffer_load_dwordx4 v2, s[12:15], s68 offen offset:1024 lds
    buffer_load_dwordx4 v2, s[12:15], s68 offen offset:2048 lds
    buffer_load_dwordx4 v2, s[12:15], s68 offen offset:3072 lds
    s_add_u32 s36, s36, 32768
    s_sub_u32 s50, s50, 1
    s_cmp_eq_u32 s50, 0
    s_cselect_b32 s36, s48, s36
    s_sub_u32 s52, s52, 1
    s_cmp_eq_u32 s52, 0
    s_cselect_b32 s36, 0x80000000, s36
    s_cselect_b32 s48, 0x80000000, s48
    s_add_u32 m0, s38, 0
    s_add_u32 s68, s35, 0
    buffer_load_dwordx4 v2, s[8:11], s68 offen offset:0 lds
    buffer_load_dwordx4 v2, s[8:11], s68 offen offset:1024 lds
    buffer_load_dwordx4 v2, s[8:11], s68 offen offset:2048 lds
    buffer_load_dwordx4 v2, s[8:11], s68 offen offset:3072 lds
    s_add_u32 m0, s38, 4096
    s_add_u32 s68, s35, 4096
    buffer_load_dwordx4 v2, s[8:11], s68 offen offset:0 lds
    buffer_load_dwordx4 v2, s[8:11], s68 offen offset:1024 lds
    buffer_load_dwordx4 v2, s[8:11], s68 offen offset:2048 lds
    buffer_load_dwordx4 v2, s[8:11], s68 offen offset:3072 lds
    s_add_u32 s35, s35, 32768
    s_sub_u32 s49, s49, 1
    s_cmp_eq_u32 s49, 0
    s_cselect_b32 s35, s47, s35
    s_sub_u32 s51, s51, 1
    s_cmp_eq_u32 s51, 0
    s_cselect_b32 s35, 0x80000000, s35
    s_cselect_b32 s47, 0x80000000, s47
    s_add_u32 s38, s38, 32768
    s_cmp_ge_u32 s38, 98304
    s_cselect_b32 s68, 98304, 0
    s_sub_u32 s38, s38, s68
    v_lshlrev_b32 v34, 2, v31
    v_sub_u32 v29, v32, v34
    s_cmp_ge_u32 s2, 224
    s_cbranch_scc1 L_noconv2
    v_and_b32 v128, 31, v1
    v_lshrrev_b32 v129, 5, v1
    v_add_u32 v130, 1, v128
    v_and_b32 v130, 3, v130
    v_mul_u32_u24 v138, 4414, v130
    v_lshl_add_u32 v138, v128, 1, v138
    v_lshlrev_b32 v131, 4, v129
    v_sub_u32 v138, v138, v131
    s_lshl_b32 s82, s32, 6
    s_add_u32 s82, s82, 65618
    v_add_u32 v138, s82, v138
    v_mul_u32_u24 v139, 80, v128
    v_add_u32 v139, v139, v131
    s_mul_i32 s82, s32, 80
    s_sub_u32 s82, 80960, s82
    v_add_u32 v139, s82, v139
    v_mov_b32 v172, 0
    v_mov_b32 v173, 0
    v_mov_b32 v174, 0
    v_mov_b32 v175, 0
    v_add_u32 v133, 83200, v132
    v_add_u32 v134, 148736, v132
    v_cmp_gt_u32 vcc, 160, v0
    s_and_saveexec_b64 s[86:87], vcc
    ds_write_b128 v133, v[172:175]
    ds_write_b128 v134, v[172:175]
    s_mov_b64 exec, s[86:87]
    v_lshrrev_b32 v134, 3, v0
    v_mul_u32_u24 v136, 4416, v134
    v_and_b32 v135, 7, v0
    v_lshl_add_u32 v136, v135, 4, v136
    v_add_u32 v133, 65536, v136
    v_add_u32 v134, 131072, v136
    v_cmp_gt_u32 vcc, 32, v0
    s_and_saveexec_b64 s[86:87], vcc
    ds_write_b128 v133, v[172:175]
    ds_write_b128 v134, v[172:175]
    s_mov_b64 exec, s[86:87]
    s_waitcnt lgkmcnt(0)
    s_barrier
    s_add_u32 s28, s4, 67108864
    s_addc_u32 s29, s5, 0
    s_mov_b32 s30, 1835008
    s_mov_b32 s31, 0x00020000
    s_waitcnt vmcnt(40)
    v_lshrrev_b32 v135, 2, v0
    v_mul_u32_u24 v135, 80, v135
    v_and_b32 v134, 3, v0
    v_lshl_add_u32 v135, v134, 4, v135
    v_alignbit_b32 v160, v141, v140, 16
    v_alignbit_b32 v161, v142, v141, 16
    v_alignbit_b32 v162, v143, v142, 16
    v_alignbit_b32 v163, v149, v143, 16
    v_add_u32 v136, 65664, v132
    ds_write2_b32 v136, v140, v141 offset0:0 offset1:1
    ds_write2_b32 v136, v142, v143 offset0:2 offset1:3
    v_add_u32 v137, 70080, v132
    ds_write2_b32 v137, v160, v161 offset0:0 offset1:1
    ds_write2_b32 v137, v162, v163 offset0:2 offset1:3
    v_add_u32 v136, 74492, v132
    ds_write2_b32 v136, v140, v141 offset0:0 offset1:1
    ds_write2_b32 v136, v142, v143 offset0:2 offset1:3
    v_add_u32 v137, 78908, v132
    ds_write2_b32 v137, v160, v161 offset0:0 offset1:1
    ds_write2_b32 v137, v162, v163 offset0:2 offset1:3
    v_add_u32 v133, 85760, v135
    ds_write_b128 v133, v[144:147]
    v_mov_b32 v133, 65536
    v_cmp_eq_u32 vcc, 0, v0
    s_and_saveexec_b64 s[86:87], vcc
    ds_write_b16 v133, v140 offset:4542
    ds_write_b16 v133, v140 offset:13370
    s_mov_b64 exec, s[86:87]
    v_alignbit_b32 v160, v151, v150, 16
    v_alignbit_b32 v161, v152, v151, 16
    v_alignbit_b32 v162, v153, v152, 16
    v_alignbit_b32 v163, v159, v153, 16
    v_add_u32 v136, 131200, v132
    ds_write2_b32 v136, v150, v151 offset0:0 offset1:1
    ds_write2_b32 v136, v152, v153 offset0:2 offset1:3
    v_add_u32 v137, 135616, v132
    ds_write2_b32 v137, v160, v161 offset0:0 offset1:1
    ds_write2_b32 v137, v162, v163 offset0:2 offset1:3
    v_add_u32 v136, 140028, v132
    ds_write2_b32 v136, v150, v151 offset0:0 offset1:1
    ds_write2_b32 v136, v152, v153 offset0:2 offset1:3
    v_add_u32 v137, 144444, v132
    ds_write2_b32 v137, v160, v161 offset0:0 offset1:1
    ds_write2_b32 v137, v162, v163 offset0:2 offset1:3
    v_add_u32 v133, 151296, v135
    ds_write_b128 v133, v[154:157]
    v_mov_b32 v133, 131072
    v_cmp_eq_u32 vcc, 0, v0
    s_and_saveexec_b64 s[86:87], vcc
    ds_write_b16 v133, v150 offset:4542
    ds_write_b16 v133, v150 offset:13370
    s_mov_b64 exec, s[86:87]
    v_add_u32 v136, 65536, v138
    v_add_u32 v137, 65536, v139
    s_waitcnt lgkmcnt(0)
    s_barrier
    ds_read_b64 v[172:173], v138 offset:32
    ds_read_b64 v[174:175], v138 offset:40
    ds_read_b128 v[188:191], v139 offset:7360
    ds_read_b128 v[184:187], v139 offset:4800
    ds_read_b64 v[176:177], v138 offset:0
    ds_read_b64 v[178:179], v138 offset:8
    ds_read_b128 v[196:199], v139 offset:7392
    ds_read_b128 v[192:195], v139 offset:4832
    ds_read_b64 v[180:181], v138 offset:288
    ds_read_b64 v[182:183], v138 offset:296
    ds_read_b128 v[204:207], v139 offset:7040
    ds_read_b128 v[200:203], v139 offset:4480
    s_waitcnt lgkmcnt(8)
    v_mfma_f32_32x32x16_bf16 v[80:95], v[172:175], v[188:191], 0
    v_mfma_f32_32x32x16_bf16 v[64:79], v[172:175], v[184:187], 0
    ds_read_b64 v[172:173], v138 offset:256
    ds_read_b64 v[174:175], v138 offset:264
    ds_read_b128 v[188:191], v139 offset:7072
    ds_read_b128 v[184:187], v139 offset:4512
    s_waitcnt lgkmcnt(8)
    v_mfma_f32_32x32x16_bf16 v[80:95], v[176:179], v[196:199], v[80:95]
    v_mfma_f32_32x32x16_bf16 v[64:79], v[176:179], v[192:195], v[64:79]
    ds_read_b64 v[176:177], v138 offset:544
    ds_read_b64 v[178:179], v138 offset:552
    ds_read_b128 v[196:199], v139 offset:6720
    ds_read_b128 v[192:195], v139 offset:4160
    s_waitcnt lgkmcnt(8)
    v_mfma_f32_32x32x16_bf16 v[80:95], v[180:183], v[204:207], v[80:95]
    v_mfma_f32_32x32x16_bf16 v[64:79], v[180:183], v[200:203], v[64:79]
    ds_read_b64 v[180:181], v138 offset:512
    ds_read_b64 v[182:183], v138 offset:520
    ds_read_b128 v[204:207], v139 offset:6752
    ds_read_b128 v[200:203], v139 offset:4192
    s_waitcnt lgkmcnt(8)
    v_mfma_f32_32x32x16_bf16 v[80:95], v[172:175], v[188:191], v[80:95]
    v_mfma_f32_32x32x16_bf16 v[64:79], v[172:175], v[184:187], v[64:79]
    ds_read_b64 v[172:173], v138 offset:800
    ds_read_b64 v[174:175], v138 offset:808
    ds_read_b128 v[188:191], v139 offset:6400
    ds_read_b128 v[184:187], v139 offset:3840
    s_waitcnt lgkmcnt(8)
    v_mfma_f32_32x32x16_bf16 v[80:95], v[176:179], v[196:199], v[80:95]
    v_mfma_f32_32x32x16_bf16 v[64:79], v[176:179], v[192:195], v[64:79]
    ds_read_b64 v[176:177], v138 offset:768
    ds_read_b64 v[178:179], v138 offset:776
    ds_read_b128 v[196:199], v139 offset:6432
    ds_read_b128 v[192:195], v139 offset:3872
    s_waitcnt lgkmcnt(8)
    v_mfma_f32_32x32x16_bf16 v[80:95], v[180:183], v[204:207], v[80:95]
    v_mfma_f32_32x32x16_bf16 v[64:79], v[180:183], v[200:203], v[64:79]
    ds_read_b64 v[180:181], v138 offset:1056
    ds_read_b64 v[182:183], v138 offset:1064
    ds_read_b128 v[204:207], v139 offset:6080
    ds_read_b128 v[200:203], v139 offset:3520
    s_waitcnt lgkmcnt(8)
    v_mfma_f32_32x32x16_bf16 v[80:95], v[172:175], v[188:191], v[80:95]
    v_mfma_f32_32x32x16_bf16 v[64:79], v[172:175], v[184:187], v[64:79]
    ds_read_b64 v[172:173], v138 offset:1024
    ds_read_b64 v[174:175], v138 offset:1032
    ds_read_b128 v[188:191], v139 offset:6112
    ds_read_b128 v[184:187], v139 offset:3552
    s_waitcnt lgkmcnt(8)
    v_mfma_f32_32x32x16_bf16 v[80:95], v[176:179], v[196:199], v[80:95]
    v_mfma_f32_32x32x16_bf16 v[64:79], v[176:179], v[192:195], v[64:79]
    ds_read_b64 v[176:177], v138 offset:1312
    ds_read_b64 v[178:179], v138 offset:1320
    ds_read_b128 v[196:199], v139 offset:5760
    ds_read_b128 v[192:195], v139 offset:3200
    s_waitcnt lgkmcnt(8)
    v_mfma_f32_32x32x16_bf16 v[80:95], v[180:183], v[204:207], v[80:95]
    v_mfma_f32_32x32x16_bf16 v[64:79], v[180:183], v[200:203], v[64:79]
    ds_read_b64 v[180:181], v138 offset:1280
    ds_read_b64 v[182:183], v138 offset:1288
    ds_read_b128 v[204:207], v139 offset:5792
    ds_read_b128 v[200:203], v139 offset:3232
    s_waitcnt lgkmcnt(8)
    v_mfma_f32_32x32x16_bf16 v[80:95], v[172:175], v[188:191], v[80:95]
    v_mfma_f32_32x32x16_bf16 v[64:79], v[172:175], v[184:187], v[64:79]
    ds_read_b64 v[172:173], v138 offset:1568
    ds_read_b64 v[174:175], v138 offset:1576
    ds_read_b128 v[188:191], v139 offset:5440
    ds_read_b128 v[184:187], v139 offset:2880
    s_waitcnt lgkmcnt(8)
    v_mfma_f32_32x32x16_bf16 v[80:95], v[176:179], v[196:199], v[80:95]
    v_mfma_f32_32x32x16_bf16 v[64:79], v[176:179], v[192:195], v[64:79]
    ds_read_b64 v[176:177], v138 offset:1536
    ds_read_b64 v[178:179], v138 offset:1544
    ds_read_b128 v[196:199], v139 offset:5472
    ds_read_b128 v[192:195], v139 offset:2912
    s_waitcnt lgkmcnt(8)
    v_mfma_f32_32x32x16_bf16 v[80:95], v[180:183], v[204:207], v[80:95]
    v_mfma_f32_32x32x16_bf16 v[64:79], v[180:183], v[200:203], v[64:79]
    ds_read_b64 v[180:181], v138 offset:1824
    ds_read_b64 v[182:183], v138 offset:1832
    ds_read_b128 v[204:207], v139 offset:5120
    ds_read_b128 v[200:203], v139 offset:2560
    s_waitcnt lgkmcnt(8)
    v_mfma_f32_32x32x16_bf16 v[80:95], v[172:175], v[188:191], v[80:95]
    v_mfma_f32_32x32x16_bf16 v[64:79], v[172:175], v[184:187], v[64:79]
    ds_read_b64 v[172:173], v138 offset:1792
    ds_read_b64 v[174:175], v138 offset:1800
    ds_read_b128 v[188:191], v139 offset:5152
    ds_read_b128 v[184:187], v139 offset:2592
    s_waitcnt lgkmcnt(8)
    v_mfma_f32_32x32x16_bf16 v[80:95], v[176:179], v[196:199], v[80:95]
    v_mfma_f32_32x32x16_bf16 v[64:79], v[176:179], v[192:195], v[64:79]
    ds_read_b64 v[176:177], v138 offset:2080
    ds_read_b64 v[178:179], v138 offset:2088
    ds_read_b128 v[196:199], v139 offset:4800
    s_waitcnt lgkmcnt(7)
    v_mfma_f32_32x32x16_bf16 v[80:95], v[180:183], v[204:207], v[80:95]
    v_mfma_f32_32x32x16_bf16 v[64:79], v[180:183], v[200:203], v[64:79]
    ds_read_b64 v[180:181], v138 offset:2048
    ds_read_b64 v[182:183], v138 offset:2056
    ds_read_b128 v[204:207], v139 offset:4832
    s_waitcnt lgkmcnt(6)
    v_mfma_f32_32x32x16_bf16 v[80:95], v[172:175], v[188:191], v[80:95]
    v_mfma_f32_32x32x16_bf16 v[64:79], v[172:175], v[184:187], v[64:79]
    ds_read_b64 v[172:173], v138 offset:2336
    ds_read_b64 v[174:175], v138 offset:2344
    ds_read_b128 v[188:191], v139 offset:4480
    s_waitcnt lgkmcnt(6)
    v_mfma_f32_32x32x16_bf16 v[80:95], v[176:179], v[196:199], v[80:95]
    ds_read_b64 v[176:177], v138 offset:2304
    ds_read_b64 v[178:179], v138 offset:2312
    ds_read_b128 v[196:199], v139 offset:4512
    s_waitcnt lgkmcnt(6)
    v_mfma_f32_32x32x16_bf16 v[80:95], v[180:183], v[204:207], v[80:95]
    ds_read_b64 v[180:181], v138 offset:2592
    ds_read_b64 v[182:183], v138 offset:2600
    ds_read_b128 v[204:207], v139 offset:4160
    s_waitcnt lgkmcnt(6)
    v_mfma_f32_32x32x16_bf16 v[80:95], v[172:175], v[188:191], v[80:95]
    ds_read_b64 v[172:173], v138 offset:2560
    ds_read_b64 v[174:175], v138 offset:2568
    ds_read_b128 v[188:191], v139 offset:4192
    s_waitcnt lgkmcnt(6)
    v_mfma_f32_32x32x16_bf16 v[80:95], v[176:179], v[196:199], v[80:95]
    ds_read_b64 v[176:177], v138 offset:2848
    ds_read_b64 v[178:179], v138 offset:2856
    ds_read_b128 v[196:199], v139 offset:3840
    s_waitcnt lgkmcnt(6)
    v_mfma_f32_32x32x16_bf16 v[80:95], v[180:183], v[204:207], v[80:95]
    ds_read_b64 v[180:181], v138 offset:2816
    ds_read_b64 v[182:183], v138 offset:2824
    ds_read_b128 v[204:207], v139 offset:3872
    s_waitcnt lgkmcnt(6)
    v_mfma_f32_32x32x16_bf16 v[80:95], v[172:175], v[188:191], v[80:95]
    ds_read_b64 v[172:173], v138 offset:3104
    ds_read_b64 v[174:175], v138 offset:3112
    ds_read_b128 v[188:191], v139 offset:3520
    s_waitcnt lgkmcnt(6)
    v_mfma_f32_32x32x16_bf16 v[80:95], v[176:179], v[196:199], v[80:95]
    ds_read_b64 v[176:177], v138 offset:3072
    ds_read_b64 v[178:179], v138 offset:3080
    ds_read_b128 v[196:199], v139 offset:3552
    s_waitcnt lgkmcnt(6)
    v_mfma_f32_32x32x16_bf16 v[80:95], v[180:183], v[204:207], v[80:95]
    ds_read_b64 v[180:181], v138 offset:3360
    ds_read_b64 v[182:183], v138 offset:3368
    ds_read_b128 v[204:207], v139 offset:3200
    s_waitcnt lgkmcnt(6)
    v_mfma_f32_32x32x16_bf16 v[80:95], v[172:175], v[188:191], v[80:95]
    ds_read_b64 v[172:173], v138 offset:3328
    ds_read_b64 v[174:175], v138 offset:3336
    ds_read_b128 v[188:191], v139 offset:3232
    s_waitcnt lgkmcnt(6)
    v_mfma_f32_32x32x16_bf16 v[80:95], v[176:179], v[196:199], v[80:95]
    ds_read_b64 v[176:177], v138 offset:3616
    ds_read_b64 v[178:179], v138 offset:3624
    ds_read_b128 v[196:199], v139 offset:2880
    s_waitcnt lgkmcnt(6)
    v_mfma_f32_32x32x16_bf16 v[80:95], v[180:183], v[204:207], v[80:95]
    ds_read_b64 v[180:181], v138 offset:3584
    ds_read_b64 v[182:183], v138 offset:3592
    ds_read_b128 v[204:207], v139 offset:2912
    s_waitcnt lgkmcnt(6)
    v_mfma_f32_32x32x16_bf16 v[80:95], v[172:175], v[188:191], v[80:95]
    ds_read_b64 v[172:173], v138 offset:3872
    ds_read_b64 v[174:175], v138 offset:3880
    ds_read_b128 v[188:191], v139 offset:2560
    s_waitcnt lgkmcnt(6)
    v_mfma_f32_32x32x16_bf16 v[80:95], v[176:179], v[196:199], v[80:95]
    ds_read_b64 v[176:177], v138 offset:3840
    ds_read_b64 v[178:179], v138 offset:3848
    ds_read_b128 v[196:199], v139 offset:2592
    s_waitcnt lgkmcnt(6)
    v_mfma_f32_32x32x16_bf16 v[80:95], v[180:183], v[204:207], v[80:95]
    ds_read_b64 v[180:181], v136 offset:32
    ds_read_b64 v[182:183], v136 offset:40
    ds_read_b128 v[204:207], v137 offset:7360
    ds_read_b128 v[200:203], v137 offset:4800
    s_waitcnt lgkmcnt(7)
    v_mfma_f32_32x32x16_bf16 v[80:95], v[172:175], v[188:191], v[80:95]
    ds_read_b64 v[172:173], v136 offset:0
    ds_read_b64 v[174:175], v136 offset:8
    ds_read_b128 v[188:191], v137 offset:7392
    ds_read_b128 v[184:187], v137 offset:4832
    s_waitcnt lgkmcnt(8)
    v_mfma_f32_32x32x16_bf16 v[80:95], v[176:179], v[196:199], v[80:95]
    ds_read_b64 v[176:177], v136 offset:288
    ds_read_b64 v[178:179], v136 offset:296
    ds_read_b128 v[196:199], v137 offset:7040
    ds_read_b128 v[192:195], v137 offset:4480
    s_waitcnt lgkmcnt(8)
    v_mfma_f32_32x32x16_bf16 v[112:127], v[180:183], v[204:207], 0
    v_mfma_f32_32x32x16_bf16 v[96:111], v[180:183], v[200:203], 0
    ds_read_b64 v[180:181], v136 offset:256
    ds_read_b64 v[182:183], v136 offset:264
    ds_read_b128 v[204:207], v137 offset:7072
    ds_read_b128 v[200:203], v137 offset:4512
    s_waitcnt lgkmcnt(8)
    v_mfma_f32_32x32x16_bf16 v[112:127], v[172:175], v[188:191], v[112:127]
    v_mfma_f32_32x32x16_bf16 v[96:111], v[172:175], v[184:187], v[96:111]
    ds_read_b64 v[172:173], v136 offset:544
    ds_read_b64 v[174:175], v136 offset:552
    ds_read_b128 v[188:191], v137 offset:6720
    ds_read_b128 v[184:187], v137 offset:4160
    s_waitcnt lgkmcnt(8)
    v_mfma_f32_32x32x16_bf16 v[112:127], v[176:179], v[196:199], v[112:127]
    v_mfma_f32_32x32x16_bf16 v[96:111], v[176:179], v[192:195], v[96:111]
    ds_read_b64 v[176:177], v136 offset:512
    ds_read_b64 v[178:179], v136 offset:520
    ds_read_b128 v[196:199], v137 offset:6752
    ds_read_b128 v[192:195], v137 offset:4192
    s_waitcnt lgkmcnt(8)
    v_mfma_f32_32x32x16_bf16 v[112:127], v[180:183], v[204:207], v[112:127]
    v_mfma_f32_32x32x16_bf16 v[96:111], v[180:183], v[200:203], v[96:111]
    ds_read_b64 v[180:181], v136 offset:800
    ds_read_b64 v[182:183], v136 offset:808
    ds_read_b128 v[204:207], v137 offset:6400
    ds_read_b128 v[200:203], v137 offset:3840
    s_waitcnt lgkmcnt(8)
    v_mfma_f32_32x32x16_bf16 v[112:127], v[172:175], v[188:191], v[112:127]
    v_mfma_f32_32x32x16_bf16 v[96:111], v[172:175], v[184:187], v[96:111]
    ds_read_b64 v[172:173], v136 offset:768
    ds_read_b64 v[174:175], v136 offset:776
    ds_read_b128 v[188:191], v137 offset:6432
    ds_read_b128 v[184:187], v137 offset:3872
    s_waitcnt lgkmcnt(8)
    v_mfma_f32_32x32x16_bf16 v[112:127], v[176:179], v[196:199], v[112:127]
    v_mfma_f32_32x32x16_bf16 v[96:111], v[176:179], v[192:195], v[96:111]
    ds_read_b64 v[176:177], v136 offset:1056
    ds_read_b64 v[178:179], v136 offset:1064
    ds_read_b128 v[196:199], v137 offset:6080
    ds_read_b128 v[192:195], v137 offset:3520
    s_waitcnt lgkmcnt(8)
    v_mfma_f32_32x32x16_bf16 v[112:127], v[180:183], v[204:207], v[112:127]
    v_mfma_f32_32x32x16_bf16 v[96:111], v[180:183], v[200:203], v[96:111]
    ds_read_b64 v[180:181], v136 offset:1024
    ds_read_b64 v[182:183], v136 offset:1032
    ds_read_b128 v[204:207], v137 offset:6112
    ds_read_b128 v[200:203], v137 offset:3552
    s_waitcnt lgkmcnt(8)
    v_mfma_f32_32x32x16_bf16 v[112:127], v[172:175], v[188:191], v[112:127]
    v_mfma_f32_32x32x16_bf16 v[96:111], v[172:175], v[184:187], v[96:111]
    ds_read_b64 v[172:173], v136 offset:1312
    ds_read_b64 v[174:175], v136 offset:1320
    ds_read_b128 v[188:191], v137 offset:5760
    ds_read_b128 v[184:187], v137 offset:3200
    s_waitcnt lgkmcnt(8)
    v_mfma_f32_32x32x16_bf16 v[112:127], v[176:179], v[196:199], v[112:127]
    v_mfma_f32_32x32x16_bf16 v[96:111], v[176:179], v[192:195], v[96:111]
    ds_read_b64 v[176:177], v136 offset:1280
    ds_read_b64 v[178:179], v136 offset:1288
    ds_read_b128 v[196:199], v137 offset:5792
    ds_read_b128 v[192:195], v137 offset:3232
    s_waitcnt lgkmcnt(8)
    v_mfma_f32_32x32x16_bf16 v[112:127], v[180:183], v[204:207], v[112:127]
    v_mfma_f32_32x32x16_bf16 v[96:111], v[180:183], v[200:203], v[96:111]
    ds_read_b64 v[180:181], v136 offset:1568
    ds_read_b64 v[182:183], v136 offset:1576
    ds_read_b128 v[204:207], v137 offset:5440
    ds_read_b128 v[200:203], v137 offset:2880
    s_waitcnt lgkmcnt(8)
    v_mfma_f32_32x32x16_bf16 v[112:127], v[172:175], v[188:191], v[112:127]
    v_mfma_f32_32x32x16_bf16 v[96:111], v[172:175], v[184:187], v[96:111]
    ds_read_b64 v[172:173], v136 offset:1536
    ds_read_b64 v[174:175], v136 offset:1544
    ds_read_b128 v[188:191], v137 offset:5472
    ds_read_b128 v[184:187], v137 offset:2912
    s_waitcnt lgkmcnt(8)
    v_mfma_f32_32x32x16_bf16 v[112:127], v[176:179], v[196:199], v[112:127]
    v_mfma_f32_32x32x16_bf16 v[96:111], v[176:179], v[192:195], v[96:111]
    ds_read_b64 v[176:177], v136 offset:1824
    ds_read_b64 v[178:179], v136 offset:1832
    ds_read_b128 v[196:199], v137 offset:5120
    ds_read_b128 v[192:195], v137 offset:2560
    s_waitcnt lgkmcnt(8)
    v_mfma_f32_32x32x16_bf16 v[112:127], v[180:183], v[204:207], v[112:127]
    v_mfma_f32_32x32x16_bf16 v[96:111], v[180:183], v[200:203], v[96:111]
    ds_read_b64 v[180:181], v136 offset:1792
    ds_read_b64 v[182:183], v136 offset:1800
    ds_read_b128 v[204:207], v137 offset:5152
    ds_read_b128 v[200:203], v137 offset:2592
    s_waitcnt lgkmcnt(8)
    v_mfma_f32_32x32x16_bf16 v[112:127], v[172:175], v[188:191], v[112:127]
    v_mfma_f32_32x32x16_bf16 v[96:111], v[172:175], v[184:187], v[96:111]
    ds_read_b64 v[172:173], v136 offset:2080
    ds_read_b64 v[174:175], v136 offset:2088
    ds_read_b128 v[188:191], v137 offset:4800
    s_waitcnt lgkmcnt(7)
    v_mfma_f32_32x32x16_bf16 v[112:127], v[176:179], v[196:199], v[112:127]
    v_mfma_f32_32x32x16_bf16 v[96:111], v[176:179], v[192:195], v[96:111]
    ds_read_b64 v[176:177], v136 offset:2048
    ds_read_b64 v[178:179], v136 offset:2056
    ds_read_b128 v[196:199], v137 offset:4832
    s_waitcnt lgkmcnt(6)
    v_mfma_f32_32x32x16_bf16 v[112:127], v[180:183], v[204:207], v[112:127]
    v_mfma_f32_32x32x16_bf16 v[96:111], v[180:183], v[200:203], v[96:111]
    ds_read_b64 v[180:181], v136 offset:2336
    ds_read_b64 v[182:183], v136 offset:2344
    ds_read_b128 v[204:207], v137 offset:4480
    s_waitcnt lgkmcnt(6)
    v_mfma_f32_32x32x16_bf16 v[112:127], v[172:175], v[188:191], v[112:127]
    ds_read_b64 v[172:173], v136 offset:2304
    ds_read_b64 v[174:175], v136 offset:2312
    ds_read_b128 v[188:191], v137 offset:4512
    s_waitcnt lgkmcnt(6)
    v_mfma_f32_32x32x16_bf16 v[112:127], v[176:179], v[196:199], v[112:127]
    ds_read_b64 v[176:177], v136 offset:2592
    ds_read_b64 v[178:179], v136 offset:2600
    ds_read_b128 v[196:199], v137 offset:4160
    s_waitcnt lgkmcnt(6)
    v_mfma_f32_32x32x16_bf16 v[112:127], v[180:183], v[204:207], v[112:127]
    ds_read_b64 v[180:181], v136 offset:2560
    ds_read_b64 v[182:183], v136 offset:2568
    ds_read_b128 v[204:207], v137 offset:4192
    s_waitcnt lgkmcnt(6)
    v_mfma_f32_32x32x16_bf16 v[112:127], v[172:175], v[188:191], v[112:127]
    ds_read_b64 v[172:173], v136 offset:2848
    ds_read_b64 v[174:175], v136 offset:2856
    ds_read_b128 v[188:191], v137 offset:3840
    s_waitcnt lgkmcnt(6)
    v_mfma_f32_32x32x16_bf16 v[112:127], v[176:179], v[196:199], v[112:127]
    ds_read_b64 v[176:177], v136 offset:2816
    ds_read_b64 v[178:179], v136 offset:2824
    ds_read_b128 v[196:199], v137 offset:3872
    s_waitcnt lgkmcnt(6)
    v_mfma_f32_32x32x16_bf16 v[112:127], v[180:183], v[204:207], v[112:127]
    ds_read_b64 v[180:181], v136 offset:3104
    ds_read_b64 v[182:183], v136 offset:3112
    ds_read_b128 v[204:207], v137 offset:3520
    s_waitcnt lgkmcnt(6)
    v_mfma_f32_32x32x16_bf16 v[112:127], v[172:175], v[188:191], v[112:127]
    ds_read_b64 v[172:173], v136 offset:3072
    ds_read_b64 v[174:175], v136 offset:3080
    ds_read_b128 v[188:191], v137 offset:3552
    s_waitcnt lgkmcnt(6)
    v_mfma_f32_32x32x16_bf16 v[112:127], v[176:179], v[196:199], v[112:127]
    ds_read_b64 v[176:177], v136 offset:3360
    ds_read_b64 v[178:179], v136 offset:3368
    ds_read_b128 v[196:199], v137 offset:3200
    s_waitcnt lgkmcnt(6)
    v_mfma_f32_32x32x16_bf16 v[112:127], v[180:183], v[204:207], v[112:127]
    ds_read_b64 v[180:181], v136 offset:3328
    ds_read_b64 v[182:183], v136 offset:3336
    ds_read_b128 v[204:207], v137 offset:3232
    s_waitcnt lgkmcnt(6)
    v_mfma_f32_32x32x16_bf16 v[112:127], v[172:175], v[188:191], v[112:127]
    ds_read_b64 v[172:173], v136 offset:3616
    ds_read_b64 v[174:175], v136 offset:3624
    ds_read_b128 v[188:191], v137 offset:2880
    s_waitcnt lgkmcnt(6)
    v_mfma_f32_32x32x16_bf16 v[112:127], v[176:179], v[196:199], v[112:127]
    ds_read_b64 v[176:177], v136 offset:3584
    ds_read_b64 v[178:179], v136 offset:3592
    ds_read_b128 v[196:199], v137 offset:2912
    s_waitcnt lgkmcnt(6)
    v_mfma_f32_32x32x16_bf16 v[112:127], v[180:183], v[204:207], v[112:127]
    ds_read_b64 v[180:181], v136 offset:3872
    ds_read_b64 v[182:183], v136 offset:3880
    ds_read_b128 v[204:207], v137 offset:2560
    s_waitcnt lgkmcnt(6)
    v_mfma_f32_32x32x16_bf16 v[112:127], v[172:175], v[188:191], v[112:127]
    ds_read_b64 v[172:173], v136 offset:3840
    ds_read_b64 v[174:175], v136 offset:3848
    ds_read_b128 v[188:191], v137 offset:2592
    s_waitcnt lgkmcnt(6)
    v_mfma_f32_32x32x16_bf16 v[112:127], v[176:179], v[196:199], v[112:127]
    s_waitcnt lgkmcnt(3)
    v_mfma_f32_32x32x16_bf16 v[112:127], v[180:183], v[204:207], v[112:127]
    s_waitcnt lgkmcnt(0)
    v_mfma_f32_32x32x16_bf16 v[112:127], v[172:175], v[188:191], v[112:127]
    s_lshr_b32 s82, s32, 1
    s_lshl_b32 s82, s82, 16
    s_and_b32 s83, s32, 1
    s_mul_i32 s83, s83, 2560
    s_add_u32 s82, s82, s83
    s_add_u32 s82, s82, 85768
    v_mul_u32_u24 v135, 80, v128
    v_lshlrev_b32 v131, 3, v129
    v_sub_u32 v135, v135, v131
    v_add_u32 v135, s82, v135
    ds_read_b64 v[164:165], v135 offset:0
    ds_read_b64 v[166:167], v135 offset:16
    ds_read_b64 v[168:169], v135 offset:32
    ds_read_b64 v[170:171], v135 offset:48
    s_waitcnt lgkmcnt(0)
    s_barrier
    v_lshlrev_b32 v133, 4, v1
    s_lshr_b32 s82, s32, 1
    s_lshl_b32 s82, s82, 16
    s_and_b32 s83, s32, 1
    s_lshl_b32 s83, s83, 14
    s_add_u32 s82, s82, s83
    s_add_u32 s82, s82, 65536
    v_add_u32 v135, s82, v133
    ds_write_b128 v135, v[64:67] offset:0
    ds_write_b128 v135, v[68:71] offset:1024
    ds_write_b128 v135, v[72:75] offset:2048
    ds_write_b128 v135, v[76:79] offset:3072
    ds_write_b128 v135, v[80:83] offset:4096
    ds_write_b128 v135, v[84:87] offset:5120
    ds_write_b128 v135, v[88:91] offset:6144
    ds_write_b128 v135, v[92:95] offset:7168
    ds_write_b128 v135, v[96:99] offset:8192
    ds_write_b128 v135, v[100:103] offset:9216
    ds_write_b128 v135, v[104:107] offset:10240
    ds_write_b128 v135, v[108:111] offset:11264
    ds_write_b128 v135, v[112:115] offset:12288
    ds_write_b128 v135, v[116:119] offset:13312
    ds_write_b128 v135, v[120:123] offset:14336
    ds_write_b128 v135, v[124:127] offset:15360
    s_waitcnt lgkmcnt(0)
    s_barrier
    s_lshl_b32 s82, s32, 12
    s_add_u32 s82, s82, 65536
    v_add_u32 v135, s82, v133
    v_add_u32 v136, 65536, v135
    ds_read_b128 v[64:67], v135 offset:0
    ds_read_b128 v[68:71], v135 offset:1024
    ds_read_b128 v[72:75], v135 offset:2048
    ds_read_b128 v[76:79], v135 offset:3072
    ds_read_b128 v[80:83], v135 offset:16384
    ds_read_b128 v[84:87], v135 offset:17408
    ds_read_b128 v[88:91], v135 offset:18432
    ds_read_b128 v[92:95], v135 offset:19456
    ds_read_b128 v[96:99], v136 offset:0
    ds_read_b128 v[100:103], v136 offset:1024
    ds_read_b128 v[104:107], v136 offset:2048
    ds_read_b128 v[108:111], v136 offset:3072
    ds_read_b128 v[112:115], v136 offset:16384
    ds_read_b128 v[116:119], v136 offset:17408
    ds_read_b128 v[120:123], v136 offset:18432
    ds_read_b128 v[124:127], v136 offset:19456
    s_cmp_ge_u32 s32, 2
    s_cselect_b64 vcc, -1, 0
    v_cndmask_b32 v134, v148, v158, vcc
    v_lshlrev_b32 v134, 16, v134
    s_waitcnt lgkmcnt(0)
    v_add_f32 v64, v64, v80
    v_add_f32 v96, v96, v112
    v_add_f32 v64, v64, v96
    v_add_f32 v65, v65, v81
    v_add_f32 v97, v97, v113
    v_add_f32 v65, v65, v97
    v_add_f32 v66, v66, v82
    v_add_f32 v98, v98, v114
    v_add_f32 v66, v66, v98
    v_add_f32 v67, v67, v83
    v_add_f32 v99, v99, v115
    v_add_f32 v67, v67, v99
    v_add_f32 v68, v68, v84
    v_add_f32 v100, v100, v116
    v_add_f32 v68, v68, v100
    v_add_f32 v69, v69, v85
    v_add_f32 v101, v101, v117
    v_add_f32 v69, v69, v101
    v_add_f32 v70, v70, v86
    v_add_f32 v102, v102, v118
    v_add_f32 v70, v70, v102
    v_add_f32 v71, v71, v87
    v_add_f32 v103, v103, v119
    v_add_f32 v71, v71, v103
    v_add_f32 v72, v72, v88
    v_add_f32 v104, v104, v120
    v_add_f32 v72, v72, v104
    v_add_f32 v73, v73, v89
    v_add_f32 v105, v105, v121
    v_add_f32 v73, v73, v105
    v_add_f32 v74, v74, v90
    v_add_f32 v106, v106, v122
    v_add_f32 v74, v74, v106
    v_add_f32 v75, v75, v91
    v_add_f32 v107, v107, v123
    v_add_f32 v75, v75, v107
    v_add_f32 v76, v76, v92
    v_add_f32 v108, v108, v124
    v_add_f32 v76, v76, v108
    v_add_f32 v77, v77, v93
    v_add_f32 v109, v109, v125
    v_add_f32 v77, v77, v109
    v_add_f32 v78, v78, v94
    v_add_f32 v110, v110, v126
    v_add_f32 v78, v78, v110
    v_add_f32 v79, v79, v95
    v_add_f32 v111, v111, v127
    v_add_f32 v79, v79, v111
    v_and_b32 v80, 0xffff0000, v165
    v_lshlrev_b32 v81, 16, v165
    v_mul_f32 v80, v80, v134
    v_mul_f32 v81, v81, v134
    v_cvt_pk_bf16_f32 v80, v80, v81
    v_cvt_pk_bf16_f32 v82, v64, v65
    v_lshlrev_b32 v81, 16, v80
    v_and_b32 v80, 0xffff0000, v80
    v_lshlrev_b32 v83, 16, v82
    v_and_b32 v82, 0xffff0000, v82
    v_add_f32 v81, v81, v83
    v_add_f32 v80, v80, v82
    v_cvt_pk_bf16_f32 v88, v81, v80
    v_and_b32 v80, 0xffff0000, v164
    v_lshlrev_b32 v81, 16, v164
    v_mul_f32 v80, v80, v134
    v_mul_f32 v81, v81, v134
    v_cvt_pk_bf16_f32 v80, v80, v81
    v_cvt_pk_bf16_f32 v82, v66, v67
    v_lshlrev_b32 v81, 16, v80
    v_and_b32 v80, 0xffff0000, v80
    v_lshlrev_b32 v83, 16, v82
    v_and_b32 v82, 0xffff0000, v82
    v_add_f32 v81, v81, v83
    v_add_f32 v80, v80, v82
    v_cvt_pk_bf16_f32 v89, v81, v80
    v_and_b32 v80, 0xffff0000, v167
    v_lshlrev_b32 v81, 16, v167
    v_mul_f32 v80, v80, v134
    v_mul_f32 v81, v81, v134
    v_cvt_pk_bf16_f32 v80, v80, v81
    v_cvt_pk_bf16_f32 v82, v68, v69
    v_lshlrev_b32 v81, 16, v80
    v_and_b32 v80, 0xffff0000, v80
    v_lshlrev_b32 v83, 16, v82
    v_and_b32 v82, 0xffff0000, v82
    v_add_f32 v81, v81, v83
    v_add_f32 v80, v80, v82
    v_cvt_pk_bf16_f32 v90, v81, v80
    v_and_b32 v80, 0xffff0000, v166
    v_lshlrev_b32 v81, 16, v166
    v_mul_f32 v80, v80, v134
    v_mul_f32 v81, v81, v134
    v_cvt_pk_bf16_f32 v80, v80, v81
    v_cvt_pk_bf16_f32 v82, v70, v71
    v_lshlrev_b32 v81, 16, v80
    v_and_b32 v80, 0xffff0000, v80
    v_lshlrev_b32 v83, 16, v82
    v_and_b32 v82, 0xffff0000, v82
    v_add_f32 v81, v81, v83
    v_add_f32 v80, v80, v82
    v_cvt_pk_bf16_f32 v91, v81, v80
    v_and_b32 v80, 0xffff0000, v169
    v_lshlrev_b32 v81, 16, v169
    v_mul_f32 v80, v80, v134
    v_mul_f32 v81, v81, v134
    v_cvt_pk_bf16_f32 v80, v80, v81
    v_cvt_pk_bf16_f32 v82, v72, v73
    v_lshlrev_b32 v81, 16, v80
    v_and_b32 v80, 0xffff0000, v80
    v_lshlrev_b32 v83, 16, v82
    v_and_b32 v82, 0xffff0000, v82
    v_add_f32 v81, v81, v83
    v_add_f32 v80, v80, v82
    v_cvt_pk_bf16_f32 v92, v81, v80
    v_and_b32 v80, 0xffff0000, v168
    v_lshlrev_b32 v81, 16, v168
    v_mul_f32 v80, v80, v134
    v_mul_f32 v81, v81, v134
    v_cvt_pk_bf16_f32 v80, v80, v81
    v_cvt_pk_bf16_f32 v82, v74, v75
    v_lshlrev_b32 v81, 16, v80
    v_and_b32 v80, 0xffff0000, v80
    v_lshlrev_b32 v83, 16, v82
    v_and_b32 v82, 0xffff0000, v82
    v_add_f32 v81, v81, v83
    v_add_f32 v80, v80, v82
    v_cvt_pk_bf16_f32 v93, v81, v80
    v_and_b32 v80, 0xffff0000, v171
    v_lshlrev_b32 v81, 16, v171
    v_mul_f32 v80, v80, v134
    v_mul_f32 v81, v81, v134
    v_cvt_pk_bf16_f32 v80, v80, v81
    v_cvt_pk_bf16_f32 v82, v76, v77
    v_lshlrev_b32 v81, 16, v80
    v_and_b32 v80, 0xffff0000, v80
    v_lshlrev_b32 v83, 16, v82
    v_and_b32 v82, 0xffff0000, v82
    v_add_f32 v81, v81, v83
    v_add_f32 v80, v80, v82
    v_cvt_pk_bf16_f32 v94, v81, v80
    v_and_b32 v80, 0xffff0000, v170
    v_lshlrev_b32 v81, 16, v170
    v_mul_f32 v80, v80, v134
    v_mul_f32 v81, v81, v134
    v_cvt_pk_bf16_f32 v80, v80, v81
    v_cvt_pk_bf16_f32 v82, v78, v79
    v_lshlrev_b32 v81, 16, v80
    v_and_b32 v80, 0xffff0000, v80
    v_lshlrev_b32 v83, 16, v82
    v_and_b32 v82, 0xffff0000, v82
    v_add_f32 v81, v81, v83
    v_add_f32 v80, v80, v82
    v_cvt_pk_bf16_f32 v95, v81, v80
    v_lshlrev_b32 v135, 6, v128
    v_lshl_add_u32 v135, v129, 3, v135
    s_lshl_b32 s82, s2, 13
    s_lshl_b32 s83, s32, 11
    s_add_u32 s82, s82, s83
    buffer_store_dwordx2 v[88:89], v135, s[28:31], s82 offen offset:0
    buffer_store_dwordx2 v[90:91], v135, s[28:31], s82 offen offset:16
    buffer_store_dwordx2 v[92:93], v135, s[28:31], s82 offen offset:32
    buffer_store_dwordx2 v[94:95], v135, s[28:31], s82 offen offset:48
    s_nop 1
L_noconv2:
    s_add_u32 s20, s4, 79691776
    s_addc_u32 s21, s5, 0
    s_mov_b32 s22, 17825792
    s_mov_b32 s23, 0x00020000
    s_add_u32 s24, s4, 50331648
    s_addc_u32 s25, s5, 0
    s_mov_b32 s26, 16777216
    s_mov_b32 s27, 0x00020000
    s_mov_b32 s28, s6
    s_mov_b32 s29, s7
    s_mov_b32 s30, 256
    s_mov_b32 s31, 0x00020000
    s_lshr_b32 s37, s42, 3
    s_lshl_b32 s37, s37, 2
    v_mov_b32 v43, s37
    s_and_b32 s37, s42, 7
    s_lshl_b32 s37, s37, 2
    s_add_u32 s37, s37, s32
    s_lshl_b32 s79, 1, s37
    v_mov_b32 v24, s46
    v_mov_b32 v25, 0
    v_mov_b32 v26, 0
    v_mov_b32 v27, 0
    v_mov_b32 v28, 0
    v_mov_b32 v128, 0
    v_mov_b32 v129, 0
    v_mov_b32 v130, 0
    v_mov_b32 v131, 0
    v_mov_b32 v132, 0
    v_mov_b32 v133, 0
    v_mov_b32 v134, 0
    v_mov_b32 v135, 0
    v_mov_b32 v136, 0
    v_mov_b32 v137, 0
    v_mov_b32 v138, 0
    v_mov_b32 v139, 0
    v_mov_b32 v140, 0
    v_mov_b32 v141, 0
    v_mov_b32 v142, 0
    v_mov_b32 v143, 0
    v_mov_b32 v144, 0
    v_mov_b32 v145, 0
    v_mov_b32 v146, 0
    v_mov_b32 v147, 0
    v_mov_b32 v148, 0
    v_mov_b32 v149, 0
    v_mov_b32 v150, 0
    v_mov_b32 v151, 0
    v_mov_b32 v152, 0
    v_mov_b32 v153, 0
    v_mov_b32 v154, 0
    v_mov_b32 v155, 0
    v_mov_b32 v156, 0
    v_mov_b32 v157, 0
    v_mov_b32 v158, 0
    v_mov_b32 v159, 0
    v_mov_b32 v160, 0
    v_mov_b32 v161, 0
    v_mov_b32 v162, 0
    v_mov_b32 v163, 0
    v_mov_b32 v164, 0
    v_mov_b32 v165, 0
    v_mov_b32 v166, 0
    v_mov_b32 v167, 0
    v_mov_b32 v168, 0
    v_mov_b32 v169, 0
    v_mov_b32 v170, 0
    v_mov_b32 v171, 0
    v_mov_b32 v172, 0
    v_mov_b32 v173, 0
    v_mov_b32 v174, 0
    v_mov_b32 v175, 0
    v_mov_b32 v176, 0
    v_mov_b32 v177, 0
    v_mov_b32 v178, 0
    v_mov_b32 v179, 0
    v_mov_b32 v180, 0
    v_mov_b32 v181, 0
    v_mov_b32 v182, 0
    v_mov_b32 v183, 0
    v_mov_b32 v184, 0
    v_mov_b32 v185, 0
    v_mov_b32 v186, 0
    v_mov_b32 v187, 0
    v_mov_b32 v188, 0
    v_mov_b32 v189, 0
    v_mov_b32 v190, 0
    v_mov_b32 v191, 0
    v_mov_b32 v192, 0
    v_mov_b32 v193, 0
    v_mov_b32 v194, 0
    v_mov_b32 v195, 0
    v_mov_b32 v196, 0
    v_mov_b32 v197, 0
    v_mov_b32 v198, 0
    v_mov_b32 v199, 0
    v_mov_b32 v200, 0
    v_mov_b32 v201, 0
    v_mov_b32 v202, 0
    v_mov_b32 v203, 0
    v_mov_b32 v204, 0
    v_mov_b32 v205, 0
    v_mov_b32 v206, 0
    v_mov_b32 v207, 0
    v_mov_b32 v208, 0
    v_mov_b32 v209, 0
    v_mov_b32 v210, 0
    v_mov_b32 v211, 0
    v_mov_b32 v212, 0
    v_mov_b32 v213, 0
    v_mov_b32 v214, 0
    v_mov_b32 v215, 0
    v_mov_b32 v216, 0
    v_mov_b32 v217, 0
    v_mov_b32 v218, 0
    v_mov_b32 v219, 0
    v_mov_b32 v220, 0
    v_mov_b32 v221, 0
    v_mov_b32 v222, 0
    v_mov_b32 v223, 0
    v_mov_b32 v224, 0
    v_mov_b32 v225, 0
    v_mov_b32 v226, 0
    v_mov_b32 v227, 0
    v_mov_b32 v228, 0
    v_mov_b32 v229, 0
    v_mov_b32 v230, 0
    v_mov_b32 v231, 0
    v_mov_b32 v232, 0
    v_mov_b32 v233, 0
    v_mov_b32 v234, 0
    v_mov_b32 v235, 0
    v_mov_b32 v236, 0
    v_mov_b32 v237, 0
    v_mov_b32 v238, 0
    v_mov_b32 v239, 0
    v_mov_b32 v240, 0
    v_mov_b32 v241, 0
    v_mov_b32 v242, 0
    v_mov_b32 v243, 0
    v_mov_b32 v244, 0
    v_mov_b32 v245, 0
    v_mov_b32 v246, 0
    v_mov_b32 v247, 0
    v_mov_b32 v248, 0
    v_mov_b32 v249, 0
    v_mov_b32 v250, 0
    v_mov_b32 v251, 0
    v_mov_b32 v252, 0
    v_mov_b32 v253, 0
    v_mov_b32 v254, 0
    v_mov_b32 v255, 0
    s_waitcnt vmcnt(16)
    s_barrier
    ds_read_b128 a[128:131], v12 offset:0
    ds_read_b128 a[132:135], v12 offset:1024
    ds_read_b128 a[136:139], v12 offset:2048
    ds_read_b128 a[140:143], v12 offset:3072
    s_waitcnt lgkmcnt(2)
    v_mfma_f32_32x32x16_bf16 v[64:79], a[128:131], a[0:3], 0
    ds_read_b128 a[144:147], v12 offset:4096
    s_add_u32 m0, s38, 0
    s_add_u32 s68, s35, 0
    buffer_load_dwordx4 v2, s[8:11], s68 offen offset:0 lds
    v_mfma_f32_32x32x16_bf16 v[64:79], a[132:135], a[4:7], v[64:79]
    ds_read_b128 a[148:151], v12 offset:5120
    buffer_load_dwordx4 v2, s[8:11], s68 offen offset:1024 lds
    s_waitcnt lgkmcnt(2)
    v_mfma_f32_32x32x16_bf16 v[64:79], a[136:139], a[8:11], v[64:79]
    ds_read_b128 a[152:155], v12 offset:6144
    buffer_load_dwordx4 v2, s[8:11], s68 offen offset:2048 lds
    v_mfma_f32_32x32x16_bf16 v[64:79], a[140:143], a[12:15], v[64:79]
    ds_read_b128 a[156:159], v12 offset:7168
    buffer_load_dwordx4 v2, s[8:11], s68 offen offset:3072 lds
    s_waitcnt lgkmcnt(2)
    v_mfma_f32_32x32x16_bf16 v[64:79], a[144:147], a[16:19], v[64:79]
    ds_read_b128 a[128:131], v12 offset:8192
    s_add_u32 m0, s38, 4096
    s_add_u32 s68, s35, 4096
    buffer_load_dwordx4 v2, s[8:11], s68 offen offset:0 lds
    v_mfma_f32_32x32x16_bf16 v[64:79], a[148:151], a[20:23], v[64:79]
    ds_read_b128 a[132:135], v12 offset:9216
    buffer_load_dwordx4 v2, s[8:11], s68 offen offset:1024 lds
    s_waitcnt lgkmcnt(2)
    v_mfma_f32_32x32x16_bf16 v[64:79], a[152:155], a[24:27], v[64:79]
    ds_read_b128 a[136:139], v12 offset:10240
    buffer_load_dwordx4 v2, s[8:11], s68 offen offset:2048 lds
    v_mfma_f32_32x32x16_bf16 v[64:79], a[156:159], a[28:31], v[64:79]
    ds_read_b128 a[140:143], v12 offset:11264
    buffer_load_dwordx4 v2, s[8:11], s68 offen offset:3072 lds
    s_waitcnt lgkmcnt(2)
    v_mfma_f32_32x32x16_bf16 v[64:79], a[128:131], a[32:35], v[64:79]
    ds_read_b128 a[144:147], v12 offset:12288
    s_add_u32 s35, s35, 32768
    s_sub_u32 s49, s49, 1
    s_cmp_eq_u32 s49, 0
    s_cselect_b32 s35, s47, s35
    s_sub_u32 s51, s51, 1
    s_cmp_eq_u32 s51, 0
    s_cselect_b32 s35, 0x80000000, s35
    s_cselect_b32 s47, 0x80000000, s47
    v_mfma_f32_32x32x16_bf16 v[64:79], a[132:135], a[36:39], v[64:79]
    ds_read_b128 a[148:151], v12 offset:13312
    s_add_u32 s38, s38, 32768
    s_cmp_ge_u32 s38, 98304
    s_cselect_b32 s68, 98304, 0
    s_sub_u32 s38, s38, s68
    s_waitcnt lgkmcnt(2)
    v_mfma_f32_32x32x16_bf16 v[64:79], a[136:139], a[40:43], v[64:79]
    ds_read_b128 a[152:155], v12 offset:14336
    s_lshl_b32 s75, s53, 16
    s_add_u32 s75, s75, s76
    v_mfma_f32_32x32x16_bf16 v[64:79], a[140:143], a[44:47], v[64:79]
    ds_read_b128 a[156:159], v12 offset:15360
    buffer_load_dwordx4 a[64:67], v2, s[16:19], s75 offen offset:0
    s_waitcnt lgkmcnt(2)
    v_mfma_f32_32x32x16_bf16 v[64:79], a[144:147], a[48:51], v[64:79]
    ds_read_b128 a[128:131], v12 offset:16384
    buffer_load_dwordx4 a[68:71], v2, s[16:19], s75 offen offset:1024
    v_mfma_f32_32x32x16_bf16 v[64:79], a[148:151], a[52:55], v[64:79]
    ds_read_b128 a[132:135], v12 offset:17408
    buffer_load_dwordx4 a[72:75], v2, s[16:19], s75 offen offset:2048
    s_waitcnt lgkmcnt(2)
    v_mfma_f32_32x32x16_bf16 v[64:79], a[152:155], a[56:59], v[64:79]
    ds_read_b128 a[136:139], v12 offset:18432
    buffer_load_dwordx4 a[76:79], v2, s[16:19], s75 offen offset:3072
    v_mfma_f32_32x32x16_bf16 v[64:79], a[156:159], a[60:63], v[64:79]
    ds_read_b128 a[140:143], v12 offset:19456
    s_add_u32 s75, s75, 4096
    buffer_load_dwordx4 a[80:83], v2, s[16:19], s75 offen offset:0
    s_waitcnt lgkmcnt(2)
    v_mfma_f32_32x32x16_bf16 v[80:95], a[128:131], a[0:3], 0
    ds_read_b128 a[144:147], v12 offset:20480
    buffer_load_dwordx4 a[84:87], v2, s[16:19], s75 offen offset:1024
    v_mfma_f32_32x32x16_bf16 v[80:95], a[132:135], a[4:7], v[80:95]
    ds_read_b128 a[148:151], v12 offset:21504
    buffer_load_dwordx4 a[88:91], v2, s[16:19], s75 offen offset:2048
    s_waitcnt lgkmcnt(2)
    v_mfma_f32_32x32x16_bf16 v[80:95], a[136:139], a[8:11], v[80:95]
    ds_read_b128 a[152:155], v12 offset:22528
    buffer_load_dwordx4 a[92:95], v2, s[16:19], s75 offen offset:3072
    v_mfma_f32_32x32x16_bf16 v[80:95], a[140:143], a[12:15], v[80:95]
    ds_read_b128 a[156:159], v12 offset:23552
    s_add_u32 s75, s75, 4096
    buffer_load_dwordx4 a[96:99], v2, s[16:19], s75 offen offset:0
    s_waitcnt lgkmcnt(2)
    v_mfma_f32_32x32x16_bf16 v[80:95], a[144:147], a[16:19], v[80:95]
    ds_read_b128 a[128:131], v12 offset:24576
    buffer_load_dwordx4 a[100:103], v2, s[16:19], s75 offen offset:1024
    v_mfma_f32_32x32x16_bf16 v[80:95], a[148:151], a[20:23], v[80:95]
    ds_read_b128 a[132:135], v12 offset:25600
    buffer_load_dwordx4 a[104:107], v2, s[16:19], s75 offen offset:2048
    s_waitcnt lgkmcnt(2)
    v_mfma_f32_32x32x16_bf16 v[80:95], a[152:155], a[24:27], v[80:95]
    ds_read_b128 a[136:139], v12 offset:26624
    buffer_load_dwordx4 a[108:111], v2, s[16:19], s75 offen offset:3072
    v_mfma_f32_32x32x16_bf16 v[80:95], a[156:159], a[28:31], v[80:95]
    ds_read_b128 a[140:143], v12 offset:27648
    s_add_u32 s75, s75, 4096
    buffer_load_dwordx4 a[112:115], v2, s[16:19], s75 offen offset:0
    s_waitcnt lgkmcnt(2)
    v_mfma_f32_32x32x16_bf16 v[80:95], a[128:131], a[32:35], v[80:95]
    ds_read_b128 a[144:147], v12 offset:28672
    buffer_load_dwordx4 a[116:119], v2, s[16:19], s75 offen offset:1024
    v_mfma_f32_32x32x16_bf16 v[80:95], a[132:135], a[36:39], v[80:95]
    ds_read_b128 a[148:151], v12 offset:29696
    buffer_load_dwordx4 a[120:123], v2, s[16:19], s75 offen offset:2048
    s_waitcnt lgkmcnt(2)
    v_mfma_f32_32x32x16_bf16 v[80:95], a[136:139], a[40:43], v[80:95]
    ds_read_b128 a[152:155], v12 offset:30720
    buffer_load_dwordx4 a[124:127], v2, s[16:19], s75 offen offset:3072
    v_mfma_f32_32x32x16_bf16 v[80:95], a[140:143], a[44:47], v[80:95]
    ds_read_b128 a[156:159], v12 offset:31744
    s_waitcnt lgkmcnt(2)
    v_mfma_f32_32x32x16_bf16 v[80:95], a[144:147], a[48:51], v[80:95]
    v_mfma_f32_32x32x16_bf16 v[80:95], a[148:151], a[52:55], v[80:95]
    s_waitcnt lgkmcnt(0)
    v_mfma_f32_32x32x16_bf16 v[80:95], a[152:155], a[56:59], v[80:95]
    s_add_u32 s54, s54, 1
    s_mov_b32 s55, 32768
    s_cmp_eq_u32 s54, 3
    s_cselect_b32 s55, 0xffff0000, s55
    s_cselect_b32 s54, 0, s54
    v_mfma_f32_32x32x16_bf16 v[80:95], a[156:159], a[60:63], v[80:95]
    v_add_u32 v12, s55, v12
    s_waitcnt vmcnt(0)
    s_barrier
    ds_read_b128 a[128:131], v12 offset:0
    ds_read_b128 a[132:135], v12 offset:1024
    ds_read_b128 a[136:139], v12 offset:2048
    ds_read_b128 a[140:143], v12 offset:3072
    s_cmp_eq_u32 s40, 0
    s_cbranch_scc1 L_x0_entry
    s_branch L_y0_entry
L_x0:
    s_waitcnt vmcnt(8)
    s_barrier
L_x0_entry:
    s_add_u32 s34, s34, 1
    s_cmp_ge_u32 s34, s33
    s_cbranch_scc1 L_xl0
    s_waitcnt lgkmcnt(2)
    v_mfma_f32_32x32x16_bf16 v[96:111], a[128:131], a[0:3], 0
    ds_read_b128 a[144:147], v12 offset:4096
    v_max3_f32 v30, v64, v65, v66
    v_max3_f32 v31, v67, v68, v69
    v_max3_f32 v30, v30, v70, v71
    v_mfma_f32_32x32x16_bf16 v[96:111], a[132:135], a[4:7], v[96:111]
    ds_read_b128 a[148:151], v12 offset:5120
    v_max3_f32 v31, v31, v72, v73
    v_max3_f32 v30, v30, v74, v75
    v_max3_f32 v31, v31, v76, v77
    s_waitcnt lgkmcnt(2)
    v_mfma_f32_32x32x16_bf16 v[96:111], a[136:139], a[8:11], v[96:111]
    ds_read_b128 a[152:155], v12 offset:6144
    v_max3_f32 v30, v30, v78, v79
    v_max3_f32 v31, v31, v80, v81
    v_max3_f32 v30, v30, v82, v83
    s_add_u32 m0, s56, 131072
    s_add_u32 s68, s36, 0
    buffer_load_dwordx4 v2, s[12:15], s68 offen offset:0 lds
    v_mfma_f32_32x32x16_bf16 v[96:111], a[140:143], a[12:15], v[96:111]
    ds_read_b128 a[156:159], v12 offset:7168
    v_max3_f32 v31, v31, v84, v85
    v_max3_f32 v30, v30, v86, v87
    v_max3_f32 v31, v31, v88, v89
    s_waitcnt lgkmcnt(2)
    v_mfma_f32_32x32x16_bf16 v[96:111], a[144:147], a[16:19], v[96:111]
    ds_read_b128 a[128:131], v12 offset:8192
    v_max3_f32 v30, v30, v90, v91
    v_max3_f32 v31, v31, v92, v93
    v_max3_f32 v30, v30, v94, v95
    v_mfma_f32_32x32x16_bf16 v[96:111], a[148:151], a[20:23], v[96:111]
    ds_read_b128 a[132:135], v12 offset:9216
    v_max_f32 v30, v30, v31
    v_mov_b32 v31, v30
    s_nop 1
    v_permlane32_swap_b32 v30, v31
    v_max_f32 v30, v30, v31
    v_fma_f32 v31, v30, s43, -v24
    v_cmp_lt_f32 vcc, s44, v31
    s_cbranch_vccnz L_resc_a_67
    L_resc_ret_a_67:
    buffer_load_dwordx4 v2, s[12:15], s68 offen offset:1024 lds
    s_waitcnt lgkmcnt(2)
    v_mfma_f32_32x32x16_bf16 v[96:111], a[152:155], a[24:27], v[96:111]
    ds_read_b128 a[136:139], v12 offset:10240
    v_fma_f32 v64, v64, s43, -v24
    v_fma_f32 v65, v65, s43, -v24
    v_exp_f32 v64, v64
    v_mfma_f32_32x32x16_bf16 v[96:111], a[156:159], a[28:31], v[96:111]
    ds_read_b128 a[140:143], v12 offset:11264
    v_fma_f32 v66, v66, s43, -v24
    v_exp_f32 v65, v65
    s_waitcnt lgkmcnt(2)
    v_mfma_f32_32x32x16_bf16 v[96:111], a[128:131], a[32:35], v[96:111]
    ds_read_b128 a[144:147], v12 offset:12288
    v_fma_f32 v67, v67, s43, -v24
    v_exp_f32 v66, v66
    buffer_load_dwordx4 v2, s[12:15], s68 offen offset:2048 lds
    v_mfma_f32_32x32x16_bf16 v[96:111], a[132:135], a[36:39], v[96:111]
    ds_read_b128 a[148:151], v12 offset:13312
    v_add_f32 v25, v25, v64
    v_fma_f32 v68, v68, s43, -v24
    v_exp_f32 v67, v67
    s_waitcnt lgkmcnt(2)
    v_mfma_f32_32x32x16_bf16 v[96:111], a[136:139], a[40:43], v[96:111]
    ds_read_b128 a[152:155], v12 offset:14336
    v_add_f32 v26, v26, v65
    v_cvt_pk_bf16_f32 v48, v64, v65
    v_mfma_f32_32x32x16_bf16 v[96:111], a[140:143], a[44:47], v[96:111]
    ds_read_b128 a[156:159], v12 offset:15360
    v_fma_f32 v69, v69, s43, -v24
    v_exp_f32 v68, v68
    buffer_load_dwordx4 v2, s[12:15], s68 offen offset:3072 lds
    s_waitcnt lgkmcnt(2)
    v_mfma_f32_32x32x16_bf16 v[96:111], a[144:147], a[48:51], v[96:111]
    ds_read_b128 a[128:131], v12 offset:16384
    v_add_f32 v27, v27, v66
    v_fma_f32 v70, v70, s43, -v24
    v_exp_f32 v69, v69
    v_mfma_f32_32x32x16_bf16 v[96:111], a[148:151], a[52:55], v[96:111]
    ds_read_b128 a[132:135], v12 offset:17408
    v_add_f32 v28, v28, v67
    v_cvt_pk_bf16_f32 v49, v66, v67
    s_waitcnt lgkmcnt(2)
    v_mfma_f32_32x32x16_bf16 v[96:111], a[152:155], a[56:59], v[96:111]
    ds_read_b128 a[136:139], v12 offset:18432
    v_fma_f32 v71, v71, s43, -v24
    v_exp_f32 v70, v70
    s_add_u32 m0, s56, 135168
    s_add_u32 s68, s36, 4096
    buffer_load_dwordx4 v2, s[12:15], s68 offen offset:0 lds
    v_mfma_f32_32x32x16_bf16 v[96:111], a[156:159], a[60:63], v[96:111]
    ds_read_b128 a[140:143], v12 offset:19456
    v_add_f32 v25, v25, v68
    v_fma_f32 v72, v72, s43, -v24
    v_exp_f32 v71, v71
    s_waitcnt lgkmcnt(2)
    v_mfma_f32_32x32x16_bf16 v[112:127], a[128:131], a[0:3], 0
    ds_read_b128 a[144:147], v12 offset:20480
    v_add_f32 v26, v26, v69
    v_cvt_pk_bf16_f32 v50, v68, v69
    v_mfma_f32_32x32x16_bf16 v[112:127], a[132:135], a[4:7], v[112:127]
    ds_read_b128 a[148:151], v12 offset:21504
    v_fma_f32 v73, v73, s43, -v24
    v_exp_f32 v72, v72
    buffer_load_dwordx4 v2, s[12:15], s68 offen offset:1024 lds
    s_waitcnt lgkmcnt(2)
    v_mfma_f32_32x32x16_bf16 v[112:127], a[136:139], a[8:11], v[112:127]
    ds_read_b128 a[152:155], v12 offset:22528
    v_add_f32 v27, v27, v70
    v_fma_f32 v74, v74, s43, -v24
    v_exp_f32 v73, v73
    v_mfma_f32_32x32x16_bf16 v[112:127], a[140:143], a[12:15], v[112:127]
    ds_read_b128 a[156:159], v12 offset:23552
    v_add_f32 v28, v28, v71
    v_cvt_pk_bf16_f32 v51, v70, v71
    s_waitcnt lgkmcnt(2)
    v_mfma_f32_32x32x16_bf16 v[112:127], a[144:147], a[16:19], v[112:127]
    ds_read_b128 a[128:131], v12 offset:24576
    v_fma_f32 v75, v75, s43, -v24
    v_exp_f32 v74, v74
    buffer_load_dwordx4 v2, s[12:15], s68 offen offset:2048 lds
    v_mfma_f32_32x32x16_bf16 v[112:127], a[148:151], a[20:23], v[112:127]
    ds_read_b128 a[132:135], v12 offset:25600
    v_add_f32 v25, v25, v72
    v_fma_f32 v76, v76, s43, -v24
    v_exp_f32 v75, v75
    s_waitcnt lgkmcnt(2)
    v_mfma_f32_32x32x16_bf16 v[112:127], a[152:155], a[24:27], v[112:127]
    ds_read_b128 a[136:139], v12 offset:26624
    v_add_f32 v26, v26, v73
    v_cvt_pk_bf16_f32 v52, v72, v73
    v_mfma_f32_32x32x16_bf16 v[112:127], a[156:159], a[28:31], v[112:127]
    ds_read_b128 a[140:143], v12 offset:27648
    v_fma_f32 v77, v77, s43, -v24
    v_exp_f32 v76, v76
    buffer_load_dwordx4 v2, s[12:15], s68 offen offset:3072 lds
    s_waitcnt lgkmcnt(2)
    v_mfma_f32_32x32x16_bf16 v[112:127], a[128:131], a[32:35], v[112:127]
    ds_read_b128 a[144:147], v12 offset:28672
    v_add_f32 v27, v27, v74
    v_fma_f32 v78, v78, s43, -v24
    v_exp_f32 v77, v77
    v_mfma_f32_32x32x16_bf16 v[112:127], a[132:135], a[36:39], v[112:127]
    ds_read_b128 a[148:151], v12 offset:29696
    v_add_f32 v28, v28, v75
    v_cvt_pk_bf16_f32 v53, v74, v75
    s_waitcnt lgkmcnt(2)
    v_mfma_f32_32x32x16_bf16 v[112:127], a[136:139], a[40:43], v[112:127]
    ds_read_b128 a[152:155], v12 offset:30720
    v_fma_f32 v79, v79, s43, -v24
    v_exp_f32 v78, v78
    s_add_u32 s36, s36, 32768
    s_sub_u32 s50, s50, 1
    s_cmp_eq_u32 s50, 0
    s_cselect_b32 s36, s48, s36
    s_sub_u32 s52, s52, 1
    s_cmp_eq_u32 s52, 0
    s_cselect_b32 s36, 0x80000000, s36
    s_cselect_b32 s48, 0x80000000, s48
    v_mfma_f32_32x32x16_bf16 v[112:127], a[140:143], a[44:47], v[112:127]
    ds_read_b128 a[156:159], v12 offset:31744
    v_add_f32 v25, v25, v76
    v_fma_f32 v80, v80, s43, -v24
    v_exp_f32 v79, v79
    s_waitcnt lgkmcnt(2)
    v_mfma_f32_32x32x16_bf16 v[112:127], a[144:147], a[48:51], v[112:127]
    ds_read_b128 a[128:131], v20 offset:0
    v_add_f32 v26, v26, v77
    v_cvt_pk_bf16_f32 v54, v76, v77
    v_mfma_f32_32x32x16_bf16 v[112:127], a[148:151], a[52:55], v[112:127]
    ds_read_b128 a[132:135], v20 offset:4096
    v_fma_f32 v81, v81, s43, -v24
    v_exp_f32 v80, v80
    s_waitcnt lgkmcnt(2)
    v_mfma_f32_32x32x16_bf16 v[112:127], a[152:155], a[56:59], v[112:127]
    ds_read_b128 a[136:139], v20 offset:8192
    v_add_f32 v27, v27, v78
    v_fma_f32 v82, v82, s43, -v24
    v_exp_f32 v81, v81
    v_mfma_f32_32x32x16_bf16 v[112:127], a[156:159], a[60:63], v[112:127]
    ds_read_b128 a[140:143], v20 offset:12288
    v_add_f32 v28, v28, v79
    v_cvt_pk_bf16_f32 v55, v78, v79
    s_waitcnt lgkmcnt(2)
    v_mfma_f32_32x32x16_bf16 v[128:143], a[128:131], v[48:51], v[128:143]
    ds_read_b128 a[144:147], v20 offset:16384
    v_fma_f32 v83, v83, s43, -v24
    v_exp_f32 v82, v82
    v_mfma_f32_32x32x16_bf16 v[144:159], a[132:135], v[48:51], v[144:159]
    ds_read_b128 a[148:151], v20 offset:20480
    v_add_f32 v25, v25, v80
    v_fma_f32 v84, v84, s43, -v24
    v_exp_f32 v83, v83
    s_waitcnt lgkmcnt(2)
    v_mfma_f32_32x32x16_bf16 v[160:175], a[136:139], v[48:51], v[160:175]
    ds_read_b128 a[152:155], v20 offset:24576
    v_add_f32 v26, v26, v81
    v_cvt_pk_bf16_f32 v56, v80, v81
    v_mfma_f32_32x32x16_bf16 v[176:191], a[140:143], v[48:51], v[176:191]
    ds_read_b128 a[156:159], v20 offset:28672
    v_fma_f32 v85, v85, s43, -v24
    v_exp_f32 v84, v84
    s_waitcnt lgkmcnt(2)
    v_mfma_f32_32x32x16_bf16 v[192:207], a[144:147], v[48:51], v[192:207]
    ds_read_b128 a[128:131], v20 offset:1024
    v_add_f32 v27, v27, v82
    v_fma_f32 v86, v86, s43, -v24
    v_exp_f32 v85, v85
    s_add_u32 m0, s38, 0
    s_add_u32 s68, s35, 0
    buffer_load_dwordx4 v2, s[8:11], s68 offen offset:0 lds
    v_mfma_f32_32x32x16_bf16 v[208:223], a[148:151], v[48:51], v[208:223]
    ds_read_b128 a[132:135], v20 offset:5120
    v_add_f32 v28, v28, v83
    v_cvt_pk_bf16_f32 v57, v82, v83
    s_waitcnt lgkmcnt(2)
    v_mfma_f32_32x32x16_bf16 v[224:239], a[152:155], v[48:51], v[224:239]
    ds_read_b128 a[136:139], v20 offset:9216
    v_fma_f32 v87, v87, s43, -v24
    v_exp_f32 v86, v86
    buffer_load_dwordx4 v2, s[8:11], s68 offen offset:1024 lds
    v_mfma_f32_32x32x16_bf16 v[240:255], a[156:159], v[48:51], v[240:255]
    ds_read_b128 a[140:143], v20 offset:13312
    v_add_f32 v25, v25, v84
    v_fma_f32 v88, v88, s43, -v24
    v_exp_f32 v87, v87
    s_waitcnt lgkmcnt(2)
    v_mfma_f32_32x32x16_bf16 v[128:143], a[128:131], v[52:55], v[128:143]
    ds_read_b128 a[144:147], v20 offset:17408
    v_add_f32 v26, v26, v85
    v_cvt_pk_bf16_f32 v58, v84, v85
    v_mfma_f32_32x32x16_bf16 v[144:159], a[132:135], v[52:55], v[144:159]
    ds_read_b128 a[148:151], v20 offset:21504
    v_fma_f32 v89, v89, s43, -v24
    v_exp_f32 v88, v88
    buffer_load_dwordx4 v2, s[8:11], s68 offen offset:2048 lds
    s_waitcnt lgkmcnt(2)
    v_mfma_f32_32x32x16_bf16 v[160:175], a[136:139], v[52:55], v[160:175]
    ds_read_b128 a[152:155], v20 offset:25600
    v_add_f32 v27, v27, v86
    v_fma_f32 v90, v90, s43, -v24
    v_exp_f32 v89, v89
    v_mfma_f32_32x32x16_bf16 v[176:191], a[140:143], v[52:55], v[176:191]
    ds_read_b128 a[156:159], v20 offset:29696
    v_add_f32 v28, v28, v87
    v_cvt_pk_bf16_f32 v59, v86, v87
    buffer_load_dwordx4 v2, s[8:11], s68 offen offset:3072 lds
    s_waitcnt lgkmcnt(2)
    v_mfma_f32_32x32x16_bf16 v[192:207], a[144:147], v[52:55], v[192:207]
    ds_read_b128 a[128:131], v20 offset:2048
    v_fma_f32 v91, v91, s43, -v24
    v_exp_f32 v90, v90
    v_mfma_f32_32x32x16_bf16 v[208:223], a[148:151], v[52:55], v[208:223]
    ds_read_b128 a[132:135], v20 offset:6144
    v_add_f32 v25, v25, v88
    v_fma_f32 v92, v92, s43, -v24
    v_exp_f32 v91, v91
    s_waitcnt lgkmcnt(2)
    v_mfma_f32_32x32x16_bf16 v[224:239], a[152:155], v[52:55], v[224:239]
    ds_read_b128 a[136:139], v20 offset:10240
    v_add_f32 v26, v26, v89
    v_cvt_pk_bf16_f32 v60, v88, v89
    s_add_u32 m0, s38, 4096
    s_add_u32 s68, s35, 4096
    buffer_load_dwordx4 v2, s[8:11], s68 offen offset:0 lds
    v_mfma_f32_32x32x16_bf16 v[240:255], a[156:159], v[52:55], v[240:255]
    ds_read_b128 a[140:143], v20 offset:14336
    v_fma_f32 v93, v93, s43, -v24
    v_exp_f32 v92, v92
    s_waitcnt lgkmcnt(2)
    v_mfma_f32_32x32x16_bf16 v[128:143], a[128:131], v[56:59], v[128:143]
    ds_read_b128 a[144:147], v20 offset:18432
    v_add_f32 v27, v27, v90
    v_fma_f32 v94, v94, s43, -v24
    v_exp_f32 v93, v93
    v_mfma_f32_32x32x16_bf16 v[144:159], a[132:135], v[56:59], v[144:159]
    ds_read_b128 a[148:151], v20 offset:22528
    v_add_f32 v28, v28, v91
    v_cvt_pk_bf16_f32 v61, v90, v91
    buffer_load_dwordx4 v2, s[8:11], s68 offen offset:1024 lds
    s_waitcnt lgkmcnt(2)
    v_mfma_f32_32x32x16_bf16 v[160:175], a[136:139], v[56:59], v[160:175]
    ds_read_b128 a[152:155], v20 offset:26624
    v_fma_f32 v95, v95, s43, -v24
    v_exp_f32 v94, v94
    s_add_u32 s54, s54, 1
    s_mov_b32 s55, 32768
    s_cmp_eq_u32 s54, 3
    s_cselect_b32 s55, 0xffff0000, s55
    s_cselect_b32 s54, 0, s54
    v_mfma_f32_32x32x16_bf16 v[176:191], a[140:143], v[56:59], v[176:191]
    ds_read_b128 a[156:159], v20 offset:30720
    v_add_f32 v25, v25, v92
    v_exp_f32 v95, v95
    v_add_f32 v26, v26, v93
    buffer_load_dwordx4 v2, s[8:11], s68 offen offset:2048 lds
    s_waitcnt lgkmcnt(2)
    v_mfma_f32_32x32x16_bf16 v[192:207], a[144:147], v[56:59], v[192:207]
    ds_read_b128 a[128:131], v20 offset:3072
    v_add_f32 v27, v27, v94
    v_add_f32 v28, v28, v95
    v_mfma_f32_32x32x16_bf16 v[208:223], a[148:151], v[56:59], v[208:223]
    ds_read_b128 a[132:135], v20 offset:7168
    v_cvt_pk_bf16_f32 v62, v92, v93
    v_cvt_pk_bf16_f32 v63, v94, v95
    v_add_u32 v12, s55, v12
    s_waitcnt lgkmcnt(2)
    v_mfma_f32_32x32x16_bf16 v[224:239], a[152:155], v[56:59], v[224:239]
    ds_read_b128 a[136:139], v20 offset:11264
    buffer_load_dwordx4 v2, s[8:11], s68 offen offset:3072 lds
    v_mfma_f32_32x32x16_bf16 v[240:255], a[156:159], v[56:59], v[240:255]
    ds_read_b128 a[140:143], v20 offset:15360
    s_waitcnt lgkmcnt(2)
    v_mfma_f32_32x32x16_bf16 v[128:143], a[128:131], v[60:63], v[128:143]
    ds_read_b128 a[144:147], v20 offset:19456
    s_add_u32 s35, s35, 32768
    s_sub_u32 s49, s49, 1
    s_cmp_eq_u32 s49, 0
    s_cselect_b32 s35, s47, s35
    s_sub_u32 s51, s51, 1
    s_cmp_eq_u32 s51, 0
    s_cselect_b32 s35, 0x80000000, s35
    s_cselect_b32 s47, 0x80000000, s47
    v_mfma_f32_32x32x16_bf16 v[144:159], a[132:135], v[60:63], v[144:159]
    ds_read_b128 a[148:151], v20 offset:23552
    s_waitcnt lgkmcnt(2)
    v_mfma_f32_32x32x16_bf16 v[160:175], a[136:139], v[60:63], v[160:175]
    ds_read_b128 a[152:155], v20 offset:27648
    v_mfma_f32_32x32x16_bf16 v[176:191], a[140:143], v[60:63], v[176:191]
    ds_read_b128 a[156:159], v20 offset:31744
    s_add_u32 s38, s38, 32768
    s_cmp_ge_u32 s38, 98304
    s_cselect_b32 s68, 98304, 0
    s_sub_u32 s38, s38, s68
    s_waitcnt lgkmcnt(2)
    v_mfma_f32_32x32x16_bf16 v[192:207], a[144:147], v[60:63], v[192:207]
    ds_read_b128 a[128:131], v12 offset:0
    v_mfma_f32_32x32x16_bf16 v[208:223], a[148:151], v[60:63], v[208:223]
    ds_read_b128 a[132:135], v12 offset:1024
    s_waitcnt lgkmcnt(2)
    v_mfma_f32_32x32x16_bf16 v[224:239], a[152:155], v[60:63], v[224:239]
    ds_read_b128 a[136:139], v12 offset:2048
    v_mfma_f32_32x32x16_bf16 v[240:255], a[156:159], v[60:63], v[240:255]
    ds_read_b128 a[140:143], v12 offset:3072
L_x1:
    s_waitcnt vmcnt(8)
    s_barrier
    s_add_u32 s34, s34, 1
    s_cmp_ge_u32 s34, s33
    s_cbranch_scc1 L_xl1
    s_waitcnt lgkmcnt(2)
    v_mfma_f32_32x32x16_bf16 v[64:79], a[128:131], a[0:3], 0
    ds_read_b128 a[144:147], v12 offset:4096
    v_max3_f32 v30, v96, v97, v98
    v_max3_f32 v31, v99, v100, v101
    v_max3_f32 v30, v30, v102, v103
    v_mfma_f32_32x32x16_bf16 v[64:79], a[132:135], a[4:7], v[64:79]
    ds_read_b128 a[148:151], v12 offset:5120
    v_max3_f32 v31, v31, v104, v105
    v_max3_f32 v30, v30, v106, v107
    v_max3_f32 v31, v31, v108, v109
    s_waitcnt lgkmcnt(2)
    v_mfma_f32_32x32x16_bf16 v[64:79], a[136:139], a[8:11], v[64:79]
    ds_read_b128 a[152:155], v12 offset:6144
    v_max3_f32 v30, v30, v110, v111
    v_max3_f32 v31, v31, v112, v113
    v_max3_f32 v30, v30, v114, v115
    s_add_u32 m0, s56, 98304
    s_add_u32 s68, s36, 0
    buffer_load_dwordx4 v2, s[12:15], s68 offen offset:0 lds
    v_mfma_f32_32x32x16_bf16 v[64:79], a[140:143], a[12:15], v[64:79]
    ds_read_b128 a[156:159], v12 offset:7168
    v_max3_f32 v31, v31, v116, v117
    v_max3_f32 v30, v30, v118, v119
    v_max3_f32 v31, v31, v120, v121
    s_waitcnt lgkmcnt(2)
    v_mfma_f32_32x32x16_bf16 v[64:79], a[144:147], a[16:19], v[64:79]
    ds_read_b128 a[128:131], v12 offset:8192
    v_max3_f32 v30, v30, v122, v123
    v_max3_f32 v31, v31, v124, v125
    v_max3_f32 v30, v30, v126, v127
    v_mfma_f32_32x32x16_bf16 v[64:79], a[148:151], a[20:23], v[64:79]
    ds_read_b128 a[132:135], v12 offset:9216
    v_max_f32 v30, v30, v31
    v_mov_b32 v31, v30
    s_nop 1
    v_permlane32_swap_b32 v30, v31
    v_max_f32 v30, v30, v31
    v_fma_f32 v31, v30, s43, -v24
    v_cmp_lt_f32 vcc, s44, v31
    s_cbranch_vccnz L_resc_a_68
    L_resc_ret_a_68:
    buffer_load_dwordx4 v2, s[12:15], s68 offen offset:1024 lds
    s_waitcnt lgkmcnt(2)
    v_mfma_f32_32x32x16_bf16 v[64:79], a[152:155], a[24:27], v[64:79]
    ds_read_b128 a[136:139], v12 offset:10240
    v_fma_f32 v96, v96, s43, -v24
    v_fma_f32 v97, v97, s43, -v24
    v_exp_f32 v96, v96
    v_mfma_f32_32x32x16_bf16 v[64:79], a[156:159], a[28:31], v[64:79]
    ds_read_b128 a[140:143], v12 offset:11264
    v_fma_f32 v98, v98, s43, -v24
    v_exp_f32 v97, v97
    s_waitcnt lgkmcnt(2)
    v_mfma_f32_32x32x16_bf16 v[64:79], a[128:131], a[32:35], v[64:79]
    ds_read_b128 a[144:147], v12 offset:12288
    v_fma_f32 v99, v99, s43, -v24
    v_exp_f32 v98, v98
    buffer_load_dwordx4 v2, s[12:15], s68 offen offset:2048 lds
    v_mfma_f32_32x32x16_bf16 v[64:79], a[132:135], a[36:39], v[64:79]
    ds_read_b128 a[148:151], v12 offset:13312
    v_add_f32 v25, v25, v96
    v_fma_f32 v100, v100, s43, -v24
    v_exp_f32 v99, v99
    s_waitcnt lgkmcnt(2)
    v_mfma_f32_32x32x16_bf16 v[64:79], a[136:139], a[40:43], v[64:79]
    ds_read_b128 a[152:155], v12 offset:14336
    v_add_f32 v26, v26, v97
    v_cvt_pk_bf16_f32 v48, v96, v97
    v_mfma_f32_32x32x16_bf16 v[64:79], a[140:143], a[44:47], v[64:79]
    ds_read_b128 a[156:159], v12 offset:15360
    v_fma_f32 v101, v101, s43, -v24
    v_exp_f32 v100, v100
    buffer_load_dwordx4 v2, s[12:15], s68 offen offset:3072 lds
    s_waitcnt lgkmcnt(2)
    v_mfma_f32_32x32x16_bf16 v[64:79], a[144:147], a[48:51], v[64:79]
    ds_read_b128 a[128:131], v12 offset:16384
    v_add_f32 v27, v27, v98
    v_fma_f32 v102, v102, s43, -v24
    v_exp_f32 v101, v101
    v_mfma_f32_32x32x16_bf16 v[64:79], a[148:151], a[52:55], v[64:79]
    ds_read_b128 a[132:135], v12 offset:17408
    v_add_f32 v28, v28, v99
    v_cvt_pk_bf16_f32 v49, v98, v99
    s_waitcnt lgkmcnt(2)
    v_mfma_f32_32x32x16_bf16 v[64:79], a[152:155], a[56:59], v[64:79]
    ds_read_b128 a[136:139], v12 offset:18432
    v_fma_f32 v103, v103, s43, -v24
    v_exp_f32 v102, v102
    s_add_u32 m0, s56, 102400
    s_add_u32 s68, s36, 4096
    buffer_load_dwordx4 v2, s[12:15], s68 offen offset:0 lds
    v_mfma_f32_32x32x16_bf16 v[64:79], a[156:159], a[60:63], v[64:79]
    ds_read_b128 a[140:143], v12 offset:19456
    v_add_f32 v25, v25, v100
    v_fma_f32 v104, v104, s43, -v24
    v_exp_f32 v103, v103
    s_waitcnt lgkmcnt(2)
    v_mfma_f32_32x32x16_bf16 v[80:95], a[128:131], a[0:3], 0
    ds_read_b128 a[144:147], v12 offset:20480
    v_add_f32 v26, v26, v101
    v_cvt_pk_bf16_f32 v50, v100, v101
    v_mfma_f32_32x32x16_bf16 v[80:95], a[132:135], a[4:7], v[80:95]
    ds_read_b128 a[148:151], v12 offset:21504
    v_fma_f32 v105, v105, s43, -v24
    v_exp_f32 v104, v104
    buffer_load_dwordx4 v2, s[12:15], s68 offen offset:1024 lds
    s_waitcnt lgkmcnt(2)
    v_mfma_f32_32x32x16_bf16 v[80:95], a[136:139], a[8:11], v[80:95]
    ds_read_b128 a[152:155], v12 offset:22528
    v_add_f32 v27, v27, v102
    v_fma_f32 v106, v106, s43, -v24
    v_exp_f32 v105, v105
    v_mfma_f32_32x32x16_bf16 v[80:95], a[140:143], a[12:15], v[80:95]
    ds_read_b128 a[156:159], v12 offset:23552
    v_add_f32 v28, v28, v103
    v_cvt_pk_bf16_f32 v51, v102, v103
    s_waitcnt lgkmcnt(2)
    v_mfma_f32_32x32x16_bf16 v[80:95], a[144:147], a[16:19], v[80:95]
    ds_read_b128 a[128:131], v12 offset:24576
    v_fma_f32 v107, v107, s43, -v24
    v_exp_f32 v106, v106
    buffer_load_dwordx4 v2, s[12:15], s68 offen offset:2048 lds
    v_mfma_f32_32x32x16_bf16 v[80:95], a[148:151], a[20:23], v[80:95]
    ds_read_b128 a[132:135], v12 offset:25600
    v_add_f32 v25, v25, v104
    v_fma_f32 v108, v108, s43, -v24
    v_exp_f32 v107, v107
    s_waitcnt lgkmcnt(2)
    v_mfma_f32_32x32x16_bf16 v[80:95], a[152:155], a[24:27], v[80:95]
    ds_read_b128 a[136:139], v12 offset:26624
    v_add_f32 v26, v26, v105
    v_cvt_pk_bf16_f32 v52, v104, v105
    v_mfma_f32_32x32x16_bf16 v[80:95], a[156:159], a[28:31], v[80:95]
    ds_read_b128 a[140:143], v12 offset:27648
    v_fma_f32 v109, v109, s43, -v24
    v_exp_f32 v108, v108
    buffer_load_dwordx4 v2, s[12:15], s68 offen offset:3072 lds
    s_waitcnt lgkmcnt(2)
    v_mfma_f32_32x32x16_bf16 v[80:95], a[128:131], a[32:35], v[80:95]
    ds_read_b128 a[144:147], v12 offset:28672
    v_add_f32 v27, v27, v106
    v_fma_f32 v110, v110, s43, -v24
    v_exp_f32 v109, v109
    v_mfma_f32_32x32x16_bf16 v[80:95], a[132:135], a[36:39], v[80:95]
    ds_read_b128 a[148:151], v12 offset:29696
    v_add_f32 v28, v28, v107
    v_cvt_pk_bf16_f32 v53, v106, v107
    s_waitcnt lgkmcnt(2)
    v_mfma_f32_32x32x16_bf16 v[80:95], a[136:139], a[40:43], v[80:95]
    ds_read_b128 a[152:155], v12 offset:30720
    v_fma_f32 v111, v111, s43, -v24
    v_exp_f32 v110, v110
    s_add_u32 s36, s36, 32768
    s_sub_u32 s50, s50, 1
    s_cmp_eq_u32 s50, 0
    s_cselect_b32 s36, s48, s36
    s_sub_u32 s52, s52, 1
    s_cmp_eq_u32 s52, 0
    s_cselect_b32 s36, 0x80000000, s36
    s_cselect_b32 s48, 0x80000000, s48
    v_mfma_f32_32x32x16_bf16 v[80:95], a[140:143], a[44:47], v[80:95]
    ds_read_b128 a[156:159], v12 offset:31744
    v_add_f32 v25, v25, v108
    v_fma_f32 v112, v112, s43, -v24
    v_exp_f32 v111, v111
    s_waitcnt lgkmcnt(2)
    v_mfma_f32_32x32x16_bf16 v[80:95], a[144:147], a[48:51], v[80:95]
    ds_read_b128 a[128:131], v20 offset:32768
    v_add_f32 v26, v26, v109
    v_cvt_pk_bf16_f32 v54, v108, v109
    v_mfma_f32_32x32x16_bf16 v[80:95], a[148:151], a[52:55], v[80:95]
    ds_read_b128 a[132:135], v20 offset:36864
    v_fma_f32 v113, v113, s43, -v24
    v_exp_f32 v112, v112
    s_waitcnt lgkmcnt(2)
    v_mfma_f32_32x32x16_bf16 v[80:95], a[152:155], a[56:59], v[80:95]
    ds_read_b128 a[136:139], v20 offset:40960
    v_add_f32 v27, v27, v110
    v_fma_f32 v114, v114, s43, -v24
    v_exp_f32 v113, v113
    v_mfma_f32_32x32x16_bf16 v[80:95], a[156:159], a[60:63], v[80:95]
    ds_read_b128 a[140:143], v20 offset:45056
    v_add_f32 v28, v28, v111
    v_cvt_pk_bf16_f32 v55, v110, v111
    s_waitcnt lgkmcnt(2)
    v_mfma_f32_32x32x16_bf16 v[128:143], a[128:131], v[48:51], v[128:143]
    ds_read_b128 a[144:147], v20 offset:49152
    v_fma_f32 v115, v115, s43, -v24
    v_exp_f32 v114, v114
    v_mfma_f32_32x32x16_bf16 v[144:159], a[132:135], v[48:51], v[144:159]
    ds_read_b128 a[148:151], v20 offset:53248
    v_add_f32 v25, v25, v112
    v_fma_f32 v116, v116, s43, -v24
    v_exp_f32 v115, v115
    s_waitcnt lgkmcnt(2)
    v_mfma_f32_32x32x16_bf16 v[160:175], a[136:139], v[48:51], v[160:175]
    ds_read_b128 a[152:155], v20 offset:57344
    v_add_f32 v26, v26, v113
    v_cvt_pk_bf16_f32 v56, v112, v113
    v_mfma_f32_32x32x16_bf16 v[176:191], a[140:143], v[48:51], v[176:191]
    ds_read_b128 a[156:159], v20 offset:61440
    v_fma_f32 v117, v117, s43, -v24
    v_exp_f32 v116, v116
    s_waitcnt lgkmcnt(2)
    v_mfma_f32_32x32x16_bf16 v[192:207], a[144:147], v[48:51], v[192:207]
    ds_read_b128 a[128:131], v20 offset:33792
    v_add_f32 v27, v27, v114
    v_fma_f32 v118, v118, s43, -v24
    v_exp_f32 v117, v117
    s_add_u32 m0, s38, 0
    s_add_u32 s68, s35, 0
    buffer_load_dwordx4 v2, s[8:11], s68 offen offset:0 lds
    v_mfma_f32_32x32x16_bf16 v[208:223], a[148:151], v[48:51], v[208:223]
    ds_read_b128 a[132:135], v20 offset:37888
    v_add_f32 v28, v28, v115
    v_cvt_pk_bf16_f32 v57, v114, v115
    s_waitcnt lgkmcnt(2)
    v_mfma_f32_32x32x16_bf16 v[224:239], a[152:155], v[48:51], v[224:239]
    ds_read_b128 a[136:139], v20 offset:41984
    v_fma_f32 v119, v119, s43, -v24
    v_exp_f32 v118, v118
    buffer_load_dwordx4 v2, s[8:11], s68 offen offset:1024 lds
    v_mfma_f32_32x32x16_bf16 v[240:255], a[156:159], v[48:51], v[240:255]
    ds_read_b128 a[140:143], v20 offset:46080
    v_add_f32 v25, v25, v116
    v_fma_f32 v120, v120, s43, -v24
    v_exp_f32 v119, v119
    s_waitcnt lgkmcnt(2)
    v_mfma_f32_32x32x16_bf16 v[128:143], a[128:131], v[52:55], v[128:143]
    ds_read_b128 a[144:147], v20 offset:50176
    v_add_f32 v26, v26, v117
    v_cvt_pk_bf16_f32 v58, v116, v117
    v_mfma_f32_32x32x16_bf16 v[144:159], a[132:135], v[52:55], v[144:159]
    ds_read_b128 a[148:151], v20 offset:54272
    v_fma_f32 v121, v121, s43, -v24
    v_exp_f32 v120, v120
    buffer_load_dwordx4 v2, s[8:11], s68 offen offset:2048 lds
    s_waitcnt lgkmcnt(2)
    v_mfma_f32_32x32x16_bf16 v[160:175], a[136:139], v[52:55], v[160:175]
    ds_read_b128 a[152:155], v20 offset:58368
    v_add_f32 v27, v27, v118
    v_fma_f32 v122, v122, s43, -v24
    v_exp_f32 v121, v121
    v_mfma_f32_32x32x16_bf16 v[176:191], a[140:143], v[52:55], v[176:191]
    ds_read_b128 a[156:159], v20 offset:62464
    v_add_f32 v28, v28, v119
    v_cvt_pk_bf16_f32 v59, v118, v119
    buffer_load_dwordx4 v2, s[8:11], s68 offen offset:3072 lds
    s_waitcnt lgkmcnt(2)
    v_mfma_f32_32x32x16_bf16 v[192:207], a[144:147], v[52:55], v[192:207]
    ds_read_b128 a[128:131], v20 offset:34816
    v_fma_f32 v123, v123, s43, -v24
    v_exp_f32 v122, v122
    v_mfma_f32_32x32x16_bf16 v[208:223], a[148:151], v[52:55], v[208:223]
    ds_read_b128 a[132:135], v20 offset:38912
    v_add_f32 v25, v25, v120
    v_fma_f32 v124, v124, s43, -v24
    v_exp_f32 v123, v123
    s_waitcnt lgkmcnt(2)
    v_mfma_f32_32x32x16_bf16 v[224:239], a[152:155], v[52:55], v[224:239]
    ds_read_b128 a[136:139], v20 offset:43008
    v_add_f32 v26, v26, v121
    v_cvt_pk_bf16_f32 v60, v120, v121
    s_add_u32 m0, s38, 4096
    s_add_u32 s68, s35, 4096
    buffer_load_dwordx4 v2, s[8:11], s68 offen offset:0 lds
    v_mfma_f32_32x32x16_bf16 v[240:255], a[156:159], v[52:55], v[240:255]
    ds_read_b128 a[140:143], v20 offset:47104
    v_fma_f32 v125, v125, s43, -v24
    v_exp_f32 v124, v124
    s_waitcnt lgkmcnt(2)
    v_mfma_f32_32x32x16_bf16 v[128:143], a[128:131], v[56:59], v[128:143]
    ds_read_b128 a[144:147], v20 offset:51200
    v_add_f32 v27, v27, v122
    v_fma_f32 v126, v126, s43, -v24
    v_exp_f32 v125, v125
    v_mfma_f32_32x32x16_bf16 v[144:159], a[132:135], v[56:59], v[144:159]
    ds_read_b128 a[148:151], v20 offset:55296
    v_add_f32 v28, v28, v123
    v_cvt_pk_bf16_f32 v61, v122, v123
    buffer_load_dwordx4 v2, s[8:11], s68 offen offset:1024 lds
    s_waitcnt lgkmcnt(2)
    v_mfma_f32_32x32x16_bf16 v[160:175], a[136:139], v[56:59], v[160:175]
    ds_read_b128 a[152:155], v20 offset:59392
    v_fma_f32 v127, v127, s43, -v24
    v_exp_f32 v126, v126
    s_add_u32 s54, s54, 1
    s_mov_b32 s55, 32768
    s_cmp_eq_u32 s54, 3
    s_cselect_b32 s55, 0xffff0000, s55
    s_cselect_b32 s54, 0, s54
    v_mfma_f32_32x32x16_bf16 v[176:191], a[140:143], v[56:59], v[176:191]
    ds_read_b128 a[156:159], v20 offset:63488
    v_add_f32 v25, v25, v124
    v_exp_f32 v127, v127
    v_add_f32 v26, v26, v125
    buffer_load_dwordx4 v2, s[8:11], s68 offen offset:2048 lds
    s_waitcnt lgkmcnt(2)
    v_mfma_f32_32x32x16_bf16 v[192:207], a[144:147], v[56:59], v[192:207]
    ds_read_b128 a[128:131], v20 offset:35840
    v_add_f32 v27, v27, v126
    v_add_f32 v28, v28, v127
    v_mfma_f32_32x32x16_bf16 v[208:223], a[148:151], v[56:59], v[208:223]
    ds_read_b128 a[132:135], v20 offset:39936
    v_cvt_pk_bf16_f32 v62, v124, v125
    v_cvt_pk_bf16_f32 v63, v126, v127
    v_add_u32 v12, s55, v12
    s_waitcnt lgkmcnt(2)
    v_mfma_f32_32x32x16_bf16 v[224:239], a[152:155], v[56:59], v[224:239]
    ds_read_b128 a[136:139], v20 offset:44032
    buffer_load_dwordx4 v2, s[8:11], s68 offen offset:3072 lds
    v_mfma_f32_32x32x16_bf16 v[240:255], a[156:159], v[56:59], v[240:255]
    ds_read_b128 a[140:143], v20 offset:48128
    s_waitcnt lgkmcnt(2)
    v_mfma_f32_32x32x16_bf16 v[128:143], a[128:131], v[60:63], v[128:143]
    ds_read_b128 a[144:147], v20 offset:52224
    s_add_u32 s35, s35, 32768
    s_sub_u32 s49, s49, 1
    s_cmp_eq_u32 s49, 0
    s_cselect_b32 s35, s47, s35
    s_sub_u32 s51, s51, 1
    s_cmp_eq_u32 s51, 0
    s_cselect_b32 s35, 0x80000000, s35
    s_cselect_b32 s47, 0x80000000, s47
    v_mfma_f32_32x32x16_bf16 v[144:159], a[132:135], v[60:63], v[144:159]
    ds_read_b128 a[148:151], v20 offset:56320
    s_waitcnt lgkmcnt(2)
    v_mfma_f32_32x32x16_bf16 v[160:175], a[136:139], v[60:63], v[160:175]
    ds_read_b128 a[152:155], v20 offset:60416
    v_mfma_f32_32x32x16_bf16 v[176:191], a[140:143], v[60:63], v[176:191]
    ds_read_b128 a[156:159], v20 offset:64512
    s_add_u32 s38, s38, 32768
    s_cmp_ge_u32 s38, 98304
    s_cselect_b32 s68, 98304, 0
    s_sub_u32 s38, s38, s68
    s_waitcnt lgkmcnt(2)
    v_mfma_f32_32x32x16_bf16 v[192:207], a[144:147], v[60:63], v[192:207]
    ds_read_b128 a[128:131], v12 offset:0
    v_mfma_f32_32x32x16_bf16 v[208:223], a[148:151], v[60:63], v[208:223]
    ds_read_b128 a[132:135], v12 offset:1024
    s_waitcnt lgkmcnt(2)
    v_mfma_f32_32x32x16_bf16 v[224:239], a[152:155], v[60:63], v[224:239]
    ds_read_b128 a[136:139], v12 offset:2048
    v_mfma_f32_32x32x16_bf16 v[240:255], a[156:159], v[60:63], v[240:255]
    ds_read_b128 a[140:143], v12 offset:3072
    s_branch L_x0
L_xl0:
    s_waitcnt lgkmcnt(2)
    v_mfma_f32_32x32x16_bf16 v[96:111], a[128:131], a[64:67], 0
    ds_read_b128 a[144:147], v12 offset:4096
    v_max3_f32 v30, v64, v65, v66
    v_max3_f32 v31, v67, v68, v69
    v_max3_f32 v30, v30, v70, v71
    v_mfma_f32_32x32x16_bf16 v[96:111], a[132:135], a[68:71], v[96:111]
    ds_read_b128 a[148:151], v12 offset:5120
    v_max3_f32 v31, v31, v72, v73
    v_max3_f32 v30, v30, v74, v75
    v_max3_f32 v31, v31, v76, v77
    s_waitcnt lgkmcnt(2)
    v_mfma_f32_32x32x16_bf16 v[96:111], a[136:139], a[72:75], v[96:111]
    ds_read_b128 a[152:155], v12 offset:6144
    v_max3_f32 v30, v30, v78, v79
    v_max3_f32 v31, v31, v80, v81
    v_max3_f32 v30, v30, v82, v83
    s_add_u32 m0, s56, 131072
    s_add_u32 s68, s36, 0
    buffer_load_dwordx4 v2, s[12:15], s68 offen offset:0 lds
    v_mfma_f32_32x32x16_bf16 v[96:111], a[140:143], a[76:79], v[96:111]
    ds_read_b128 a[156:159], v12 offset:7168
    v_max3_f32 v31, v31, v84, v85
    v_max3_f32 v30, v30, v86, v87
    v_max3_f32 v31, v31, v88, v89
    s_waitcnt lgkmcnt(2)
    v_mfma_f32_32x32x16_bf16 v[96:111], a[144:147], a[80:83], v[96:111]
    ds_read_b128 a[128:131], v12 offset:8192
    v_max3_f32 v30, v30, v90, v91
    v_max3_f32 v31, v31, v92, v93
    v_max3_f32 v30, v30, v94, v95
    v_mfma_f32_32x32x16_bf16 v[96:111], a[148:151], a[84:87], v[96:111]
    ds_read_b128 a[132:135], v12 offset:9216
    v_max_f32 v30, v30, v31
    v_mov_b32 v31, v30
    s_nop 1
    v_permlane32_swap_b32 v30, v31
    v_max_f32 v30, v30, v31
    v_fma_f32 v31, v30, s43, -v24
    v_cmp_lt_f32 vcc, s44, v31
    s_cbranch_vccnz L_resc_a_69
    L_resc_ret_a_69:
    buffer_load_dwordx4 v2, s[12:15], s68 offen offset:1024 lds
    s_waitcnt lgkmcnt(2)
    v_mfma_f32_32x32x16_bf16 v[96:111], a[152:155], a[88:91], v[96:111]
    ds_read_b128 a[136:139], v12 offset:10240
    v_fma_f32 v64, v64, s43, -v24
    v_fma_f32 v65, v65, s43, -v24
    v_exp_f32 v64, v64
    v_mfma_f32_32x32x16_bf16 v[96:111], a[156:159], a[92:95], v[96:111]
    ds_read_b128 a[140:143], v12 offset:11264
    v_fma_f32 v66, v66, s43, -v24
    v_exp_f32 v65, v65
    s_waitcnt lgkmcnt(2)
    v_mfma_f32_32x32x16_bf16 v[96:111], a[128:131], a[96:99], v[96:111]
    ds_read_b128 a[144:147], v12 offset:12288
    v_fma_f32 v67, v67, s43, -v24
    v_exp_f32 v66, v66
    buffer_load_dwordx4 v2, s[12:15], s68 offen offset:2048 lds
    v_mfma_f32_32x32x16_bf16 v[96:111], a[132:135], a[100:103], v[96:111]
    ds_read_b128 a[148:151], v12 offset:13312
    v_add_f32 v25, v25, v64
    v_fma_f32 v68, v68, s43, -v24
    v_exp_f32 v67, v67
    s_waitcnt lgkmcnt(2)
    v_mfma_f32_32x32x16_bf16 v[96:111], a[136:139], a[104:107], v[96:111]
    ds_read_b128 a[152:155], v12 offset:14336
    v_add_f32 v26, v26, v65
    v_cvt_pk_bf16_f32 v48, v64, v65
    v_mfma_f32_32x32x16_bf16 v[96:111], a[140:143], a[108:111], v[96:111]
    ds_read_b128 a[156:159], v12 offset:15360
    v_fma_f32 v69, v69, s43, -v24
    v_exp_f32 v68, v68
    buffer_load_dwordx4 v2, s[12:15], s68 offen offset:3072 lds
    s_waitcnt lgkmcnt(2)
    v_mfma_f32_32x32x16_bf16 v[96:111], a[144:147], a[112:115], v[96:111]
    ds_read_b128 a[128:131], v12 offset:16384
    v_add_f32 v27, v27, v66
    v_fma_f32 v70, v70, s43, -v24
    v_exp_f32 v69, v69
    v_mfma_f32_32x32x16_bf16 v[96:111], a[148:151], a[116:119], v[96:111]
    ds_read_b128 a[132:135], v12 offset:17408
    v_add_f32 v28, v28, v67
    v_cvt_pk_bf16_f32 v49, v66, v67
    s_waitcnt lgkmcnt(2)
    v_mfma_f32_32x32x16_bf16 v[96:111], a[152:155], a[120:123], v[96:111]
    ds_read_b128 a[136:139], v12 offset:18432
    v_fma_f32 v71, v71, s43, -v24
    v_exp_f32 v70, v70
    s_add_u32 m0, s56, 135168
    s_add_u32 s68, s36, 4096
    buffer_load_dwordx4 v2, s[12:15], s68 offen offset:0 lds
    v_mfma_f32_32x32x16_bf16 v[96:111], a[156:159], a[124:127], v[96:111]
    ds_read_b128 a[140:143], v12 offset:19456
    v_add_f32 v25, v25, v68
    v_fma_f32 v72, v72, s43, -v24
    v_exp_f32 v71, v71
    s_waitcnt lgkmcnt(2)
    v_mfma_f32_32x32x16_bf16 v[112:127], a[128:131], a[64:67], 0
    ds_read_b128 a[144:147], v12 offset:20480
    v_add_f32 v26, v26, v69
    v_cvt_pk_bf16_f32 v50, v68, v69
    v_mfma_f32_32x32x16_bf16 v[112:127], a[132:135], a[68:71], v[112:127]
    ds_read_b128 a[148:151], v12 offset:21504
    v_fma_f32 v73, v73, s43, -v24
    v_exp_f32 v72, v72
    buffer_load_dwordx4 v2, s[12:15], s68 offen offset:1024 lds
    s_waitcnt lgkmcnt(2)
    v_mfma_f32_32x32x16_bf16 v[112:127], a[136:139], a[72:75], v[112:127]
    ds_read_b128 a[152:155], v12 offset:22528
    v_add_f32 v27, v27, v70
    v_fma_f32 v74, v74, s43, -v24
    v_exp_f32 v73, v73
    v_mfma_f32_32x32x16_bf16 v[112:127], a[140:143], a[76:79], v[112:127]
    ds_read_b128 a[156:159], v12 offset:23552
    v_add_f32 v28, v28, v71
    v_cvt_pk_bf16_f32 v51, v70, v71
    s_waitcnt lgkmcnt(2)
    v_mfma_f32_32x32x16_bf16 v[112:127], a[144:147], a[80:83], v[112:127]
    ds_read_b128 a[128:131], v12 offset:24576
    v_fma_f32 v75, v75, s43, -v24
    v_exp_f32 v74, v74
    buffer_load_dwordx4 v2, s[12:15], s68 offen offset:2048 lds
    v_mfma_f32_32x32x16_bf16 v[112:127], a[148:151], a[84:87], v[112:127]
    ds_read_b128 a[132:135], v12 offset:25600
    v_add_f32 v25, v25, v72
    v_fma_f32 v76, v76, s43, -v24
    v_exp_f32 v75, v75
    s_waitcnt lgkmcnt(2)
    v_mfma_f32_32x32x16_bf16 v[112:127], a[152:155], a[88:91], v[112:127]
    ds_read_b128 a[136:139], v12 offset:26624
    v_add_f32 v26, v26, v73
    v_cvt_pk_bf16_f32 v52, v72, v73
    v_mfma_f32_32x32x16_bf16 v[112:127], a[156:159], a[92:95], v[112:127]
    ds_read_b128 a[140:143], v12 offset:27648
    v_fma_f32 v77, v77, s43, -v24
    v_exp_f32 v76, v76
    buffer_load_dwordx4 v2, s[12:15], s68 offen offset:3072 lds
    s_waitcnt lgkmcnt(2)
    v_mfma_f32_32x32x16_bf16 v[112:127], a[128:131], a[96:99], v[112:127]
    ds_read_b128 a[144:147], v12 offset:28672
    v_add_f32 v27, v27, v74
    v_fma_f32 v78, v78, s43, -v24
    v_exp_f32 v77, v77
    v_mfma_f32_32x32x16_bf16 v[112:127], a[132:135], a[100:103], v[112:127]
    ds_read_b128 a[148:151], v12 offset:29696
    v_add_f32 v28, v28, v75
    v_cvt_pk_bf16_f32 v53, v74, v75
    s_waitcnt lgkmcnt(2)
    v_mfma_f32_32x32x16_bf16 v[112:127], a[136:139], a[104:107], v[112:127]
    ds_read_b128 a[152:155], v12 offset:30720
    v_fma_f32 v79, v79, s43, -v24
    v_exp_f32 v78, v78
    s_add_u32 s36, s36, 32768
    s_sub_u32 s50, s50, 1
    s_cmp_eq_u32 s50, 0
    s_cselect_b32 s36, s48, s36
    s_sub_u32 s52, s52, 1
    s_cmp_eq_u32 s52, 0
    s_cselect_b32 s36, 0x80000000, s36
    s_cselect_b32 s48, 0x80000000, s48
    v_mfma_f32_32x32x16_bf16 v[112:127], a[140:143], a[108:111], v[112:127]
    ds_read_b128 a[156:159], v12 offset:31744
    v_add_f32 v25, v25, v76
    v_fma_f32 v80, v80, s43, -v24
    v_exp_f32 v79, v79
    s_waitcnt lgkmcnt(2)
    v_mfma_f32_32x32x16_bf16 v[112:127], a[144:147], a[112:115], v[112:127]
    ds_read_b128 a[128:131], v20 offset:0
    v_add_f32 v26, v26, v77
    v_cvt_pk_bf16_f32 v54, v76, v77
    v_mfma_f32_32x32x16_bf16 v[112:127], a[148:151], a[116:119], v[112:127]
    ds_read_b128 a[132:135], v20 offset:4096
    v_fma_f32 v81, v81, s43, -v24
    v_exp_f32 v80, v80
    s_waitcnt lgkmcnt(2)
    v_mfma_f32_32x32x16_bf16 v[112:127], a[152:155], a[120:123], v[112:127]
    ds_read_b128 a[136:139], v20 offset:8192
    v_add_f32 v27, v27, v78
    v_fma_f32 v82, v82, s43, -v24
    v_exp_f32 v81, v81
    v_mfma_f32_32x32x16_bf16 v[112:127], a[156:159], a[124:127], v[112:127]
    ds_read_b128 a[140:143], v20 offset:12288
    v_add_f32 v28, v28, v79
    v_cvt_pk_bf16_f32 v55, v78, v79
    s_waitcnt lgkmcnt(2)
    v_mfma_f32_32x32x16_bf16 v[128:143], a[128:131], v[48:51], v[128:143]
    ds_read_b128 a[144:147], v20 offset:16384
    v_fma_f32 v83, v83, s43, -v24
    v_exp_f32 v82, v82
    v_mfma_f32_32x32x16_bf16 v[144:159], a[132:135], v[48:51], v[144:159]
    ds_read_b128 a[148:151], v20 offset:20480
    v_add_f32 v25, v25, v80
    v_fma_f32 v84, v84, s43, -v24
    v_exp_f32 v83, v83
    s_waitcnt lgkmcnt(2)
    v_mfma_f32_32x32x16_bf16 v[160:175], a[136:139], v[48:51], v[160:175]
    ds_read_b128 a[152:155], v20 offset:24576
    v_add_f32 v26, v26, v81
    v_cvt_pk_bf16_f32 v56, v80, v81
    v_mfma_f32_32x32x16_bf16 v[176:191], a[140:143], v[48:51], v[176:191]
    ds_read_b128 a[156:159], v20 offset:28672
    v_fma_f32 v85, v85, s43, -v24
    v_exp_f32 v84, v84
    s_waitcnt lgkmcnt(2)
    v_mfma_f32_32x32x16_bf16 v[192:207], a[144:147], v[48:51], v[192:207]
    ds_read_b128 a[128:131], v20 offset:1024
    v_add_f32 v27, v27, v82
    v_fma_f32 v86, v86, s43, -v24
    v_exp_f32 v85, v85
    s_add_u32 m0, s38, 0
    s_add_u32 s68, s35, 0
    buffer_load_dwordx4 v2, s[8:11], s68 offen offset:0 lds
    v_mfma_f32_32x32x16_bf16 v[208:223], a[148:151], v[48:51], v[208:223]
    ds_read_b128 a[132:135], v20 offset:5120
    v_add_f32 v28, v28, v83
    v_cvt_pk_bf16_f32 v57, v82, v83
    s_waitcnt lgkmcnt(2)
    v_mfma_f32_32x32x16_bf16 v[224:239], a[152:155], v[48:51], v[224:239]
    ds_read_b128 a[136:139], v20 offset:9216
    v_fma_f32 v87, v87, s43, -v24
    v_exp_f32 v86, v86
    buffer_load_dwordx4 v2, s[8:11], s68 offen offset:1024 lds
    v_mfma_f32_32x32x16_bf16 v[240:255], a[156:159], v[48:51], v[240:255]
    ds_read_b128 a[140:143], v20 offset:13312
    v_add_f32 v25, v25, v84
    v_fma_f32 v88, v88, s43, -v24
    v_exp_f32 v87, v87
    s_waitcnt lgkmcnt(2)
    v_mfma_f32_32x32x16_bf16 v[128:143], a[128:131], v[52:55], v[128:143]
    ds_read_b128 a[144:147], v20 offset:17408
    v_add_f32 v26, v26, v85
    v_cvt_pk_bf16_f32 v58, v84, v85
    v_mfma_f32_32x32x16_bf16 v[144:159], a[132:135], v[52:55], v[144:159]
    ds_read_b128 a[148:151], v20 offset:21504
    v_fma_f32 v89, v89, s43, -v24
    v_exp_f32 v88, v88
    buffer_load_dwordx4 v2, s[8:11], s68 offen offset:2048 lds
    s_waitcnt lgkmcnt(2)
    v_mfma_f32_32x32x16_bf16 v[160:175], a[136:139], v[52:55], v[160:175]
    ds_read_b128 a[152:155], v20 offset:25600
    v_add_f32 v27, v27, v86
    v_fma_f32 v90, v90, s43, -v24
    v_exp_f32 v89, v89
    v_mfma_f32_32x32x16_bf16 v[176:191], a[140:143], v[52:55], v[176:191]
    ds_read_b128 a[156:159], v20 offset:29696
    v_add_f32 v28, v28, v87
    v_cvt_pk_bf16_f32 v59, v86, v87
    buffer_load_dwordx4 v2, s[8:11], s68 offen offset:3072 lds
    s_waitcnt lgkmcnt(2)
    v_mfma_f32_32x32x16_bf16 v[192:207], a[144:147], v[52:55], v[192:207]
    ds_read_b128 a[128:131], v20 offset:2048
    v_fma_f32 v91, v91, s43, -v24
    v_exp_f32 v90, v90
    v_mfma_f32_32x32x16_bf16 v[208:223], a[148:151], v[52:55], v[208:223]
    ds_read_b128 a[132:135], v20 offset:6144
    v_add_f32 v25, v25, v88
    v_fma_f32 v92, v92, s43, -v24
    v_exp_f32 v91, v91
    s_waitcnt lgkmcnt(2)
    v_mfma_f32_32x32x16_bf16 v[224:239], a[152:155], v[52:55], v[224:239]
    ds_read_b128 a[136:139], v20 offset:10240
    v_add_f32 v26, v26, v89
    v_cvt_pk_bf16_f32 v60, v88, v89
    s_add_u32 m0, s38, 4096
    s_add_u32 s68, s35, 4096
    buffer_load_dwordx4 v2, s[8:11], s68 offen offset:0 lds
    v_mfma_f32_32x32x16_bf16 v[240:255], a[156:159], v[52:55], v[240:255]
    ds_read_b128 a[140:143], v20 offset:14336
    v_fma_f32 v93, v93, s43, -v24
    v_exp_f32 v92, v92
    s_waitcnt lgkmcnt(2)
    v_mfma_f32_32x32x16_bf16 v[128:143], a[128:131], v[56:59], v[128:143]
    ds_read_b128 a[144:147], v20 offset:18432
    v_add_f32 v27, v27, v90
    v_fma_f32 v94, v94, s43, -v24
    v_exp_f32 v93, v93
    v_mfma_f32_32x32x16_bf16 v[144:159], a[132:135], v[56:59], v[144:159]
    ds_read_b128 a[148:151], v20 offset:22528
    v_add_f32 v28, v28, v91
    v_cvt_pk_bf16_f32 v61, v90, v91
    buffer_load_dwordx4 v2, s[8:11], s68 offen offset:1024 lds
    s_waitcnt lgkmcnt(2)
    v_mfma_f32_32x32x16_bf16 v[160:175], a[136:139], v[56:59], v[160:175]
    ds_read_b128 a[152:155], v20 offset:26624
    v_fma_f32 v95, v95, s43, -v24
    v_exp_f32 v94, v94
    s_add_u32 s54, s54, 1
    s_mov_b32 s55, 32768
    s_cmp_eq_u32 s54, 3
    s_cselect_b32 s55, 0xffff0000, s55
    s_cselect_b32 s54, 0, s54
    v_mfma_f32_32x32x16_bf16 v[176:191], a[140:143], v[56:59], v[176:191]
    ds_read_b128 a[156:159], v20 offset:30720
    v_add_f32 v25, v25, v92
    v_exp_f32 v95, v95
    v_add_f32 v26, v26, v93
    buffer_load_dwordx4 v2, s[8:11], s68 offen offset:2048 lds
    s_waitcnt lgkmcnt(2)
    v_mfma_f32_32x32x16_bf16 v[192:207], a[144:147], v[56:59], v[192:207]
    ds_read_b128 a[128:131], v20 offset:3072
    v_add_f32 v27, v27, v94
    v_add_f32 v28, v28, v95
    v_mfma_f32_32x32x16_bf16 v[208:223], a[148:151], v[56:59], v[208:223]
    ds_read_b128 a[132:135], v20 offset:7168
    v_cvt_pk_bf16_f32 v62, v92, v93
    v_cvt_pk_bf16_f32 v63, v94, v95
    v_add_u32 v12, s55, v12
    s_waitcnt lgkmcnt(2)
    v_mfma_f32_32x32x16_bf16 v[224:239], a[152:155], v[56:59], v[224:239]
    ds_read_b128 a[136:139], v20 offset:11264
    buffer_load_dwordx4 v2, s[8:11], s68 offen offset:3072 lds
    v_mfma_f32_32x32x16_bf16 v[240:255], a[156:159], v[56:59], v[240:255]
    ds_read_b128 a[140:143], v20 offset:15360
    s_waitcnt lgkmcnt(2)
    v_mfma_f32_32x32x16_bf16 v[128:143], a[128:131], v[60:63], v[128:143]
    ds_read_b128 a[144:147], v20 offset:19456
    s_add_u32 s35, s35, 32768
    s_sub_u32 s49, s49, 1
    s_cmp_eq_u32 s49, 0
    s_cselect_b32 s35, s47, s35
    s_sub_u32 s51, s51, 1
    s_cmp_eq_u32 s51, 0
    s_cselect_b32 s35, 0x80000000, s35
    s_cselect_b32 s47, 0x80000000, s47
    v_mfma_f32_32x32x16_bf16 v[144:159], a[132:135], v[60:63], v[144:159]
    ds_read_b128 a[148:151], v20 offset:23552
    s_waitcnt lgkmcnt(2)
    v_mfma_f32_32x32x16_bf16 v[160:175], a[136:139], v[60:63], v[160:175]
    ds_read_b128 a[152:155], v20 offset:27648
    v_mfma_f32_32x32x16_bf16 v[176:191], a[140:143], v[60:63], v[176:191]
    ds_read_b128 a[156:159], v20 offset:31744
    s_add_u32 s38, s38, 32768
    s_cmp_ge_u32 s38, 98304
    s_cselect_b32 s68, 98304, 0
    s_sub_u32 s38, s38, s68
    s_waitcnt lgkmcnt(2)
    v_mfma_f32_32x32x16_bf16 v[192:207], a[144:147], v[60:63], v[192:207]
    ds_read_b128 a[128:131], v12 offset:0
    v_mfma_f32_32x32x16_bf16 v[208:223], a[148:151], v[60:63], v[208:223]
    ds_read_b128 a[132:135], v12 offset:1024
    s_waitcnt lgkmcnt(2)
    v_mfma_f32_32x32x16_bf16 v[224:239], a[152:155], v[60:63], v[224:239]
    ds_read_b128 a[136:139], v12 offset:2048
    v_mfma_f32_32x32x16_bf16 v[240:255], a[156:159], v[60:63], v[240:255]
    ds_read_b128 a[140:143], v12 offset:3072
    s_mul_i32 s37, s42, 69632
    s_mul_i32 s45, s32, 17408
    s_add_u32 s37, s37, s45
    v_lshlrev_b32 v34, 4, v1
    v_add_f32 v31, v25, v26
    v_add_f32 v32, v27, v28
    v_mov_b32 v30, v24
    v_add_f32 v31, v31, v32
    s_add_u32 s45, s37, 16384
    buffer_store_dwordx2 v[30:31], v34, s[20:23], s45 offen sc1
    v_mov_b32 v24, s46
    v_mov_b32 v25, 0
    v_mov_b32 v26, 0
    v_mov_b32 v27, 0
    v_mov_b32 v28, 0
    s_nop 4
    v_cvt_pk_bf16_f32 v64, v128, v129
    v_cvt_pk_bf16_f32 v65, v130, v131
    v_cvt_pk_bf16_f32 v66, v132, v133
    v_cvt_pk_bf16_f32 v67, v134, v135
    buffer_store_dwordx4 v[64:67], v34, s[20:23], s37 offen offset:0 sc1
    v_cvt_pk_bf16_f32 v68, v136, v137
    v_cvt_pk_bf16_f32 v69, v138, v139
    v_cvt_pk_bf16_f32 v70, v140, v141
    v_cvt_pk_bf16_f32 v71, v142, v143
    buffer_store_dwordx4 v[68:71], v34, s[20:23], s37 offen offset:1024 sc1
    v_cvt_pk_bf16_f32 v72, v144, v145
    v_cvt_pk_bf16_f32 v73, v146, v147
    v_cvt_pk_bf16_f32 v74, v148, v149
    v_cvt_pk_bf16_f32 v75, v150, v151
    buffer_store_dwordx4 v[72:75], v34, s[20:23], s37 offen offset:2048 sc1
    v_cvt_pk_bf16_f32 v76, v152, v153
    v_cvt_pk_bf16_f32 v77, v154, v155
    v_cvt_pk_bf16_f32 v78, v156, v157
    v_cvt_pk_bf16_f32 v79, v158, v159
    buffer_store_dwordx4 v[76:79], v34, s[20:23], s37 offen offset:3072 sc1
    v_cvt_pk_bf16_f32 v80, v160, v161
    v_cvt_pk_bf16_f32 v81, v162, v163
    v_cvt_pk_bf16_f32 v82, v164, v165
    v_cvt_pk_bf16_f32 v83, v166, v167
    s_add_u32 s37, s37, 4096
    buffer_store_dwordx4 v[80:83], v34, s[20:23], s37 offen offset:0 sc1
    v_cvt_pk_bf16_f32 v84, v168, v169
    v_cvt_pk_bf16_f32 v85, v170, v171
    v_cvt_pk_bf16_f32 v86, v172, v173
    v_cvt_pk_bf16_f32 v87, v174, v175
    buffer_store_dwordx4 v[84:87], v34, s[20:23], s37 offen offset:1024 sc1
    v_cvt_pk_bf16_f32 v88, v176, v177
    v_cvt_pk_bf16_f32 v89, v178, v179
    v_cvt_pk_bf16_f32 v90, v180, v181
    v_cvt_pk_bf16_f32 v91, v182, v183
    buffer_store_dwordx4 v[88:91], v34, s[20:23], s37 offen offset:2048 sc1
    v_cvt_pk_bf16_f32 v92, v184, v185
    v_cvt_pk_bf16_f32 v93, v186, v187
    v_cvt_pk_bf16_f32 v94, v188, v189
    v_cvt_pk_bf16_f32 v95, v190, v191
    buffer_store_dwordx4 v[92:95], v34, s[20:23], s37 offen offset:3072 sc1
    v_cvt_pk_bf16_f32 v64, v192, v193
    v_cvt_pk_bf16_f32 v65, v194, v195
    v_cvt_pk_bf16_f32 v66, v196, v197
    v_cvt_pk_bf16_f32 v67, v198, v199
    s_add_u32 s37, s37, 4096
    buffer_store_dwordx4 v[64:67], v34, s[20:23], s37 offen offset:0 sc1
    v_cvt_pk_bf16_f32 v68, v200, v201
    v_cvt_pk_bf16_f32 v69, v202, v203
    v_cvt_pk_bf16_f32 v70, v204, v205
    v_cvt_pk_bf16_f32 v71, v206, v207
    buffer_store_dwordx4 v[68:71], v34, s[20:23], s37 offen offset:1024 sc1
    v_cvt_pk_bf16_f32 v72, v208, v209
    v_cvt_pk_bf16_f32 v73, v210, v211
    v_cvt_pk_bf16_f32 v74, v212, v213
    v_cvt_pk_bf16_f32 v75, v214, v215
    buffer_store_dwordx4 v[72:75], v34, s[20:23], s37 offen offset:2048 sc1
    v_cvt_pk_bf16_f32 v76, v216, v217
    v_cvt_pk_bf16_f32 v77, v218, v219
    v_cvt_pk_bf16_f32 v78, v220, v221
    v_cvt_pk_bf16_f32 v79, v222, v223
    buffer_store_dwordx4 v[76:79], v34, s[20:23], s37 offen offset:3072 sc1
    v_cvt_pk_bf16_f32 v80, v224, v225
    v_cvt_pk_bf16_f32 v81, v226, v227
    v_cvt_pk_bf16_f32 v82, v228, v229
    v_cvt_pk_bf16_f32 v83, v230, v231
    s_add_u32 s37, s37, 4096
    buffer_store_dwordx4 v[80:83], v34, s[20:23], s37 offen offset:0 sc1
    v_cvt_pk_bf16_f32 v84, v232, v233
    v_cvt_pk_bf16_f32 v85, v234, v235
    v_cvt_pk_bf16_f32 v86, v236, v237
    v_cvt_pk_bf16_f32 v87, v238, v239
    buffer_store_dwordx4 v[84:87], v34, s[20:23], s37 offen offset:1024 sc1
    v_cvt_pk_bf16_f32 v88, v240, v241
    v_cvt_pk_bf16_f32 v89, v242, v243
    v_cvt_pk_bf16_f32 v90, v244, v245
    v_cvt_pk_bf16_f32 v91, v246, v247
    buffer_store_dwordx4 v[88:91], v34, s[20:23], s37 offen offset:2048 sc1
    v_cvt_pk_bf16_f32 v92, v248, v249
    v_cvt_pk_bf16_f32 v93, v250, v251
    v_cvt_pk_bf16_f32 v94, v252, v253
    v_cvt_pk_bf16_f32 v95, v254, v255
    buffer_store_dwordx4 v[92:95], v34, s[20:23], s37 offen offset:3072 sc1
    s_mov_b32 s34, 0
    s_mov_b32 s33, s59
    s_mov_b32 s69, 1
    s_waitcnt vmcnt(25)
    s_barrier
    s_branch L_y1_entry
L_xl1:
    s_waitcnt lgkmcnt(2)
    v_mfma_f32_32x32x16_bf16 v[64:79], a[128:131], a[64:67], 0
    ds_read_b128 a[144:147], v12 offset:4096
    v_max3_f32 v30, v96, v97, v98
    v_max3_f32 v31, v99, v100, v101
    v_max3_f32 v30, v30, v102, v103
    v_mfma_f32_32x32x16_bf16 v[64:79], a[132:135], a[68:71], v[64:79]
    ds_read_b128 a[148:151], v12 offset:5120
    v_max3_f32 v31, v31, v104, v105
    v_max3_f32 v30, v30, v106, v107
    v_max3_f32 v31, v31, v108, v109
    s_waitcnt lgkmcnt(2)
    v_mfma_f32_32x32x16_bf16 v[64:79], a[136:139], a[72:75], v[64:79]
    ds_read_b128 a[152:155], v12 offset:6144
    v_max3_f32 v30, v30, v110, v111
    v_max3_f32 v31, v31, v112, v113
    v_max3_f32 v30, v30, v114, v115
    s_add_u32 m0, s56, 98304
    s_add_u32 s68, s36, 0
    buffer_load_dwordx4 v2, s[12:15], s68 offen offset:0 lds
    v_mfma_f32_32x32x16_bf16 v[64:79], a[140:143], a[76:79], v[64:79]
    ds_read_b128 a[156:159], v12 offset:7168
    v_max3_f32 v31, v31, v116, v117
    v_max3_f32 v30, v30, v118, v119
    v_max3_f32 v31, v31, v120, v121
    s_waitcnt lgkmcnt(2)
    v_mfma_f32_32x32x16_bf16 v[64:79], a[144:147], a[80:83], v[64:79]
    ds_read_b128 a[128:131], v12 offset:8192
    v_max3_f32 v30, v30, v122, v123
    v_max3_f32 v31, v31, v124, v125
    v_max3_f32 v30, v30, v126, v127
    v_mfma_f32_32x32x16_bf16 v[64:79], a[148:151], a[84:87], v[64:79]
    ds_read_b128 a[132:135], v12 offset:9216
    v_max_f32 v30, v30, v31
    v_mov_b32 v31, v30
    s_nop 1
    v_permlane32_swap_b32 v30, v31
    v_max_f32 v30, v30, v31
    v_fma_f32 v31, v30, s43, -v24
    v_cmp_lt_f32 vcc, s44, v31
    s_cbranch_vccnz L_resc_a_70
    L_resc_ret_a_70:
    buffer_load_dwordx4 v2, s[12:15], s68 offen offset:1024 lds
    s_waitcnt lgkmcnt(2)
    v_mfma_f32_32x32x16_bf16 v[64:79], a[152:155], a[88:91], v[64:79]
    ds_read_b128 a[136:139], v12 offset:10240
    v_fma_f32 v96, v96, s43, -v24
    v_fma_f32 v97, v97, s43, -v24
    v_exp_f32 v96, v96
    v_mfma_f32_32x32x16_bf16 v[64:79], a[156:159], a[92:95], v[64:79]
    ds_read_b128 a[140:143], v12 offset:11264
    v_fma_f32 v98, v98, s43, -v24
    v_exp_f32 v97, v97
    s_waitcnt lgkmcnt(2)
    v_mfma_f32_32x32x16_bf16 v[64:79], a[128:131], a[96:99], v[64:79]
    ds_read_b128 a[144:147], v12 offset:12288
    v_fma_f32 v99, v99, s43, -v24
    v_exp_f32 v98, v98
    buffer_load_dwordx4 v2, s[12:15], s68 offen offset:2048 lds
    v_mfma_f32_32x32x16_bf16 v[64:79], a[132:135], a[100:103], v[64:79]
    ds_read_b128 a[148:151], v12 offset:13312
    v_add_f32 v25, v25, v96
    v_fma_f32 v100, v100, s43, -v24
    v_exp_f32 v99, v99
    s_waitcnt lgkmcnt(2)
    v_mfma_f32_32x32x16_bf16 v[64:79], a[136:139], a[104:107], v[64:79]
    ds_read_b128 a[152:155], v12 offset:14336
    v_add_f32 v26, v26, v97
    v_cvt_pk_bf16_f32 v48, v96, v97
    v_mfma_f32_32x32x16_bf16 v[64:79], a[140:143], a[108:111], v[64:79]
    ds_read_b128 a[156:159], v12 offset:15360
    v_fma_f32 v101, v101, s43, -v24
    v_exp_f32 v100, v100
    buffer_load_dwordx4 v2, s[12:15], s68 offen offset:3072 lds
    s_waitcnt lgkmcnt(2)
    v_mfma_f32_32x32x16_bf16 v[64:79], a[144:147], a[112:115], v[64:79]
    ds_read_b128 a[128:131], v12 offset:16384
    v_add_f32 v27, v27, v98
    v_fma_f32 v102, v102, s43, -v24
    v_exp_f32 v101, v101
    v_mfma_f32_32x32x16_bf16 v[64:79], a[148:151], a[116:119], v[64:79]
    ds_read_b128 a[132:135], v12 offset:17408
    v_add_f32 v28, v28, v99
    v_cvt_pk_bf16_f32 v49, v98, v99
    s_waitcnt lgkmcnt(2)
    v_mfma_f32_32x32x16_bf16 v[64:79], a[152:155], a[120:123], v[64:79]
    ds_read_b128 a[136:139], v12 offset:18432
    v_fma_f32 v103, v103, s43, -v24
    v_exp_f32 v102, v102
    s_add_u32 m0, s56, 102400
    s_add_u32 s68, s36, 4096
    buffer_load_dwordx4 v2, s[12:15], s68 offen offset:0 lds
    v_mfma_f32_32x32x16_bf16 v[64:79], a[156:159], a[124:127], v[64:79]
    ds_read_b128 a[140:143], v12 offset:19456
    v_add_f32 v25, v25, v100
    v_fma_f32 v104, v104, s43, -v24
    v_exp_f32 v103, v103
    s_waitcnt lgkmcnt(2)
    v_mfma_f32_32x32x16_bf16 v[80:95], a[128:131], a[64:67], 0
    ds_read_b128 a[144:147], v12 offset:20480
    v_add_f32 v26, v26, v101
    v_cvt_pk_bf16_f32 v50, v100, v101
    v_mfma_f32_32x32x16_bf16 v[80:95], a[132:135], a[68:71], v[80:95]
    ds_read_b128 a[148:151], v12 offset:21504
    v_fma_f32 v105, v105, s43, -v24
    v_exp_f32 v104, v104
    buffer_load_dwordx4 v2, s[12:15], s68 offen offset:1024 lds
    s_waitcnt lgkmcnt(2)
    v_mfma_f32_32x32x16_bf16 v[80:95], a[136:139], a[72:75], v[80:95]
    ds_read_b128 a[152:155], v12 offset:22528
    v_add_f32 v27, v27, v102
    v_fma_f32 v106, v106, s43, -v24
    v_exp_f32 v105, v105
    v_mfma_f32_32x32x16_bf16 v[80:95], a[140:143], a[76:79], v[80:95]
    ds_read_b128 a[156:159], v12 offset:23552
    v_add_f32 v28, v28, v103
    v_cvt_pk_bf16_f32 v51, v102, v103
    s_waitcnt lgkmcnt(2)
    v_mfma_f32_32x32x16_bf16 v[80:95], a[144:147], a[80:83], v[80:95]
    ds_read_b128 a[128:131], v12 offset:24576
    v_fma_f32 v107, v107, s43, -v24
    v_exp_f32 v106, v106
    buffer_load_dwordx4 v2, s[12:15], s68 offen offset:2048 lds
    v_mfma_f32_32x32x16_bf16 v[80:95], a[148:151], a[84:87], v[80:95]
    ds_read_b128 a[132:135], v12 offset:25600
    v_add_f32 v25, v25, v104
    v_fma_f32 v108, v108, s43, -v24
    v_exp_f32 v107, v107
    s_waitcnt lgkmcnt(2)
    v_mfma_f32_32x32x16_bf16 v[80:95], a[152:155], a[88:91], v[80:95]
    ds_read_b128 a[136:139], v12 offset:26624
    v_add_f32 v26, v26, v105
    v_cvt_pk_bf16_f32 v52, v104, v105
    v_mfma_f32_32x32x16_bf16 v[80:95], a[156:159], a[92:95], v[80:95]
    ds_read_b128 a[140:143], v12 offset:27648
    v_fma_f32 v109, v109, s43, -v24
    v_exp_f32 v108, v108
    buffer_load_dwordx4 v2, s[12:15], s68 offen offset:3072 lds
    s_waitcnt lgkmcnt(2)
    v_mfma_f32_32x32x16_bf16 v[80:95], a[128:131], a[96:99], v[80:95]
    ds_read_b128 a[144:147], v12 offset:28672
    v_add_f32 v27, v27, v106
    v_fma_f32 v110, v110, s43, -v24
    v_exp_f32 v109, v109
    v_mfma_f32_32x32x16_bf16 v[80:95], a[132:135], a[100:103], v[80:95]
    ds_read_b128 a[148:151], v12 offset:29696
    v_add_f32 v28, v28, v107
    v_cvt_pk_bf16_f32 v53, v106, v107
    s_waitcnt lgkmcnt(2)
    v_mfma_f32_32x32x16_bf16 v[80:95], a[136:139], a[104:107], v[80:95]
    ds_read_b128 a[152:155], v12 offset:30720
    v_fma_f32 v111, v111, s43, -v24
    v_exp_f32 v110, v110
    s_add_u32 s36, s36, 32768
    s_sub_u32 s50, s50, 1
    s_cmp_eq_u32 s50, 0
    s_cselect_b32 s36, s48, s36
    s_sub_u32 s52, s52, 1
    s_cmp_eq_u32 s52, 0
    s_cselect_b32 s36, 0x80000000, s36
    s_cselect_b32 s48, 0x80000000, s48
    v_mfma_f32_32x32x16_bf16 v[80:95], a[140:143], a[108:111], v[80:95]
    ds_read_b128 a[156:159], v12 offset:31744
    v_add_f32 v25, v25, v108
    v_fma_f32 v112, v112, s43, -v24
    v_exp_f32 v111, v111
    s_waitcnt lgkmcnt(2)
    v_mfma_f32_32x32x16_bf16 v[80:95], a[144:147], a[112:115], v[80:95]
    ds_read_b128 a[128:131], v20 offset:32768
    v_add_f32 v26, v26, v109
    v_cvt_pk_bf16_f32 v54, v108, v109
    v_mfma_f32_32x32x16_bf16 v[80:95], a[148:151], a[116:119], v[80:95]
    ds_read_b128 a[132:135], v20 offset:36864
    v_fma_f32 v113, v113, s43, -v24
    v_exp_f32 v112, v112
    s_waitcnt lgkmcnt(2)
    v_mfma_f32_32x32x16_bf16 v[80:95], a[152:155], a[120:123], v[80:95]
    ds_read_b128 a[136:139], v20 offset:40960
    v_add_f32 v27, v27, v110
    v_fma_f32 v114, v114, s43, -v24
    v_exp_f32 v113, v113
    v_mfma_f32_32x32x16_bf16 v[80:95], a[156:159], a[124:127], v[80:95]
    ds_read_b128 a[140:143], v20 offset:45056
    v_add_f32 v28, v28, v111
    v_cvt_pk_bf16_f32 v55, v110, v111
    s_waitcnt lgkmcnt(2)
    v_mfma_f32_32x32x16_bf16 v[128:143], a[128:131], v[48:51], v[128:143]
    ds_read_b128 a[144:147], v20 offset:49152
    v_fma_f32 v115, v115, s43, -v24
    v_exp_f32 v114, v114
    v_mfma_f32_32x32x16_bf16 v[144:159], a[132:135], v[48:51], v[144:159]
    ds_read_b128 a[148:151], v20 offset:53248
    v_add_f32 v25, v25, v112
    v_fma_f32 v116, v116, s43, -v24
    v_exp_f32 v115, v115
    s_waitcnt lgkmcnt(2)
    v_mfma_f32_32x32x16_bf16 v[160:175], a[136:139], v[48:51], v[160:175]
    ds_read_b128 a[152:155], v20 offset:57344
    v_add_f32 v26, v26, v113
    v_cvt_pk_bf16_f32 v56, v112, v113
    v_mfma_f32_32x32x16_bf16 v[176:191], a[140:143], v[48:51], v[176:191]
    ds_read_b128 a[156:159], v20 offset:61440
    v_fma_f32 v117, v117, s43, -v24
    v_exp_f32 v116, v116
    s_waitcnt lgkmcnt(2)
    v_mfma_f32_32x32x16_bf16 v[192:207], a[144:147], v[48:51], v[192:207]
    ds_read_b128 a[128:131], v20 offset:33792
    v_add_f32 v27, v27, v114
    v_fma_f32 v118, v118, s43, -v24
    v_exp_f32 v117, v117
    s_add_u32 m0, s38, 0
    s_add_u32 s68, s35, 0
    buffer_load_dwordx4 v2, s[8:11], s68 offen offset:0 lds
    v_mfma_f32_32x32x16_bf16 v[208:223], a[148:151], v[48:51], v[208:223]
    ds_read_b128 a[132:135], v20 offset:37888
    v_add_f32 v28, v28, v115
    v_cvt_pk_bf16_f32 v57, v114, v115
    s_waitcnt lgkmcnt(2)
    v_mfma_f32_32x32x16_bf16 v[224:239], a[152:155], v[48:51], v[224:239]
    ds_read_b128 a[136:139], v20 offset:41984
    v_fma_f32 v119, v119, s43, -v24
    v_exp_f32 v118, v118
    buffer_load_dwordx4 v2, s[8:11], s68 offen offset:1024 lds
    v_mfma_f32_32x32x16_bf16 v[240:255], a[156:159], v[48:51], v[240:255]
    ds_read_b128 a[140:143], v20 offset:46080
    v_add_f32 v25, v25, v116
    v_fma_f32 v120, v120, s43, -v24
    v_exp_f32 v119, v119
    s_waitcnt lgkmcnt(2)
    v_mfma_f32_32x32x16_bf16 v[128:143], a[128:131], v[52:55], v[128:143]
    ds_read_b128 a[144:147], v20 offset:50176
    v_add_f32 v26, v26, v117
    v_cvt_pk_bf16_f32 v58, v116, v117
    v_mfma_f32_32x32x16_bf16 v[144:159], a[132:135], v[52:55], v[144:159]
    ds_read_b128 a[148:151], v20 offset:54272
    v_fma_f32 v121, v121, s43, -v24
    v_exp_f32 v120, v120
    buffer_load_dwordx4 v2, s[8:11], s68 offen offset:2048 lds
    s_waitcnt lgkmcnt(2)
    v_mfma_f32_32x32x16_bf16 v[160:175], a[136:139], v[52:55], v[160:175]
    ds_read_b128 a[152:155], v20 offset:58368
    v_add_f32 v27, v27, v118
    v_fma_f32 v122, v122, s43, -v24
    v_exp_f32 v121, v121
    v_mfma_f32_32x32x16_bf16 v[176:191], a[140:143], v[52:55], v[176:191]
    ds_read_b128 a[156:159], v20 offset:62464
    v_add_f32 v28, v28, v119
    v_cvt_pk_bf16_f32 v59, v118, v119
    buffer_load_dwordx4 v2, s[8:11], s68 offen offset:3072 lds
    s_waitcnt lgkmcnt(2)
    v_mfma_f32_32x32x16_bf16 v[192:207], a[144:147], v[52:55], v[192:207]
    ds_read_b128 a[128:131], v20 offset:34816
    v_fma_f32 v123, v123, s43, -v24
    v_exp_f32 v122, v122
    v_mfma_f32_32x32x16_bf16 v[208:223], a[148:151], v[52:55], v[208:223]
    ds_read_b128 a[132:135], v20 offset:38912
    v_add_f32 v25, v25, v120
    v_fma_f32 v124, v124, s43, -v24
    v_exp_f32 v123, v123
    s_waitcnt lgkmcnt(2)
    v_mfma_f32_32x32x16_bf16 v[224:239], a[152:155], v[52:55], v[224:239]
    ds_read_b128 a[136:139], v20 offset:43008
    v_add_f32 v26, v26, v121
    v_cvt_pk_bf16_f32 v60, v120, v121
    s_add_u32 m0, s38, 4096
    s_add_u32 s68, s35, 4096
    buffer_load_dwordx4 v2, s[8:11], s68 offen offset:0 lds
    v_mfma_f32_32x32x16_bf16 v[240:255], a[156:159], v[52:55], v[240:255]
    ds_read_b128 a[140:143], v20 offset:47104
    v_fma_f32 v125, v125, s43, -v24
    v_exp_f32 v124, v124
    s_waitcnt lgkmcnt(2)
    v_mfma_f32_32x32x16_bf16 v[128:143], a[128:131], v[56:59], v[128:143]
    ds_read_b128 a[144:147], v20 offset:51200
    v_add_f32 v27, v27, v122
    v_fma_f32 v126, v126, s43, -v24
    v_exp_f32 v125, v125
    v_mfma_f32_32x32x16_bf16 v[144:159], a[132:135], v[56:59], v[144:159]
    ds_read_b128 a[148:151], v20 offset:55296
    v_add_f32 v28, v28, v123
    v_cvt_pk_bf16_f32 v61, v122, v123
    buffer_load_dwordx4 v2, s[8:11], s68 offen offset:1024 lds
    s_waitcnt lgkmcnt(2)
    v_mfma_f32_32x32x16_bf16 v[160:175], a[136:139], v[56:59], v[160:175]
    ds_read_b128 a[152:155], v20 offset:59392
    v_fma_f32 v127, v127, s43, -v24
    v_exp_f32 v126, v126
    s_add_u32 s54, s54, 1
    s_mov_b32 s55, 32768
    s_cmp_eq_u32 s54, 3
    s_cselect_b32 s55, 0xffff0000, s55
    s_cselect_b32 s54, 0, s54
    v_mfma_f32_32x32x16_bf16 v[176:191], a[140:143], v[56:59], v[176:191]
    ds_read_b128 a[156:159], v20 offset:63488
    v_add_f32 v25, v25, v124
    v_exp_f32 v127, v127
    v_add_f32 v26, v26, v125
    buffer_load_dwordx4 v2, s[8:11], s68 offen offset:2048 lds
    s_waitcnt lgkmcnt(2)
    v_mfma_f32_32x32x16_bf16 v[192:207], a[144:147], v[56:59], v[192:207]
    ds_read_b128 a[128:131], v20 offset:35840
    v_add_f32 v27, v27, v126
    v_add_f32 v28, v28, v127
    v_mfma_f32_32x32x16_bf16 v[208:223], a[148:151], v[56:59], v[208:223]
    ds_read_b128 a[132:135], v20 offset:39936
    v_cvt_pk_bf16_f32 v62, v124, v125
    v_cvt_pk_bf16_f32 v63, v126, v127
    v_add_u32 v12, s55, v12
    s_waitcnt lgkmcnt(2)
    v_mfma_f32_32x32x16_bf16 v[224:239], a[152:155], v[56:59], v[224:239]
    ds_read_b128 a[136:139], v20 offset:44032
    buffer_load_dwordx4 v2, s[8:11], s68 offen offset:3072 lds
    v_mfma_f32_32x32x16_bf16 v[240:255], a[156:159], v[56:59], v[240:255]
    ds_read_b128 a[140:143], v20 offset:48128
    s_waitcnt lgkmcnt(2)
    v_mfma_f32_32x32x16_bf16 v[128:143], a[128:131], v[60:63], v[128:143]
    ds_read_b128 a[144:147], v20 offset:52224
    s_add_u32 s35, s35, 32768
    s_sub_u32 s49, s49, 1
    s_cmp_eq_u32 s49, 0
    s_cselect_b32 s35, s47, s35
    s_sub_u32 s51, s51, 1
    s_cmp_eq_u32 s51, 0
    s_cselect_b32 s35, 0x80000000, s35
    s_cselect_b32 s47, 0x80000000, s47
    v_mfma_f32_32x32x16_bf16 v[144:159], a[132:135], v[60:63], v[144:159]
    ds_read_b128 a[148:151], v20 offset:56320
    s_waitcnt lgkmcnt(2)
    v_mfma_f32_32x32x16_bf16 v[160:175], a[136:139], v[60:63], v[160:175]
    ds_read_b128 a[152:155], v20 offset:60416
    v_mfma_f32_32x32x16_bf16 v[176:191], a[140:143], v[60:63], v[176:191]
    ds_read_b128 a[156:159], v20 offset:64512
    s_add_u32 s38, s38, 32768
    s_cmp_ge_u32 s38, 98304
    s_cselect_b32 s68, 98304, 0
    s_sub_u32 s38, s38, s68
    s_waitcnt lgkmcnt(2)
    v_mfma_f32_32x32x16_bf16 v[192:207], a[144:147], v[60:63], v[192:207]
    ds_read_b128 a[128:131], v12 offset:0
    v_mfma_f32_32x32x16_bf16 v[208:223], a[148:151], v[60:63], v[208:223]
    ds_read_b128 a[132:135], v12 offset:1024
    s_waitcnt lgkmcnt(2)
    v_mfma_f32_32x32x16_bf16 v[224:239], a[152:155], v[60:63], v[224:239]
    ds_read_b128 a[136:139], v12 offset:2048
    v_mfma_f32_32x32x16_bf16 v[240:255], a[156:159], v[60:63], v[240:255]
    ds_read_b128 a[140:143], v12 offset:3072
    s_mul_i32 s37, s42, 69632
    s_mul_i32 s45, s32, 17408
    s_add_u32 s37, s37, s45
    v_lshlrev_b32 v34, 4, v1
    v_add_f32 v31, v25, v26
    v_add_f32 v32, v27, v28
    v_mov_b32 v30, v24
    v_add_f32 v31, v31, v32
    s_add_u32 s45, s37, 16384
    buffer_store_dwordx2 v[30:31], v34, s[20:23], s45 offen sc1
    v_mov_b32 v24, s46
    v_mov_b32 v25, 0
    v_mov_b32 v26, 0
    v_mov_b32 v27, 0
    v_mov_b32 v28, 0
    s_nop 4
    v_cvt_pk_bf16_f32 v96, v128, v129
    v_cvt_pk_bf16_f32 v97, v130, v131
    v_cvt_pk_bf16_f32 v98, v132, v133
    v_cvt_pk_bf16_f32 v99, v134, v135
    buffer_store_dwordx4 v[96:99], v34, s[20:23], s37 offen offset:0 sc1
    v_cvt_pk_bf16_f32 v100, v136, v137
    v_cvt_pk_bf16_f32 v101, v138, v139
    v_cvt_pk_bf16_f32 v102, v140, v141
    v_cvt_pk_bf16_f32 v103, v142, v143
    buffer_store_dwordx4 v[100:103], v34, s[20:23], s37 offen offset:1024 sc1
    v_cvt_pk_bf16_f32 v104, v144, v145
    v_cvt_pk_bf16_f32 v105, v146, v147
    v_cvt_pk_bf16_f32 v106, v148, v149
    v_cvt_pk_bf16_f32 v107, v150, v151
    buffer_store_dwordx4 v[104:107], v34, s[20:23], s37 offen offset:2048 sc1
    v_cvt_pk_bf16_f32 v108, v152, v153
    v_cvt_pk_bf16_f32 v109, v154, v155
    v_cvt_pk_bf16_f32 v110, v156, v157
    v_cvt_pk_bf16_f32 v111, v158, v159
    buffer_store_dwordx4 v[108:111], v34, s[20:23], s37 offen offset:3072 sc1
    v_cvt_pk_bf16_f32 v112, v160, v161
    v_cvt_pk_bf16_f32 v113, v162, v163
    v_cvt_pk_bf16_f32 v114, v164, v165
    v_cvt_pk_bf16_f32 v115, v166, v167
    s_add_u32 s37, s37, 4096
    buffer_store_dwordx4 v[112:115], v34, s[20:23], s37 offen offset:0 sc1
    v_cvt_pk_bf16_f32 v116, v168, v169
    v_cvt_pk_bf16_f32 v117, v170, v171
    v_cvt_pk_bf16_f32 v118, v172, v173
    v_cvt_pk_bf16_f32 v119, v174, v175
    buffer_store_dwordx4 v[116:119], v34, s[20:23], s37 offen offset:1024 sc1
    v_cvt_pk_bf16_f32 v120, v176, v177
    v_cvt_pk_bf16_f32 v121, v178, v179
    v_cvt_pk_bf16_f32 v122, v180, v181
    v_cvt_pk_bf16_f32 v123, v182, v183
    buffer_store_dwordx4 v[120:123], v34, s[20:23], s37 offen offset:2048 sc1
    v_cvt_pk_bf16_f32 v124, v184, v185
    v_cvt_pk_bf16_f32 v125, v186, v187
    v_cvt_pk_bf16_f32 v126, v188, v189
    v_cvt_pk_bf16_f32 v127, v190, v191
    buffer_store_dwordx4 v[124:127], v34, s[20:23], s37 offen offset:3072 sc1
    v_cvt_pk_bf16_f32 v96, v192, v193
    v_cvt_pk_bf16_f32 v97, v194, v195
    v_cvt_pk_bf16_f32 v98, v196, v197
    v_cvt_pk_bf16_f32 v99, v198, v199
    s_add_u32 s37, s37, 4096
    buffer_store_dwordx4 v[96:99], v34, s[20:23], s37 offen offset:0 sc1
    v_cvt_pk_bf16_f32 v100, v200, v201
    v_cvt_pk_bf16_f32 v101, v202, v203
    v_cvt_pk_bf16_f32 v102, v204, v205
    v_cvt_pk_bf16_f32 v103, v206, v207
    buffer_store_dwordx4 v[100:103], v34, s[20:23], s37 offen offset:1024 sc1
    v_cvt_pk_bf16_f32 v104, v208, v209
    v_cvt_pk_bf16_f32 v105, v210, v211
    v_cvt_pk_bf16_f32 v106, v212, v213
    v_cvt_pk_bf16_f32 v107, v214, v215
    buffer_store_dwordx4 v[104:107], v34, s[20:23], s37 offen offset:2048 sc1
    v_cvt_pk_bf16_f32 v108, v216, v217
    v_cvt_pk_bf16_f32 v109, v218, v219
    v_cvt_pk_bf16_f32 v110, v220, v221
    v_cvt_pk_bf16_f32 v111, v222, v223
    buffer_store_dwordx4 v[108:111], v34, s[20:23], s37 offen offset:3072 sc1
    v_cvt_pk_bf16_f32 v112, v224, v225
    v_cvt_pk_bf16_f32 v113, v226, v227
    v_cvt_pk_bf16_f32 v114, v228, v229
    v_cvt_pk_bf16_f32 v115, v230, v231
    s_add_u32 s37, s37, 4096
    buffer_store_dwordx4 v[112:115], v34, s[20:23], s37 offen offset:0 sc1
    v_cvt_pk_bf16_f32 v116, v232, v233
    v_cvt_pk_bf16_f32 v117, v234, v235
    v_cvt_pk_bf16_f32 v118, v236, v237
    v_cvt_pk_bf16_f32 v119, v238, v239
    buffer_store_dwordx4 v[116:119], v34, s[20:23], s37 offen offset:1024 sc1
    v_cvt_pk_bf16_f32 v120, v240, v241
    v_cvt_pk_bf16_f32 v121, v242, v243
    v_cvt_pk_bf16_f32 v122, v244, v245
    v_cvt_pk_bf16_f32 v123, v246, v247
    buffer_store_dwordx4 v[120:123], v34, s[20:23], s37 offen offset:2048 sc1
    v_cvt_pk_bf16_f32 v124, v248, v249
    v_cvt_pk_bf16_f32 v125, v250, v251
    v_cvt_pk_bf16_f32 v126, v252, v253
    v_cvt_pk_bf16_f32 v127, v254, v255
    buffer_store_dwordx4 v[124:127], v34, s[20:23], s37 offen offset:3072 sc1
    s_mov_b32 s34, 0
    s_mov_b32 s33, s59
    s_mov_b32 s69, 1
    s_waitcnt vmcnt(25)
    s_barrier
    s_branch L_y0_entry
L_y0:
    s_waitcnt vmcnt(8)
    s_barrier
L_y0_entry:
    s_add_u32 s34, s34, 1
    s_cmp_ge_u32 s34, s33
    s_cbranch_scc1 L_yl0
    s_add_u32 s45, s34, 1
    s_cmp_ge_u32 s45, s33
    s_cbranch_scc1 L_ym0
    s_waitcnt lgkmcnt(2)
    v_mfma_f32_32x32x16_bf16 v[96:111], a[128:131], a[64:67], 0
    ds_read_b128 a[144:147], v12 offset:4096
    v_max3_f32 v30, v64, v65, v66
    v_max3_f32 v31, v67, v68, v69
    v_max3_f32 v30, v30, v70, v71
    v_mfma_f32_32x32x16_bf16 v[96:111], a[132:135], a[68:71], v[96:111]
    ds_read_b128 a[148:151], v12 offset:5120
    v_max3_f32 v31, v31, v72, v73
    v_max3_f32 v30, v30, v74, v75
    v_max3_f32 v31, v31, v76, v77
    s_waitcnt lgkmcnt(2)
    v_mfma_f32_32x32x16_bf16 v[96:111], a[136:139], a[72:75], v[96:111]
    ds_read_b128 a[152:155], v12 offset:6144
    v_max3_f32 v30, v30, v78, v79
    v_max3_f32 v31, v31, v80, v81
    v_max3_f32 v30, v30, v82, v83
    s_add_u32 m0, s56, 131072
    s_add_u32 s68, s36, 0
    buffer_load_dwordx4 v2, s[12:15], s68 offen offset:0 lds
    v_mfma_f32_32x32x16_bf16 v[96:111], a[140:143], a[76:79], v[96:111]
    ds_read_b128 a[156:159], v12 offset:7168
    v_max3_f32 v31, v31, v84, v85
    v_max3_f32 v30, v30, v86, v87
    v_max3_f32 v31, v31, v88, v89
    s_waitcnt lgkmcnt(2)
    v_mfma_f32_32x32x16_bf16 v[96:111], a[144:147], a[80:83], v[96:111]
    ds_read_b128 a[128:131], v12 offset:8192
    v_max3_f32 v30, v30, v90, v91
    v_max3_f32 v31, v31, v92, v93
    v_max3_f32 v30, v30, v94, v95
    v_mfma_f32_32x32x16_bf16 v[96:111], a[148:151], a[84:87], v[96:111]
    ds_read_b128 a[132:135], v12 offset:9216
    v_max_f32 v30, v30, v31
    v_mov_b32 v31, v30
    s_nop 1
    v_permlane32_swap_b32 v30, v31
    v_max_f32 v30, v30, v31
    v_fma_f32 v31, v30, s43, -v24
    v_cmp_lt_f32 vcc, s44, v31
    s_cbranch_vccnz L_resc_a_71
    L_resc_ret_a_71:
    buffer_load_dwordx4 v2, s[12:15], s68 offen offset:1024 lds
    s_waitcnt lgkmcnt(2)
    v_mfma_f32_32x32x16_bf16 v[96:111], a[152:155], a[88:91], v[96:111]
    ds_read_b128 a[136:139], v12 offset:10240
    v_fma_f32 v64, v64, s43, -v24
    v_fma_f32 v65, v65, s43, -v24
    v_exp_f32 v64, v64
    v_mfma_f32_32x32x16_bf16 v[96:111], a[156:159], a[92:95], v[96:111]
    ds_read_b128 a[140:143], v12 offset:11264
    v_fma_f32 v66, v66, s43, -v24
    v_exp_f32 v65, v65
    s_waitcnt lgkmcnt(2)
    v_mfma_f32_32x32x16_bf16 v[96:111], a[128:131], a[96:99], v[96:111]
    ds_read_b128 a[144:147], v12 offset:12288
    v_fma_f32 v67, v67, s43, -v24
    v_exp_f32 v66, v66
    buffer_load_dwordx4 v2, s[12:15], s68 offen offset:2048 lds
    v_mfma_f32_32x32x16_bf16 v[96:111], a[132:135], a[100:103], v[96:111]
    ds_read_b128 a[148:151], v12 offset:13312
    v_add_f32 v25, v25, v64
    v_fma_f32 v68, v68, s43, -v24
    v_exp_f32 v67, v67
    s_waitcnt lgkmcnt(2)
    v_mfma_f32_32x32x16_bf16 v[96:111], a[136:139], a[104:107], v[96:111]
    ds_read_b128 a[152:155], v12 offset:14336
    v_add_f32 v26, v26, v65
    v_cvt_pk_bf16_f32 v48, v64, v65
    v_mfma_f32_32x32x16_bf16 v[96:111], a[140:143], a[108:111], v[96:111]
    ds_read_b128 a[156:159], v12 offset:15360
    v_fma_f32 v69, v69, s43, -v24
    v_exp_f32 v68, v68
    buffer_load_dwordx4 v2, s[12:15], s68 offen offset:3072 lds
    s_waitcnt lgkmcnt(2)
    v_mfma_f32_32x32x16_bf16 v[96:111], a[144:147], a[112:115], v[96:111]
    ds_read_b128 a[128:131], v12 offset:16384
    v_add_f32 v27, v27, v66
    v_fma_f32 v70, v70, s43, -v24
    v_exp_f32 v69, v69
    v_mfma_f32_32x32x16_bf16 v[96:111], a[148:151], a[116:119], v[96:111]
    ds_read_b128 a[132:135], v12 offset:17408
    v_add_f32 v28, v28, v67
    v_cvt_pk_bf16_f32 v49, v66, v67
    s_waitcnt lgkmcnt(2)
    v_mfma_f32_32x32x16_bf16 v[96:111], a[152:155], a[120:123], v[96:111]
    ds_read_b128 a[136:139], v12 offset:18432
    v_fma_f32 v71, v71, s43, -v24
    v_exp_f32 v70, v70
    s_add_u32 m0, s56, 135168
    s_add_u32 s68, s36, 4096
    buffer_load_dwordx4 v2, s[12:15], s68 offen offset:0 lds
    v_mfma_f32_32x32x16_bf16 v[96:111], a[156:159], a[124:127], v[96:111]
    ds_read_b128 a[140:143], v12 offset:19456
    v_add_f32 v25, v25, v68
    v_fma_f32 v72, v72, s43, -v24
    v_exp_f32 v71, v71
    s_waitcnt lgkmcnt(2)
    v_mfma_f32_32x32x16_bf16 v[112:127], a[128:131], a[64:67], 0
    ds_read_b128 a[144:147], v12 offset:20480
    v_add_f32 v26, v26, v69
    v_cvt_pk_bf16_f32 v50, v68, v69
    v_mfma_f32_32x32x16_bf16 v[112:127], a[132:135], a[68:71], v[112:127]
    ds_read_b128 a[148:151], v12 offset:21504
    v_fma_f32 v73, v73, s43, -v24
    v_exp_f32 v72, v72
    buffer_load_dwordx4 v2, s[12:15], s68 offen offset:1024 lds
    s_waitcnt lgkmcnt(2)
    v_mfma_f32_32x32x16_bf16 v[112:127], a[136:139], a[72:75], v[112:127]
    ds_read_b128 a[152:155], v12 offset:22528
    v_add_f32 v27, v27, v70
    v_fma_f32 v74, v74, s43, -v24
    v_exp_f32 v73, v73
    v_mfma_f32_32x32x16_bf16 v[112:127], a[140:143], a[76:79], v[112:127]
    ds_read_b128 a[156:159], v12 offset:23552
    v_add_f32 v28, v28, v71
    v_cvt_pk_bf16_f32 v51, v70, v71
    s_waitcnt lgkmcnt(2)
    v_mfma_f32_32x32x16_bf16 v[112:127], a[144:147], a[80:83], v[112:127]
    ds_read_b128 a[128:131], v12 offset:24576
    v_fma_f32 v75, v75, s43, -v24
    v_exp_f32 v74, v74
    buffer_load_dwordx4 v2, s[12:15], s68 offen offset:2048 lds
    v_mfma_f32_32x32x16_bf16 v[112:127], a[148:151], a[84:87], v[112:127]
    ds_read_b128 a[132:135], v12 offset:25600
    v_add_f32 v25, v25, v72
    v_fma_f32 v76, v76, s43, -v24
    v_exp_f32 v75, v75
    s_waitcnt lgkmcnt(2)
    v_mfma_f32_32x32x16_bf16 v[112:127], a[152:155], a[88:91], v[112:127]
    ds_read_b128 a[136:139], v12 offset:26624
    v_add_f32 v26, v26, v73
    v_cvt_pk_bf16_f32 v52, v72, v73
    v_mfma_f32_32x32x16_bf16 v[112:127], a[156:159], a[92:95], v[112:127]
    ds_read_b128 a[140:143], v12 offset:27648
    v_fma_f32 v77, v77, s43, -v24
    v_exp_f32 v76, v76
    buffer_load_dwordx4 v2, s[12:15], s68 offen offset:3072 lds
    s_waitcnt lgkmcnt(2)
    v_mfma_f32_32x32x16_bf16 v[112:127], a[128:131], a[96:99], v[112:127]
    ds_read_b128 a[144:147], v12 offset:28672
    v_add_f32 v27, v27, v74
    v_fma_f32 v78, v78, s43, -v24
    v_exp_f32 v77, v77
    v_mfma_f32_32x32x16_bf16 v[112:127], a[132:135], a[100:103], v[112:127]
    ds_read_b128 a[148:151], v12 offset:29696
    v_add_f32 v28, v28, v75
    v_cvt_pk_bf16_f32 v53, v74, v75
    s_waitcnt lgkmcnt(2)
    v_mfma_f32_32x32x16_bf16 v[112:127], a[136:139], a[104:107], v[112:127]
    ds_read_b128 a[152:155], v12 offset:30720
    v_fma_f32 v79, v79, s43, -v24
    v_exp_f32 v78, v78
    s_add_u32 s36, s36, 32768
    s_sub_u32 s50, s50, 1
    s_cmp_eq_u32 s50, 0
    s_cselect_b32 s36, s48, s36
    s_sub_u32 s52, s52, 1
    s_cmp_eq_u32 s52, 0
    s_cselect_b32 s36, 0x80000000, s36
    s_cselect_b32 s48, 0x80000000, s48
    v_mfma_f32_32x32x16_bf16 v[112:127], a[140:143], a[108:111], v[112:127]
    ds_read_b128 a[156:159], v12 offset:31744
    v_add_f32 v25, v25, v76
    v_fma_f32 v80, v80, s43, -v24
    v_exp_f32 v79, v79
    s_waitcnt lgkmcnt(2)
    v_mfma_f32_32x32x16_bf16 v[112:127], a[144:147], a[112:115], v[112:127]
    ds_read_b128 a[128:131], v20 offset:0
    v_add_f32 v26, v26, v77
    v_cvt_pk_bf16_f32 v54, v76, v77
    v_mfma_f32_32x32x16_bf16 v[112:127], a[148:151], a[116:119], v[112:127]
    ds_read_b128 a[132:135], v20 offset:4096
    v_fma_f32 v81, v81, s43, -v24
    v_exp_f32 v80, v80
    s_waitcnt lgkmcnt(2)
    v_mfma_f32_32x32x16_bf16 v[112:127], a[152:155], a[120:123], v[112:127]
    ds_read_b128 a[136:139], v20 offset:8192
    v_add_f32 v27, v27, v78
    v_fma_f32 v82, v82, s43, -v24
    v_exp_f32 v81, v81
    v_mfma_f32_32x32x16_bf16 v[112:127], a[156:159], a[124:127], v[112:127]
    ds_read_b128 a[140:143], v20 offset:12288
    v_add_f32 v28, v28, v79
    v_cvt_pk_bf16_f32 v55, v78, v79
    s_waitcnt lgkmcnt(2)
    v_mfma_f32_32x32x16_bf16 v[128:143], a[128:131], v[48:51], v[128:143]
    ds_read_b128 a[144:147], v20 offset:16384
    v_fma_f32 v83, v83, s43, -v24
    v_exp_f32 v82, v82
    v_mfma_f32_32x32x16_bf16 v[144:159], a[132:135], v[48:51], v[144:159]
    ds_read_b128 a[148:151], v20 offset:20480
    v_add_f32 v25, v25, v80
    v_fma_f32 v84, v84, s43, -v24
    v_exp_f32 v83, v83
    s_waitcnt lgkmcnt(2)
    v_mfma_f32_32x32x16_bf16 v[160:175], a[136:139], v[48:51], v[160:175]
    ds_read_b128 a[152:155], v20 offset:24576
    v_add_f32 v26, v26, v81
    v_cvt_pk_bf16_f32 v56, v80, v81
    s_cmp_eq_u32 s69, 0
    s_cbranch_scc1 L_nosig_sg_72
    s_mov_b32 s69, 0
    s_waitcnt vmcnt(8)
    v_mov_b32 v40, s79
    s_mov_b64 exec, 1
    buffer_atomic_or v40, v43, s[28:31], 0 offen
    s_mov_b64 exec, -1
    L_nosig_sg_72:
    v_mfma_f32_32x32x16_bf16 v[176:191], a[140:143], v[48:51], v[176:191]
    ds_read_b128 a[156:159], v20 offset:28672
    v_fma_f32 v85, v85, s43, -v24
    v_exp_f32 v84, v84
    s_waitcnt lgkmcnt(2)
    v_mfma_f32_32x32x16_bf16 v[192:207], a[144:147], v[48:51], v[192:207]
    ds_read_b128 a[128:131], v20 offset:1024
    v_add_f32 v27, v27, v82
    v_fma_f32 v86, v86, s43, -v24
    v_exp_f32 v85, v85
    s_add_u32 m0, s38, 0
    s_add_u32 s68, s35, 0
    buffer_load_dwordx4 v2, s[8:11], s68 offen offset:0 lds
    v_mfma_f32_32x32x16_bf16 v[208:223], a[148:151], v[48:51], v[208:223]
    ds_read_b128 a[132:135], v20 offset:5120
    v_add_f32 v28, v28, v83
    v_cvt_pk_bf16_f32 v57, v82, v83
    s_waitcnt lgkmcnt(2)
    v_mfma_f32_32x32x16_bf16 v[224:239], a[152:155], v[48:51], v[224:239]
    ds_read_b128 a[136:139], v20 offset:9216
    v_fma_f32 v87, v87, s43, -v24
    v_exp_f32 v86, v86
    buffer_load_dwordx4 v2, s[8:11], s68 offen offset:1024 lds
    v_mfma_f32_32x32x16_bf16 v[240:255], a[156:159], v[48:51], v[240:255]
    ds_read_b128 a[140:143], v20 offset:13312
    v_add_f32 v25, v25, v84
    v_fma_f32 v88, v88, s43, -v24
    v_exp_f32 v87, v87
    s_waitcnt lgkmcnt(2)
    v_mfma_f32_32x32x16_bf16 v[128:143], a[128:131], v[52:55], v[128:143]
    ds_read_b128 a[144:147], v20 offset:17408
    v_add_f32 v26, v26, v85
    v_cvt_pk_bf16_f32 v58, v84, v85
    v_mfma_f32_32x32x16_bf16 v[144:159], a[132:135], v[52:55], v[144:159]
    ds_read_b128 a[148:151], v20 offset:21504
    v_fma_f32 v89, v89, s43, -v24
    v_exp_f32 v88, v88
    buffer_load_dwordx4 v2, s[8:11], s68 offen offset:2048 lds
    s_waitcnt lgkmcnt(2)
    v_mfma_f32_32x32x16_bf16 v[160:175], a[136:139], v[52:55], v[160:175]
    ds_read_b128 a[152:155], v20 offset:25600
    v_add_f32 v27, v27, v86
    v_fma_f32 v90, v90, s43, -v24
    v_exp_f32 v89, v89
    v_mfma_f32_32x32x16_bf16 v[176:191], a[140:143], v[52:55], v[176:191]
    ds_read_b128 a[156:159], v20 offset:29696
    v_add_f32 v28, v28, v87
    v_cvt_pk_bf16_f32 v59, v86, v87
    buffer_load_dwordx4 v2, s[8:11], s68 offen offset:3072 lds
    s_waitcnt lgkmcnt(2)
    v_mfma_f32_32x32x16_bf16 v[192:207], a[144:147], v[52:55], v[192:207]
    ds_read_b128 a[128:131], v20 offset:2048
    v_fma_f32 v91, v91, s43, -v24
    v_exp_f32 v90, v90
    v_mfma_f32_32x32x16_bf16 v[208:223], a[148:151], v[52:55], v[208:223]
    ds_read_b128 a[132:135], v20 offset:6144
    v_add_f32 v25, v25, v88
    v_fma_f32 v92, v92, s43, -v24
    v_exp_f32 v91, v91
    s_waitcnt lgkmcnt(2)
    v_mfma_f32_32x32x16_bf16 v[224:239], a[152:155], v[52:55], v[224:239]
    ds_read_b128 a[136:139], v20 offset:10240
    v_add_f32 v26, v26, v89
    v_cvt_pk_bf16_f32 v60, v88, v89
    s_add_u32 m0, s38, 4096
    s_add_u32 s68, s35, 4096
    buffer_load_dwordx4 v2, s[8:11], s68 offen offset:0 lds
    v_mfma_f32_32x32x16_bf16 v[240:255], a[156:159], v[52:55], v[240:255]
    ds_read_b128 a[140:143], v20 offset:14336
    v_fma_f32 v93, v93, s43, -v24
    v_exp_f32 v92, v92
    s_waitcnt lgkmcnt(2)
    v_mfma_f32_32x32x16_bf16 v[128:143], a[128:131], v[56:59], v[128:143]
    ds_read_b128 a[144:147], v20 offset:18432
    v_add_f32 v27, v27, v90
    v_fma_f32 v94, v94, s43, -v24
    v_exp_f32 v93, v93
    v_mfma_f32_32x32x16_bf16 v[144:159], a[132:135], v[56:59], v[144:159]
    ds_read_b128 a[148:151], v20 offset:22528
    v_add_f32 v28, v28, v91
    v_cvt_pk_bf16_f32 v61, v90, v91
    buffer_load_dwordx4 v2, s[8:11], s68 offen offset:1024 lds
    s_waitcnt lgkmcnt(2)
    v_mfma_f32_32x32x16_bf16 v[160:175], a[136:139], v[56:59], v[160:175]
    ds_read_b128 a[152:155], v20 offset:26624
    v_fma_f32 v95, v95, s43, -v24
    v_exp_f32 v94, v94
    s_add_u32 s54, s54, 1
    s_mov_b32 s55, 32768
    s_cmp_eq_u32 s54, 3
    s_cselect_b32 s55, 0xffff0000, s55
    s_cselect_b32 s54, 0, s54
    v_mfma_f32_32x32x16_bf16 v[176:191], a[140:143], v[56:59], v[176:191]
    ds_read_b128 a[156:159], v20 offset:30720
    v_add_f32 v25, v25, v92
    v_exp_f32 v95, v95
    v_add_f32 v26, v26, v93
    buffer_load_dwordx4 v2, s[8:11], s68 offen offset:2048 lds
    s_waitcnt lgkmcnt(2)
    v_mfma_f32_32x32x16_bf16 v[192:207], a[144:147], v[56:59], v[192:207]
    ds_read_b128 a[128:131], v20 offset:3072
    v_add_f32 v27, v27, v94
    v_add_f32 v28, v28, v95
    v_mfma_f32_32x32x16_bf16 v[208:223], a[148:151], v[56:59], v[208:223]
    ds_read_b128 a[132:135], v20 offset:7168
    v_cvt_pk_bf16_f32 v62, v92, v93
    v_cvt_pk_bf16_f32 v63, v94, v95
    v_add_u32 v12, s55, v12
    s_waitcnt lgkmcnt(2)
    v_mfma_f32_32x32x16_bf16 v[224:239], a[152:155], v[56:59], v[224:239]
    ds_read_b128 a[136:139], v20 offset:11264
    buffer_load_dwordx4 v2, s[8:11], s68 offen offset:3072 lds
    v_mfma_f32_32x32x16_bf16 v[240:255], a[156:159], v[56:59], v[240:255]
    ds_read_b128 a[140:143], v20 offset:15360
    s_waitcnt lgkmcnt(2)
    v_mfma_f32_32x32x16_bf16 v[128:143], a[128:131], v[60:63], v[128:143]
    ds_read_b128 a[144:147], v20 offset:19456
    s_add_u32 s35, s35, 32768
    s_sub_u32 s49, s49, 1
    s_cmp_eq_u32 s49, 0
    s_cselect_b32 s35, s47, s35
    s_sub_u32 s51, s51, 1
    s_cmp_eq_u32 s51, 0
    s_cselect_b32 s35, 0x80000000, s35
    s_cselect_b32 s47, 0x80000000, s47
    v_mfma_f32_32x32x16_bf16 v[144:159], a[132:135], v[60:63], v[144:159]
    ds_read_b128 a[148:151], v20 offset:23552
    s_waitcnt lgkmcnt(2)
    v_mfma_f32_32x32x16_bf16 v[160:175], a[136:139], v[60:63], v[160:175]
    ds_read_b128 a[152:155], v20 offset:27648
    v_mfma_f32_32x32x16_bf16 v[176:191], a[140:143], v[60:63], v[176:191]
    ds_read_b128 a[156:159], v20 offset:31744
    s_add_u32 s38, s38, 32768
    s_cmp_ge_u32 s38, 98304
    s_cselect_b32 s68, 98304, 0
    s_sub_u32 s38, s38, s68
    s_waitcnt lgkmcnt(2)
    v_mfma_f32_32x32x16_bf16 v[192:207], a[144:147], v[60:63], v[192:207]
    ds_read_b128 a[128:131], v12 offset:0
    v_mfma_f32_32x32x16_bf16 v[208:223], a[148:151], v[60:63], v[208:223]
    ds_read_b128 a[132:135], v12 offset:1024
    s_waitcnt lgkmcnt(2)
    v_mfma_f32_32x32x16_bf16 v[224:239], a[152:155], v[60:63], v[224:239]
    ds_read_b128 a[136:139], v12 offset:2048
    v_mfma_f32_32x32x16_bf16 v[240:255], a[156:159], v[60:63], v[240:255]
    ds_read_b128 a[140:143], v12 offset:3072
L_y1:
    s_waitcnt vmcnt(8)
    s_barrier
L_y1_entry:
    s_add_u32 s34, s34, 1
    s_cmp_ge_u32 s34, s33
    s_cbranch_scc1 L_yl1
    s_add_u32 s45, s34, 1
    s_cmp_ge_u32 s45, s33
    s_cbranch_scc1 L_ym1
    s_waitcnt lgkmcnt(2)
    v_mfma_f32_32x32x16_bf16 v[64:79], a[128:131], a[64:67], 0
    ds_read_b128 a[144:147], v12 offset:4096
    v_max3_f32 v30, v96, v97, v98
    v_max3_f32 v31, v99, v100, v101
    v_max3_f32 v30, v30, v102, v103
    v_mfma_f32_32x32x16_bf16 v[64:79], a[132:135], a[68:71], v[64:79]
    ds_read_b128 a[148:151], v12 offset:5120
    v_max3_f32 v31, v31, v104, v105
    v_max3_f32 v30, v30, v106, v107
    v_max3_f32 v31, v31, v108, v109
    s_waitcnt lgkmcnt(2)
    v_mfma_f32_32x32x16_bf16 v[64:79], a[136:139], a[72:75], v[64:79]
    ds_read_b128 a[152:155], v12 offset:6144
    v_max3_f32 v30, v30, v110, v111
    v_max3_f32 v31, v31, v112, v113
    v_max3_f32 v30, v30, v114, v115
    s_add_u32 m0, s56, 98304
    s_add_u32 s68, s36, 0
    buffer_load_dwordx4 v2, s[12:15], s68 offen offset:0 lds
    v_mfma_f32_32x32x16_bf16 v[64:79], a[140:143], a[76:79], v[64:79]
    ds_read_b128 a[156:159], v12 offset:7168
    v_max3_f32 v31, v31, v116, v117
    v_max3_f32 v30, v30, v118, v119
    v_max3_f32 v31, v31, v120, v121
    s_waitcnt lgkmcnt(2)
    v_mfma_f32_32x32x16_bf16 v[64:79], a[144:147], a[80:83], v[64:79]
    ds_read_b128 a[128:131], v12 offset:8192
    v_max3_f32 v30, v30, v122, v123
    v_max3_f32 v31, v31, v124, v125
    v_max3_f32 v30, v30, v126, v127
    v_mfma_f32_32x32x16_bf16 v[64:79], a[148:151], a[84:87], v[64:79]
    ds_read_b128 a[132:135], v12 offset:9216
    v_max_f32 v30, v30, v31
    v_mov_b32 v31, v30
    s_nop 1
    v_permlane32_swap_b32 v30, v31
    v_max_f32 v30, v30, v31
    v_fma_f32 v31, v30, s43, -v24
    v_cmp_lt_f32 vcc, s44, v31
    s_cbranch_vccnz L_resc_a_73
    L_resc_ret_a_73:
    buffer_load_dwordx4 v2, s[12:15], s68 offen offset:1024 lds
    s_waitcnt lgkmcnt(2)
    v_mfma_f32_32x32x16_bf16 v[64:79], a[152:155], a[88:91], v[64:79]
    ds_read_b128 a[136:139], v12 offset:10240
    v_fma_f32 v96, v96, s43, -v24
    v_fma_f32 v97, v97, s43, -v24
    v_exp_f32 v96, v96
    v_mfma_f32_32x32x16_bf16 v[64:79], a[156:159], a[92:95], v[64:79]
    ds_read_b128 a[140:143], v12 offset:11264
    v_fma_f32 v98, v98, s43, -v24
    v_exp_f32 v97, v97
    s_waitcnt lgkmcnt(2)
    v_mfma_f32_32x32x16_bf16 v[64:79], a[128:131], a[96:99], v[64:79]
    ds_read_b128 a[144:147], v12 offset:12288
    v_fma_f32 v99, v99, s43, -v24
    v_exp_f32 v98, v98
    buffer_load_dwordx4 v2, s[12:15], s68 offen offset:2048 lds
    v_mfma_f32_32x32x16_bf16 v[64:79], a[132:135], a[100:103], v[64:79]
    ds_read_b128 a[148:151], v12 offset:13312
    v_add_f32 v25, v25, v96
    v_fma_f32 v100, v100, s43, -v24
    v_exp_f32 v99, v99
    s_waitcnt lgkmcnt(2)
    v_mfma_f32_32x32x16_bf16 v[64:79], a[136:139], a[104:107], v[64:79]
    ds_read_b128 a[152:155], v12 offset:14336
    v_add_f32 v26, v26, v97
    v_cvt_pk_bf16_f32 v48, v96, v97
    v_mfma_f32_32x32x16_bf16 v[64:79], a[140:143], a[108:111], v[64:79]
    ds_read_b128 a[156:159], v12 offset:15360
    v_fma_f32 v101, v101, s43, -v24
    v_exp_f32 v100, v100
    buffer_load_dwordx4 v2, s[12:15], s68 offen offset:3072 lds
    s_waitcnt lgkmcnt(2)
    v_mfma_f32_32x32x16_bf16 v[64:79], a[144:147], a[112:115], v[64:79]
    ds_read_b128 a[128:131], v12 offset:16384
    v_add_f32 v27, v27, v98
    v_fma_f32 v102, v102, s43, -v24
    v_exp_f32 v101, v101
    v_mfma_f32_32x32x16_bf16 v[64:79], a[148:151], a[116:119], v[64:79]
    ds_read_b128 a[132:135], v12 offset:17408
    v_add_f32 v28, v28, v99
    v_cvt_pk_bf16_f32 v49, v98, v99
    s_waitcnt lgkmcnt(2)
    v_mfma_f32_32x32x16_bf16 v[64:79], a[152:155], a[120:123], v[64:79]
    ds_read_b128 a[136:139], v12 offset:18432
    v_fma_f32 v103, v103, s43, -v24
    v_exp_f32 v102, v102
    s_add_u32 m0, s56, 102400
    s_add_u32 s68, s36, 4096
    buffer_load_dwordx4 v2, s[12:15], s68 offen offset:0 lds
    v_mfma_f32_32x32x16_bf16 v[64:79], a[156:159], a[124:127], v[64:79]
    ds_read_b128 a[140:143], v12 offset:19456
    v_add_f32 v25, v25, v100
    v_fma_f32 v104, v104, s43, -v24
    v_exp_f32 v103, v103
    s_waitcnt lgkmcnt(2)
    v_mfma_f32_32x32x16_bf16 v[80:95], a[128:131], a[64:67], 0
    ds_read_b128 a[144:147], v12 offset:20480
    v_add_f32 v26, v26, v101
    v_cvt_pk_bf16_f32 v50, v100, v101
    v_mfma_f32_32x32x16_bf16 v[80:95], a[132:135], a[68:71], v[80:95]
    ds_read_b128 a[148:151], v12 offset:21504
    v_fma_f32 v105, v105, s43, -v24
    v_exp_f32 v104, v104
    buffer_load_dwordx4 v2, s[12:15], s68 offen offset:1024 lds
    s_waitcnt lgkmcnt(2)
    v_mfma_f32_32x32x16_bf16 v[80:95], a[136:139], a[72:75], v[80:95]
    ds_read_b128 a[152:155], v12 offset:22528
    v_add_f32 v27, v27, v102
    v_fma_f32 v106, v106, s43, -v24
    v_exp_f32 v105, v105
    v_mfma_f32_32x32x16_bf16 v[80:95], a[140:143], a[76:79], v[80:95]
    ds_read_b128 a[156:159], v12 offset:23552
    v_add_f32 v28, v28, v103
    v_cvt_pk_bf16_f32 v51, v102, v103
    s_waitcnt lgkmcnt(2)
    v_mfma_f32_32x32x16_bf16 v[80:95], a[144:147], a[80:83], v[80:95]
    ds_read_b128 a[128:131], v12 offset:24576
    v_fma_f32 v107, v107, s43, -v24
    v_exp_f32 v106, v106
    buffer_load_dwordx4 v2, s[12:15], s68 offen offset:2048 lds
    v_mfma_f32_32x32x16_bf16 v[80:95], a[148:151], a[84:87], v[80:95]
    ds_read_b128 a[132:135], v12 offset:25600
    v_add_f32 v25, v25, v104
    v_fma_f32 v108, v108, s43, -v24
    v_exp_f32 v107, v107
    s_waitcnt lgkmcnt(2)
    v_mfma_f32_32x32x16_bf16 v[80:95], a[152:155], a[88:91], v[80:95]
    ds_read_b128 a[136:139], v12 offset:26624
    v_add_f32 v26, v26, v105
    v_cvt_pk_bf16_f32 v52, v104, v105
    v_mfma_f32_32x32x16_bf16 v[80:95], a[156:159], a[92:95], v[80:95]
    ds_read_b128 a[140:143], v12 offset:27648
    v_fma_f32 v109, v109, s43, -v24
    v_exp_f32 v108, v108
    buffer_load_dwordx4 v2, s[12:15], s68 offen offset:3072 lds
    s_waitcnt lgkmcnt(2)
    v_mfma_f32_32x32x16_bf16 v[80:95], a[128:131], a[96:99], v[80:95]
    ds_read_b128 a[144:147], v12 offset:28672
    v_add_f32 v27, v27, v106
    v_fma_f32 v110, v110, s43, -v24
    v_exp_f32 v109, v109
    v_mfma_f32_32x32x16_bf16 v[80:95], a[132:135], a[100:103], v[80:95]
    ds_read_b128 a[148:151], v12 offset:29696
    v_add_f32 v28, v28, v107
    v_cvt_pk_bf16_f32 v53, v106, v107
    s_waitcnt lgkmcnt(2)
    v_mfma_f32_32x32x16_bf16 v[80:95], a[136:139], a[104:107], v[80:95]
    ds_read_b128 a[152:155], v12 offset:30720
    v_fma_f32 v111, v111, s43, -v24
    v_exp_f32 v110, v110
    s_add_u32 s36, s36, 32768
    s_sub_u32 s50, s50, 1
    s_cmp_eq_u32 s50, 0
    s_cselect_b32 s36, s48, s36
    s_sub_u32 s52, s52, 1
    s_cmp_eq_u32 s52, 0
    s_cselect_b32 s36, 0x80000000, s36
    s_cselect_b32 s48, 0x80000000, s48
    v_mfma_f32_32x32x16_bf16 v[80:95], a[140:143], a[108:111], v[80:95]
    ds_read_b128 a[156:159], v12 offset:31744
    v_add_f32 v25, v25, v108
    v_fma_f32 v112, v112, s43, -v24
    v_exp_f32 v111, v111
    s_waitcnt lgkmcnt(2)
    v_mfma_f32_32x32x16_bf16 v[80:95], a[144:147], a[112:115], v[80:95]
    ds_read_b128 a[128:131], v20 offset:32768
    v_add_f32 v26, v26, v109
    v_cvt_pk_bf16_f32 v54, v108, v109
    v_mfma_f32_32x32x16_bf16 v[80:95], a[148:151], a[116:119], v[80:95]
    ds_read_b128 a[132:135], v20 offset:36864
    v_fma_f32 v113, v113, s43, -v24
    v_exp_f32 v112, v112
    s_waitcnt lgkmcnt(2)
    v_mfma_f32_32x32x16_bf16 v[80:95], a[152:155], a[120:123], v[80:95]
    ds_read_b128 a[136:139], v20 offset:40960
    v_add_f32 v27, v27, v110
    v_fma_f32 v114, v114, s43, -v24
    v_exp_f32 v113, v113
    v_mfma_f32_32x32x16_bf16 v[80:95], a[156:159], a[124:127], v[80:95]
    ds_read_b128 a[140:143], v20 offset:45056
    v_add_f32 v28, v28, v111
    v_cvt_pk_bf16_f32 v55, v110, v111
    s_waitcnt lgkmcnt(2)
    v_mfma_f32_32x32x16_bf16 v[128:143], a[128:131], v[48:51], v[128:143]
    ds_read_b128 a[144:147], v20 offset:49152
    v_fma_f32 v115, v115, s43, -v24
    v_exp_f32 v114, v114
    v_mfma_f32_32x32x16_bf16 v[144:159], a[132:135], v[48:51], v[144:159]
    ds_read_b128 a[148:151], v20 offset:53248
    v_add_f32 v25, v25, v112
    v_fma_f32 v116, v116, s43, -v24
    v_exp_f32 v115, v115
    s_waitcnt lgkmcnt(2)
    v_mfma_f32_32x32x16_bf16 v[160:175], a[136:139], v[48:51], v[160:175]
    ds_read_b128 a[152:155], v20 offset:57344
    v_add_f32 v26, v26, v113
    v_cvt_pk_bf16_f32 v56, v112, v113
    s_cmp_eq_u32 s69, 0
    s_cbranch_scc1 L_nosig_sg_74
    s_mov_b32 s69, 0
    s_waitcnt vmcnt(8)
    v_mov_b32 v40, s79
    s_mov_b64 exec, 1
    buffer_atomic_or v40, v43, s[28:31], 0 offen
    s_mov_b64 exec, -1
    L_nosig_sg_74:
    v_mfma_f32_32x32x16_bf16 v[176:191], a[140:143], v[48:51], v[176:191]
    ds_read_b128 a[156:159], v20 offset:61440
    v_fma_f32 v117, v117, s43, -v24
    v_exp_f32 v116, v116
    s_waitcnt lgkmcnt(2)
    v_mfma_f32_32x32x16_bf16 v[192:207], a[144:147], v[48:51], v[192:207]
    ds_read_b128 a[128:131], v20 offset:33792
    v_add_f32 v27, v27, v114
    v_fma_f32 v118, v118, s43, -v24
    v_exp_f32 v117, v117
    s_add_u32 m0, s38, 0
    s_add_u32 s68, s35, 0
    buffer_load_dwordx4 v2, s[8:11], s68 offen offset:0 lds
    v_mfma_f32_32x32x16_bf16 v[208:223], a[148:151], v[48:51], v[208:223]
    ds_read_b128 a[132:135], v20 offset:37888
    v_add_f32 v28, v28, v115
    v_cvt_pk_bf16_f32 v57, v114, v115
    s_waitcnt lgkmcnt(2)
    v_mfma_f32_32x32x16_bf16 v[224:239], a[152:155], v[48:51], v[224:239]
    ds_read_b128 a[136:139], v20 offset:41984
    v_fma_f32 v119, v119, s43, -v24
    v_exp_f32 v118, v118
    buffer_load_dwordx4 v2, s[8:11], s68 offen offset:1024 lds
    v_mfma_f32_32x32x16_bf16 v[240:255], a[156:159], v[48:51], v[240:255]
    ds_read_b128 a[140:143], v20 offset:46080
    v_add_f32 v25, v25, v116
    v_fma_f32 v120, v120, s43, -v24
    v_exp_f32 v119, v119
    s_waitcnt lgkmcnt(2)
    v_mfma_f32_32x32x16_bf16 v[128:143], a[128:131], v[52:55], v[128:143]
    ds_read_b128 a[144:147], v20 offset:50176
    v_add_f32 v26, v26, v117
    v_cvt_pk_bf16_f32 v58, v116, v117
    v_mfma_f32_32x32x16_bf16 v[144:159], a[132:135], v[52:55], v[144:159]
    ds_read_b128 a[148:151], v20 offset:54272
    v_fma_f32 v121, v121, s43, -v24
    v_exp_f32 v120, v120
    buffer_load_dwordx4 v2, s[8:11], s68 offen offset:2048 lds
    s_waitcnt lgkmcnt(2)
    v_mfma_f32_32x32x16_bf16 v[160:175], a[136:139], v[52:55], v[160:175]
    ds_read_b128 a[152:155], v20 offset:58368
    v_add_f32 v27, v27, v118
    v_fma_f32 v122, v122, s43, -v24
    v_exp_f32 v121, v121
    v_mfma_f32_32x32x16_bf16 v[176:191], a[140:143], v[52:55], v[176:191]
    ds_read_b128 a[156:159], v20 offset:62464
    v_add_f32 v28, v28, v119
    v_cvt_pk_bf16_f32 v59, v118, v119
    buffer_load_dwordx4 v2, s[8:11], s68 offen offset:3072 lds
    s_waitcnt lgkmcnt(2)
    v_mfma_f32_32x32x16_bf16 v[192:207], a[144:147], v[52:55], v[192:207]
    ds_read_b128 a[128:131], v20 offset:34816
    v_fma_f32 v123, v123, s43, -v24
    v_exp_f32 v122, v122
    v_mfma_f32_32x32x16_bf16 v[208:223], a[148:151], v[52:55], v[208:223]
    ds_read_b128 a[132:135], v20 offset:38912
    v_add_f32 v25, v25, v120
    v_fma_f32 v124, v124, s43, -v24
    v_exp_f32 v123, v123
    s_waitcnt lgkmcnt(2)
    v_mfma_f32_32x32x16_bf16 v[224:239], a[152:155], v[52:55], v[224:239]
    ds_read_b128 a[136:139], v20 offset:43008
    v_add_f32 v26, v26, v121
    v_cvt_pk_bf16_f32 v60, v120, v121
    s_add_u32 m0, s38, 4096
    s_add_u32 s68, s35, 4096
    buffer_load_dwordx4 v2, s[8:11], s68 offen offset:0 lds
    v_mfma_f32_32x32x16_bf16 v[240:255], a[156:159], v[52:55], v[240:255]
    ds_read_b128 a[140:143], v20 offset:47104
    v_fma_f32 v125, v125, s43, -v24
    v_exp_f32 v124, v124
    s_waitcnt lgkmcnt(2)
    v_mfma_f32_32x32x16_bf16 v[128:143], a[128:131], v[56:59], v[128:143]
    ds_read_b128 a[144:147], v20 offset:51200
    v_add_f32 v27, v27, v122
    v_fma_f32 v126, v126, s43, -v24
    v_exp_f32 v125, v125
    v_mfma_f32_32x32x16_bf16 v[144:159], a[132:135], v[56:59], v[144:159]
    ds_read_b128 a[148:151], v20 offset:55296
    v_add_f32 v28, v28, v123
    v_cvt_pk_bf16_f32 v61, v122, v123
    buffer_load_dwordx4 v2, s[8:11], s68 offen offset:1024 lds
    s_waitcnt lgkmcnt(2)
    v_mfma_f32_32x32x16_bf16 v[160:175], a[136:139], v[56:59], v[160:175]
    ds_read_b128 a[152:155], v20 offset:59392
    v_fma_f32 v127, v127, s43, -v24
    v_exp_f32 v126, v126
    s_add_u32 s54, s54, 1
    s_mov_b32 s55, 32768
    s_cmp_eq_u32 s54, 3
    s_cselect_b32 s55, 0xffff0000, s55
    s_cselect_b32 s54, 0, s54
    v_mfma_f32_32x32x16_bf16 v[176:191], a[140:143], v[56:59], v[176:191]
    ds_read_b128 a[156:159], v20 offset:63488
    v_add_f32 v25, v25, v124
    v_exp_f32 v127, v127
    v_add_f32 v26, v26, v125
    buffer_load_dwordx4 v2, s[8:11], s68 offen offset:2048 lds
    s_waitcnt lgkmcnt(2)
    v_mfma_f32_32x32x16_bf16 v[192:207], a[144:147], v[56:59], v[192:207]
    ds_read_b128 a[128:131], v20 offset:35840
    v_add_f32 v27, v27, v126
    v_add_f32 v28, v28, v127
    v_mfma_f32_32x32x16_bf16 v[208:223], a[148:151], v[56:59], v[208:223]
    ds_read_b128 a[132:135], v20 offset:39936
    v_cvt_pk_bf16_f32 v62, v124, v125
    v_cvt_pk_bf16_f32 v63, v126, v127
    v_add_u32 v12, s55, v12
    s_waitcnt lgkmcnt(2)
    v_mfma_f32_32x32x16_bf16 v[224:239], a[152:155], v[56:59], v[224:239]
    ds_read_b128 a[136:139], v20 offset:44032
    buffer_load_dwordx4 v2, s[8:11], s68 offen offset:3072 lds
    v_mfma_f32_32x32x16_bf16 v[240:255], a[156:159], v[56:59], v[240:255]
    ds_read_b128 a[140:143], v20 offset:48128
    s_waitcnt lgkmcnt(2)
    v_mfma_f32_32x32x16_bf16 v[128:143], a[128:131], v[60:63], v[128:143]
    ds_read_b128 a[144:147], v20 offset:52224
    s_add_u32 s35, s35, 32768
    s_sub_u32 s49, s49, 1
    s_cmp_eq_u32 s49, 0
    s_cselect_b32 s35, s47, s35
    s_sub_u32 s51, s51, 1
    s_cmp_eq_u32 s51, 0
    s_cselect_b32 s35, 0x80000000, s35
    s_cselect_b32 s47, 0x80000000, s47
    v_mfma_f32_32x32x16_bf16 v[144:159], a[132:135], v[60:63], v[144:159]
    ds_read_b128 a[148:151], v20 offset:56320
    s_waitcnt lgkmcnt(2)
    v_mfma_f32_32x32x16_bf16 v[160:175], a[136:139], v[60:63], v[160:175]
    ds_read_b128 a[152:155], v20 offset:60416
    v_mfma_f32_32x32x16_bf16 v[176:191], a[140:143], v[60:63], v[176:191]
    ds_read_b128 a[156:159], v20 offset:64512
    s_add_u32 s38, s38, 32768
    s_cmp_ge_u32 s38, 98304
    s_cselect_b32 s68, 98304, 0
    s_sub_u32 s38, s38, s68
    s_waitcnt lgkmcnt(2)
    v_mfma_f32_32x32x16_bf16 v[192:207], a[144:147], v[60:63], v[192:207]
    ds_read_b128 a[128:131], v12 offset:0
    v_mfma_f32_32x32x16_bf16 v[208:223], a[148:151], v[60:63], v[208:223]
    ds_read_b128 a[132:135], v12 offset:1024
    s_waitcnt lgkmcnt(2)
    v_mfma_f32_32x32x16_bf16 v[224:239], a[152:155], v[60:63], v[224:239]
    ds_read_b128 a[136:139], v12 offset:2048
    v_mfma_f32_32x32x16_bf16 v[240:255], a[156:159], v[60:63], v[240:255]
    ds_read_b128 a[140:143], v12 offset:3072
    s_branch L_y0
L_ym0:
    s_waitcnt lgkmcnt(2)
    v_mfma_f32_32x32x16_bf16 v[96:111], a[128:131], a[64:67], 0
    ds_read_b128 a[144:147], v12 offset:4096
    v_mov_b32 v38, 0xff800000
    v_cmp_lt_i32 s[60:61], v29, 0
    v_cmp_lt_i32 s[62:63], v29, 1
    v_cmp_lt_i32 s[64:65], v29, 2
    v_cmp_lt_i32 s[66:67], v29, 3
    v_cndmask_b32 v64, v64, v38, s[60:61]
    v_cndmask_b32 v65, v65, v38, s[62:63]
    v_cndmask_b32 v66, v66, v38, s[64:65]
    v_cndmask_b32 v67, v67, v38, s[66:67]
    v_cmp_lt_i32 s[60:61], v29, 8
    v_cmp_lt_i32 s[62:63], v29, 9
    v_cmp_lt_i32 s[64:65], v29, 10
    v_cmp_lt_i32 s[66:67], v29, 11
    v_cndmask_b32 v68, v68, v38, s[60:61]
    v_cndmask_b32 v69, v69, v38, s[62:63]
    v_cndmask_b32 v70, v70, v38, s[64:65]
    v_cndmask_b32 v71, v71, v38, s[66:67]
    v_mfma_f32_32x32x16_bf16 v[96:111], a[132:135], a[68:71], v[96:111]
    ds_read_b128 a[148:151], v12 offset:5120
    v_cmp_lt_i32 s[60:61], v29, 16
    v_cmp_lt_i32 s[62:63], v29, 17
    v_cmp_lt_i32 s[64:65], v29, 18
    v_cmp_lt_i32 s[66:67], v29, 19
    v_cndmask_b32 v72, v72, v38, s[60:61]
    v_cndmask_b32 v73, v73, v38, s[62:63]
    v_cndmask_b32 v74, v74, v38, s[64:65]
    v_cndmask_b32 v75, v75, v38, s[66:67]
    v_cmp_lt_i32 s[60:61], v29, 24
    v_cmp_lt_i32 s[62:63], v29, 25
    v_cmp_lt_i32 s[64:65], v29, 26
    v_cmp_lt_i32 s[66:67], v29, 27
    v_cndmask_b32 v76, v76, v38, s[60:61]
    v_cndmask_b32 v77, v77, v38, s[62:63]
    v_cndmask_b32 v78, v78, v38, s[64:65]
    v_cndmask_b32 v79, v79, v38, s[66:67]
    buffer_load_dword v42, v43, s[28:31], 0 offen sc1
    s_waitcnt lgkmcnt(2)
    v_mfma_f32_32x32x16_bf16 v[96:111], a[136:139], a[72:75], v[96:111]
    ds_read_b128 a[152:155], v12 offset:6144
    v_cmp_lt_i32 s[60:61], v29, 32
    v_cmp_lt_i32 s[62:63], v29, 33
    v_cmp_lt_i32 s[64:65], v29, 34
    v_cmp_lt_i32 s[66:67], v29, 35
    v_cndmask_b32 v80, v80, v38, s[60:61]
    v_cndmask_b32 v81, v81, v38, s[62:63]
    v_cndmask_b32 v82, v82, v38, s[64:65]
    v_cndmask_b32 v83, v83, v38, s[66:67]
    v_cmp_lt_i32 s[60:61], v29, 40
    v_cmp_lt_i32 s[62:63], v29, 41
    v_cmp_lt_i32 s[64:65], v29, 42
    v_cmp_lt_i32 s[66:67], v29, 43
    v_cndmask_b32 v84, v84, v38, s[60:61]
    v_cndmask_b32 v85, v85, v38, s[62:63]
    v_cndmask_b32 v86, v86, v38, s[64:65]
    v_cndmask_b32 v87, v87, v38, s[66:67]
    s_add_u32 m0, s56, 131072
    s_add_u32 s68, s36, 0
    buffer_load_dwordx4 v2, s[12:15], s68 offen offset:0 lds
    v_mfma_f32_32x32x16_bf16 v[96:111], a[140:143], a[76:79], v[96:111]
    ds_read_b128 a[156:159], v12 offset:7168
    v_cmp_lt_i32 s[60:61], v29, 48
    v_cmp_lt_i32 s[62:63], v29, 49
    v_cmp_lt_i32 s[64:65], v29, 50
    v_cmp_lt_i32 s[66:67], v29, 51
    v_cndmask_b32 v88, v88, v38, s[60:61]
    v_cndmask_b32 v89, v89, v38, s[62:63]
    v_cndmask_b32 v90, v90, v38, s[64:65]
    v_cndmask_b32 v91, v91, v38, s[66:67]
    v_cmp_lt_i32 s[60:61], v29, 56
    v_cmp_lt_i32 s[62:63], v29, 57
    v_cmp_lt_i32 s[64:65], v29, 58
    v_cmp_lt_i32 s[66:67], v29, 59
    v_cndmask_b32 v92, v92, v38, s[60:61]
    v_cndmask_b32 v93, v93, v38, s[62:63]
    v_cndmask_b32 v94, v94, v38, s[64:65]
    v_cndmask_b32 v95, v95, v38, s[66:67]
    s_waitcnt lgkmcnt(2)
    v_mfma_f32_32x32x16_bf16 v[96:111], a[144:147], a[80:83], v[96:111]
    ds_read_b128 a[128:131], v12 offset:8192
    v_max3_f32 v30, v64, v65, v66
    v_max3_f32 v31, v67, v68, v69
    v_mfma_f32_32x32x16_bf16 v[96:111], a[148:151], a[84:87], v[96:111]
    ds_read_b128 a[132:135], v12 offset:9216
    v_max3_f32 v30, v30, v70, v71
    v_max3_f32 v31, v31, v72, v73
    buffer_load_dwordx4 v2, s[12:15], s68 offen offset:1024 lds
    s_waitcnt lgkmcnt(2)
    v_mfma_f32_32x32x16_bf16 v[96:111], a[152:155], a[88:91], v[96:111]
    ds_read_b128 a[136:139], v12 offset:10240
    v_max3_f32 v30, v30, v74, v75
    v_max3_f32 v31, v31, v76, v77
    v_max3_f32 v30, v30, v78, v79
    v_mfma_f32_32x32x16_bf16 v[96:111], a[156:159], a[92:95], v[96:111]
    ds_read_b128 a[140:143], v12 offset:11264
    v_max3_f32 v31, v31, v80, v81
    v_max3_f32 v30, v30, v82, v83
    s_waitcnt lgkmcnt(2)
    v_mfma_f32_32x32x16_bf16 v[96:111], a[128:131], a[96:99], v[96:111]
    ds_read_b128 a[144:147], v12 offset:12288
    v_max3_f32 v31, v31, v84, v85
    v_max3_f32 v30, v30, v86, v87
    buffer_load_dwordx4 v2, s[12:15], s68 offen offset:2048 lds
    v_mfma_f32_32x32x16_bf16 v[96:111], a[132:135], a[100:103], v[96:111]
    ds_read_b128 a[148:151], v12 offset:13312
    v_max3_f32 v31, v31, v88, v89
    v_max3_f32 v30, v30, v90, v91
    s_waitcnt lgkmcnt(2)
    v_mfma_f32_32x32x16_bf16 v[96:111], a[136:139], a[104:107], v[96:111]
    ds_read_b128 a[152:155], v12 offset:14336
    v_max3_f32 v31, v31, v92, v93
    v_max3_f32 v30, v30, v94, v95
    v_mfma_f32_32x32x16_bf16 v[96:111], a[140:143], a[108:111], v[96:111]
    ds_read_b128 a[156:159], v12 offset:15360
    v_max_f32 v30, v30, v31
    v_mov_b32 v31, v30
    s_nop 1
    v_permlane32_swap_b32 v30, v31
    v_max_f32 v30, v30, v31
    v_fma_f32 v31, v30, s43, -v24
    v_cmp_lt_f32 vcc, s44, v31
    s_cbranch_vccnz L_resc_a_75
    L_resc_ret_a_75:
    buffer_load_dwordx4 v2, s[12:15], s68 offen offset:3072 lds
    s_waitcnt lgkmcnt(2)
    v_mfma_f32_32x32x16_bf16 v[96:111], a[144:147], a[112:115], v[96:111]
    ds_read_b128 a[128:131], v12 offset:16384
    v_fma_f32 v64, v64, s43, -v24
    v_fma_f32 v65, v65, s43, -v24
    v_exp_f32 v64, v64
    v_mfma_f32_32x32x16_bf16 v[96:111], a[148:151], a[116:119], v[96:111]
    ds_read_b128 a[132:135], v12 offset:17408
    v_fma_f32 v66, v66, s43, -v24
    v_exp_f32 v65, v65
    v_fma_f32 v67, v67, s43, -v24
    s_waitcnt lgkmcnt(2)
    v_mfma_f32_32x32x16_bf16 v[96:111], a[152:155], a[120:123], v[96:111]
    ds_read_b128 a[136:139], v12 offset:18432
    v_exp_f32 v66, v66
    v_add_f32 v25, v25, v64
    v_fma_f32 v68, v68, s43, -v24
    s_add_u32 m0, s56, 135168
    s_add_u32 s68, s36, 4096
    buffer_load_dwordx4 v2, s[12:15], s68 offen offset:0 lds
    v_mfma_f32_32x32x16_bf16 v[96:111], a[156:159], a[124:127], v[96:111]
    ds_read_b128 a[140:143], v12 offset:19456
    v_exp_f32 v67, v67
    v_add_f32 v26, v26, v65
    s_waitcnt lgkmcnt(2)
    v_mfma_f32_32x32x16_bf16 v[112:127], a[128:131], a[64:67], 0
    ds_read_b128 a[144:147], v12 offset:20480
    v_cvt_pk_bf16_f32 v48, v64, v65
    v_fma_f32 v69, v69, s43, -v24
    v_exp_f32 v68, v68
    v_mfma_f32_32x32x16_bf16 v[112:127], a[132:135], a[68:71], v[112:127]
    ds_read_b128 a[148:151], v12 offset:21504
    v_add_f32 v27, v27, v66
    v_fma_f32 v70, v70, s43, -v24
    v_exp_f32 v69, v69
    buffer_load_dwordx4 v2, s[12:15], s68 offen offset:1024 lds
    s_waitcnt lgkmcnt(2)
    v_mfma_f32_32x32x16_bf16 v[112:127], a[136:139], a[72:75], v[112:127]
    ds_read_b128 a[152:155], v12 offset:22528
    v_add_f32 v28, v28, v67
    v_cvt_pk_bf16_f32 v49, v66, v67
    v_mfma_f32_32x32x16_bf16 v[112:127], a[140:143], a[76:79], v[112:127]
    ds_read_b128 a[156:159], v12 offset:23552
    v_fma_f32 v71, v71, s43, -v24
    v_exp_f32 v70, v70
    v_add_f32 v25, v25, v68
    s_waitcnt lgkmcnt(2)
    v_mfma_f32_32x32x16_bf16 v[112:127], a[144:147], a[80:83], v[112:127]
    ds_read_b128 a[128:131], v12 offset:24576
    v_fma_f32 v72, v72, s43, -v24
    v_exp_f32 v71, v71
    v_add_f32 v26, v26, v69
    buffer_load_dwordx4 v2, s[12:15], s68 offen offset:2048 lds
    v_mfma_f32_32x32x16_bf16 v[112:127], a[148:151], a[84:87], v[112:127]
    ds_read_b128 a[132:135], v12 offset:25600
    v_cvt_pk_bf16_f32 v50, v68, v69
    v_fma_f32 v73, v73, s43, -v24
    s_waitcnt lgkmcnt(2)
    v_mfma_f32_32x32x16_bf16 v[112:127], a[152:155], a[88:91], v[112:127]
    ds_read_b128 a[136:139], v12 offset:26624
    v_exp_f32 v72, v72
    v_add_f32 v27, v27, v70
    v_fma_f32 v74, v74, s43, -v24
    v_mfma_f32_32x32x16_bf16 v[112:127], a[156:159], a[92:95], v[112:127]
    ds_read_b128 a[140:143], v12 offset:27648
    v_exp_f32 v73, v73
    v_add_f32 v28, v28, v71
    v_cvt_pk_bf16_f32 v51, v70, v71
    buffer_load_dwordx4 v2, s[12:15], s68 offen offset:3072 lds
    s_waitcnt lgkmcnt(2)
    v_mfma_f32_32x32x16_bf16 v[112:127], a[128:131], a[96:99], v[112:127]
    ds_read_b128 a[144:147], v12 offset:28672
    v_fma_f32 v75, v75, s43, -v24
    v_exp_f32 v74, v74
    v_mfma_f32_32x32x16_bf16 v[112:127], a[132:135], a[100:103], v[112:127]
    ds_read_b128 a[148:151], v12 offset:29696
    v_add_f32 v25, v25, v72
    v_fma_f32 v76, v76, s43, -v24
    v_exp_f32 v75, v75
    s_waitcnt lgkmcnt(2)
    v_mfma_f32_32x32x16_bf16 v[112:127], a[136:139], a[104:107], v[112:127]
    ds_read_b128 a[152:155], v12 offset:30720
    v_add_f32 v26, v26, v73
    v_cvt_pk_bf16_f32 v52, v72, v73
    v_fma_f32 v77, v77, s43, -v24
    s_add_u32 s36, s36, 32768
    s_sub_u32 s50, s50, 1
    s_cmp_eq_u32 s50, 0
    s_cselect_b32 s36, s48, s36
    s_sub_u32 s52, s52, 1
    s_cmp_eq_u32 s52, 0
    s_cselect_b32 s36, 0x80000000, s36
    s_cselect_b32 s48, 0x80000000, s48
    v_mfma_f32_32x32x16_bf16 v[112:127], a[140:143], a[108:111], v[112:127]
    ds_read_b128 a[156:159], v12 offset:31744
    v_exp_f32 v76, v76
    v_add_f32 v27, v27, v74
    v_fma_f32 v78, v78, s43, -v24
    s_waitcnt lgkmcnt(2)
    v_mfma_f32_32x32x16_bf16 v[112:127], a[144:147], a[112:115], v[112:127]
    ds_read_b128 a[128:131], v20 offset:0
    v_exp_f32 v77, v77
    v_add_f32 v28, v28, v75
    v_mfma_f32_32x32x16_bf16 v[112:127], a[148:151], a[116:119], v[112:127]
    ds_read_b128 a[132:135], v20 offset:4096
    v_cvt_pk_bf16_f32 v53, v74, v75
    v_fma_f32 v79, v79, s43, -v24
    v_exp_f32 v78, v78
    s_waitcnt lgkmcnt(2)
    v_mfma_f32_32x32x16_bf16 v[112:127], a[152:155], a[120:123], v[112:127]
    ds_read_b128 a[136:139], v20 offset:8192
    v_add_f32 v25, v25, v76
    v_fma_f32 v80, v80, s43, -v24
    v_exp_f32 v79, v79
    v_mfma_f32_32x32x16_bf16 v[112:127], a[156:159], a[124:127], v[112:127]
    ds_read_b128 a[140:143], v20 offset:12288
    v_add_f32 v26, v26, v77
    v_cvt_pk_bf16_f32 v54, v76, v77
    s_waitcnt lgkmcnt(2)
    v_mfma_f32_32x32x16_bf16 v[128:143], a[128:131], v[48:51], v[128:143]
    ds_read_b128 a[144:147], v20 offset:16384
    v_fma_f32 v81, v81, s43, -v24
    v_exp_f32 v80, v80
    v_add_f32 v27, v27, v78
    v_mfma_f32_32x32x16_bf16 v[144:159], a[132:135], v[48:51], v[144:159]
    ds_read_b128 a[148:151], v20 offset:20480
    v_fma_f32 v82, v82, s43, -v24
    v_exp_f32 v81, v81
    v_add_f32 v28, v28, v79
    s_waitcnt lgkmcnt(2)
    v_mfma_f32_32x32x16_bf16 v[160:175], a[136:139], v[48:51], v[160:175]
    ds_read_b128 a[152:155], v20 offset:24576
    v_cvt_pk_bf16_f32 v55, v78, v79
    v_fma_f32 v83, v83, s43, -v24
    s_cmp_eq_u32 s69, 0
    s_cbranch_scc1 L_nosig_sg_76
    s_mov_b32 s69, 0
    s_waitcnt vmcnt(8)
    v_mov_b32 v40, s79
    s_mov_b64 exec, 1
    buffer_atomic_or v40, v43, s[28:31], 0 offen
    s_mov_b64 exec, -1
    L_nosig_sg_76:
    v_mfma_f32_32x32x16_bf16 v[176:191], a[140:143], v[48:51], v[176:191]
    ds_read_b128 a[156:159], v20 offset:28672
    v_exp_f32 v82, v82
    v_add_f32 v25, v25, v80
    v_fma_f32 v84, v84, s43, -v24
    s_waitcnt lgkmcnt(2)
    v_mfma_f32_32x32x16_bf16 v[192:207], a[144:147], v[48:51], v[192:207]
    ds_read_b128 a[128:131], v20 offset:1024
    v_exp_f32 v83, v83
    v_add_f32 v26, v26, v81
    v_cvt_pk_bf16_f32 v56, v80, v81
    s_add_u32 m0, s38, 0
    s_add_u32 s68, s35, 0
    buffer_load_dwordx4 v2, s[8:11], s68 offen offset:0 lds
    v_mfma_f32_32x32x16_bf16 v[208:223], a[148:151], v[48:51], v[208:223]
    ds_read_b128 a[132:135], v20 offset:5120
    v_fma_f32 v85, v85, s43, -v24
    v_exp_f32 v84, v84
    s_waitcnt lgkmcnt(2)
    v_mfma_f32_32x32x16_bf16 v[224:239], a[152:155], v[48:51], v[224:239]
    ds_read_b128 a[136:139], v20 offset:9216
    v_add_f32 v27, v27, v82
    v_fma_f32 v86, v86, s43, -v24
    v_exp_f32 v85, v85
    buffer_load_dwordx4 v2, s[8:11], s68 offen offset:1024 lds
    v_mfma_f32_32x32x16_bf16 v[240:255], a[156:159], v[48:51], v[240:255]
    ds_read_b128 a[140:143], v20 offset:13312
    v_add_f32 v28, v28, v83
    v_cvt_pk_bf16_f32 v57, v82, v83
    v_fma_f32 v87, v87, s43, -v24
    s_waitcnt lgkmcnt(2)
    v_mfma_f32_32x32x16_bf16 v[128:143], a[128:131], v[52:55], v[128:143]
    ds_read_b128 a[144:147], v20 offset:17408
    v_exp_f32 v86, v86
    v_add_f32 v25, v25, v84
    v_fma_f32 v88, v88, s43, -v24
    v_mfma_f32_32x32x16_bf16 v[144:159], a[132:135], v[52:55], v[144:159]
    ds_read_b128 a[148:151], v20 offset:21504
    v_exp_f32 v87, v87
    v_add_f32 v26, v26, v85
    buffer_load_dwordx4 v2, s[8:11], s68 offen offset:2048 lds
    s_waitcnt lgkmcnt(2)
    v_mfma_f32_32x32x16_bf16 v[160:175], a[136:139], v[52:55], v[160:175]
    ds_read_b128 a[152:155], v20 offset:25600
    v_cvt_pk_bf16_f32 v58, v84, v85
    v_fma_f32 v89, v89, s43, -v24
    v_exp_f32 v88, v88
    v_mfma_f32_32x32x16_bf16 v[176:191], a[140:143], v[52:55], v[176:191]
    ds_read_b128 a[156:159], v20 offset:29696
    v_add_f32 v27, v27, v86
    v_fma_f32 v90, v90, s43, -v24
    v_exp_f32 v89, v89
    buffer_load_dwordx4 v2, s[8:11], s68 offen offset:3072 lds
    s_waitcnt lgkmcnt(2)
    v_mfma_f32_32x32x16_bf16 v[192:207], a[144:147], v[52:55], v[192:207]
    ds_read_b128 a[128:131], v20 offset:2048
    v_add_f32 v28, v28, v87
    v_cvt_pk_bf16_f32 v59, v86, v87
    v_mfma_f32_32x32x16_bf16 v[208:223], a[148:151], v[52:55], v[208:223]
    ds_read_b128 a[132:135], v20 offset:6144
    v_fma_f32 v91, v91, s43, -v24
    v_exp_f32 v90, v90
    v_add_f32 v25, v25, v88
    s_waitcnt lgkmcnt(2)
    v_mfma_f32_32x32x16_bf16 v[224:239], a[152:155], v[52:55], v[224:239]
    ds_read_b128 a[136:139], v20 offset:10240
    v_fma_f32 v92, v92, s43, -v24
    v_exp_f32 v91, v91
    v_add_f32 v26, v26, v89
    s_add_u32 m0, s38, 4096
    s_add_u32 s68, s35, 4096
    buffer_load_dwordx4 v2, s[8:11], s68 offen offset:0 lds
    v_mfma_f32_32x32x16_bf16 v[240:255], a[156:159], v[52:55], v[240:255]
    ds_read_b128 a[140:143], v20 offset:14336
    v_cvt_pk_bf16_f32 v60, v88, v89
    v_fma_f32 v93, v93, s43, -v24
    s_waitcnt lgkmcnt(2)
    v_mfma_f32_32x32x16_bf16 v[128:143], a[128:131], v[56:59], v[128:143]
    ds_read_b128 a[144:147], v20 offset:18432
    v_exp_f32 v92, v92
    v_add_f32 v27, v27, v90
    v_fma_f32 v94, v94, s43, -v24
    v_mfma_f32_32x32x16_bf16 v[144:159], a[132:135], v[56:59], v[144:159]
    ds_read_b128 a[148:151], v20 offset:22528
    v_exp_f32 v93, v93
    v_add_f32 v28, v28, v91
    v_cvt_pk_bf16_f32 v61, v90, v91
    buffer_load_dwordx4 v2, s[8:11], s68 offen offset:1024 lds
    s_waitcnt lgkmcnt(2)
    v_mfma_f32_32x32x16_bf16 v[160:175], a[136:139], v[56:59], v[160:175]
    ds_read_b128 a[152:155], v20 offset:26624
    v_fma_f32 v95, v95, s43, -v24
    v_exp_f32 v94, v94
    s_add_u32 s54, s54, 1
    s_mov_b32 s55, 32768
    s_cmp_eq_u32 s54, 3
    s_cselect_b32 s55, 0xffff0000, s55
    s_cselect_b32 s54, 0, s54
    v_mfma_f32_32x32x16_bf16 v[176:191], a[140:143], v[56:59], v[176:191]
    ds_read_b128 a[156:159], v20 offset:30720
    v_add_f32 v25, v25, v92
    v_exp_f32 v95, v95
    v_add_f32 v26, v26, v93
    buffer_load_dwordx4 v2, s[8:11], s68 offen offset:2048 lds
    s_waitcnt lgkmcnt(2)
    v_mfma_f32_32x32x16_bf16 v[192:207], a[144:147], v[56:59], v[192:207]
    ds_read_b128 a[128:131], v20 offset:3072
    v_add_f32 v27, v27, v94
    v_add_f32 v28, v28, v95
    v_cvt_pk_bf16_f32 v62, v92, v93
    v_mfma_f32_32x32x16_bf16 v[208:223], a[148:151], v[56:59], v[208:223]
    ds_read_b128 a[132:135], v20 offset:7168
    v_cvt_pk_bf16_f32 v63, v94, v95
    v_subrev_u32 v29, 64, v29
    v_add_u32 v12, s55, v12
    s_waitcnt lgkmcnt(2)
    v_mfma_f32_32x32x16_bf16 v[224:239], a[152:155], v[56:59], v[224:239]
    ds_read_b128 a[136:139], v20 offset:11264
    buffer_load_dwordx4 v2, s[8:11], s68 offen offset:3072 lds
    v_mfma_f32_32x32x16_bf16 v[240:255], a[156:159], v[56:59], v[240:255]
    ds_read_b128 a[140:143], v20 offset:15360
    s_waitcnt lgkmcnt(2)
    v_mfma_f32_32x32x16_bf16 v[128:143], a[128:131], v[60:63], v[128:143]
    ds_read_b128 a[144:147], v20 offset:19456
    s_add_u32 s35, s35, 32768
    s_sub_u32 s49, s49, 1
    s_cmp_eq_u32 s49, 0
    s_cselect_b32 s35, s47, s35
    s_sub_u32 s51, s51, 1
    s_cmp_eq_u32 s51, 0
    s_cselect_b32 s35, 0x80000000, s35
    s_cselect_b32 s47, 0x80000000, s47
    v_mfma_f32_32x32x16_bf16 v[144:159], a[132:135], v[60:63], v[144:159]
    ds_read_b128 a[148:151], v20 offset:23552
    s_waitcnt lgkmcnt(2)
    v_mfma_f32_32x32x16_bf16 v[160:175], a[136:139], v[60:63], v[160:175]
    ds_read_b128 a[152:155], v20 offset:27648
    v_mfma_f32_32x32x16_bf16 v[176:191], a[140:143], v[60:63], v[176:191]
    ds_read_b128 a[156:159], v20 offset:31744
    s_add_u32 s38, s38, 32768
    s_cmp_ge_u32 s38, 98304
    s_cselect_b32 s68, 98304, 0
    s_sub_u32 s38, s38, s68
    s_waitcnt lgkmcnt(2)
    v_mfma_f32_32x32x16_bf16 v[192:207], a[144:147], v[60:63], v[192:207]
    ds_read_b128 a[128:131], v12 offset:0
    v_mfma_f32_32x32x16_bf16 v[208:223], a[148:151], v[60:63], v[208:223]
    ds_read_b128 a[132:135], v12 offset:1024
    s_waitcnt lgkmcnt(2)
    v_mfma_f32_32x32x16_bf16 v[224:239], a[152:155], v[60:63], v[224:239]
    ds_read_b128 a[136:139], v12 offset:2048
    v_mfma_f32_32x32x16_bf16 v[240:255], a[156:159], v[60:63], v[240:255]
    ds_read_b128 a[140:143], v12 offset:3072
    s_branch L_y1
L_ym1:
    s_waitcnt lgkmcnt(2)
    v_mfma_f32_32x32x16_bf16 v[64:79], a[128:131], a[64:67], 0
    ds_read_b128 a[144:147], v12 offset:4096
    v_mov_b32 v38, 0xff800000
    v_cmp_lt_i32 s[60:61], v29, 0
    v_cmp_lt_i32 s[62:63], v29, 1
    v_cmp_lt_i32 s[64:65], v29, 2
    v_cmp_lt_i32 s[66:67], v29, 3
    v_cndmask_b32 v96, v96, v38, s[60:61]
    v_cndmask_b32 v97, v97, v38, s[62:63]
    v_cndmask_b32 v98, v98, v38, s[64:65]
    v_cndmask_b32 v99, v99, v38, s[66:67]
    v_cmp_lt_i32 s[60:61], v29, 8
    v_cmp_lt_i32 s[62:63], v29, 9
    v_cmp_lt_i32 s[64:65], v29, 10
    v_cmp_lt_i32 s[66:67], v29, 11
    v_cndmask_b32 v100, v100, v38, s[60:61]
    v_cndmask_b32 v101, v101, v38, s[62:63]
    v_cndmask_b32 v102, v102, v38, s[64:65]
    v_cndmask_b32 v103, v103, v38, s[66:67]
    v_mfma_f32_32x32x16_bf16 v[64:79], a[132:135], a[68:71], v[64:79]
    ds_read_b128 a[148:151], v12 offset:5120
    v_cmp_lt_i32 s[60:61], v29, 16
    v_cmp_lt_i32 s[62:63], v29, 17
    v_cmp_lt_i32 s[64:65], v29, 18
    v_cmp_lt_i32 s[66:67], v29, 19
    v_cndmask_b32 v104, v104, v38, s[60:61]
    v_cndmask_b32 v105, v105, v38, s[62:63]
    v_cndmask_b32 v106, v106, v38, s[64:65]
    v_cndmask_b32 v107, v107, v38, s[66:67]
    v_cmp_lt_i32 s[60:61], v29, 24
    v_cmp_lt_i32 s[62:63], v29, 25
    v_cmp_lt_i32 s[64:65], v29, 26
    v_cmp_lt_i32 s[66:67], v29, 27
    v_cndmask_b32 v108, v108, v38, s[60:61]
    v_cndmask_b32 v109, v109, v38, s[62:63]
    v_cndmask_b32 v110, v110, v38, s[64:65]
    v_cndmask_b32 v111, v111, v38, s[66:67]
    buffer_load_dword v42, v43, s[28:31], 0 offen sc1
    s_waitcnt lgkmcnt(2)
    v_mfma_f32_32x32x16_bf16 v[64:79], a[136:139], a[72:75], v[64:79]
    ds_read_b128 a[152:155], v12 offset:6144
    v_cmp_lt_i32 s[60:61], v29, 32
    v_cmp_lt_i32 s[62:63], v29, 33
    v_cmp_lt_i32 s[64:65], v29, 34
    v_cmp_lt_i32 s[66:67], v29, 35
    v_cndmask_b32 v112, v112, v38, s[60:61]
    v_cndmask_b32 v113, v113, v38, s[62:63]
    v_cndmask_b32 v114, v114, v38, s[64:65]
    v_cndmask_b32 v115, v115, v38, s[66:67]
    v_cmp_lt_i32 s[60:61], v29, 40
    v_cmp_lt_i32 s[62:63], v29, 41
    v_cmp_lt_i32 s[64:65], v29, 42
    v_cmp_lt_i32 s[66:67], v29, 43
    v_cndmask_b32 v116, v116, v38, s[60:61]
    v_cndmask_b32 v117, v117, v38, s[62:63]
    v_cndmask_b32 v118, v118, v38, s[64:65]
    v_cndmask_b32 v119, v119, v38, s[66:67]
    s_add_u32 m0, s56, 98304
    s_add_u32 s68, s36, 0
    buffer_load_dwordx4 v2, s[12:15], s68 offen offset:0 lds
    v_mfma_f32_32x32x16_bf16 v[64:79], a[140:143], a[76:79], v[64:79]
    ds_read_b128 a[156:159], v12 offset:7168
    v_cmp_lt_i32 s[60:61], v29, 48
    v_cmp_lt_i32 s[62:63], v29, 49
    v_cmp_lt_i32 s[64:65], v29, 50
    v_cmp_lt_i32 s[66:67], v29, 51
    v_cndmask_b32 v120, v120, v38, s[60:61]
    v_cndmask_b32 v121, v121, v38, s[62:63]
    v_cndmask_b32 v122, v122, v38, s[64:65]
    v_cndmask_b32 v123, v123, v38, s[66:67]
    v_cmp_lt_i32 s[60:61], v29, 56
    v_cmp_lt_i32 s[62:63], v29, 57
    v_cmp_lt_i32 s[64:65], v29, 58
    v_cmp_lt_i32 s[66:67], v29, 59
    v_cndmask_b32 v124, v124, v38, s[60:61]
    v_cndmask_b32 v125, v125, v38, s[62:63]
    v_cndmask_b32 v126, v126, v38, s[64:65]
    v_cndmask_b32 v127, v127, v38, s[66:67]
    s_waitcnt lgkmcnt(2)
    v_mfma_f32_32x32x16_bf16 v[64:79], a[144:147], a[80:83], v[64:79]
    ds_read_b128 a[128:131], v12 offset:8192
    v_max3_f32 v30, v96, v97, v98
    v_max3_f32 v31, v99, v100, v101
    v_mfma_f32_32x32x16_bf16 v[64:79], a[148:151], a[84:87], v[64:79]
    ds_read_b128 a[132:135], v12 offset:9216
    v_max3_f32 v30, v30, v102, v103
    v_max3_f32 v31, v31, v104, v105
    buffer_load_dwordx4 v2, s[12:15], s68 offen offset:1024 lds
    s_waitcnt lgkmcnt(2)
    v_mfma_f32_32x32x16_bf16 v[64:79], a[152:155], a[88:91], v[64:79]
    ds_read_b128 a[136:139], v12 offset:10240
    v_max3_f32 v30, v30, v106, v107
    v_max3_f32 v31, v31, v108, v109
    v_max3_f32 v30, v30, v110, v111
    v_mfma_f32_32x32x16_bf16 v[64:79], a[156:159], a[92:95], v[64:79]
    ds_read_b128 a[140:143], v12 offset:11264
    v_max3_f32 v31, v31, v112, v113
    v_max3_f32 v30, v30, v114, v115
    s_waitcnt lgkmcnt(2)
    v_mfma_f32_32x32x16_bf16 v[64:79], a[128:131], a[96:99], v[64:79]
    ds_read_b128 a[144:147], v12 offset:12288
    v_max3_f32 v31, v31, v116, v117
    v_max3_f32 v30, v30, v118, v119
    buffer_load_dwordx4 v2, s[12:15], s68 offen offset:2048 lds
    v_mfma_f32_32x32x16_bf16 v[64:79], a[132:135], a[100:103], v[64:79]
    ds_read_b128 a[148:151], v12 offset:13312
    v_max3_f32 v31, v31, v120, v121
    v_max3_f32 v30, v30, v122, v123
    s_waitcnt lgkmcnt(2)
    v_mfma_f32_32x32x16_bf16 v[64:79], a[136:139], a[104:107], v[64:79]
    ds_read_b128 a[152:155], v12 offset:14336
    v_max3_f32 v31, v31, v124, v125
    v_max3_f32 v30, v30, v126, v127
    v_mfma_f32_32x32x16_bf16 v[64:79], a[140:143], a[108:111], v[64:79]
    ds_read_b128 a[156:159], v12 offset:15360
    v_max_f32 v30, v30, v31
    v_mov_b32 v31, v30
    s_nop 1
    v_permlane32_swap_b32 v30, v31
    v_max_f32 v30, v30, v31
    v_fma_f32 v31, v30, s43, -v24
    v_cmp_lt_f32 vcc, s44, v31
    s_cbranch_vccnz L_resc_a_77
    L_resc_ret_a_77:
    buffer_load_dwordx4 v2, s[12:15], s68 offen offset:3072 lds
    s_waitcnt lgkmcnt(2)
    v_mfma_f32_32x32x16_bf16 v[64:79], a[144:147], a[112:115], v[64:79]
    ds_read_b128 a[128:131], v12 offset:16384
    v_fma_f32 v96, v96, s43, -v24
    v_fma_f32 v97, v97, s43, -v24
    v_exp_f32 v96, v96
    v_mfma_f32_32x32x16_bf16 v[64:79], a[148:151], a[116:119], v[64:79]
    ds_read_b128 a[132:135], v12 offset:17408
    v_fma_f32 v98, v98, s43, -v24
    v_exp_f32 v97, v97
    v_fma_f32 v99, v99, s43, -v24
    s_waitcnt lgkmcnt(2)
    v_mfma_f32_32x32x16_bf16 v[64:79], a[152:155], a[120:123], v[64:79]
    ds_read_b128 a[136:139], v12 offset:18432
    v_exp_f32 v98, v98
    v_add_f32 v25, v25, v96
    v_fma_f32 v100, v100, s43, -v24
    s_add_u32 m0, s56, 102400
    s_add_u32 s68, s36, 4096
    buffer_load_dwordx4 v2, s[12:15], s68 offen offset:0 lds
    v_mfma_f32_32x32x16_bf16 v[64:79], a[156:159], a[124:127], v[64:79]
    ds_read_b128 a[140:143], v12 offset:19456
    v_exp_f32 v99, v99
    v_add_f32 v26, v26, v97
    s_waitcnt lgkmcnt(2)
    v_mfma_f32_32x32x16_bf16 v[80:95], a[128:131], a[64:67], 0
    ds_read_b128 a[144:147], v12 offset:20480
    v_cvt_pk_bf16_f32 v48, v96, v97
    v_fma_f32 v101, v101, s43, -v24
    v_exp_f32 v100, v100
    v_mfma_f32_32x32x16_bf16 v[80:95], a[132:135], a[68:71], v[80:95]
    ds_read_b128 a[148:151], v12 offset:21504
    v_add_f32 v27, v27, v98
    v_fma_f32 v102, v102, s43, -v24
    v_exp_f32 v101, v101
    buffer_load_dwordx4 v2, s[12:15], s68 offen offset:1024 lds
    s_waitcnt lgkmcnt(2)
    v_mfma_f32_32x32x16_bf16 v[80:95], a[136:139], a[72:75], v[80:95]
    ds_read_b128 a[152:155], v12 offset:22528
    v_add_f32 v28, v28, v99
    v_cvt_pk_bf16_f32 v49, v98, v99
    v_mfma_f32_32x32x16_bf16 v[80:95], a[140:143], a[76:79], v[80:95]
    ds_read_b128 a[156:159], v12 offset:23552
    v_fma_f32 v103, v103, s43, -v24
    v_exp_f32 v102, v102
    v_add_f32 v25, v25, v100
    s_waitcnt lgkmcnt(2)
    v_mfma_f32_32x32x16_bf16 v[80:95], a[144:147], a[80:83], v[80:95]
    ds_read_b128 a[128:131], v12 offset:24576
    v_fma_f32 v104, v104, s43, -v24
    v_exp_f32 v103, v103
    v_add_f32 v26, v26, v101
    buffer_load_dwordx4 v2, s[12:15], s68 offen offset:2048 lds
    v_mfma_f32_32x32x16_bf16 v[80:95], a[148:151], a[84:87], v[80:95]
    ds_read_b128 a[132:135], v12 offset:25600
    v_cvt_pk_bf16_f32 v50, v100, v101
    v_fma_f32 v105, v105, s43, -v24
    s_waitcnt lgkmcnt(2)
    v_mfma_f32_32x32x16_bf16 v[80:95], a[152:155], a[88:91], v[80:95]
    ds_read_b128 a[136:139], v12 offset:26624
    v_exp_f32 v104, v104
    v_add_f32 v27, v27, v102
    v_fma_f32 v106, v106, s43, -v24
    v_mfma_f32_32x32x16_bf16 v[80:95], a[156:159], a[92:95], v[80:95]
    ds_read_b128 a[140:143], v12 offset:27648
    v_exp_f32 v105, v105
    v_add_f32 v28, v28, v103
    v_cvt_pk_bf16_f32 v51, v102, v103
    buffer_load_dwordx4 v2, s[12:15], s68 offen offset:3072 lds
    s_waitcnt lgkmcnt(2)
    v_mfma_f32_32x32x16_bf16 v[80:95], a[128:131], a[96:99], v[80:95]
    ds_read_b128 a[144:147], v12 offset:28672
    v_fma_f32 v107, v107, s43, -v24
    v_exp_f32 v106, v106
    v_mfma_f32_32x32x16_bf16 v[80:95], a[132:135], a[100:103], v[80:95]
    ds_read_b128 a[148:151], v12 offset:29696
    v_add_f32 v25, v25, v104
    v_fma_f32 v108, v108, s43, -v24
    v_exp_f32 v107, v107
    s_waitcnt lgkmcnt(2)
    v_mfma_f32_32x32x16_bf16 v[80:95], a[136:139], a[104:107], v[80:95]
    ds_read_b128 a[152:155], v12 offset:30720
    v_add_f32 v26, v26, v105
    v_cvt_pk_bf16_f32 v52, v104, v105
    v_fma_f32 v109, v109, s43, -v24
    s_add_u32 s36, s36, 32768
    s_sub_u32 s50, s50, 1
    s_cmp_eq_u32 s50, 0
    s_cselect_b32 s36, s48, s36
    s_sub_u32 s52, s52, 1
    s_cmp_eq_u32 s52, 0
    s_cselect_b32 s36, 0x80000000, s36
    s_cselect_b32 s48, 0x80000000, s48
    v_mfma_f32_32x32x16_bf16 v[80:95], a[140:143], a[108:111], v[80:95]
    ds_read_b128 a[156:159], v12 offset:31744
    v_exp_f32 v108, v108
    v_add_f32 v27, v27, v106
    v_fma_f32 v110, v110, s43, -v24
    s_waitcnt lgkmcnt(2)
    v_mfma_f32_32x32x16_bf16 v[80:95], a[144:147], a[112:115], v[80:95]
    ds_read_b128 a[128:131], v20 offset:32768
    v_exp_f32 v109, v109
    v_add_f32 v28, v28, v107
    v_mfma_f32_32x32x16_bf16 v[80:95], a[148:151], a[116:119], v[80:95]
    ds_read_b128 a[132:135], v20 offset:36864
    v_cvt_pk_bf16_f32 v53, v106, v107
    v_fma_f32 v111, v111, s43, -v24
    v_exp_f32 v110, v110
    s_waitcnt lgkmcnt(2)
    v_mfma_f32_32x32x16_bf16 v[80:95], a[152:155], a[120:123], v[80:95]
    ds_read_b128 a[136:139], v20 offset:40960
    v_add_f32 v25, v25, v108
    v_fma_f32 v112, v112, s43, -v24
    v_exp_f32 v111, v111
    v_mfma_f32_32x32x16_bf16 v[80:95], a[156:159], a[124:127], v[80:95]
    ds_read_b128 a[140:143], v20 offset:45056
    v_add_f32 v26, v26, v109
    v_cvt_pk_bf16_f32 v54, v108, v109
    s_waitcnt lgkmcnt(2)
    v_mfma_f32_32x32x16_bf16 v[128:143], a[128:131], v[48:51], v[128:143]
    ds_read_b128 a[144:147], v20 offset:49152
    v_fma_f32 v113, v113, s43, -v24
    v_exp_f32 v112, v112
    v_add_f32 v27, v27, v110
    v_mfma_f32_32x32x16_bf16 v[144:159], a[132:135], v[48:51], v[144:159]
    ds_read_b128 a[148:151], v20 offset:53248
    v_fma_f32 v114, v114, s43, -v24
    v_exp_f32 v113, v113
    v_add_f32 v28, v28, v111
    s_waitcnt lgkmcnt(2)
    v_mfma_f32_32x32x16_bf16 v[160:175], a[136:139], v[48:51], v[160:175]
    ds_read_b128 a[152:155], v20 offset:57344
    v_cvt_pk_bf16_f32 v55, v110, v111
    v_fma_f32 v115, v115, s43, -v24
    s_cmp_eq_u32 s69, 0
    s_cbranch_scc1 L_nosig_sg_78
    s_mov_b32 s69, 0
    s_waitcnt vmcnt(8)
    v_mov_b32 v40, s79
    s_mov_b64 exec, 1
    buffer_atomic_or v40, v43, s[28:31], 0 offen
    s_mov_b64 exec, -1
    L_nosig_sg_78:
    v_mfma_f32_32x32x16_bf16 v[176:191], a[140:143], v[48:51], v[176:191]
    ds_read_b128 a[156:159], v20 offset:61440
    v_exp_f32 v114, v114
    v_add_f32 v25, v25, v112
    v_fma_f32 v116, v116, s43, -v24
    s_waitcnt lgkmcnt(2)
    v_mfma_f32_32x32x16_bf16 v[192:207], a[144:147], v[48:51], v[192:207]
    ds_read_b128 a[128:131], v20 offset:33792
    v_exp_f32 v115, v115
    v_add_f32 v26, v26, v113
    v_cvt_pk_bf16_f32 v56, v112, v113
    s_add_u32 m0, s38, 0
    s_add_u32 s68, s35, 0
    buffer_load_dwordx4 v2, s[8:11], s68 offen offset:0 lds
    v_mfma_f32_32x32x16_bf16 v[208:223], a[148:151], v[48:51], v[208:223]
    ds_read_b128 a[132:135], v20 offset:37888
    v_fma_f32 v117, v117, s43, -v24
    v_exp_f32 v116, v116
    s_waitcnt lgkmcnt(2)
    v_mfma_f32_32x32x16_bf16 v[224:239], a[152:155], v[48:51], v[224:239]
    ds_read_b128 a[136:139], v20 offset:41984
    v_add_f32 v27, v27, v114
    v_fma_f32 v118, v118, s43, -v24
    v_exp_f32 v117, v117
    buffer_load_dwordx4 v2, s[8:11], s68 offen offset:1024 lds
    v_mfma_f32_32x32x16_bf16 v[240:255], a[156:159], v[48:51], v[240:255]
    ds_read_b128 a[140:143], v20 offset:46080
    v_add_f32 v28, v28, v115
    v_cvt_pk_bf16_f32 v57, v114, v115
    v_fma_f32 v119, v119, s43, -v24
    s_waitcnt lgkmcnt(2)
    v_mfma_f32_32x32x16_bf16 v[128:143], a[128:131], v[52:55], v[128:143]
    ds_read_b128 a[144:147], v20 offset:50176
    v_exp_f32 v118, v118
    v_add_f32 v25, v25, v116
    v_fma_f32 v120, v120, s43, -v24
    v_mfma_f32_32x32x16_bf16 v[144:159], a[132:135], v[52:55], v[144:159]
    ds_read_b128 a[148:151], v20 offset:54272
    v_exp_f32 v119, v119
    v_add_f32 v26, v26, v117
    buffer_load_dwordx4 v2, s[8:11], s68 offen offset:2048 lds
    s_waitcnt lgkmcnt(2)
    v_mfma_f32_32x32x16_bf16 v[160:175], a[136:139], v[52:55], v[160:175]
    ds_read_b128 a[152:155], v20 offset:58368
    v_cvt_pk_bf16_f32 v58, v116, v117
    v_fma_f32 v121, v121, s43, -v24
    v_exp_f32 v120, v120
    v_mfma_f32_32x32x16_bf16 v[176:191], a[140:143], v[52:55], v[176:191]
    ds_read_b128 a[156:159], v20 offset:62464
    v_add_f32 v27, v27, v118
    v_fma_f32 v122, v122, s43, -v24
    v_exp_f32 v121, v121
    buffer_load_dwordx4 v2, s[8:11], s68 offen offset:3072 lds
    s_waitcnt lgkmcnt(2)
    v_mfma_f32_32x32x16_bf16 v[192:207], a[144:147], v[52:55], v[192:207]
    ds_read_b128 a[128:131], v20 offset:34816
    v_add_f32 v28, v28, v119
    v_cvt_pk_bf16_f32 v59, v118, v119
    v_mfma_f32_32x32x16_bf16 v[208:223], a[148:151], v[52:55], v[208:223]
    ds_read_b128 a[132:135], v20 offset:38912
    v_fma_f32 v123, v123, s43, -v24
    v_exp_f32 v122, v122
    v_add_f32 v25, v25, v120
    s_waitcnt lgkmcnt(2)
    v_mfma_f32_32x32x16_bf16 v[224:239], a[152:155], v[52:55], v[224:239]
    ds_read_b128 a[136:139], v20 offset:43008
    v_fma_f32 v124, v124, s43, -v24
    v_exp_f32 v123, v123
    v_add_f32 v26, v26, v121
    s_add_u32 m0, s38, 4096
    s_add_u32 s68, s35, 4096
    buffer_load_dwordx4 v2, s[8:11], s68 offen offset:0 lds
    v_mfma_f32_32x32x16_bf16 v[240:255], a[156:159], v[52:55], v[240:255]
    ds_read_b128 a[140:143], v20 offset:47104
    v_cvt_pk_bf16_f32 v60, v120, v121
    v_fma_f32 v125, v125, s43, -v24
    s_waitcnt lgkmcnt(2)
    v_mfma_f32_32x32x16_bf16 v[128:143], a[128:131], v[56:59], v[128:143]
    ds_read_b128 a[144:147], v20 offset:51200
    v_exp_f32 v124, v124
    v_add_f32 v27, v27, v122
    v_fma_f32 v126, v126, s43, -v24
    v_mfma_f32_32x32x16_bf16 v[144:159], a[132:135], v[56:59], v[144:159]
    ds_read_b128 a[148:151], v20 offset:55296
    v_exp_f32 v125, v125
    v_add_f32 v28, v28, v123
    v_cvt_pk_bf16_f32 v61, v122, v123
    buffer_load_dwordx4 v2, s[8:11], s68 offen offset:1024 lds
    s_waitcnt lgkmcnt(2)
    v_mfma_f32_32x32x16_bf16 v[160:175], a[136:139], v[56:59], v[160:175]
    ds_read_b128 a[152:155], v20 offset:59392
    v_fma_f32 v127, v127, s43, -v24
    v_exp_f32 v126, v126
    s_add_u32 s54, s54, 1
    s_mov_b32 s55, 32768
    s_cmp_eq_u32 s54, 3
    s_cselect_b32 s55, 0xffff0000, s55
    s_cselect_b32 s54, 0, s54
    v_mfma_f32_32x32x16_bf16 v[176:191], a[140:143], v[56:59], v[176:191]
    ds_read_b128 a[156:159], v20 offset:63488
    v_add_f32 v25, v25, v124
    v_exp_f32 v127, v127
    v_add_f32 v26, v26, v125
    buffer_load_dwordx4 v2, s[8:11], s68 offen offset:2048 lds
    s_waitcnt lgkmcnt(2)
    v_mfma_f32_32x32x16_bf16 v[192:207], a[144:147], v[56:59], v[192:207]
    ds_read_b128 a[128:131], v20 offset:35840
    v_add_f32 v27, v27, v126
    v_add_f32 v28, v28, v127
    v_cvt_pk_bf16_f32 v62, v124, v125
    v_mfma_f32_32x32x16_bf16 v[208:223], a[148:151], v[56:59], v[208:223]
    ds_read_b128 a[132:135], v20 offset:39936
    v_cvt_pk_bf16_f32 v63, v126, v127
    v_subrev_u32 v29, 64, v29
    v_add_u32 v12, s55, v12
    s_waitcnt lgkmcnt(2)
    v_mfma_f32_32x32x16_bf16 v[224:239], a[152:155], v[56:59], v[224:239]
    ds_read_b128 a[136:139], v20 offset:44032
    buffer_load_dwordx4 v2, s[8:11], s68 offen offset:3072 lds
    v_mfma_f32_32x32x16_bf16 v[240:255], a[156:159], v[56:59], v[240:255]
    ds_read_b128 a[140:143], v20 offset:48128
    s_waitcnt lgkmcnt(2)
    v_mfma_f32_32x32x16_bf16 v[128:143], a[128:131], v[60:63], v[128:143]
    ds_read_b128 a[144:147], v20 offset:52224
    s_add_u32 s35, s35, 32768
    s_sub_u32 s49, s49, 1
    s_cmp_eq_u32 s49, 0
    s_cselect_b32 s35, s47, s35
    s_sub_u32 s51, s51, 1
    s_cmp_eq_u32 s51, 0
    s_cselect_b32 s35, 0x80000000, s35
    s_cselect_b32 s47, 0x80000000, s47
    v_mfma_f32_32x32x16_bf16 v[144:159], a[132:135], v[60:63], v[144:159]
    ds_read_b128 a[148:151], v20 offset:56320
    s_waitcnt lgkmcnt(2)
    v_mfma_f32_32x32x16_bf16 v[160:175], a[136:139], v[60:63], v[160:175]
    ds_read_b128 a[152:155], v20 offset:60416
    v_mfma_f32_32x32x16_bf16 v[176:191], a[140:143], v[60:63], v[176:191]
    ds_read_b128 a[156:159], v20 offset:64512
    s_add_u32 s38, s38, 32768
    s_cmp_ge_u32 s38, 98304
    s_cselect_b32 s68, 98304, 0
    s_sub_u32 s38, s38, s68
    s_waitcnt lgkmcnt(2)
    v_mfma_f32_32x32x16_bf16 v[192:207], a[144:147], v[60:63], v[192:207]
    ds_read_b128 a[128:131], v12 offset:0
    v_mfma_f32_32x32x16_bf16 v[208:223], a[148:151], v[60:63], v[208:223]
    ds_read_b128 a[132:135], v12 offset:1024
    s_waitcnt lgkmcnt(2)
    v_mfma_f32_32x32x16_bf16 v[224:239], a[152:155], v[60:63], v[224:239]
    ds_read_b128 a[136:139], v12 offset:2048
    v_mfma_f32_32x32x16_bf16 v[240:255], a[156:159], v[60:63], v[240:255]
    ds_read_b128 a[140:143], v12 offset:3072
    s_branch L_y0
L_yl0:
    s_mov_b32 s57, 1
    s_cmp_eq_u32 s40, 0
    s_cbranch_scc1 L_go_fs_80
    s_waitcnt vmcnt(8)
    v_readfirstlane_b32 s57, v42
    s_nop 3
    s_and_b32 s57, s57, s79
    s_cmp_eq_u32 s57, 0
    s_cbranch_scc1 L_late_fs_80
L_poll_pp_81:
    s_waitcnt vmcnt(0)
    v_readfirstlane_b32 s37, v42
    s_nop 3
    s_and_b32 s37, s37, s79
    s_cmp_lg_u32 s37, 0
    s_cbranch_scc1 L_pok_pp_81
    s_sleep 1
    buffer_load_dword v42, v43, s[28:31], 0 offen sc1
    s_branch L_poll_pp_81
L_pok_pp_81:
    s_mul_i32 s37, s58, 69632
    s_mul_i32 s45, s32, 17408
    s_add_u32 s37, s37, s45
    v_lshlrev_b32 v34, 4, v1
    buffer_load_dwordx4 a[160:163], v34, s[20:23], s37 offen offset:0 sc1
    buffer_load_dwordx4 a[164:167], v34, s[20:23], s37 offen offset:1024 sc1
    buffer_load_dwordx4 a[168:171], v34, s[20:23], s37 offen offset:2048 sc1
    buffer_load_dwordx4 a[172:175], v34, s[20:23], s37 offen offset:3072 sc1
    s_add_u32 s37, s37, 4096
    buffer_load_dwordx4 a[176:179], v34, s[20:23], s37 offen offset:0 sc1
    buffer_load_dwordx4 a[180:183], v34, s[20:23], s37 offen offset:1024 sc1
    buffer_load_dwordx4 a[184:187], v34, s[20:23], s37 offen offset:2048 sc1
    buffer_load_dwordx4 a[188:191], v34, s[20:23], s37 offen offset:3072 sc1
    s_add_u32 s37, s37, 4096
    buffer_load_dwordx4 a[192:195], v34, s[20:23], s37 offen offset:0 sc1
    buffer_load_dwordx4 a[196:199], v34, s[20:23], s37 offen offset:1024 sc1
    buffer_load_dwordx4 a[200:203], v34, s[20:23], s37 offen offset:2048 sc1
    buffer_load_dwordx4 a[204:207], v34, s[20:23], s37 offen offset:3072 sc1
    s_add_u32 s37, s37, 4096
    buffer_load_dwordx4 a[208:211], v34, s[20:23], s37 offen offset:0 sc1
    buffer_load_dwordx4 a[212:215], v34, s[20:23], s37 offen offset:1024 sc1
    buffer_load_dwordx4 a[216:219], v34, s[20:23], s37 offen offset:2048 sc1
    buffer_load_dwordx4 a[220:223], v34, s[20:23], s37 offen offset:3072 sc1
    s_add_u32 s37, s37, 4096
    buffer_load_dwordx2 v[44:45], v34, s[20:23], s37 offen sc1
    s_branch L_go_fs_80
L_late_fs_80:
    buffer_load_dword v42, v43, s[28:31], 0 offen sc1
L_go_fs_80:
    s_waitcnt lgkmcnt(0)
    ds_read_b128 a[128:131], v20 offset:0
    ds_read_b128 a[132:135], v20 offset:4096
    ds_read_b128 a[136:139], v20 offset:8192
    ds_read_b128 a[140:143], v20 offset:12288
    v_mov_b32 v38, 0xff800000
    v_cmp_lt_i32 s[60:61], v29, 0
    v_cmp_lt_i32 s[62:63], v29, 1
    v_cmp_lt_i32 s[64:65], v29, 2
    v_cmp_lt_i32 s[66:67], v29, 3
    v_cndmask_b32 v64, v64, v38, s[60:61]
    v_cndmask_b32 v65, v65, v38, s[62:63]
    v_cndmask_b32 v66, v66, v38, s[64:65]
    v_cndmask_b32 v67, v67, v38, s[66:67]
    v_cmp_lt_i32 s[60:61], v29, 8
    v_cmp_lt_i32 s[62:63], v29, 9
    v_cmp_lt_i32 s[64:65], v29, 10
    v_cmp_lt_i32 s[66:67], v29, 11
    v_cndmask_b32 v68, v68, v38, s[60:61]
    v_cndmask_b32 v69, v69, v38, s[62:63]
    v_cndmask_b32 v70, v70, v38, s[64:65]
    v_cndmask_b32 v71, v71, v38, s[66:67]
    v_cmp_lt_i32 s[60:61], v29, 16
    v_cmp_lt_i32 s[62:63], v29, 17
    v_cmp_lt_i32 s[64:65], v29, 18
    v_cmp_lt_i32 s[66:67], v29, 19
    v_cndmask_b32 v72, v72, v38, s[60:61]
    v_cndmask_b32 v73, v73, v38, s[62:63]
    v_cndmask_b32 v74, v74, v38, s[64:65]
    v_cndmask_b32 v75, v75, v38, s[66:67]
    v_cmp_lt_i32 s[60:61], v29, 24
    v_cmp_lt_i32 s[62:63], v29, 25
    v_cmp_lt_i32 s[64:65], v29, 26
    v_cmp_lt_i32 s[66:67], v29, 27
    v_cndmask_b32 v76, v76, v38, s[60:61]
    v_cndmask_b32 v77, v77, v38, s[62:63]
    v_cndmask_b32 v78, v78, v38, s[64:65]
    v_cndmask_b32 v79, v79, v38, s[66:67]
    v_cmp_lt_i32 s[60:61], v29, 32
    v_cmp_lt_i32 s[62:63], v29, 33
    v_cmp_lt_i32 s[64:65], v29, 34
    v_cmp_lt_i32 s[66:67], v29, 35
    v_cndmask_b32 v80, v80, v38, s[60:61]
    v_cndmask_b32 v81, v81, v38, s[62:63]
    v_cndmask_b32 v82, v82, v38, s[64:65]
    v_cndmask_b32 v83, v83, v38, s[66:67]
    v_cmp_lt_i32 s[60:61], v29, 40
    v_cmp_lt_i32 s[62:63], v29, 41
    v_cmp_lt_i32 s[64:65], v29, 42
    v_cmp_lt_i32 s[66:67], v29, 43
    v_cndmask_b32 v84, v84, v38, s[60:61]
    v_cndmask_b32 v85, v85, v38, s[62:63]
    v_cndmask_b32 v86, v86, v38, s[64:65]
    v_cndmask_b32 v87, v87, v38, s[66:67]
    v_cmp_lt_i32 s[60:61], v29, 48
    v_cmp_lt_i32 s[62:63], v29, 49
    v_cmp_lt_i32 s[64:65], v29, 50
    v_cmp_lt_i32 s[66:67], v29, 51
    v_cndmask_b32 v88, v88, v38, s[60:61]
    v_cndmask_b32 v89, v89, v38, s[62:63]
    v_cndmask_b32 v90, v90, v38, s[64:65]
    v_cndmask_b32 v91, v91, v38, s[66:67]
    v_cmp_lt_i32 s[60:61], v29, 56
    v_cmp_lt_i32 s[62:63], v29, 57
    v_cmp_lt_i32 s[64:65], v29, 58
    v_cmp_lt_i32 s[66:67], v29, 59
    v_cndmask_b32 v92, v92, v38, s[60:61]
    v_cndmask_b32 v93, v93, v38, s[62:63]
    v_cndmask_b32 v94, v94, v38, s[64:65]
    v_cndmask_b32 v95, v95, v38, s[66:67]
    v_max3_f32 v30, v64, v65, v66
    v_max3_f32 v31, v67, v68, v69
    v_max3_f32 v30, v30, v70, v71
    v_max3_f32 v31, v31, v72, v73
    v_max3_f32 v30, v30, v74, v75
    v_max3_f32 v31, v31, v76, v77
    v_max3_f32 v30, v30, v78, v79
    v_max3_f32 v31, v31, v80, v81
    v_max3_f32 v30, v30, v82, v83
    v_max3_f32 v31, v31, v84, v85
    v_max3_f32 v30, v30, v86, v87
    v_max3_f32 v31, v31, v88, v89
    v_max3_f32 v30, v30, v90, v91
    v_max3_f32 v31, v31, v92, v93
    v_max3_f32 v30, v30, v94, v95
    v_max_f32 v30, v30, v31
    v_mov_b32 v31, v30
    s_nop 1
    v_permlane32_swap_b32 v30, v31
    v_max_f32 v30, v30, v31
    v_fma_f32 v31, v30, s43, -v24
    v_cmp_lt_f32 vcc, s44, v31
    s_cbranch_vccnz L_resc_a_79
    L_resc_ret_a_79:
    v_fma_f32 v64, v64, s43, -v24
    v_fma_f32 v65, v65, s43, -v24
    v_exp_f32 v64, v64
    v_fma_f32 v66, v66, s43, -v24
    v_exp_f32 v65, v65
    v_fma_f32 v67, v67, s43, -v24
    v_exp_f32 v66, v66
    v_add_f32 v25, v25, v64
    v_fma_f32 v68, v68, s43, -v24
    v_exp_f32 v67, v67
    v_add_f32 v26, v26, v65
    v_cvt_pk_bf16_f32 v48, v64, v65
    v_fma_f32 v69, v69, s43, -v24
    v_exp_f32 v68, v68
    v_add_f32 v27, v27, v66
    v_fma_f32 v70, v70, s43, -v24
    v_exp_f32 v69, v69
    v_add_f32 v28, v28, v67
    v_cvt_pk_bf16_f32 v49, v66, v67
    v_fma_f32 v71, v71, s43, -v24
    v_exp_f32 v70, v70
    v_add_f32 v25, v25, v68
    v_fma_f32 v72, v72, s43, -v24
    v_exp_f32 v71, v71
    v_add_f32 v26, v26, v69
    v_cvt_pk_bf16_f32 v50, v68, v69
    v_fma_f32 v73, v73, s43, -v24
    v_exp_f32 v72, v72
    v_add_f32 v27, v27, v70
    v_fma_f32 v74, v74, s43, -v24
    v_exp_f32 v73, v73
    v_add_f32 v28, v28, v71
    v_cvt_pk_bf16_f32 v51, v70, v71
    v_fma_f32 v75, v75, s43, -v24
    v_exp_f32 v74, v74
    v_add_f32 v25, v25, v72
    v_fma_f32 v76, v76, s43, -v24
    v_exp_f32 v75, v75
    v_add_f32 v26, v26, v73
    v_cvt_pk_bf16_f32 v52, v72, v73
    v_fma_f32 v77, v77, s43, -v24
    v_exp_f32 v76, v76
    v_add_f32 v27, v27, v74
    v_fma_f32 v78, v78, s43, -v24
    v_exp_f32 v77, v77
    v_add_f32 v28, v28, v75
    v_cvt_pk_bf16_f32 v53, v74, v75
    v_fma_f32 v79, v79, s43, -v24
    v_exp_f32 v78, v78
    v_add_f32 v25, v25, v76
    v_fma_f32 v80, v80, s43, -v24
    v_exp_f32 v79, v79
    v_add_f32 v26, v26, v77
    v_cvt_pk_bf16_f32 v54, v76, v77
    v_fma_f32 v81, v81, s43, -v24
    v_exp_f32 v80, v80
    v_add_f32 v27, v27, v78
    v_fma_f32 v82, v82, s43, -v24
    v_exp_f32 v81, v81
    v_add_f32 v28, v28, v79
    v_cvt_pk_bf16_f32 v55, v78, v79
    v_fma_f32 v83, v83, s43, -v24
    v_exp_f32 v82, v82
    v_add_f32 v25, v25, v80
    v_fma_f32 v84, v84, s43, -v24
    v_exp_f32 v83, v83
    v_add_f32 v26, v26, v81
    v_cvt_pk_bf16_f32 v56, v80, v81
    v_fma_f32 v85, v85, s43, -v24
    v_exp_f32 v84, v84
    v_add_f32 v27, v27, v82
    v_fma_f32 v86, v86, s43, -v24
    v_exp_f32 v85, v85
    v_add_f32 v28, v28, v83
    v_cvt_pk_bf16_f32 v57, v82, v83
    v_fma_f32 v87, v87, s43, -v24
    v_exp_f32 v86, v86
    v_add_f32 v25, v25, v84
    v_fma_f32 v88, v88, s43, -v24
    v_exp_f32 v87, v87
    v_add_f32 v26, v26, v85
    v_cvt_pk_bf16_f32 v58, v84, v85
    v_fma_f32 v89, v89, s43, -v24
    v_exp_f32 v88, v88
    v_add_f32 v27, v27, v86
    v_fma_f32 v90, v90, s43, -v24
    v_exp_f32 v89, v89
    v_add_f32 v28, v28, v87
    v_cvt_pk_bf16_f32 v59, v86, v87
    v_fma_f32 v91, v91, s43, -v24
    v_exp_f32 v90, v90
    v_add_f32 v25, v25, v88
    v_fma_f32 v92, v92, s43, -v24
    v_exp_f32 v91, v91
    v_add_f32 v26, v26, v89
    v_cvt_pk_bf16_f32 v60, v88, v89
    v_fma_f32 v93, v93, s43, -v24
    v_exp_f32 v92, v92
    v_add_f32 v27, v27, v90
    v_fma_f32 v94, v94, s43, -v24
    v_exp_f32 v93, v93
    v_add_f32 v28, v28, v91
    v_cvt_pk_bf16_f32 v61, v90, v91
    v_fma_f32 v95, v95, s43, -v24
    v_exp_f32 v94, v94
    v_add_f32 v25, v25, v92
    v_exp_f32 v95, v95
    v_add_f32 v26, v26, v93
    v_add_f32 v27, v27, v94
    v_add_f32 v28, v28, v95
    v_cvt_pk_bf16_f32 v62, v92, v93
    v_cvt_pk_bf16_f32 v63, v94, v95
    s_cmp_lg_u32 s57, 0
    s_cbranch_scc1 L_go2_fs_80
L_poll_pp_82:
    s_waitcnt vmcnt(0)
    v_readfirstlane_b32 s37, v42
    s_nop 3
    s_and_b32 s37, s37, s79
    s_cmp_lg_u32 s37, 0
    s_cbranch_scc1 L_pok_pp_82
    s_sleep 1
    buffer_load_dword v42, v43, s[28:31], 0 offen sc1
    s_branch L_poll_pp_82
L_pok_pp_82:
    s_mul_i32 s37, s58, 69632
    s_mul_i32 s45, s32, 17408
    s_add_u32 s37, s37, s45
    v_lshlrev_b32 v34, 4, v1
    buffer_load_dwordx4 a[160:163], v34, s[20:23], s37 offen offset:0 sc1
    buffer_load_dwordx4 a[164:167], v34, s[20:23], s37 offen offset:1024 sc1
    buffer_load_dwordx4 a[168:171], v34, s[20:23], s37 offen offset:2048 sc1
    buffer_load_dwordx4 a[172:175], v34, s[20:23], s37 offen offset:3072 sc1
    s_add_u32 s37, s37, 4096
    buffer_load_dwordx4 a[176:179], v34, s[20:23], s37 offen offset:0 sc1
    buffer_load_dwordx4 a[180:183], v34, s[20:23], s37 offen offset:1024 sc1
    buffer_load_dwordx4 a[184:187], v34, s[20:23], s37 offen offset:2048 sc1
    buffer_load_dwordx4 a[188:191], v34, s[20:23], s37 offen offset:3072 sc1
    s_add_u32 s37, s37, 4096
    buffer_load_dwordx4 a[192:195], v34, s[20:23], s37 offen offset:0 sc1
    buffer_load_dwordx4 a[196:199], v34, s[20:23], s37 offen offset:1024 sc1
    buffer_load_dwordx4 a[200:203], v34, s[20:23], s37 offen offset:2048 sc1
    buffer_load_dwordx4 a[204:207], v34, s[20:23], s37 offen offset:3072 sc1
    s_add_u32 s37, s37, 4096
    buffer_load_dwordx4 a[208:211], v34, s[20:23], s37 offen offset:0 sc1
    buffer_load_dwordx4 a[212:215], v34, s[20:23], s37 offen offset:1024 sc1
    buffer_load_dwordx4 a[216:219], v34, s[20:23], s37 offen offset:2048 sc1
    buffer_load_dwordx4 a[220:223], v34, s[20:23], s37 offen offset:3072 sc1
    s_add_u32 s37, s37, 4096
    buffer_load_dwordx2 v[44:45], v34, s[20:23], s37 offen sc1
L_go2_fs_80:
    s_nop 1
    s_waitcnt lgkmcnt(2)
    v_mfma_f32_32x32x16_bf16 v[128:143], a[128:131], v[48:51], v[128:143]
    ds_read_b128 a[144:147], v20 offset:16384
    v_mfma_f32_32x32x16_bf16 v[144:159], a[132:135], v[48:51], v[144:159]
    ds_read_b128 a[148:151], v20 offset:20480
    s_waitcnt lgkmcnt(2)
    v_mfma_f32_32x32x16_bf16 v[160:175], a[136:139], v[48:51], v[160:175]
    ds_read_b128 a[152:155], v20 offset:24576
    v_mfma_f32_32x32x16_bf16 v[176:191], a[140:143], v[48:51], v[176:191]
    ds_read_b128 a[156:159], v20 offset:28672
    s_waitcnt lgkmcnt(2)
    v_mfma_f32_32x32x16_bf16 v[192:207], a[144:147], v[48:51], v[192:207]
    ds_read_b128 a[128:131], v20 offset:1024
    v_mfma_f32_32x32x16_bf16 v[208:223], a[148:151], v[48:51], v[208:223]
    ds_read_b128 a[132:135], v20 offset:5120
    s_waitcnt lgkmcnt(2)
    v_mfma_f32_32x32x16_bf16 v[224:239], a[152:155], v[48:51], v[224:239]
    ds_read_b128 a[136:139], v20 offset:9216
    v_mfma_f32_32x32x16_bf16 v[240:255], a[156:159], v[48:51], v[240:255]
    ds_read_b128 a[140:143], v20 offset:13312
    s_waitcnt lgkmcnt(2)
    v_mfma_f32_32x32x16_bf16 v[128:143], a[128:131], v[52:55], v[128:143]
    ds_read_b128 a[144:147], v20 offset:17408
    v_mfma_f32_32x32x16_bf16 v[144:159], a[132:135], v[52:55], v[144:159]
    ds_read_b128 a[148:151], v20 offset:21504
    s_waitcnt lgkmcnt(2)
    v_mfma_f32_32x32x16_bf16 v[160:175], a[136:139], v[52:55], v[160:175]
    ds_read_b128 a[152:155], v20 offset:25600
    v_mfma_f32_32x32x16_bf16 v[176:191], a[140:143], v[52:55], v[176:191]
    ds_read_b128 a[156:159], v20 offset:29696
    s_waitcnt lgkmcnt(2)
    v_mfma_f32_32x32x16_bf16 v[192:207], a[144:147], v[52:55], v[192:207]
    ds_read_b128 a[128:131], v20 offset:2048
    v_mfma_f32_32x32x16_bf16 v[208:223], a[148:151], v[52:55], v[208:223]
    ds_read_b128 a[132:135], v20 offset:6144
    s_waitcnt lgkmcnt(2)
    v_mfma_f32_32x32x16_bf16 v[224:239], a[152:155], v[52:55], v[224:239]
    ds_read_b128 a[136:139], v20 offset:10240
    v_mfma_f32_32x32x16_bf16 v[240:255], a[156:159], v[52:55], v[240:255]
    ds_read_b128 a[140:143], v20 offset:14336
    s_waitcnt lgkmcnt(2)
    v_mfma_f32_32x32x16_bf16 v[128:143], a[128:131], v[56:59], v[128:143]
    ds_read_b128 a[144:147], v20 offset:18432
    v_mfma_f32_32x32x16_bf16 v[144:159], a[132:135], v[56:59], v[144:159]
    ds_read_b128 a[148:151], v20 offset:22528
    s_waitcnt lgkmcnt(2)
    v_mfma_f32_32x32x16_bf16 v[160:175], a[136:139], v[56:59], v[160:175]
    ds_read_b128 a[152:155], v20 offset:26624
    v_mfma_f32_32x32x16_bf16 v[176:191], a[140:143], v[56:59], v[176:191]
    ds_read_b128 a[156:159], v20 offset:30720
    s_waitcnt lgkmcnt(2)
    v_mfma_f32_32x32x16_bf16 v[192:207], a[144:147], v[56:59], v[192:207]
    ds_read_b128 a[128:131], v20 offset:3072
    v_mfma_f32_32x32x16_bf16 v[208:223], a[148:151], v[56:59], v[208:223]
    ds_read_b128 a[132:135], v20 offset:7168
    s_waitcnt lgkmcnt(2)
    v_mfma_f32_32x32x16_bf16 v[224:239], a[152:155], v[56:59], v[224:239]
    ds_read_b128 a[136:139], v20 offset:11264
    v_mfma_f32_32x32x16_bf16 v[240:255], a[156:159], v[56:59], v[240:255]
    ds_read_b128 a[140:143], v20 offset:15360
    s_waitcnt lgkmcnt(2)
    v_mfma_f32_32x32x16_bf16 v[128:143], a[128:131], v[60:63], v[128:143]
    ds_read_b128 a[144:147], v20 offset:19456
    v_mfma_f32_32x32x16_bf16 v[144:159], a[132:135], v[60:63], v[144:159]
    ds_read_b128 a[148:151], v20 offset:23552
    s_waitcnt lgkmcnt(2)
    v_mfma_f32_32x32x16_bf16 v[160:175], a[136:139], v[60:63], v[160:175]
    ds_read_b128 a[152:155], v20 offset:27648
    v_mfma_f32_32x32x16_bf16 v[176:191], a[140:143], v[60:63], v[176:191]
    ds_read_b128 a[156:159], v20 offset:31744
    s_waitcnt lgkmcnt(2)
    v_mfma_f32_32x32x16_bf16 v[192:207], a[144:147], v[60:63], v[192:207]
    v_mfma_f32_32x32x16_bf16 v[208:223], a[148:151], v[60:63], v[208:223]
    s_waitcnt lgkmcnt(0)
    v_mfma_f32_32x32x16_bf16 v[224:239], a[152:155], v[60:63], v[224:239]
    v_mfma_f32_32x32x16_bf16 v[240:255], a[156:159], v[60:63], v[240:255]
    s_branch L_fin
L_yl1:
    s_mov_b32 s57, 1
    s_cmp_eq_u32 s40, 0
    s_cbranch_scc1 L_go_fs_84
    s_waitcnt vmcnt(8)
    v_readfirstlane_b32 s57, v42
    s_nop 3
    s_and_b32 s57, s57, s79
    s_cmp_eq_u32 s57, 0
    s_cbranch_scc1 L_late_fs_84
L_poll_pp_85:
    s_waitcnt vmcnt(0)
    v_readfirstlane_b32 s37, v42
    s_nop 3
    s_and_b32 s37, s37, s79
    s_cmp_lg_u32 s37, 0
    s_cbranch_scc1 L_pok_pp_85
    s_sleep 1
    buffer_load_dword v42, v43, s[28:31], 0 offen sc1
    s_branch L_poll_pp_85
L_pok_pp_85:
    s_mul_i32 s37, s58, 69632
    s_mul_i32 s45, s32, 17408
    s_add_u32 s37, s37, s45
    v_lshlrev_b32 v34, 4, v1
    buffer_load_dwordx4 a[160:163], v34, s[20:23], s37 offen offset:0 sc1
    buffer_load_dwordx4 a[164:167], v34, s[20:23], s37 offen offset:1024 sc1
    buffer_load_dwordx4 a[168:171], v34, s[20:23], s37 offen offset:2048 sc1
    buffer_load_dwordx4 a[172:175], v34, s[20:23], s37 offen offset:3072 sc1
    s_add_u32 s37, s37, 4096
    buffer_load_dwordx4 a[176:179], v34, s[20:23], s37 offen offset:0 sc1
    buffer_load_dwordx4 a[180:183], v34, s[20:23], s37 offen offset:1024 sc1
    buffer_load_dwordx4 a[184:187], v34, s[20:23], s37 offen offset:2048 sc1
    buffer_load_dwordx4 a[188:191], v34, s[20:23], s37 offen offset:3072 sc1
    s_add_u32 s37, s37, 4096
    buffer_load_dwordx4 a[192:195], v34, s[20:23], s37 offen offset:0 sc1
    buffer_load_dwordx4 a[196:199], v34, s[20:23], s37 offen offset:1024 sc1
    buffer_load_dwordx4 a[200:203], v34, s[20:23], s37 offen offset:2048 sc1
    buffer_load_dwordx4 a[204:207], v34, s[20:23], s37 offen offset:3072 sc1
    s_add_u32 s37, s37, 4096
    buffer_load_dwordx4 a[208:211], v34, s[20:23], s37 offen offset:0 sc1
    buffer_load_dwordx4 a[212:215], v34, s[20:23], s37 offen offset:1024 sc1
    buffer_load_dwordx4 a[216:219], v34, s[20:23], s37 offen offset:2048 sc1
    buffer_load_dwordx4 a[220:223], v34, s[20:23], s37 offen offset:3072 sc1
    s_add_u32 s37, s37, 4096
    buffer_load_dwordx2 v[44:45], v34, s[20:23], s37 offen sc1
    s_branch L_go_fs_84
L_late_fs_84:
    buffer_load_dword v42, v43, s[28:31], 0 offen sc1
L_go_fs_84:
    s_waitcnt lgkmcnt(0)
    ds_read_b128 a[128:131], v20 offset:32768
    ds_read_b128 a[132:135], v20 offset:36864
    ds_read_b128 a[136:139], v20 offset:40960
    ds_read_b128 a[140:143], v20 offset:45056
    v_mov_b32 v38, 0xff800000
    v_cmp_lt_i32 s[60:61], v29, 0
    v_cmp_lt_i32 s[62:63], v29, 1
    v_cmp_lt_i32 s[64:65], v29, 2
    v_cmp_lt_i32 s[66:67], v29, 3
    v_cndmask_b32 v96, v96, v38, s[60:61]
    v_cndmask_b32 v97, v97, v38, s[62:63]
    v_cndmask_b32 v98, v98, v38, s[64:65]
    v_cndmask_b32 v99, v99, v38, s[66:67]
    v_cmp_lt_i32 s[60:61], v29, 8
    v_cmp_lt_i32 s[62:63], v29, 9
    v_cmp_lt_i32 s[64:65], v29, 10
    v_cmp_lt_i32 s[66:67], v29, 11
    v_cndmask_b32 v100, v100, v38, s[60:61]
    v_cndmask_b32 v101, v101, v38, s[62:63]
    v_cndmask_b32 v102, v102, v38, s[64:65]
    v_cndmask_b32 v103, v103, v38, s[66:67]
    v_cmp_lt_i32 s[60:61], v29, 16
    v_cmp_lt_i32 s[62:63], v29, 17
    v_cmp_lt_i32 s[64:65], v29, 18
    v_cmp_lt_i32 s[66:67], v29, 19
    v_cndmask_b32 v104, v104, v38, s[60:61]
    v_cndmask_b32 v105, v105, v38, s[62:63]
    v_cndmask_b32 v106, v106, v38, s[64:65]
    v_cndmask_b32 v107, v107, v38, s[66:67]
    v_cmp_lt_i32 s[60:61], v29, 24
    v_cmp_lt_i32 s[62:63], v29, 25
    v_cmp_lt_i32 s[64:65], v29, 26
    v_cmp_lt_i32 s[66:67], v29, 27
    v_cndmask_b32 v108, v108, v38, s[60:61]
    v_cndmask_b32 v109, v109, v38, s[62:63]
    v_cndmask_b32 v110, v110, v38, s[64:65]
    v_cndmask_b32 v111, v111, v38, s[66:67]
    v_cmp_lt_i32 s[60:61], v29, 32
    v_cmp_lt_i32 s[62:63], v29, 33
    v_cmp_lt_i32 s[64:65], v29, 34
    v_cmp_lt_i32 s[66:67], v29, 35
    v_cndmask_b32 v112, v112, v38, s[60:61]
    v_cndmask_b32 v113, v113, v38, s[62:63]
    v_cndmask_b32 v114, v114, v38, s[64:65]
    v_cndmask_b32 v115, v115, v38, s[66:67]
    v_cmp_lt_i32 s[60:61], v29, 40
    v_cmp_lt_i32 s[62:63], v29, 41
    v_cmp_lt_i32 s[64:65], v29, 42
    v_cmp_lt_i32 s[66:67], v29, 43
    v_cndmask_b32 v116, v116, v38, s[60:61]
    v_cndmask_b32 v117, v117, v38, s[62:63]
    v_cndmask_b32 v118, v118, v38, s[64:65]
    v_cndmask_b32 v119, v119, v38, s[66:67]
    v_cmp_lt_i32 s[60:61], v29, 48
    v_cmp_lt_i32 s[62:63], v29, 49
    v_cmp_lt_i32 s[64:65], v29, 50
    v_cmp_lt_i32 s[66:67], v29, 51
    v_cndmask_b32 v120, v120, v38, s[60:61]
    v_cndmask_b32 v121, v121, v38, s[62:63]
    v_cndmask_b32 v122, v122, v38, s[64:65]
    v_cndmask_b32 v123, v123, v38, s[66:67]
    v_cmp_lt_i32 s[60:61], v29, 56
    v_cmp_lt_i32 s[62:63], v29, 57
    v_cmp_lt_i32 s[64:65], v29, 58
    v_cmp_lt_i32 s[66:67], v29, 59
    v_cndmask_b32 v124, v124, v38, s[60:61]
    v_cndmask_b32 v125, v125, v38, s[62:63]
    v_cndmask_b32 v126, v126, v38, s[64:65]
    v_cndmask_b32 v127, v127, v38, s[66:67]
    v_max3_f32 v30, v96, v97, v98
    v_max3_f32 v31, v99, v100, v101
    v_max3_f32 v30, v30, v102, v103
    v_max3_f32 v31, v31, v104, v105
    v_max3_f32 v30, v30, v106, v107
    v_max3_f32 v31, v31, v108, v109
    v_max3_f32 v30, v30, v110, v111
    v_max3_f32 v31, v31, v112, v113
    v_max3_f32 v30, v30, v114, v115
    v_max3_f32 v31, v31, v116, v117
    v_max3_f32 v30, v30, v118, v119
    v_max3_f32 v31, v31, v120, v121
    v_max3_f32 v30, v30, v122, v123
    v_max3_f32 v31, v31, v124, v125
    v_max3_f32 v30, v30, v126, v127
    v_max_f32 v30, v30, v31
    v_mov_b32 v31, v30
    s_nop 1
    v_permlane32_swap_b32 v30, v31
    v_max_f32 v30, v30, v31
    v_fma_f32 v31, v30, s43, -v24
    v_cmp_lt_f32 vcc, s44, v31
    s_cbranch_vccnz L_resc_a_83
    L_resc_ret_a_83:
    v_fma_f32 v96, v96, s43, -v24
    v_fma_f32 v97, v97, s43, -v24
    v_exp_f32 v96, v96
    v_fma_f32 v98, v98, s43, -v24
    v_exp_f32 v97, v97
    v_fma_f32 v99, v99, s43, -v24
    v_exp_f32 v98, v98
    v_add_f32 v25, v25, v96
    v_fma_f32 v100, v100, s43, -v24
    v_exp_f32 v99, v99
    v_add_f32 v26, v26, v97
    v_cvt_pk_bf16_f32 v48, v96, v97
    v_fma_f32 v101, v101, s43, -v24
    v_exp_f32 v100, v100
    v_add_f32 v27, v27, v98
    v_fma_f32 v102, v102, s43, -v24
    v_exp_f32 v101, v101
    v_add_f32 v28, v28, v99
    v_cvt_pk_bf16_f32 v49, v98, v99
    v_fma_f32 v103, v103, s43, -v24
    v_exp_f32 v102, v102
    v_add_f32 v25, v25, v100
    v_fma_f32 v104, v104, s43, -v24
    v_exp_f32 v103, v103
    v_add_f32 v26, v26, v101
    v_cvt_pk_bf16_f32 v50, v100, v101
    v_fma_f32 v105, v105, s43, -v24
    v_exp_f32 v104, v104
    v_add_f32 v27, v27, v102
    v_fma_f32 v106, v106, s43, -v24
    v_exp_f32 v105, v105
    v_add_f32 v28, v28, v103
    v_cvt_pk_bf16_f32 v51, v102, v103
    v_fma_f32 v107, v107, s43, -v24
    v_exp_f32 v106, v106
    v_add_f32 v25, v25, v104
    v_fma_f32 v108, v108, s43, -v24
    v_exp_f32 v107, v107
    v_add_f32 v26, v26, v105
    v_cvt_pk_bf16_f32 v52, v104, v105
    v_fma_f32 v109, v109, s43, -v24
    v_exp_f32 v108, v108
    v_add_f32 v27, v27, v106
    v_fma_f32 v110, v110, s43, -v24
    v_exp_f32 v109, v109
    v_add_f32 v28, v28, v107
    v_cvt_pk_bf16_f32 v53, v106, v107
    v_fma_f32 v111, v111, s43, -v24
    v_exp_f32 v110, v110
    v_add_f32 v25, v25, v108
    v_fma_f32 v112, v112, s43, -v24
    v_exp_f32 v111, v111
    v_add_f32 v26, v26, v109
    v_cvt_pk_bf16_f32 v54, v108, v109
    v_fma_f32 v113, v113, s43, -v24
    v_exp_f32 v112, v112
    v_add_f32 v27, v27, v110
    v_fma_f32 v114, v114, s43, -v24
    v_exp_f32 v113, v113
    v_add_f32 v28, v28, v111
    v_cvt_pk_bf16_f32 v55, v110, v111
    v_fma_f32 v115, v115, s43, -v24
    v_exp_f32 v114, v114
    v_add_f32 v25, v25, v112
    v_fma_f32 v116, v116, s43, -v24
    v_exp_f32 v115, v115
    v_add_f32 v26, v26, v113
    v_cvt_pk_bf16_f32 v56, v112, v113
    v_fma_f32 v117, v117, s43, -v24
    v_exp_f32 v116, v116
    v_add_f32 v27, v27, v114
    v_fma_f32 v118, v118, s43, -v24
    v_exp_f32 v117, v117
    v_add_f32 v28, v28, v115
    v_cvt_pk_bf16_f32 v57, v114, v115
    v_fma_f32 v119, v119, s43, -v24
    v_exp_f32 v118, v118
    v_add_f32 v25, v25, v116
    v_fma_f32 v120, v120, s43, -v24
    v_exp_f32 v119, v119
    v_add_f32 v26, v26, v117
    v_cvt_pk_bf16_f32 v58, v116, v117
    v_fma_f32 v121, v121, s43, -v24
    v_exp_f32 v120, v120
    v_add_f32 v27, v27, v118
    v_fma_f32 v122, v122, s43, -v24
    v_exp_f32 v121, v121
    v_add_f32 v28, v28, v119
    v_cvt_pk_bf16_f32 v59, v118, v119
    v_fma_f32 v123, v123, s43, -v24
    v_exp_f32 v122, v122
    v_add_f32 v25, v25, v120
    v_fma_f32 v124, v124, s43, -v24
    v_exp_f32 v123, v123
    v_add_f32 v26, v26, v121
    v_cvt_pk_bf16_f32 v60, v120, v121
    v_fma_f32 v125, v125, s43, -v24
    v_exp_f32 v124, v124
    v_add_f32 v27, v27, v122
    v_fma_f32 v126, v126, s43, -v24
    v_exp_f32 v125, v125
    v_add_f32 v28, v28, v123
    v_cvt_pk_bf16_f32 v61, v122, v123
    v_fma_f32 v127, v127, s43, -v24
    v_exp_f32 v126, v126
    v_add_f32 v25, v25, v124
    v_exp_f32 v127, v127
    v_add_f32 v26, v26, v125
    v_add_f32 v27, v27, v126
    v_add_f32 v28, v28, v127
    v_cvt_pk_bf16_f32 v62, v124, v125
    v_cvt_pk_bf16_f32 v63, v126, v127
    s_cmp_lg_u32 s57, 0
    s_cbranch_scc1 L_go2_fs_84
L_poll_pp_86:
    s_waitcnt vmcnt(0)
    v_readfirstlane_b32 s37, v42
    s_nop 3
    s_and_b32 s37, s37, s79
    s_cmp_lg_u32 s37, 0
    s_cbranch_scc1 L_pok_pp_86
    s_sleep 1
    buffer_load_dword v42, v43, s[28:31], 0 offen sc1
    s_branch L_poll_pp_86
L_pok_pp_86:
    s_mul_i32 s37, s58, 69632
    s_mul_i32 s45, s32, 17408
    s_add_u32 s37, s37, s45
    v_lshlrev_b32 v34, 4, v1
    buffer_load_dwordx4 a[160:163], v34, s[20:23], s37 offen offset:0 sc1
    buffer_load_dwordx4 a[164:167], v34, s[20:23], s37 offen offset:1024 sc1
    buffer_load_dwordx4 a[168:171], v34, s[20:23], s37 offen offset:2048 sc1
    buffer_load_dwordx4 a[172:175], v34, s[20:23], s37 offen offset:3072 sc1
    s_add_u32 s37, s37, 4096
    buffer_load_dwordx4 a[176:179], v34, s[20:23], s37 offen offset:0 sc1
    buffer_load_dwordx4 a[180:183], v34, s[20:23], s37 offen offset:1024 sc1
    buffer_load_dwordx4 a[184:187], v34, s[20:23], s37 offen offset:2048 sc1
    buffer_load_dwordx4 a[188:191], v34, s[20:23], s37 offen offset:3072 sc1
    s_add_u32 s37, s37, 4096
    buffer_load_dwordx4 a[192:195], v34, s[20:23], s37 offen offset:0 sc1
    buffer_load_dwordx4 a[196:199], v34, s[20:23], s37 offen offset:1024 sc1
    buffer_load_dwordx4 a[200:203], v34, s[20:23], s37 offen offset:2048 sc1
    buffer_load_dwordx4 a[204:207], v34, s[20:23], s37 offen offset:3072 sc1
    s_add_u32 s37, s37, 4096
    buffer_load_dwordx4 a[208:211], v34, s[20:23], s37 offen offset:0 sc1
    buffer_load_dwordx4 a[212:215], v34, s[20:23], s37 offen offset:1024 sc1
    buffer_load_dwordx4 a[216:219], v34, s[20:23], s37 offen offset:2048 sc1
    buffer_load_dwordx4 a[220:223], v34, s[20:23], s37 offen offset:3072 sc1
    s_add_u32 s37, s37, 4096
    buffer_load_dwordx2 v[44:45], v34, s[20:23], s37 offen sc1
L_go2_fs_84:
    s_nop 1
    s_waitcnt lgkmcnt(2)
    v_mfma_f32_32x32x16_bf16 v[128:143], a[128:131], v[48:51], v[128:143]
    ds_read_b128 a[144:147], v20 offset:49152
    v_mfma_f32_32x32x16_bf16 v[144:159], a[132:135], v[48:51], v[144:159]
    ds_read_b128 a[148:151], v20 offset:53248
    s_waitcnt lgkmcnt(2)
    v_mfma_f32_32x32x16_bf16 v[160:175], a[136:139], v[48:51], v[160:175]
    ds_read_b128 a[152:155], v20 offset:57344
    v_mfma_f32_32x32x16_bf16 v[176:191], a[140:143], v[48:51], v[176:191]
    ds_read_b128 a[156:159], v20 offset:61440
    s_waitcnt lgkmcnt(2)
    v_mfma_f32_32x32x16_bf16 v[192:207], a[144:147], v[48:51], v[192:207]
    ds_read_b128 a[128:131], v20 offset:33792
    v_mfma_f32_32x32x16_bf16 v[208:223], a[148:151], v[48:51], v[208:223]
    ds_read_b128 a[132:135], v20 offset:37888
    s_waitcnt lgkmcnt(2)
    v_mfma_f32_32x32x16_bf16 v[224:239], a[152:155], v[48:51], v[224:239]
    ds_read_b128 a[136:139], v20 offset:41984
    v_mfma_f32_32x32x16_bf16 v[240:255], a[156:159], v[48:51], v[240:255]
    ds_read_b128 a[140:143], v20 offset:46080
    s_waitcnt lgkmcnt(2)
    v_mfma_f32_32x32x16_bf16 v[128:143], a[128:131], v[52:55], v[128:143]
    ds_read_b128 a[144:147], v20 offset:50176
    v_mfma_f32_32x32x16_bf16 v[144:159], a[132:135], v[52:55], v[144:159]
    ds_read_b128 a[148:151], v20 offset:54272
    s_waitcnt lgkmcnt(2)
    v_mfma_f32_32x32x16_bf16 v[160:175], a[136:139], v[52:55], v[160:175]
    ds_read_b128 a[152:155], v20 offset:58368
    v_mfma_f32_32x32x16_bf16 v[176:191], a[140:143], v[52:55], v[176:191]
    ds_read_b128 a[156:159], v20 offset:62464
    s_waitcnt lgkmcnt(2)
    v_mfma_f32_32x32x16_bf16 v[192:207], a[144:147], v[52:55], v[192:207]
    ds_read_b128 a[128:131], v20 offset:34816
    v_mfma_f32_32x32x16_bf16 v[208:223], a[148:151], v[52:55], v[208:223]
    ds_read_b128 a[132:135], v20 offset:38912
    s_waitcnt lgkmcnt(2)
    v_mfma_f32_32x32x16_bf16 v[224:239], a[152:155], v[52:55], v[224:239]
    ds_read_b128 a[136:139], v20 offset:43008
    v_mfma_f32_32x32x16_bf16 v[240:255], a[156:159], v[52:55], v[240:255]
    ds_read_b128 a[140:143], v20 offset:47104
    s_waitcnt lgkmcnt(2)
    v_mfma_f32_32x32x16_bf16 v[128:143], a[128:131], v[56:59], v[128:143]
    ds_read_b128 a[144:147], v20 offset:51200
    v_mfma_f32_32x32x16_bf16 v[144:159], a[132:135], v[56:59], v[144:159]
    ds_read_b128 a[148:151], v20 offset:55296
    s_waitcnt lgkmcnt(2)
    v_mfma_f32_32x32x16_bf16 v[160:175], a[136:139], v[56:59], v[160:175]
    ds_read_b128 a[152:155], v20 offset:59392
    v_mfma_f32_32x32x16_bf16 v[176:191], a[140:143], v[56:59], v[176:191]
    ds_read_b128 a[156:159], v20 offset:63488
    s_waitcnt lgkmcnt(2)
    v_mfma_f32_32x32x16_bf16 v[192:207], a[144:147], v[56:59], v[192:207]
    ds_read_b128 a[128:131], v20 offset:35840
    v_mfma_f32_32x32x16_bf16 v[208:223], a[148:151], v[56:59], v[208:223]
    ds_read_b128 a[132:135], v20 offset:39936
    s_waitcnt lgkmcnt(2)
    v_mfma_f32_32x32x16_bf16 v[224:239], a[152:155], v[56:59], v[224:239]
    ds_read_b128 a[136:139], v20 offset:44032
    v_mfma_f32_32x32x16_bf16 v[240:255], a[156:159], v[56:59], v[240:255]
    ds_read_b128 a[140:143], v20 offset:48128
    s_waitcnt lgkmcnt(2)
    v_mfma_f32_32x32x16_bf16 v[128:143], a[128:131], v[60:63], v[128:143]
    ds_read_b128 a[144:147], v20 offset:52224
    v_mfma_f32_32x32x16_bf16 v[144:159], a[132:135], v[60:63], v[144:159]
    ds_read_b128 a[148:151], v20 offset:56320
    s_waitcnt lgkmcnt(2)
    v_mfma_f32_32x32x16_bf16 v[160:175], a[136:139], v[60:63], v[160:175]
    ds_read_b128 a[152:155], v20 offset:60416
    v_mfma_f32_32x32x16_bf16 v[176:191], a[140:143], v[60:63], v[176:191]
    ds_read_b128 a[156:159], v20 offset:64512
    s_waitcnt lgkmcnt(2)
    v_mfma_f32_32x32x16_bf16 v[192:207], a[144:147], v[60:63], v[192:207]
    v_mfma_f32_32x32x16_bf16 v[208:223], a[148:151], v[60:63], v[208:223]
    s_waitcnt lgkmcnt(0)
    v_mfma_f32_32x32x16_bf16 v[224:239], a[152:155], v[60:63], v[224:239]
    v_mfma_f32_32x32x16_bf16 v[240:255], a[156:159], v[60:63], v[240:255]
L_fin:
    v_add_f32 v31, v25, v26
    v_add_f32 v32, v27, v28
    v_add_f32 v31, v31, v32
    v_lshlrev_b32 v34, 4, v1
    s_lshl_b32 s37, s53, 2
    s_add_u32 s37, s37, s32
    s_lshl_b32 s37, s37, 18
    s_lshl_b32 s45, s41, 14
    s_add_u32 s37, s37, s45
    s_cmp_lg_u32 s40, 0
    s_cbranch_scc1 L_fin_merge
    v_mov_b32 v32, v31
    s_nop 1
    v_permlane32_swap_b32 v31, v32
    v_add_f32 v31, v31, v32
    v_rcp_f32 v38, v31
    s_nop 0
    v_mov_b32 v39, v38
    v_pk_mul_f32 v[128:129], v[128:129], v[38:39]
    v_pk_mul_f32 v[130:131], v[130:131], v[38:39]
    v_pk_mul_f32 v[132:133], v[132:133], v[38:39]
    v_pk_mul_f32 v[134:135], v[134:135], v[38:39]
    v_cvt_pk_bf16_f32 v64, v128, v129
    v_cvt_pk_bf16_f32 v65, v130, v131
    v_cvt_pk_bf16_f32 v66, v132, v133
    v_cvt_pk_bf16_f32 v67, v134, v135
    buffer_store_dwordx4 v[64:67], v34, s[24:27], s37 offen offset:0 sc1
    v_pk_mul_f32 v[136:137], v[136:137], v[38:39]
    v_pk_mul_f32 v[138:139], v[138:139], v[38:39]
    v_pk_mul_f32 v[140:141], v[140:141], v[38:39]
    v_pk_mul_f32 v[142:143], v[142:143], v[38:39]
    v_cvt_pk_bf16_f32 v68, v136, v137
    v_cvt_pk_bf16_f32 v69, v138, v139
    v_cvt_pk_bf16_f32 v70, v140, v141
    v_cvt_pk_bf16_f32 v71, v142, v143
    buffer_store_dwordx4 v[68:71], v34, s[24:27], s37 offen offset:1024 sc1
    v_pk_mul_f32 v[144:145], v[144:145], v[38:39]
    v_pk_mul_f32 v[146:147], v[146:147], v[38:39]
    v_pk_mul_f32 v[148:149], v[148:149], v[38:39]
    v_pk_mul_f32 v[150:151], v[150:151], v[38:39]
    v_cvt_pk_bf16_f32 v72, v144, v145
    v_cvt_pk_bf16_f32 v73, v146, v147
    v_cvt_pk_bf16_f32 v74, v148, v149
    v_cvt_pk_bf16_f32 v75, v150, v151
    buffer_store_dwordx4 v[72:75], v34, s[24:27], s37 offen offset:2048 sc1
    v_pk_mul_f32 v[152:153], v[152:153], v[38:39]
    v_pk_mul_f32 v[154:155], v[154:155], v[38:39]
    v_pk_mul_f32 v[156:157], v[156:157], v[38:39]
    v_pk_mul_f32 v[158:159], v[158:159], v[38:39]
    v_cvt_pk_bf16_f32 v76, v152, v153
    v_cvt_pk_bf16_f32 v77, v154, v155
    v_cvt_pk_bf16_f32 v78, v156, v157
    v_cvt_pk_bf16_f32 v79, v158, v159
    buffer_store_dwordx4 v[76:79], v34, s[24:27], s37 offen offset:3072 sc1
    v_pk_mul_f32 v[160:161], v[160:161], v[38:39]
    v_pk_mul_f32 v[162:163], v[162:163], v[38:39]
    v_pk_mul_f32 v[164:165], v[164:165], v[38:39]
    v_pk_mul_f32 v[166:167], v[166:167], v[38:39]
    v_cvt_pk_bf16_f32 v80, v160, v161
    v_cvt_pk_bf16_f32 v81, v162, v163
    v_cvt_pk_bf16_f32 v82, v164, v165
    v_cvt_pk_bf16_f32 v83, v166, v167
    s_add_u32 s37, s37, 4096
    buffer_store_dwordx4 v[80:83], v34, s[24:27], s37 offen offset:0 sc1
    v_pk_mul_f32 v[168:169], v[168:169], v[38:39]
    v_pk_mul_f32 v[170:171], v[170:171], v[38:39]
    v_pk_mul_f32 v[172:173], v[172:173], v[38:39]
    v_pk_mul_f32 v[174:175], v[174:175], v[38:39]
    v_cvt_pk_bf16_f32 v84, v168, v169
    v_cvt_pk_bf16_f32 v85, v170, v171
    v_cvt_pk_bf16_f32 v86, v172, v173
    v_cvt_pk_bf16_f32 v87, v174, v175
    buffer_store_dwordx4 v[84:87], v34, s[24:27], s37 offen offset:1024 sc1
    v_pk_mul_f32 v[176:177], v[176:177], v[38:39]
    v_pk_mul_f32 v[178:179], v[178:179], v[38:39]
    v_pk_mul_f32 v[180:181], v[180:181], v[38:39]
    v_pk_mul_f32 v[182:183], v[182:183], v[38:39]
    v_cvt_pk_bf16_f32 v88, v176, v177
    v_cvt_pk_bf16_f32 v89, v178, v179
    v_cvt_pk_bf16_f32 v90, v180, v181
    v_cvt_pk_bf16_f32 v91, v182, v183
    buffer_store_dwordx4 v[88:91], v34, s[24:27], s37 offen offset:2048 sc1
    v_pk_mul_f32 v[184:185], v[184:185], v[38:39]
    v_pk_mul_f32 v[186:187], v[186:187], v[38:39]
    v_pk_mul_f32 v[188:189], v[188:189], v[38:39]
    v_pk_mul_f32 v[190:191], v[190:191], v[38:39]
    v_cvt_pk_bf16_f32 v92, v184, v185
    v_cvt_pk_bf16_f32 v93, v186, v187
    v_cvt_pk_bf16_f32 v94, v188, v189
    v_cvt_pk_bf16_f32 v95, v190, v191
    buffer_store_dwordx4 v[92:95], v34, s[24:27], s37 offen offset:3072 sc1
    v_pk_mul_f32 v[192:193], v[192:193], v[38:39]
    v_pk_mul_f32 v[194:195], v[194:195], v[38:39]
    v_pk_mul_f32 v[196:197], v[196:197], v[38:39]
    v_pk_mul_f32 v[198:199], v[198:199], v[38:39]
    v_cvt_pk_bf16_f32 v96, v192, v193
    v_cvt_pk_bf16_f32 v97, v194, v195
    v_cvt_pk_bf16_f32 v98, v196, v197
    v_cvt_pk_bf16_f32 v99, v198, v199
    s_add_u32 s37, s37, 4096
    buffer_store_dwordx4 v[96:99], v34, s[24:27], s37 offen offset:0 sc1
    v_pk_mul_f32 v[200:201], v[200:201], v[38:39]
    v_pk_mul_f32 v[202:203], v[202:203], v[38:39]
    v_pk_mul_f32 v[204:205], v[204:205], v[38:39]
    v_pk_mul_f32 v[206:207], v[206:207], v[38:39]
    v_cvt_pk_bf16_f32 v100, v200, v201
    v_cvt_pk_bf16_f32 v101, v202, v203
    v_cvt_pk_bf16_f32 v102, v204, v205
    v_cvt_pk_bf16_f32 v103, v206, v207
    buffer_store_dwordx4 v[100:103], v34, s[24:27], s37 offen offset:1024 sc1
    v_pk_mul_f32 v[208:209], v[208:209], v[38:39]
    v_pk_mul_f32 v[210:211], v[210:211], v[38:39]
    v_pk_mul_f32 v[212:213], v[212:213], v[38:39]
    v_pk_mul_f32 v[214:215], v[214:215], v[38:39]
    v_cvt_pk_bf16_f32 v104, v208, v209
    v_cvt_pk_bf16_f32 v105, v210, v211
    v_cvt_pk_bf16_f32 v106, v212, v213
    v_cvt_pk_bf16_f32 v107, v214, v215
    buffer_store_dwordx4 v[104:107], v34, s[24:27], s37 offen offset:2048 sc1
    v_pk_mul_f32 v[216:217], v[216:217], v[38:39]
    v_pk_mul_f32 v[218:219], v[218:219], v[38:39]
    v_pk_mul_f32 v[220:221], v[220:221], v[38:39]
    v_pk_mul_f32 v[222:223], v[222:223], v[38:39]
    v_cvt_pk_bf16_f32 v108, v216, v217
    v_cvt_pk_bf16_f32 v109, v218, v219
    v_cvt_pk_bf16_f32 v110, v220, v221
    v_cvt_pk_bf16_f32 v111, v222, v223
    buffer_store_dwordx4 v[108:111], v34, s[24:27], s37 offen offset:3072 sc1
    v_pk_mul_f32 v[224:225], v[224:225], v[38:39]
    v_pk_mul_f32 v[226:227], v[226:227], v[38:39]
    v_pk_mul_f32 v[228:229], v[228:229], v[38:39]
    v_pk_mul_f32 v[230:231], v[230:231], v[38:39]
    v_cvt_pk_bf16_f32 v112, v224, v225
    v_cvt_pk_bf16_f32 v113, v226, v227
    v_cvt_pk_bf16_f32 v114, v228, v229
    v_cvt_pk_bf16_f32 v115, v230, v231
    s_add_u32 s37, s37, 4096
    buffer_store_dwordx4 v[112:115], v34, s[24:27], s37 offen offset:0 sc1
    v_pk_mul_f32 v[232:233], v[232:233], v[38:39]
    v_pk_mul_f32 v[234:235], v[234:235], v[38:39]
    v_pk_mul_f32 v[236:237], v[236:237], v[38:39]
    v_pk_mul_f32 v[238:239], v[238:239], v[38:39]
    v_cvt_pk_bf16_f32 v116, v232, v233
    v_cvt_pk_bf16_f32 v117, v234, v235
    v_cvt_pk_bf16_f32 v118, v236, v237
    v_cvt_pk_bf16_f32 v119, v238, v239
    buffer_store_dwordx4 v[116:119], v34, s[24:27], s37 offen offset:1024 sc1
    v_pk_mul_f32 v[240:241], v[240:241], v[38:39]
    v_pk_mul_f32 v[242:243], v[242:243], v[38:39]
    v_pk_mul_f32 v[244:245], v[244:245], v[38:39]
    v_pk_mul_f32 v[246:247], v[246:247], v[38:39]
    v_cvt_pk_bf16_f32 v120, v240, v241
    v_cvt_pk_bf16_f32 v121, v242, v243
    v_cvt_pk_bf16_f32 v122, v244, v245
    v_cvt_pk_bf16_f32 v123, v246, v247
    buffer_store_dwordx4 v[120:123], v34, s[24:27], s37 offen offset:2048 sc1
    v_pk_mul_f32 v[248:249], v[248:249], v[38:39]
    v_pk_mul_f32 v[250:251], v[250:251], v[38:39]
    v_pk_mul_f32 v[252:253], v[252:253], v[38:39]
    v_pk_mul_f32 v[254:255], v[254:255], v[38:39]
    v_cvt_pk_bf16_f32 v124, v248, v249
    v_cvt_pk_bf16_f32 v125, v250, v251
    v_cvt_pk_bf16_f32 v126, v252, v253
    v_cvt_pk_bf16_f32 v127, v254, v255
    buffer_store_dwordx4 v[124:127], v34, s[24:27], s37 offen offset:3072 sc1
    s_branch L_fin_done
L_fin_merge:
    s_waitcnt vmcnt(0)
    v_mov_b32 v36, v44
    v_mov_b32 v37, v45
    v_accvgpr_read_b32 v64, a160
    v_accvgpr_read_b32 v65, a161
    v_accvgpr_read_b32 v66, a162
    v_accvgpr_read_b32 v67, a163
    v_accvgpr_read_b32 v68, a164
    v_accvgpr_read_b32 v69, a165
    v_accvgpr_read_b32 v70, a166
    v_accvgpr_read_b32 v71, a167
    v_accvgpr_read_b32 v72, a168
    v_accvgpr_read_b32 v73, a169
    v_accvgpr_read_b32 v74, a170
    v_accvgpr_read_b32 v75, a171
    v_accvgpr_read_b32 v76, a172
    v_accvgpr_read_b32 v77, a173
    v_accvgpr_read_b32 v78, a174
    v_accvgpr_read_b32 v79, a175
    v_accvgpr_read_b32 v80, a176
    v_accvgpr_read_b32 v81, a177
    v_accvgpr_read_b32 v82, a178
    v_accvgpr_read_b32 v83, a179
    v_accvgpr_read_b32 v84, a180
    v_accvgpr_read_b32 v85, a181
    v_accvgpr_read_b32 v86, a182
    v_accvgpr_read_b32 v87, a183
    v_accvgpr_read_b32 v88, a184
    v_accvgpr_read_b32 v89, a185
    v_accvgpr_read_b32 v90, a186
    v_accvgpr_read_b32 v91, a187
    v_accvgpr_read_b32 v92, a188
    v_accvgpr_read_b32 v93, a189
    v_accvgpr_read_b32 v94, a190
    v_accvgpr_read_b32 v95, a191
    v_accvgpr_read_b32 v96, a192
    v_accvgpr_read_b32 v97, a193
    v_accvgpr_read_b32 v98, a194
    v_accvgpr_read_b32 v99, a195
    v_accvgpr_read_b32 v100, a196
    v_accvgpr_read_b32 v101, a197
    v_accvgpr_read_b32 v102, a198
    v_accvgpr_read_b32 v103, a199
    v_accvgpr_read_b32 v104, a200
    v_accvgpr_read_b32 v105, a201
    v_accvgpr_read_b32 v106, a202
    v_accvgpr_read_b32 v107, a203
    v_accvgpr_read_b32 v108, a204
    v_accvgpr_read_b32 v109, a205
    v_accvgpr_read_b32 v110, a206
    v_accvgpr_read_b32 v111, a207
    v_accvgpr_read_b32 v112, a208
    v_accvgpr_read_b32 v113, a209
    v_accvgpr_read_b32 v114, a210
    v_accvgpr_read_b32 v115, a211
    v_accvgpr_read_b32 v116, a212
    v_accvgpr_read_b32 v117, a213
    v_accvgpr_read_b32 v118, a214
    v_accvgpr_read_b32 v119, a215
    v_accvgpr_read_b32 v120, a216
    v_accvgpr_read_b32 v121, a217
    v_accvgpr_read_b32 v122, a218
    v_accvgpr_read_b32 v123, a219
    v_accvgpr_read_b32 v124, a220
    v_accvgpr_read_b32 v125, a221
    v_accvgpr_read_b32 v126, a222
    v_accvgpr_read_b32 v127, a223
    v_max_f32 v32, v24, v36
    v_sub_f32 v33, v24, v32
    v_sub_f32 v35, v36, v32
    v_exp_f32 v33, v33
    v_exp_f32 v35, v35
    s_nop 0
    v_mul_f32 v31, v31, v33
    v_fma_f32 v31, v37, v35, v31
    v_mov_b32 v32, v31
    s_nop 1
    v_permlane32_swap_b32 v31, v32
    v_add_f32 v31, v31, v32
    v_rcp_f32 v31, v31
    s_nop 0
    v_mul_f32 v38, v33, v31
    v_mul_f32 v40, v35, v31
    v_mov_b32 v39, v38
    v_mov_b32 v41, v40
    v_lshlrev_b32 v48, 16, v64
    v_and_b32 v49, 0xffff0000, v64
    v_lshlrev_b32 v50, 16, v65
    v_and_b32 v51, 0xffff0000, v65
    v_lshlrev_b32 v52, 16, v66
    v_and_b32 v53, 0xffff0000, v66
    v_lshlrev_b32 v54, 16, v67
    v_and_b32 v55, 0xffff0000, v67
    v_pk_mul_f32 v[128:129], v[128:129], v[38:39]
    v_pk_mul_f32 v[130:131], v[130:131], v[38:39]
    v_pk_mul_f32 v[132:133], v[132:133], v[38:39]
    v_pk_mul_f32 v[134:135], v[134:135], v[38:39]
    v_pk_fma_f32 v[128:129], v[48:49], v[40:41], v[128:129]
    v_pk_fma_f32 v[130:131], v[50:51], v[40:41], v[130:131]
    v_pk_fma_f32 v[132:133], v[52:53], v[40:41], v[132:133]
    v_pk_fma_f32 v[134:135], v[54:55], v[40:41], v[134:135]
    v_cvt_pk_bf16_f32 v64, v128, v129
    v_cvt_pk_bf16_f32 v65, v130, v131
    v_cvt_pk_bf16_f32 v66, v132, v133
    v_cvt_pk_bf16_f32 v67, v134, v135
    buffer_store_dwordx4 v[64:67], v34, s[24:27], s37 offen offset:0 sc1
    v_lshlrev_b32 v56, 16, v68
    v_and_b32 v57, 0xffff0000, v68
    v_lshlrev_b32 v58, 16, v69
    v_and_b32 v59, 0xffff0000, v69
    v_lshlrev_b32 v60, 16, v70
    v_and_b32 v61, 0xffff0000, v70
    v_lshlrev_b32 v62, 16, v71
    v_and_b32 v63, 0xffff0000, v71
    v_pk_mul_f32 v[136:137], v[136:137], v[38:39]
    v_pk_mul_f32 v[138:139], v[138:139], v[38:39]
    v_pk_mul_f32 v[140:141], v[140:141], v[38:39]
    v_pk_mul_f32 v[142:143], v[142:143], v[38:39]
    v_pk_fma_f32 v[136:137], v[56:57], v[40:41], v[136:137]
    v_pk_fma_f32 v[138:139], v[58:59], v[40:41], v[138:139]
    v_pk_fma_f32 v[140:141], v[60:61], v[40:41], v[140:141]
    v_pk_fma_f32 v[142:143], v[62:63], v[40:41], v[142:143]
    v_cvt_pk_bf16_f32 v68, v136, v137
    v_cvt_pk_bf16_f32 v69, v138, v139
    v_cvt_pk_bf16_f32 v70, v140, v141
    v_cvt_pk_bf16_f32 v71, v142, v143
    buffer_store_dwordx4 v[68:71], v34, s[24:27], s37 offen offset:1024 sc1
    v_lshlrev_b32 v48, 16, v72
    v_and_b32 v49, 0xffff0000, v72
    v_lshlrev_b32 v50, 16, v73
    v_and_b32 v51, 0xffff0000, v73
    v_lshlrev_b32 v52, 16, v74
    v_and_b32 v53, 0xffff0000, v74
    v_lshlrev_b32 v54, 16, v75
    v_and_b32 v55, 0xffff0000, v75
    v_pk_mul_f32 v[144:145], v[144:145], v[38:39]
    v_pk_mul_f32 v[146:147], v[146:147], v[38:39]
    v_pk_mul_f32 v[148:149], v[148:149], v[38:39]
    v_pk_mul_f32 v[150:151], v[150:151], v[38:39]
    v_pk_fma_f32 v[144:145], v[48:49], v[40:41], v[144:145]
    v_pk_fma_f32 v[146:147], v[50:51], v[40:41], v[146:147]
    v_pk_fma_f32 v[148:149], v[52:53], v[40:41], v[148:149]
    v_pk_fma_f32 v[150:151], v[54:55], v[40:41], v[150:151]
    v_cvt_pk_bf16_f32 v72, v144, v145
    v_cvt_pk_bf16_f32 v73, v146, v147
    v_cvt_pk_bf16_f32 v74, v148, v149
    v_cvt_pk_bf16_f32 v75, v150, v151
    buffer_store_dwordx4 v[72:75], v34, s[24:27], s37 offen offset:2048 sc1
    v_lshlrev_b32 v56, 16, v76
    v_and_b32 v57, 0xffff0000, v76
    v_lshlrev_b32 v58, 16, v77
    v_and_b32 v59, 0xffff0000, v77
    v_lshlrev_b32 v60, 16, v78
    v_and_b32 v61, 0xffff0000, v78
    v_lshlrev_b32 v62, 16, v79
    v_and_b32 v63, 0xffff0000, v79
    v_pk_mul_f32 v[152:153], v[152:153], v[38:39]
    v_pk_mul_f32 v[154:155], v[154:155], v[38:39]
    v_pk_mul_f32 v[156:157], v[156:157], v[38:39]
    v_pk_mul_f32 v[158:159], v[158:159], v[38:39]
    v_pk_fma_f32 v[152:153], v[56:57], v[40:41], v[152:153]
    v_pk_fma_f32 v[154:155], v[58:59], v[40:41], v[154:155]
    v_pk_fma_f32 v[156:157], v[60:61], v[40:41], v[156:157]
    v_pk_fma_f32 v[158:159], v[62:63], v[40:41], v[158:159]
    v_cvt_pk_bf16_f32 v76, v152, v153
    v_cvt_pk_bf16_f32 v77, v154, v155
    v_cvt_pk_bf16_f32 v78, v156, v157
    v_cvt_pk_bf16_f32 v79, v158, v159
    buffer_store_dwordx4 v[76:79], v34, s[24:27], s37 offen offset:3072 sc1
    v_lshlrev_b32 v48, 16, v80
    v_and_b32 v49, 0xffff0000, v80
    v_lshlrev_b32 v50, 16, v81
    v_and_b32 v51, 0xffff0000, v81
    v_lshlrev_b32 v52, 16, v82
    v_and_b32 v53, 0xffff0000, v82
    v_lshlrev_b32 v54, 16, v83
    v_and_b32 v55, 0xffff0000, v83
    v_pk_mul_f32 v[160:161], v[160:161], v[38:39]
    v_pk_mul_f32 v[162:163], v[162:163], v[38:39]
    v_pk_mul_f32 v[164:165], v[164:165], v[38:39]
    v_pk_mul_f32 v[166:167], v[166:167], v[38:39]
    v_pk_fma_f32 v[160:161], v[48:49], v[40:41], v[160:161]
    v_pk_fma_f32 v[162:163], v[50:51], v[40:41], v[162:163]
    v_pk_fma_f32 v[164:165], v[52:53], v[40:41], v[164:165]
    v_pk_fma_f32 v[166:167], v[54:55], v[40:41], v[166:167]
    v_cvt_pk_bf16_f32 v80, v160, v161
    v_cvt_pk_bf16_f32 v81, v162, v163
    v_cvt_pk_bf16_f32 v82, v164, v165
    v_cvt_pk_bf16_f32 v83, v166, v167
    s_add_u32 s37, s37, 4096
    buffer_store_dwordx4 v[80:83], v34, s[24:27], s37 offen offset:0 sc1
    v_lshlrev_b32 v56, 16, v84
    v_and_b32 v57, 0xffff0000, v84
    v_lshlrev_b32 v58, 16, v85
    v_and_b32 v59, 0xffff0000, v85
    v_lshlrev_b32 v60, 16, v86
    v_and_b32 v61, 0xffff0000, v86
    v_lshlrev_b32 v62, 16, v87
    v_and_b32 v63, 0xffff0000, v87
    v_pk_mul_f32 v[168:169], v[168:169], v[38:39]
    v_pk_mul_f32 v[170:171], v[170:171], v[38:39]
    v_pk_mul_f32 v[172:173], v[172:173], v[38:39]
    v_pk_mul_f32 v[174:175], v[174:175], v[38:39]
    v_pk_fma_f32 v[168:169], v[56:57], v[40:41], v[168:169]
    v_pk_fma_f32 v[170:171], v[58:59], v[40:41], v[170:171]
    v_pk_fma_f32 v[172:173], v[60:61], v[40:41], v[172:173]
    v_pk_fma_f32 v[174:175], v[62:63], v[40:41], v[174:175]
    v_cvt_pk_bf16_f32 v84, v168, v169
    v_cvt_pk_bf16_f32 v85, v170, v171
    v_cvt_pk_bf16_f32 v86, v172, v173
    v_cvt_pk_bf16_f32 v87, v174, v175
    buffer_store_dwordx4 v[84:87], v34, s[24:27], s37 offen offset:1024 sc1
    v_lshlrev_b32 v48, 16, v88
    v_and_b32 v49, 0xffff0000, v88
    v_lshlrev_b32 v50, 16, v89
    v_and_b32 v51, 0xffff0000, v89
    v_lshlrev_b32 v52, 16, v90
    v_and_b32 v53, 0xffff0000, v90
    v_lshlrev_b32 v54, 16, v91
    v_and_b32 v55, 0xffff0000, v91
    v_pk_mul_f32 v[176:177], v[176:177], v[38:39]
    v_pk_mul_f32 v[178:179], v[178:179], v[38:39]
    v_pk_mul_f32 v[180:181], v[180:181], v[38:39]
    v_pk_mul_f32 v[182:183], v[182:183], v[38:39]
    v_pk_fma_f32 v[176:177], v[48:49], v[40:41], v[176:177]
    v_pk_fma_f32 v[178:179], v[50:51], v[40:41], v[178:179]
    v_pk_fma_f32 v[180:181], v[52:53], v[40:41], v[180:181]
    v_pk_fma_f32 v[182:183], v[54:55], v[40:41], v[182:183]
    v_cvt_pk_bf16_f32 v88, v176, v177
    v_cvt_pk_bf16_f32 v89, v178, v179
    v_cvt_pk_bf16_f32 v90, v180, v181
    v_cvt_pk_bf16_f32 v91, v182, v183
    buffer_store_dwordx4 v[88:91], v34, s[24:27], s37 offen offset:2048 sc1
    v_lshlrev_b32 v56, 16, v92
    v_and_b32 v57, 0xffff0000, v92
    v_lshlrev_b32 v58, 16, v93
    v_and_b32 v59, 0xffff0000, v93
    v_lshlrev_b32 v60, 16, v94
    v_and_b32 v61, 0xffff0000, v94
    v_lshlrev_b32 v62, 16, v95
    v_and_b32 v63, 0xffff0000, v95
    v_pk_mul_f32 v[184:185], v[184:185], v[38:39]
    v_pk_mul_f32 v[186:187], v[186:187], v[38:39]
    v_pk_mul_f32 v[188:189], v[188:189], v[38:39]
    v_pk_mul_f32 v[190:191], v[190:191], v[38:39]
    v_pk_fma_f32 v[184:185], v[56:57], v[40:41], v[184:185]
    v_pk_fma_f32 v[186:187], v[58:59], v[40:41], v[186:187]
    v_pk_fma_f32 v[188:189], v[60:61], v[40:41], v[188:189]
    v_pk_fma_f32 v[190:191], v[62:63], v[40:41], v[190:191]
    v_cvt_pk_bf16_f32 v92, v184, v185
    v_cvt_pk_bf16_f32 v93, v186, v187
    v_cvt_pk_bf16_f32 v94, v188, v189
    v_cvt_pk_bf16_f32 v95, v190, v191
    buffer_store_dwordx4 v[92:95], v34, s[24:27], s37 offen offset:3072 sc1
    v_lshlrev_b32 v48, 16, v96
    v_and_b32 v49, 0xffff0000, v96
    v_lshlrev_b32 v50, 16, v97
    v_and_b32 v51, 0xffff0000, v97
    v_lshlrev_b32 v52, 16, v98
    v_and_b32 v53, 0xffff0000, v98
    v_lshlrev_b32 v54, 16, v99
    v_and_b32 v55, 0xffff0000, v99
    v_pk_mul_f32 v[192:193], v[192:193], v[38:39]
    v_pk_mul_f32 v[194:195], v[194:195], v[38:39]
    v_pk_mul_f32 v[196:197], v[196:197], v[38:39]
    v_pk_mul_f32 v[198:199], v[198:199], v[38:39]
    v_pk_fma_f32 v[192:193], v[48:49], v[40:41], v[192:193]
    v_pk_fma_f32 v[194:195], v[50:51], v[40:41], v[194:195]
    v_pk_fma_f32 v[196:197], v[52:53], v[40:41], v[196:197]
    v_pk_fma_f32 v[198:199], v[54:55], v[40:41], v[198:199]
    v_cvt_pk_bf16_f32 v96, v192, v193
    v_cvt_pk_bf16_f32 v97, v194, v195
    v_cvt_pk_bf16_f32 v98, v196, v197
    v_cvt_pk_bf16_f32 v99, v198, v199
    s_add_u32 s37, s37, 4096
    buffer_store_dwordx4 v[96:99], v34, s[24:27], s37 offen offset:0 sc1
    v_lshlrev_b32 v56, 16, v100
    v_and_b32 v57, 0xffff0000, v100
    v_lshlrev_b32 v58, 16, v101
    v_and_b32 v59, 0xffff0000, v101
    v_lshlrev_b32 v60, 16, v102
    v_and_b32 v61, 0xffff0000, v102
    v_lshlrev_b32 v62, 16, v103
    v_and_b32 v63, 0xffff0000, v103
    v_pk_mul_f32 v[200:201], v[200:201], v[38:39]
    v_pk_mul_f32 v[202:203], v[202:203], v[38:39]
    v_pk_mul_f32 v[204:205], v[204:205], v[38:39]
    v_pk_mul_f32 v[206:207], v[206:207], v[38:39]
    v_pk_fma_f32 v[200:201], v[56:57], v[40:41], v[200:201]
    v_pk_fma_f32 v[202:203], v[58:59], v[40:41], v[202:203]
    v_pk_fma_f32 v[204:205], v[60:61], v[40:41], v[204:205]
    v_pk_fma_f32 v[206:207], v[62:63], v[40:41], v[206:207]
    v_cvt_pk_bf16_f32 v100, v200, v201
    v_cvt_pk_bf16_f32 v101, v202, v203
    v_cvt_pk_bf16_f32 v102, v204, v205
    v_cvt_pk_bf16_f32 v103, v206, v207
    buffer_store_dwordx4 v[100:103], v34, s[24:27], s37 offen offset:1024 sc1
    v_lshlrev_b32 v48, 16, v104
    v_and_b32 v49, 0xffff0000, v104
    v_lshlrev_b32 v50, 16, v105
    v_and_b32 v51, 0xffff0000, v105
    v_lshlrev_b32 v52, 16, v106
    v_and_b32 v53, 0xffff0000, v106
    v_lshlrev_b32 v54, 16, v107
    v_and_b32 v55, 0xffff0000, v107
    v_pk_mul_f32 v[208:209], v[208:209], v[38:39]
    v_pk_mul_f32 v[210:211], v[210:211], v[38:39]
    v_pk_mul_f32 v[212:213], v[212:213], v[38:39]
    v_pk_mul_f32 v[214:215], v[214:215], v[38:39]
    v_pk_fma_f32 v[208:209], v[48:49], v[40:41], v[208:209]
    v_pk_fma_f32 v[210:211], v[50:51], v[40:41], v[210:211]
    v_pk_fma_f32 v[212:213], v[52:53], v[40:41], v[212:213]
    v_pk_fma_f32 v[214:215], v[54:55], v[40:41], v[214:215]
    v_cvt_pk_bf16_f32 v104, v208, v209
    v_cvt_pk_bf16_f32 v105, v210, v211
    v_cvt_pk_bf16_f32 v106, v212, v213
    v_cvt_pk_bf16_f32 v107, v214, v215
    buffer_store_dwordx4 v[104:107], v34, s[24:27], s37 offen offset:2048 sc1
    v_lshlrev_b32 v56, 16, v108
    v_and_b32 v57, 0xffff0000, v108
    v_lshlrev_b32 v58, 16, v109
    v_and_b32 v59, 0xffff0000, v109
    v_lshlrev_b32 v60, 16, v110
    v_and_b32 v61, 0xffff0000, v110
    v_lshlrev_b32 v62, 16, v111
    v_and_b32 v63, 0xffff0000, v111
    v_pk_mul_f32 v[216:217], v[216:217], v[38:39]
    v_pk_mul_f32 v[218:219], v[218:219], v[38:39]
    v_pk_mul_f32 v[220:221], v[220:221], v[38:39]
    v_pk_mul_f32 v[222:223], v[222:223], v[38:39]
    v_pk_fma_f32 v[216:217], v[56:57], v[40:41], v[216:217]
    v_pk_fma_f32 v[218:219], v[58:59], v[40:41], v[218:219]
    v_pk_fma_f32 v[220:221], v[60:61], v[40:41], v[220:221]
    v_pk_fma_f32 v[222:223], v[62:63], v[40:41], v[222:223]
    v_cvt_pk_bf16_f32 v108, v216, v217
    v_cvt_pk_bf16_f32 v109, v218, v219
    v_cvt_pk_bf16_f32 v110, v220, v221
    v_cvt_pk_bf16_f32 v111, v222, v223
    buffer_store_dwordx4 v[108:111], v34, s[24:27], s37 offen offset:3072 sc1
    v_lshlrev_b32 v48, 16, v112
    v_and_b32 v49, 0xffff0000, v112
    v_lshlrev_b32 v50, 16, v113
    v_and_b32 v51, 0xffff0000, v113
    v_lshlrev_b32 v52, 16, v114
    v_and_b32 v53, 0xffff0000, v114
    v_lshlrev_b32 v54, 16, v115
    v_and_b32 v55, 0xffff0000, v115
    v_pk_mul_f32 v[224:225], v[224:225], v[38:39]
    v_pk_mul_f32 v[226:227], v[226:227], v[38:39]
    v_pk_mul_f32 v[228:229], v[228:229], v[38:39]
    v_pk_mul_f32 v[230:231], v[230:231], v[38:39]
    v_pk_fma_f32 v[224:225], v[48:49], v[40:41], v[224:225]
    v_pk_fma_f32 v[226:227], v[50:51], v[40:41], v[226:227]
    v_pk_fma_f32 v[228:229], v[52:53], v[40:41], v[228:229]
    v_pk_fma_f32 v[230:231], v[54:55], v[40:41], v[230:231]
    v_cvt_pk_bf16_f32 v112, v224, v225
    v_cvt_pk_bf16_f32 v113, v226, v227
    v_cvt_pk_bf16_f32 v114, v228, v229
    v_cvt_pk_bf16_f32 v115, v230, v231
    s_add_u32 s37, s37, 4096
    buffer_store_dwordx4 v[112:115], v34, s[24:27], s37 offen offset:0 sc1
    v_lshlrev_b32 v56, 16, v116
    v_and_b32 v57, 0xffff0000, v116
    v_lshlrev_b32 v58, 16, v117
    v_and_b32 v59, 0xffff0000, v117
    v_lshlrev_b32 v60, 16, v118
    v_and_b32 v61, 0xffff0000, v118
    v_lshlrev_b32 v62, 16, v119
    v_and_b32 v63, 0xffff0000, v119
    v_pk_mul_f32 v[232:233], v[232:233], v[38:39]
    v_pk_mul_f32 v[234:235], v[234:235], v[38:39]
    v_pk_mul_f32 v[236:237], v[236:237], v[38:39]
    v_pk_mul_f32 v[238:239], v[238:239], v[38:39]
    v_pk_fma_f32 v[232:233], v[56:57], v[40:41], v[232:233]
    v_pk_fma_f32 v[234:235], v[58:59], v[40:41], v[234:235]
    v_pk_fma_f32 v[236:237], v[60:61], v[40:41], v[236:237]
    v_pk_fma_f32 v[238:239], v[62:63], v[40:41], v[238:239]
    v_cvt_pk_bf16_f32 v116, v232, v233
    v_cvt_pk_bf16_f32 v117, v234, v235
    v_cvt_pk_bf16_f32 v118, v236, v237
    v_cvt_pk_bf16_f32 v119, v238, v239
    buffer_store_dwordx4 v[116:119], v34, s[24:27], s37 offen offset:1024 sc1
    v_lshlrev_b32 v48, 16, v120
    v_and_b32 v49, 0xffff0000, v120
    v_lshlrev_b32 v50, 16, v121
    v_and_b32 v51, 0xffff0000, v121
    v_lshlrev_b32 v52, 16, v122
    v_and_b32 v53, 0xffff0000, v122
    v_lshlrev_b32 v54, 16, v123
    v_and_b32 v55, 0xffff0000, v123
    v_pk_mul_f32 v[240:241], v[240:241], v[38:39]
    v_pk_mul_f32 v[242:243], v[242:243], v[38:39]
    v_pk_mul_f32 v[244:245], v[244:245], v[38:39]
    v_pk_mul_f32 v[246:247], v[246:247], v[38:39]
    v_pk_fma_f32 v[240:241], v[48:49], v[40:41], v[240:241]
    v_pk_fma_f32 v[242:243], v[50:51], v[40:41], v[242:243]
    v_pk_fma_f32 v[244:245], v[52:53], v[40:41], v[244:245]
    v_pk_fma_f32 v[246:247], v[54:55], v[40:41], v[246:247]
    v_cvt_pk_bf16_f32 v120, v240, v241
    v_cvt_pk_bf16_f32 v121, v242, v243
    v_cvt_pk_bf16_f32 v122, v244, v245
    v_cvt_pk_bf16_f32 v123, v246, v247
    buffer_store_dwordx4 v[120:123], v34, s[24:27], s37 offen offset:2048 sc1
    v_lshlrev_b32 v56, 16, v124
    v_and_b32 v57, 0xffff0000, v124
    v_lshlrev_b32 v58, 16, v125
    v_and_b32 v59, 0xffff0000, v125
    v_lshlrev_b32 v60, 16, v126
    v_and_b32 v61, 0xffff0000, v126
    v_lshlrev_b32 v62, 16, v127
    v_and_b32 v63, 0xffff0000, v127
    v_pk_mul_f32 v[248:249], v[248:249], v[38:39]
    v_pk_mul_f32 v[250:251], v[250:251], v[38:39]
    v_pk_mul_f32 v[252:253], v[252:253], v[38:39]
    v_pk_mul_f32 v[254:255], v[254:255], v[38:39]
    v_pk_fma_f32 v[248:249], v[56:57], v[40:41], v[248:249]
    v_pk_fma_f32 v[250:251], v[58:59], v[40:41], v[250:251]
    v_pk_fma_f32 v[252:253], v[60:61], v[40:41], v[252:253]
    v_pk_fma_f32 v[254:255], v[62:63], v[40:41], v[254:255]
    v_cvt_pk_bf16_f32 v124, v248, v249
    v_cvt_pk_bf16_f32 v125, v250, v251
    v_cvt_pk_bf16_f32 v126, v252, v253
    v_cvt_pk_bf16_f32 v127, v254, v255
    buffer_store_dwordx4 v[124:127], v34, s[24:27], s37 offen offset:3072 sc1
L_fin_done:
L_attn_end:
    s_endpgm
L_resc_a_67:
    v_mul_f32 v31, s43, v30
    v_max_f32 v31, v31, v24
    v_sub_f32 v32, v24, v31
    v_exp_f32 v32, v32
    v_mov_b32 v24, v31
    v_mul_f32 v25, v25, v32
    v_mul_f32 v26, v26, v32
    v_mul_f32 v27, v27, v32
    v_mul_f32 v28, v28, v32
    v_mul_f32 v128, v128, v32
    v_mul_f32 v129, v129, v32
    v_mul_f32 v130, v130, v32
    v_mul_f32 v131, v131, v32
    v_mul_f32 v132, v132, v32
    v_mul_f32 v133, v133, v32
    v_mul_f32 v134, v134, v32
    v_mul_f32 v135, v135, v32
    v_mul_f32 v136, v136, v32
    v_mul_f32 v137, v137, v32
    v_mul_f32 v138, v138, v32
    v_mul_f32 v139, v139, v32
    v_mul_f32 v140, v140, v32
    v_mul_f32 v141, v141, v32
    v_mul_f32 v142, v142, v32
    v_mul_f32 v143, v143, v32
    v_mul_f32 v144, v144, v32
    v_mul_f32 v145, v145, v32
    v_mul_f32 v146, v146, v32
    v_mul_f32 v147, v147, v32
    v_mul_f32 v148, v148, v32
    v_mul_f32 v149, v149, v32
    v_mul_f32 v150, v150, v32
    v_mul_f32 v151, v151, v32
    v_mul_f32 v152, v152, v32
    v_mul_f32 v153, v153, v32
    v_mul_f32 v154, v154, v32
    v_mul_f32 v155, v155, v32
    v_mul_f32 v156, v156, v32
    v_mul_f32 v157, v157, v32
    v_mul_f32 v158, v158, v32
    v_mul_f32 v159, v159, v32
    v_mul_f32 v160, v160, v32
    v_mul_f32 v161, v161, v32
    v_mul_f32 v162, v162, v32
    v_mul_f32 v163, v163, v32
    v_mul_f32 v164, v164, v32
    v_mul_f32 v165, v165, v32
    v_mul_f32 v166, v166, v32
    v_mul_f32 v167, v167, v32
    v_mul_f32 v168, v168, v32
    v_mul_f32 v169, v169, v32
    v_mul_f32 v170, v170, v32
    v_mul_f32 v171, v171, v32
    v_mul_f32 v172, v172, v32
    v_mul_f32 v173, v173, v32
    v_mul_f32 v174, v174, v32
    v_mul_f32 v175, v175, v32
    v_mul_f32 v176, v176, v32
    v_mul_f32 v177, v177, v32
    v_mul_f32 v178, v178, v32
    v_mul_f32 v179, v179, v32
    v_mul_f32 v180, v180, v32
    v_mul_f32 v181, v181, v32
    v_mul_f32 v182, v182, v32
    v_mul_f32 v183, v183, v32
    v_mul_f32 v184, v184, v32
    v_mul_f32 v185, v185, v32
    v_mul_f32 v186, v186, v32
    v_mul_f32 v187, v187, v32
    v_mul_f32 v188, v188, v32
    v_mul_f32 v189, v189, v32
    v_mul_f32 v190, v190, v32
    v_mul_f32 v191, v191, v32
    v_mul_f32 v192, v192, v32
    v_mul_f32 v193, v193, v32
    v_mul_f32 v194, v194, v32
    v_mul_f32 v195, v195, v32
    v_mul_f32 v196, v196, v32
    v_mul_f32 v197, v197, v32
    v_mul_f32 v198, v198, v32
    v_mul_f32 v199, v199, v32
    v_mul_f32 v200, v200, v32
    v_mul_f32 v201, v201, v32
    v_mul_f32 v202, v202, v32
    v_mul_f32 v203, v203, v32
    v_mul_f32 v204, v204, v32
    v_mul_f32 v205, v205, v32
    v_mul_f32 v206, v206, v32
    v_mul_f32 v207, v207, v32
    v_mul_f32 v208, v208, v32
    v_mul_f32 v209, v209, v32
    v_mul_f32 v210, v210, v32
    v_mul_f32 v211, v211, v32
    v_mul_f32 v212, v212, v32
    v_mul_f32 v213, v213, v32
    v_mul_f32 v214, v214, v32
    v_mul_f32 v215, v215, v32
    v_mul_f32 v216, v216, v32
    v_mul_f32 v217, v217, v32
    v_mul_f32 v218, v218, v32
    v_mul_f32 v219, v219, v32
    v_mul_f32 v220, v220, v32
    v_mul_f32 v221, v221, v32
    v_mul_f32 v222, v222, v32
    v_mul_f32 v223, v223, v32
    v_mul_f32 v224, v224, v32
    v_mul_f32 v225, v225, v32
    v_mul_f32 v226, v226, v32
    v_mul_f32 v227, v227, v32
    v_mul_f32 v228, v228, v32
    v_mul_f32 v229, v229, v32
    v_mul_f32 v230, v230, v32
    v_mul_f32 v231, v231, v32
    v_mul_f32 v232, v232, v32
    v_mul_f32 v233, v233, v32
    v_mul_f32 v234, v234, v32
    v_mul_f32 v235, v235, v32
    v_mul_f32 v236, v236, v32
    v_mul_f32 v237, v237, v32
    v_mul_f32 v238, v238, v32
    v_mul_f32 v239, v239, v32
    v_mul_f32 v240, v240, v32
    v_mul_f32 v241, v241, v32
    v_mul_f32 v242, v242, v32
    v_mul_f32 v243, v243, v32
    v_mul_f32 v244, v244, v32
    v_mul_f32 v245, v245, v32
    v_mul_f32 v246, v246, v32
    v_mul_f32 v247, v247, v32
    v_mul_f32 v248, v248, v32
    v_mul_f32 v249, v249, v32
    v_mul_f32 v250, v250, v32
    v_mul_f32 v251, v251, v32
    v_mul_f32 v252, v252, v32
    v_mul_f32 v253, v253, v32
    v_mul_f32 v254, v254, v32
    v_mul_f32 v255, v255, v32
    s_branch L_resc_ret_a_67
L_resc_a_68:
    v_mul_f32 v31, s43, v30
    v_max_f32 v31, v31, v24
    v_sub_f32 v32, v24, v31
    v_exp_f32 v32, v32
    v_mov_b32 v24, v31
    v_mul_f32 v25, v25, v32
    v_mul_f32 v26, v26, v32
    v_mul_f32 v27, v27, v32
    v_mul_f32 v28, v28, v32
    v_mul_f32 v128, v128, v32
    v_mul_f32 v129, v129, v32
    v_mul_f32 v130, v130, v32
    v_mul_f32 v131, v131, v32
    v_mul_f32 v132, v132, v32
    v_mul_f32 v133, v133, v32
    v_mul_f32 v134, v134, v32
    v_mul_f32 v135, v135, v32
    v_mul_f32 v136, v136, v32
    v_mul_f32 v137, v137, v32
    v_mul_f32 v138, v138, v32
    v_mul_f32 v139, v139, v32
    v_mul_f32 v140, v140, v32
    v_mul_f32 v141, v141, v32
    v_mul_f32 v142, v142, v32
    v_mul_f32 v143, v143, v32
    v_mul_f32 v144, v144, v32
    v_mul_f32 v145, v145, v32
    v_mul_f32 v146, v146, v32
    v_mul_f32 v147, v147, v32
    v_mul_f32 v148, v148, v32
    v_mul_f32 v149, v149, v32
    v_mul_f32 v150, v150, v32
    v_mul_f32 v151, v151, v32
    v_mul_f32 v152, v152, v32
    v_mul_f32 v153, v153, v32
    v_mul_f32 v154, v154, v32
    v_mul_f32 v155, v155, v32
    v_mul_f32 v156, v156, v32
    v_mul_f32 v157, v157, v32
    v_mul_f32 v158, v158, v32
    v_mul_f32 v159, v159, v32
    v_mul_f32 v160, v160, v32
    v_mul_f32 v161, v161, v32
    v_mul_f32 v162, v162, v32
    v_mul_f32 v163, v163, v32
    v_mul_f32 v164, v164, v32
    v_mul_f32 v165, v165, v32
    v_mul_f32 v166, v166, v32
    v_mul_f32 v167, v167, v32
    v_mul_f32 v168, v168, v32
    v_mul_f32 v169, v169, v32
    v_mul_f32 v170, v170, v32
    v_mul_f32 v171, v171, v32
    v_mul_f32 v172, v172, v32
    v_mul_f32 v173, v173, v32
    v_mul_f32 v174, v174, v32
    v_mul_f32 v175, v175, v32
    v_mul_f32 v176, v176, v32
    v_mul_f32 v177, v177, v32
    v_mul_f32 v178, v178, v32
    v_mul_f32 v179, v179, v32
    v_mul_f32 v180, v180, v32
    v_mul_f32 v181, v181, v32
    v_mul_f32 v182, v182, v32
    v_mul_f32 v183, v183, v32
    v_mul_f32 v184, v184, v32
    v_mul_f32 v185, v185, v32
    v_mul_f32 v186, v186, v32
    v_mul_f32 v187, v187, v32
    v_mul_f32 v188, v188, v32
    v_mul_f32 v189, v189, v32
    v_mul_f32 v190, v190, v32
    v_mul_f32 v191, v191, v32
    v_mul_f32 v192, v192, v32
    v_mul_f32 v193, v193, v32
    v_mul_f32 v194, v194, v32
    v_mul_f32 v195, v195, v32
    v_mul_f32 v196, v196, v32
    v_mul_f32 v197, v197, v32
    v_mul_f32 v198, v198, v32
    v_mul_f32 v199, v199, v32
    v_mul_f32 v200, v200, v32
    v_mul_f32 v201, v201, v32
    v_mul_f32 v202, v202, v32
    v_mul_f32 v203, v203, v32
    v_mul_f32 v204, v204, v32
    v_mul_f32 v205, v205, v32
    v_mul_f32 v206, v206, v32
    v_mul_f32 v207, v207, v32
    v_mul_f32 v208, v208, v32
    v_mul_f32 v209, v209, v32
    v_mul_f32 v210, v210, v32
    v_mul_f32 v211, v211, v32
    v_mul_f32 v212, v212, v32
    v_mul_f32 v213, v213, v32
    v_mul_f32 v214, v214, v32
    v_mul_f32 v215, v215, v32
    v_mul_f32 v216, v216, v32
    v_mul_f32 v217, v217, v32
    v_mul_f32 v218, v218, v32
    v_mul_f32 v219, v219, v32
    v_mul_f32 v220, v220, v32
    v_mul_f32 v221, v221, v32
    v_mul_f32 v222, v222, v32
    v_mul_f32 v223, v223, v32
    v_mul_f32 v224, v224, v32
    v_mul_f32 v225, v225, v32
    v_mul_f32 v226, v226, v32
    v_mul_f32 v227, v227, v32
    v_mul_f32 v228, v228, v32
    v_mul_f32 v229, v229, v32
    v_mul_f32 v230, v230, v32
    v_mul_f32 v231, v231, v32
    v_mul_f32 v232, v232, v32
    v_mul_f32 v233, v233, v32
    v_mul_f32 v234, v234, v32
    v_mul_f32 v235, v235, v32
    v_mul_f32 v236, v236, v32
    v_mul_f32 v237, v237, v32
    v_mul_f32 v238, v238, v32
    v_mul_f32 v239, v239, v32
    v_mul_f32 v240, v240, v32
    v_mul_f32 v241, v241, v32
    v_mul_f32 v242, v242, v32
    v_mul_f32 v243, v243, v32
    v_mul_f32 v244, v244, v32
    v_mul_f32 v245, v245, v32
    v_mul_f32 v246, v246, v32
    v_mul_f32 v247, v247, v32
    v_mul_f32 v248, v248, v32
    v_mul_f32 v249, v249, v32
    v_mul_f32 v250, v250, v32
    v_mul_f32 v251, v251, v32
    v_mul_f32 v252, v252, v32
    v_mul_f32 v253, v253, v32
    v_mul_f32 v254, v254, v32
    v_mul_f32 v255, v255, v32
    s_branch L_resc_ret_a_68
L_resc_a_69:
    v_mul_f32 v31, s43, v30
    v_max_f32 v31, v31, v24
    v_sub_f32 v32, v24, v31
    v_exp_f32 v32, v32
    v_mov_b32 v24, v31
    v_mul_f32 v25, v25, v32
    v_mul_f32 v26, v26, v32
    v_mul_f32 v27, v27, v32
    v_mul_f32 v28, v28, v32
    v_mul_f32 v128, v128, v32
    v_mul_f32 v129, v129, v32
    v_mul_f32 v130, v130, v32
    v_mul_f32 v131, v131, v32
    v_mul_f32 v132, v132, v32
    v_mul_f32 v133, v133, v32
    v_mul_f32 v134, v134, v32
    v_mul_f32 v135, v135, v32
    v_mul_f32 v136, v136, v32
    v_mul_f32 v137, v137, v32
    v_mul_f32 v138, v138, v32
    v_mul_f32 v139, v139, v32
    v_mul_f32 v140, v140, v32
    v_mul_f32 v141, v141, v32
    v_mul_f32 v142, v142, v32
    v_mul_f32 v143, v143, v32
    v_mul_f32 v144, v144, v32
    v_mul_f32 v145, v145, v32
    v_mul_f32 v146, v146, v32
    v_mul_f32 v147, v147, v32
    v_mul_f32 v148, v148, v32
    v_mul_f32 v149, v149, v32
    v_mul_f32 v150, v150, v32
    v_mul_f32 v151, v151, v32
    v_mul_f32 v152, v152, v32
    v_mul_f32 v153, v153, v32
    v_mul_f32 v154, v154, v32
    v_mul_f32 v155, v155, v32
    v_mul_f32 v156, v156, v32
    v_mul_f32 v157, v157, v32
    v_mul_f32 v158, v158, v32
    v_mul_f32 v159, v159, v32
    v_mul_f32 v160, v160, v32
    v_mul_f32 v161, v161, v32
    v_mul_f32 v162, v162, v32
    v_mul_f32 v163, v163, v32
    v_mul_f32 v164, v164, v32
    v_mul_f32 v165, v165, v32
    v_mul_f32 v166, v166, v32
    v_mul_f32 v167, v167, v32
    v_mul_f32 v168, v168, v32
    v_mul_f32 v169, v169, v32
    v_mul_f32 v170, v170, v32
    v_mul_f32 v171, v171, v32
    v_mul_f32 v172, v172, v32
    v_mul_f32 v173, v173, v32
    v_mul_f32 v174, v174, v32
    v_mul_f32 v175, v175, v32
    v_mul_f32 v176, v176, v32
    v_mul_f32 v177, v177, v32
    v_mul_f32 v178, v178, v32
    v_mul_f32 v179, v179, v32
    v_mul_f32 v180, v180, v32
    v_mul_f32 v181, v181, v32
    v_mul_f32 v182, v182, v32
    v_mul_f32 v183, v183, v32
    v_mul_f32 v184, v184, v32
    v_mul_f32 v185, v185, v32
    v_mul_f32 v186, v186, v32
    v_mul_f32 v187, v187, v32
    v_mul_f32 v188, v188, v32
    v_mul_f32 v189, v189, v32
    v_mul_f32 v190, v190, v32
    v_mul_f32 v191, v191, v32
    v_mul_f32 v192, v192, v32
    v_mul_f32 v193, v193, v32
    v_mul_f32 v194, v194, v32
    v_mul_f32 v195, v195, v32
    v_mul_f32 v196, v196, v32
    v_mul_f32 v197, v197, v32
    v_mul_f32 v198, v198, v32
    v_mul_f32 v199, v199, v32
    v_mul_f32 v200, v200, v32
    v_mul_f32 v201, v201, v32
    v_mul_f32 v202, v202, v32
    v_mul_f32 v203, v203, v32
    v_mul_f32 v204, v204, v32
    v_mul_f32 v205, v205, v32
    v_mul_f32 v206, v206, v32
    v_mul_f32 v207, v207, v32
    v_mul_f32 v208, v208, v32
    v_mul_f32 v209, v209, v32
    v_mul_f32 v210, v210, v32
    v_mul_f32 v211, v211, v32
    v_mul_f32 v212, v212, v32
    v_mul_f32 v213, v213, v32
    v_mul_f32 v214, v214, v32
    v_mul_f32 v215, v215, v32
    v_mul_f32 v216, v216, v32
    v_mul_f32 v217, v217, v32
    v_mul_f32 v218, v218, v32
    v_mul_f32 v219, v219, v32
    v_mul_f32 v220, v220, v32
    v_mul_f32 v221, v221, v32
    v_mul_f32 v222, v222, v32
    v_mul_f32 v223, v223, v32
    v_mul_f32 v224, v224, v32
    v_mul_f32 v225, v225, v32
    v_mul_f32 v226, v226, v32
    v_mul_f32 v227, v227, v32
    v_mul_f32 v228, v228, v32
    v_mul_f32 v229, v229, v32
    v_mul_f32 v230, v230, v32
    v_mul_f32 v231, v231, v32
    v_mul_f32 v232, v232, v32
    v_mul_f32 v233, v233, v32
    v_mul_f32 v234, v234, v32
    v_mul_f32 v235, v235, v32
    v_mul_f32 v236, v236, v32
    v_mul_f32 v237, v237, v32
    v_mul_f32 v238, v238, v32
    v_mul_f32 v239, v239, v32
    v_mul_f32 v240, v240, v32
    v_mul_f32 v241, v241, v32
    v_mul_f32 v242, v242, v32
    v_mul_f32 v243, v243, v32
    v_mul_f32 v244, v244, v32
    v_mul_f32 v245, v245, v32
    v_mul_f32 v246, v246, v32
    v_mul_f32 v247, v247, v32
    v_mul_f32 v248, v248, v32
    v_mul_f32 v249, v249, v32
    v_mul_f32 v250, v250, v32
    v_mul_f32 v251, v251, v32
    v_mul_f32 v252, v252, v32
    v_mul_f32 v253, v253, v32
    v_mul_f32 v254, v254, v32
    v_mul_f32 v255, v255, v32
    s_branch L_resc_ret_a_69
L_resc_a_70:
    v_mul_f32 v31, s43, v30
    v_max_f32 v31, v31, v24
    v_sub_f32 v32, v24, v31
    v_exp_f32 v32, v32
    v_mov_b32 v24, v31
    v_mul_f32 v25, v25, v32
    v_mul_f32 v26, v26, v32
    v_mul_f32 v27, v27, v32
    v_mul_f32 v28, v28, v32
    v_mul_f32 v128, v128, v32
    v_mul_f32 v129, v129, v32
    v_mul_f32 v130, v130, v32
    v_mul_f32 v131, v131, v32
    v_mul_f32 v132, v132, v32
    v_mul_f32 v133, v133, v32
    v_mul_f32 v134, v134, v32
    v_mul_f32 v135, v135, v32
    v_mul_f32 v136, v136, v32
    v_mul_f32 v137, v137, v32
    v_mul_f32 v138, v138, v32
    v_mul_f32 v139, v139, v32
    v_mul_f32 v140, v140, v32
    v_mul_f32 v141, v141, v32
    v_mul_f32 v142, v142, v32
    v_mul_f32 v143, v143, v32
    v_mul_f32 v144, v144, v32
    v_mul_f32 v145, v145, v32
    v_mul_f32 v146, v146, v32
    v_mul_f32 v147, v147, v32
    v_mul_f32 v148, v148, v32
    v_mul_f32 v149, v149, v32
    v_mul_f32 v150, v150, v32
    v_mul_f32 v151, v151, v32
    v_mul_f32 v152, v152, v32
    v_mul_f32 v153, v153, v32
    v_mul_f32 v154, v154, v32
    v_mul_f32 v155, v155, v32
    v_mul_f32 v156, v156, v32
    v_mul_f32 v157, v157, v32
    v_mul_f32 v158, v158, v32
    v_mul_f32 v159, v159, v32
    v_mul_f32 v160, v160, v32
    v_mul_f32 v161, v161, v32
    v_mul_f32 v162, v162, v32
    v_mul_f32 v163, v163, v32
    v_mul_f32 v164, v164, v32
    v_mul_f32 v165, v165, v32
    v_mul_f32 v166, v166, v32
    v_mul_f32 v167, v167, v32
    v_mul_f32 v168, v168, v32
    v_mul_f32 v169, v169, v32
    v_mul_f32 v170, v170, v32
    v_mul_f32 v171, v171, v32
    v_mul_f32 v172, v172, v32
    v_mul_f32 v173, v173, v32
    v_mul_f32 v174, v174, v32
    v_mul_f32 v175, v175, v32
    v_mul_f32 v176, v176, v32
    v_mul_f32 v177, v177, v32
    v_mul_f32 v178, v178, v32
    v_mul_f32 v179, v179, v32
    v_mul_f32 v180, v180, v32
    v_mul_f32 v181, v181, v32
    v_mul_f32 v182, v182, v32
    v_mul_f32 v183, v183, v32
    v_mul_f32 v184, v184, v32
    v_mul_f32 v185, v185, v32
    v_mul_f32 v186, v186, v32
    v_mul_f32 v187, v187, v32
    v_mul_f32 v188, v188, v32
    v_mul_f32 v189, v189, v32
    v_mul_f32 v190, v190, v32
    v_mul_f32 v191, v191, v32
    v_mul_f32 v192, v192, v32
    v_mul_f32 v193, v193, v32
    v_mul_f32 v194, v194, v32
    v_mul_f32 v195, v195, v32
    v_mul_f32 v196, v196, v32
    v_mul_f32 v197, v197, v32
    v_mul_f32 v198, v198, v32
    v_mul_f32 v199, v199, v32
    v_mul_f32 v200, v200, v32
    v_mul_f32 v201, v201, v32
    v_mul_f32 v202, v202, v32
    v_mul_f32 v203, v203, v32
    v_mul_f32 v204, v204, v32
    v_mul_f32 v205, v205, v32
    v_mul_f32 v206, v206, v32
    v_mul_f32 v207, v207, v32
    v_mul_f32 v208, v208, v32
    v_mul_f32 v209, v209, v32
    v_mul_f32 v210, v210, v32
    v_mul_f32 v211, v211, v32
    v_mul_f32 v212, v212, v32
    v_mul_f32 v213, v213, v32
    v_mul_f32 v214, v214, v32
    v_mul_f32 v215, v215, v32
    v_mul_f32 v216, v216, v32
    v_mul_f32 v217, v217, v32
    v_mul_f32 v218, v218, v32
    v_mul_f32 v219, v219, v32
    v_mul_f32 v220, v220, v32
    v_mul_f32 v221, v221, v32
    v_mul_f32 v222, v222, v32
    v_mul_f32 v223, v223, v32
    v_mul_f32 v224, v224, v32
    v_mul_f32 v225, v225, v32
    v_mul_f32 v226, v226, v32
    v_mul_f32 v227, v227, v32
    v_mul_f32 v228, v228, v32
    v_mul_f32 v229, v229, v32
    v_mul_f32 v230, v230, v32
    v_mul_f32 v231, v231, v32
    v_mul_f32 v232, v232, v32
    v_mul_f32 v233, v233, v32
    v_mul_f32 v234, v234, v32
    v_mul_f32 v235, v235, v32
    v_mul_f32 v236, v236, v32
    v_mul_f32 v237, v237, v32
    v_mul_f32 v238, v238, v32
    v_mul_f32 v239, v239, v32
    v_mul_f32 v240, v240, v32
    v_mul_f32 v241, v241, v32
    v_mul_f32 v242, v242, v32
    v_mul_f32 v243, v243, v32
    v_mul_f32 v244, v244, v32
    v_mul_f32 v245, v245, v32
    v_mul_f32 v246, v246, v32
    v_mul_f32 v247, v247, v32
    v_mul_f32 v248, v248, v32
    v_mul_f32 v249, v249, v32
    v_mul_f32 v250, v250, v32
    v_mul_f32 v251, v251, v32
    v_mul_f32 v252, v252, v32
    v_mul_f32 v253, v253, v32
    v_mul_f32 v254, v254, v32
    v_mul_f32 v255, v255, v32
    s_branch L_resc_ret_a_70
L_resc_a_71:
    v_mul_f32 v31, s43, v30
    v_max_f32 v31, v31, v24
    v_sub_f32 v32, v24, v31
    v_exp_f32 v32, v32
    v_mov_b32 v24, v31
    v_mul_f32 v25, v25, v32
    v_mul_f32 v26, v26, v32
    v_mul_f32 v27, v27, v32
    v_mul_f32 v28, v28, v32
    v_mul_f32 v128, v128, v32
    v_mul_f32 v129, v129, v32
    v_mul_f32 v130, v130, v32
    v_mul_f32 v131, v131, v32
    v_mul_f32 v132, v132, v32
    v_mul_f32 v133, v133, v32
    v_mul_f32 v134, v134, v32
    v_mul_f32 v135, v135, v32
    v_mul_f32 v136, v136, v32
    v_mul_f32 v137, v137, v32
    v_mul_f32 v138, v138, v32
    v_mul_f32 v139, v139, v32
    v_mul_f32 v140, v140, v32
    v_mul_f32 v141, v141, v32
    v_mul_f32 v142, v142, v32
    v_mul_f32 v143, v143, v32
    v_mul_f32 v144, v144, v32
    v_mul_f32 v145, v145, v32
    v_mul_f32 v146, v146, v32
    v_mul_f32 v147, v147, v32
    v_mul_f32 v148, v148, v32
    v_mul_f32 v149, v149, v32
    v_mul_f32 v150, v150, v32
    v_mul_f32 v151, v151, v32
    v_mul_f32 v152, v152, v32
    v_mul_f32 v153, v153, v32
    v_mul_f32 v154, v154, v32
    v_mul_f32 v155, v155, v32
    v_mul_f32 v156, v156, v32
    v_mul_f32 v157, v157, v32
    v_mul_f32 v158, v158, v32
    v_mul_f32 v159, v159, v32
    v_mul_f32 v160, v160, v32
    v_mul_f32 v161, v161, v32
    v_mul_f32 v162, v162, v32
    v_mul_f32 v163, v163, v32
    v_mul_f32 v164, v164, v32
    v_mul_f32 v165, v165, v32
    v_mul_f32 v166, v166, v32
    v_mul_f32 v167, v167, v32
    v_mul_f32 v168, v168, v32
    v_mul_f32 v169, v169, v32
    v_mul_f32 v170, v170, v32
    v_mul_f32 v171, v171, v32
    v_mul_f32 v172, v172, v32
    v_mul_f32 v173, v173, v32
    v_mul_f32 v174, v174, v32
    v_mul_f32 v175, v175, v32
    v_mul_f32 v176, v176, v32
    v_mul_f32 v177, v177, v32
    v_mul_f32 v178, v178, v32
    v_mul_f32 v179, v179, v32
    v_mul_f32 v180, v180, v32
    v_mul_f32 v181, v181, v32
    v_mul_f32 v182, v182, v32
    v_mul_f32 v183, v183, v32
    v_mul_f32 v184, v184, v32
    v_mul_f32 v185, v185, v32
    v_mul_f32 v186, v186, v32
    v_mul_f32 v187, v187, v32
    v_mul_f32 v188, v188, v32
    v_mul_f32 v189, v189, v32
    v_mul_f32 v190, v190, v32
    v_mul_f32 v191, v191, v32
    v_mul_f32 v192, v192, v32
    v_mul_f32 v193, v193, v32
    v_mul_f32 v194, v194, v32
    v_mul_f32 v195, v195, v32
    v_mul_f32 v196, v196, v32
    v_mul_f32 v197, v197, v32
    v_mul_f32 v198, v198, v32
    v_mul_f32 v199, v199, v32
    v_mul_f32 v200, v200, v32
    v_mul_f32 v201, v201, v32
    v_mul_f32 v202, v202, v32
    v_mul_f32 v203, v203, v32
    v_mul_f32 v204, v204, v32
    v_mul_f32 v205, v205, v32
    v_mul_f32 v206, v206, v32
    v_mul_f32 v207, v207, v32
    v_mul_f32 v208, v208, v32
    v_mul_f32 v209, v209, v32
    v_mul_f32 v210, v210, v32
    v_mul_f32 v211, v211, v32
    v_mul_f32 v212, v212, v32
    v_mul_f32 v213, v213, v32
    v_mul_f32 v214, v214, v32
    v_mul_f32 v215, v215, v32
    v_mul_f32 v216, v216, v32
    v_mul_f32 v217, v217, v32
    v_mul_f32 v218, v218, v32
    v_mul_f32 v219, v219, v32
    v_mul_f32 v220, v220, v32
    v_mul_f32 v221, v221, v32
    v_mul_f32 v222, v222, v32
    v_mul_f32 v223, v223, v32
    v_mul_f32 v224, v224, v32
    v_mul_f32 v225, v225, v32
    v_mul_f32 v226, v226, v32
    v_mul_f32 v227, v227, v32
    v_mul_f32 v228, v228, v32
    v_mul_f32 v229, v229, v32
    v_mul_f32 v230, v230, v32
    v_mul_f32 v231, v231, v32
    v_mul_f32 v232, v232, v32
    v_mul_f32 v233, v233, v32
    v_mul_f32 v234, v234, v32
    v_mul_f32 v235, v235, v32
    v_mul_f32 v236, v236, v32
    v_mul_f32 v237, v237, v32
    v_mul_f32 v238, v238, v32
    v_mul_f32 v239, v239, v32
    v_mul_f32 v240, v240, v32
    v_mul_f32 v241, v241, v32
    v_mul_f32 v242, v242, v32
    v_mul_f32 v243, v243, v32
    v_mul_f32 v244, v244, v32
    v_mul_f32 v245, v245, v32
    v_mul_f32 v246, v246, v32
    v_mul_f32 v247, v247, v32
    v_mul_f32 v248, v248, v32
    v_mul_f32 v249, v249, v32
    v_mul_f32 v250, v250, v32
    v_mul_f32 v251, v251, v32
    v_mul_f32 v252, v252, v32
    v_mul_f32 v253, v253, v32
    v_mul_f32 v254, v254, v32
    v_mul_f32 v255, v255, v32
    s_branch L_resc_ret_a_71
L_resc_a_73:
    v_mul_f32 v31, s43, v30
    v_max_f32 v31, v31, v24
    v_sub_f32 v32, v24, v31
    v_exp_f32 v32, v32
    v_mov_b32 v24, v31
    v_mul_f32 v25, v25, v32
    v_mul_f32 v26, v26, v32
    v_mul_f32 v27, v27, v32
    v_mul_f32 v28, v28, v32
    v_mul_f32 v128, v128, v32
    v_mul_f32 v129, v129, v32
    v_mul_f32 v130, v130, v32
    v_mul_f32 v131, v131, v32
    v_mul_f32 v132, v132, v32
    v_mul_f32 v133, v133, v32
    v_mul_f32 v134, v134, v32
    v_mul_f32 v135, v135, v32
    v_mul_f32 v136, v136, v32
    v_mul_f32 v137, v137, v32
    v_mul_f32 v138, v138, v32
    v_mul_f32 v139, v139, v32
    v_mul_f32 v140, v140, v32
    v_mul_f32 v141, v141, v32
    v_mul_f32 v142, v142, v32
    v_mul_f32 v143, v143, v32
    v_mul_f32 v144, v144, v32
    v_mul_f32 v145, v145, v32
    v_mul_f32 v146, v146, v32
    v_mul_f32 v147, v147, v32
    v_mul_f32 v148, v148, v32
    v_mul_f32 v149, v149, v32
    v_mul_f32 v150, v150, v32
    v_mul_f32 v151, v151, v32
    v_mul_f32 v152, v152, v32
    v_mul_f32 v153, v153, v32
    v_mul_f32 v154, v154, v32
    v_mul_f32 v155, v155, v32
    v_mul_f32 v156, v156, v32
    v_mul_f32 v157, v157, v32
    v_mul_f32 v158, v158, v32
    v_mul_f32 v159, v159, v32
    v_mul_f32 v160, v160, v32
    v_mul_f32 v161, v161, v32
    v_mul_f32 v162, v162, v32
    v_mul_f32 v163, v163, v32
    v_mul_f32 v164, v164, v32
    v_mul_f32 v165, v165, v32
    v_mul_f32 v166, v166, v32
    v_mul_f32 v167, v167, v32
    v_mul_f32 v168, v168, v32
    v_mul_f32 v169, v169, v32
    v_mul_f32 v170, v170, v32
    v_mul_f32 v171, v171, v32
    v_mul_f32 v172, v172, v32
    v_mul_f32 v173, v173, v32
    v_mul_f32 v174, v174, v32
    v_mul_f32 v175, v175, v32
    v_mul_f32 v176, v176, v32
    v_mul_f32 v177, v177, v32
    v_mul_f32 v178, v178, v32
    v_mul_f32 v179, v179, v32
    v_mul_f32 v180, v180, v32
    v_mul_f32 v181, v181, v32
    v_mul_f32 v182, v182, v32
    v_mul_f32 v183, v183, v32
    v_mul_f32 v184, v184, v32
    v_mul_f32 v185, v185, v32
    v_mul_f32 v186, v186, v32
    v_mul_f32 v187, v187, v32
    v_mul_f32 v188, v188, v32
    v_mul_f32 v189, v189, v32
    v_mul_f32 v190, v190, v32
    v_mul_f32 v191, v191, v32
    v_mul_f32 v192, v192, v32
    v_mul_f32 v193, v193, v32
    v_mul_f32 v194, v194, v32
    v_mul_f32 v195, v195, v32
    v_mul_f32 v196, v196, v32
    v_mul_f32 v197, v197, v32
    v_mul_f32 v198, v198, v32
    v_mul_f32 v199, v199, v32
    v_mul_f32 v200, v200, v32
    v_mul_f32 v201, v201, v32
    v_mul_f32 v202, v202, v32
    v_mul_f32 v203, v203, v32
    v_mul_f32 v204, v204, v32
    v_mul_f32 v205, v205, v32
    v_mul_f32 v206, v206, v32
    v_mul_f32 v207, v207, v32
    v_mul_f32 v208, v208, v32
    v_mul_f32 v209, v209, v32
    v_mul_f32 v210, v210, v32
    v_mul_f32 v211, v211, v32
    v_mul_f32 v212, v212, v32
    v_mul_f32 v213, v213, v32
    v_mul_f32 v214, v214, v32
    v_mul_f32 v215, v215, v32
    v_mul_f32 v216, v216, v32
    v_mul_f32 v217, v217, v32
    v_mul_f32 v218, v218, v32
    v_mul_f32 v219, v219, v32
    v_mul_f32 v220, v220, v32
    v_mul_f32 v221, v221, v32
    v_mul_f32 v222, v222, v32
    v_mul_f32 v223, v223, v32
    v_mul_f32 v224, v224, v32
    v_mul_f32 v225, v225, v32
    v_mul_f32 v226, v226, v32
    v_mul_f32 v227, v227, v32
    v_mul_f32 v228, v228, v32
    v_mul_f32 v229, v229, v32
    v_mul_f32 v230, v230, v32
    v_mul_f32 v231, v231, v32
    v_mul_f32 v232, v232, v32
    v_mul_f32 v233, v233, v32
    v_mul_f32 v234, v234, v32
    v_mul_f32 v235, v235, v32
    v_mul_f32 v236, v236, v32
    v_mul_f32 v237, v237, v32
    v_mul_f32 v238, v238, v32
    v_mul_f32 v239, v239, v32
    v_mul_f32 v240, v240, v32
    v_mul_f32 v241, v241, v32
    v_mul_f32 v242, v242, v32
    v_mul_f32 v243, v243, v32
    v_mul_f32 v244, v244, v32
    v_mul_f32 v245, v245, v32
    v_mul_f32 v246, v246, v32
    v_mul_f32 v247, v247, v32
    v_mul_f32 v248, v248, v32
    v_mul_f32 v249, v249, v32
    v_mul_f32 v250, v250, v32
    v_mul_f32 v251, v251, v32
    v_mul_f32 v252, v252, v32
    v_mul_f32 v253, v253, v32
    v_mul_f32 v254, v254, v32
    v_mul_f32 v255, v255, v32
    s_branch L_resc_ret_a_73
L_resc_a_75:
    v_mul_f32 v31, s43, v30
    v_max_f32 v31, v31, v24
    v_sub_f32 v32, v24, v31
    v_exp_f32 v32, v32
    v_mov_b32 v24, v31
    v_mul_f32 v25, v25, v32
    v_mul_f32 v26, v26, v32
    v_mul_f32 v27, v27, v32
    v_mul_f32 v28, v28, v32
    v_mul_f32 v128, v128, v32
    v_mul_f32 v129, v129, v32
    v_mul_f32 v130, v130, v32
    v_mul_f32 v131, v131, v32
    v_mul_f32 v132, v132, v32
    v_mul_f32 v133, v133, v32
    v_mul_f32 v134, v134, v32
    v_mul_f32 v135, v135, v32
    v_mul_f32 v136, v136, v32
    v_mul_f32 v137, v137, v32
    v_mul_f32 v138, v138, v32
    v_mul_f32 v139, v139, v32
    v_mul_f32 v140, v140, v32
    v_mul_f32 v141, v141, v32
    v_mul_f32 v142, v142, v32
    v_mul_f32 v143, v143, v32
    v_mul_f32 v144, v144, v32
    v_mul_f32 v145, v145, v32
    v_mul_f32 v146, v146, v32
    v_mul_f32 v147, v147, v32
    v_mul_f32 v148, v148, v32
    v_mul_f32 v149, v149, v32
    v_mul_f32 v150, v150, v32
    v_mul_f32 v151, v151, v32
    v_mul_f32 v152, v152, v32
    v_mul_f32 v153, v153, v32
    v_mul_f32 v154, v154, v32
    v_mul_f32 v155, v155, v32
    v_mul_f32 v156, v156, v32
    v_mul_f32 v157, v157, v32
    v_mul_f32 v158, v158, v32
    v_mul_f32 v159, v159, v32
    v_mul_f32 v160, v160, v32
    v_mul_f32 v161, v161, v32
    v_mul_f32 v162, v162, v32
    v_mul_f32 v163, v163, v32
    v_mul_f32 v164, v164, v32
    v_mul_f32 v165, v165, v32
    v_mul_f32 v166, v166, v32
    v_mul_f32 v167, v167, v32
    v_mul_f32 v168, v168, v32
    v_mul_f32 v169, v169, v32
    v_mul_f32 v170, v170, v32
    v_mul_f32 v171, v171, v32
    v_mul_f32 v172, v172, v32
    v_mul_f32 v173, v173, v32
    v_mul_f32 v174, v174, v32
    v_mul_f32 v175, v175, v32
    v_mul_f32 v176, v176, v32
    v_mul_f32 v177, v177, v32
    v_mul_f32 v178, v178, v32
    v_mul_f32 v179, v179, v32
    v_mul_f32 v180, v180, v32
    v_mul_f32 v181, v181, v32
    v_mul_f32 v182, v182, v32
    v_mul_f32 v183, v183, v32
    v_mul_f32 v184, v184, v32
    v_mul_f32 v185, v185, v32
    v_mul_f32 v186, v186, v32
    v_mul_f32 v187, v187, v32
    v_mul_f32 v188, v188, v32
    v_mul_f32 v189, v189, v32
    v_mul_f32 v190, v190, v32
    v_mul_f32 v191, v191, v32
    v_mul_f32 v192, v192, v32
    v_mul_f32 v193, v193, v32
    v_mul_f32 v194, v194, v32
    v_mul_f32 v195, v195, v32
    v_mul_f32 v196, v196, v32
    v_mul_f32 v197, v197, v32
    v_mul_f32 v198, v198, v32
    v_mul_f32 v199, v199, v32
    v_mul_f32 v200, v200, v32
    v_mul_f32 v201, v201, v32
    v_mul_f32 v202, v202, v32
    v_mul_f32 v203, v203, v32
    v_mul_f32 v204, v204, v32
    v_mul_f32 v205, v205, v32
    v_mul_f32 v206, v206, v32
    v_mul_f32 v207, v207, v32
    v_mul_f32 v208, v208, v32
    v_mul_f32 v209, v209, v32
    v_mul_f32 v210, v210, v32
    v_mul_f32 v211, v211, v32
    v_mul_f32 v212, v212, v32
    v_mul_f32 v213, v213, v32
    v_mul_f32 v214, v214, v32
    v_mul_f32 v215, v215, v32
    v_mul_f32 v216, v216, v32
    v_mul_f32 v217, v217, v32
    v_mul_f32 v218, v218, v32
    v_mul_f32 v219, v219, v32
    v_mul_f32 v220, v220, v32
    v_mul_f32 v221, v221, v32
    v_mul_f32 v222, v222, v32
    v_mul_f32 v223, v223, v32
    v_mul_f32 v224, v224, v32
    v_mul_f32 v225, v225, v32
    v_mul_f32 v226, v226, v32
    v_mul_f32 v227, v227, v32
    v_mul_f32 v228, v228, v32
    v_mul_f32 v229, v229, v32
    v_mul_f32 v230, v230, v32
    v_mul_f32 v231, v231, v32
    v_mul_f32 v232, v232, v32
    v_mul_f32 v233, v233, v32
    v_mul_f32 v234, v234, v32
    v_mul_f32 v235, v235, v32
    v_mul_f32 v236, v236, v32
    v_mul_f32 v237, v237, v32
    v_mul_f32 v238, v238, v32
    v_mul_f32 v239, v239, v32
    v_mul_f32 v240, v240, v32
    v_mul_f32 v241, v241, v32
    v_mul_f32 v242, v242, v32
    v_mul_f32 v243, v243, v32
    v_mul_f32 v244, v244, v32
    v_mul_f32 v245, v245, v32
    v_mul_f32 v246, v246, v32
    v_mul_f32 v247, v247, v32
    v_mul_f32 v248, v248, v32
    v_mul_f32 v249, v249, v32
    v_mul_f32 v250, v250, v32
    v_mul_f32 v251, v251, v32
    v_mul_f32 v252, v252, v32
    v_mul_f32 v253, v253, v32
    v_mul_f32 v254, v254, v32
    v_mul_f32 v255, v255, v32
    s_branch L_resc_ret_a_75
L_resc_a_77:
    v_mul_f32 v31, s43, v30
    v_max_f32 v31, v31, v24
    v_sub_f32 v32, v24, v31
    v_exp_f32 v32, v32
    v_mov_b32 v24, v31
    v_mul_f32 v25, v25, v32
    v_mul_f32 v26, v26, v32
    v_mul_f32 v27, v27, v32
    v_mul_f32 v28, v28, v32
    v_mul_f32 v128, v128, v32
    v_mul_f32 v129, v129, v32
    v_mul_f32 v130, v130, v32
    v_mul_f32 v131, v131, v32
    v_mul_f32 v132, v132, v32
    v_mul_f32 v133, v133, v32
    v_mul_f32 v134, v134, v32
    v_mul_f32 v135, v135, v32
    v_mul_f32 v136, v136, v32
    v_mul_f32 v137, v137, v32
    v_mul_f32 v138, v138, v32
    v_mul_f32 v139, v139, v32
    v_mul_f32 v140, v140, v32
    v_mul_f32 v141, v141, v32
    v_mul_f32 v142, v142, v32
    v_mul_f32 v143, v143, v32
    v_mul_f32 v144, v144, v32
    v_mul_f32 v145, v145, v32
    v_mul_f32 v146, v146, v32
    v_mul_f32 v147, v147, v32
    v_mul_f32 v148, v148, v32
    v_mul_f32 v149, v149, v32
    v_mul_f32 v150, v150, v32
    v_mul_f32 v151, v151, v32
    v_mul_f32 v152, v152, v32
    v_mul_f32 v153, v153, v32
    v_mul_f32 v154, v154, v32
    v_mul_f32 v155, v155, v32
    v_mul_f32 v156, v156, v32
    v_mul_f32 v157, v157, v32
    v_mul_f32 v158, v158, v32
    v_mul_f32 v159, v159, v32
    v_mul_f32 v160, v160, v32
    v_mul_f32 v161, v161, v32
    v_mul_f32 v162, v162, v32
    v_mul_f32 v163, v163, v32
    v_mul_f32 v164, v164, v32
    v_mul_f32 v165, v165, v32
    v_mul_f32 v166, v166, v32
    v_mul_f32 v167, v167, v32
    v_mul_f32 v168, v168, v32
    v_mul_f32 v169, v169, v32
    v_mul_f32 v170, v170, v32
    v_mul_f32 v171, v171, v32
    v_mul_f32 v172, v172, v32
    v_mul_f32 v173, v173, v32
    v_mul_f32 v174, v174, v32
    v_mul_f32 v175, v175, v32
    v_mul_f32 v176, v176, v32
    v_mul_f32 v177, v177, v32
    v_mul_f32 v178, v178, v32
    v_mul_f32 v179, v179, v32
    v_mul_f32 v180, v180, v32
    v_mul_f32 v181, v181, v32
    v_mul_f32 v182, v182, v32
    v_mul_f32 v183, v183, v32
    v_mul_f32 v184, v184, v32
    v_mul_f32 v185, v185, v32
    v_mul_f32 v186, v186, v32
    v_mul_f32 v187, v187, v32
    v_mul_f32 v188, v188, v32
    v_mul_f32 v189, v189, v32
    v_mul_f32 v190, v190, v32
    v_mul_f32 v191, v191, v32
    v_mul_f32 v192, v192, v32
    v_mul_f32 v193, v193, v32
    v_mul_f32 v194, v194, v32
    v_mul_f32 v195, v195, v32
    v_mul_f32 v196, v196, v32
    v_mul_f32 v197, v197, v32
    v_mul_f32 v198, v198, v32
    v_mul_f32 v199, v199, v32
    v_mul_f32 v200, v200, v32
    v_mul_f32 v201, v201, v32
    v_mul_f32 v202, v202, v32
    v_mul_f32 v203, v203, v32
    v_mul_f32 v204, v204, v32
    v_mul_f32 v205, v205, v32
    v_mul_f32 v206, v206, v32
    v_mul_f32 v207, v207, v32
    v_mul_f32 v208, v208, v32
    v_mul_f32 v209, v209, v32
    v_mul_f32 v210, v210, v32
    v_mul_f32 v211, v211, v32
    v_mul_f32 v212, v212, v32
    v_mul_f32 v213, v213, v32
    v_mul_f32 v214, v214, v32
    v_mul_f32 v215, v215, v32
    v_mul_f32 v216, v216, v32
    v_mul_f32 v217, v217, v32
    v_mul_f32 v218, v218, v32
    v_mul_f32 v219, v219, v32
    v_mul_f32 v220, v220, v32
    v_mul_f32 v221, v221, v32
    v_mul_f32 v222, v222, v32
    v_mul_f32 v223, v223, v32
    v_mul_f32 v224, v224, v32
    v_mul_f32 v225, v225, v32
    v_mul_f32 v226, v226, v32
    v_mul_f32 v227, v227, v32
    v_mul_f32 v228, v228, v32
    v_mul_f32 v229, v229, v32
    v_mul_f32 v230, v230, v32
    v_mul_f32 v231, v231, v32
    v_mul_f32 v232, v232, v32
    v_mul_f32 v233, v233, v32
    v_mul_f32 v234, v234, v32
    v_mul_f32 v235, v235, v32
    v_mul_f32 v236, v236, v32
    v_mul_f32 v237, v237, v32
    v_mul_f32 v238, v238, v32
    v_mul_f32 v239, v239, v32
    v_mul_f32 v240, v240, v32
    v_mul_f32 v241, v241, v32
    v_mul_f32 v242, v242, v32
    v_mul_f32 v243, v243, v32
    v_mul_f32 v244, v244, v32
    v_mul_f32 v245, v245, v32
    v_mul_f32 v246, v246, v32
    v_mul_f32 v247, v247, v32
    v_mul_f32 v248, v248, v32
    v_mul_f32 v249, v249, v32
    v_mul_f32 v250, v250, v32
    v_mul_f32 v251, v251, v32
    v_mul_f32 v252, v252, v32
    v_mul_f32 v253, v253, v32
    v_mul_f32 v254, v254, v32
    v_mul_f32 v255, v255, v32
    s_branch L_resc_ret_a_77
L_resc_a_79:
    v_mul_f32 v31, s43, v30
    v_max_f32 v31, v31, v24
    v_sub_f32 v32, v24, v31
    v_exp_f32 v32, v32
    v_mov_b32 v24, v31
    v_mul_f32 v25, v25, v32
    v_mul_f32 v26, v26, v32
    v_mul_f32 v27, v27, v32
    v_mul_f32 v28, v28, v32
    v_mul_f32 v128, v128, v32
    v_mul_f32 v129, v129, v32
    v_mul_f32 v130, v130, v32
    v_mul_f32 v131, v131, v32
    v_mul_f32 v132, v132, v32
    v_mul_f32 v133, v133, v32
    v_mul_f32 v134, v134, v32
    v_mul_f32 v135, v135, v32
    v_mul_f32 v136, v136, v32
    v_mul_f32 v137, v137, v32
    v_mul_f32 v138, v138, v32
    v_mul_f32 v139, v139, v32
    v_mul_f32 v140, v140, v32
    v_mul_f32 v141, v141, v32
    v_mul_f32 v142, v142, v32
    v_mul_f32 v143, v143, v32
    v_mul_f32 v144, v144, v32
    v_mul_f32 v145, v145, v32
    v_mul_f32 v146, v146, v32
    v_mul_f32 v147, v147, v32
    v_mul_f32 v148, v148, v32
    v_mul_f32 v149, v149, v32
    v_mul_f32 v150, v150, v32
    v_mul_f32 v151, v151, v32
    v_mul_f32 v152, v152, v32
    v_mul_f32 v153, v153, v32
    v_mul_f32 v154, v154, v32
    v_mul_f32 v155, v155, v32
    v_mul_f32 v156, v156, v32
    v_mul_f32 v157, v157, v32
    v_mul_f32 v158, v158, v32
    v_mul_f32 v159, v159, v32
    v_mul_f32 v160, v160, v32
    v_mul_f32 v161, v161, v32
    v_mul_f32 v162, v162, v32
    v_mul_f32 v163, v163, v32
    v_mul_f32 v164, v164, v32
    v_mul_f32 v165, v165, v32
    v_mul_f32 v166, v166, v32
    v_mul_f32 v167, v167, v32
    v_mul_f32 v168, v168, v32
    v_mul_f32 v169, v169, v32
    v_mul_f32 v170, v170, v32
    v_mul_f32 v171, v171, v32
    v_mul_f32 v172, v172, v32
    v_mul_f32 v173, v173, v32
    v_mul_f32 v174, v174, v32
    v_mul_f32 v175, v175, v32
    v_mul_f32 v176, v176, v32
    v_mul_f32 v177, v177, v32
    v_mul_f32 v178, v178, v32
    v_mul_f32 v179, v179, v32
    v_mul_f32 v180, v180, v32
    v_mul_f32 v181, v181, v32
    v_mul_f32 v182, v182, v32
    v_mul_f32 v183, v183, v32
    v_mul_f32 v184, v184, v32
    v_mul_f32 v185, v185, v32
    v_mul_f32 v186, v186, v32
    v_mul_f32 v187, v187, v32
    v_mul_f32 v188, v188, v32
    v_mul_f32 v189, v189, v32
    v_mul_f32 v190, v190, v32
    v_mul_f32 v191, v191, v32
    v_mul_f32 v192, v192, v32
    v_mul_f32 v193, v193, v32
    v_mul_f32 v194, v194, v32
    v_mul_f32 v195, v195, v32
    v_mul_f32 v196, v196, v32
    v_mul_f32 v197, v197, v32
    v_mul_f32 v198, v198, v32
    v_mul_f32 v199, v199, v32
    v_mul_f32 v200, v200, v32
    v_mul_f32 v201, v201, v32
    v_mul_f32 v202, v202, v32
    v_mul_f32 v203, v203, v32
    v_mul_f32 v204, v204, v32
    v_mul_f32 v205, v205, v32
    v_mul_f32 v206, v206, v32
    v_mul_f32 v207, v207, v32
    v_mul_f32 v208, v208, v32
    v_mul_f32 v209, v209, v32
    v_mul_f32 v210, v210, v32
    v_mul_f32 v211, v211, v32
    v_mul_f32 v212, v212, v32
    v_mul_f32 v213, v213, v32
    v_mul_f32 v214, v214, v32
    v_mul_f32 v215, v215, v32
    v_mul_f32 v216, v216, v32
    v_mul_f32 v217, v217, v32
    v_mul_f32 v218, v218, v32
    v_mul_f32 v219, v219, v32
    v_mul_f32 v220, v220, v32
    v_mul_f32 v221, v221, v32
    v_mul_f32 v222, v222, v32
    v_mul_f32 v223, v223, v32
    v_mul_f32 v224, v224, v32
    v_mul_f32 v225, v225, v32
    v_mul_f32 v226, v226, v32
    v_mul_f32 v227, v227, v32
    v_mul_f32 v228, v228, v32
    v_mul_f32 v229, v229, v32
    v_mul_f32 v230, v230, v32
    v_mul_f32 v231, v231, v32
    v_mul_f32 v232, v232, v32
    v_mul_f32 v233, v233, v32
    v_mul_f32 v234, v234, v32
    v_mul_f32 v235, v235, v32
    v_mul_f32 v236, v236, v32
    v_mul_f32 v237, v237, v32
    v_mul_f32 v238, v238, v32
    v_mul_f32 v239, v239, v32
    v_mul_f32 v240, v240, v32
    v_mul_f32 v241, v241, v32
    v_mul_f32 v242, v242, v32
    v_mul_f32 v243, v243, v32
    v_mul_f32 v244, v244, v32
    v_mul_f32 v245, v245, v32
    v_mul_f32 v246, v246, v32
    v_mul_f32 v247, v247, v32
    v_mul_f32 v248, v248, v32
    v_mul_f32 v249, v249, v32
    v_mul_f32 v250, v250, v32
    v_mul_f32 v251, v251, v32
    v_mul_f32 v252, v252, v32
    v_mul_f32 v253, v253, v32
    v_mul_f32 v254, v254, v32
    v_mul_f32 v255, v255, v32
    s_branch L_resc_ret_a_79
L_resc_a_83:
    v_mul_f32 v31, s43, v30
    v_max_f32 v31, v31, v24
    v_sub_f32 v32, v24, v31
    v_exp_f32 v32, v32
    v_mov_b32 v24, v31
    v_mul_f32 v25, v25, v32
    v_mul_f32 v26, v26, v32
    v_mul_f32 v27, v27, v32
    v_mul_f32 v28, v28, v32
    v_mul_f32 v128, v128, v32
    v_mul_f32 v129, v129, v32
    v_mul_f32 v130, v130, v32
    v_mul_f32 v131, v131, v32
    v_mul_f32 v132, v132, v32
    v_mul_f32 v133, v133, v32
    v_mul_f32 v134, v134, v32
    v_mul_f32 v135, v135, v32
    v_mul_f32 v136, v136, v32
    v_mul_f32 v137, v137, v32
    v_mul_f32 v138, v138, v32
    v_mul_f32 v139, v139, v32
    v_mul_f32 v140, v140, v32
    v_mul_f32 v141, v141, v32
    v_mul_f32 v142, v142, v32
    v_mul_f32 v143, v143, v32
    v_mul_f32 v144, v144, v32
    v_mul_f32 v145, v145, v32
    v_mul_f32 v146, v146, v32
    v_mul_f32 v147, v147, v32
    v_mul_f32 v148, v148, v32
    v_mul_f32 v149, v149, v32
    v_mul_f32 v150, v150, v32
    v_mul_f32 v151, v151, v32
    v_mul_f32 v152, v152, v32
    v_mul_f32 v153, v153, v32
    v_mul_f32 v154, v154, v32
    v_mul_f32 v155, v155, v32
    v_mul_f32 v156, v156, v32
    v_mul_f32 v157, v157, v32
    v_mul_f32 v158, v158, v32
    v_mul_f32 v159, v159, v32
    v_mul_f32 v160, v160, v32
    v_mul_f32 v161, v161, v32
    v_mul_f32 v162, v162, v32
    v_mul_f32 v163, v163, v32
    v_mul_f32 v164, v164, v32
    v_mul_f32 v165, v165, v32
    v_mul_f32 v166, v166, v32
    v_mul_f32 v167, v167, v32
    v_mul_f32 v168, v168, v32
    v_mul_f32 v169, v169, v32
    v_mul_f32 v170, v170, v32
    v_mul_f32 v171, v171, v32
    v_mul_f32 v172, v172, v32
    v_mul_f32 v173, v173, v32
    v_mul_f32 v174, v174, v32
    v_mul_f32 v175, v175, v32
    v_mul_f32 v176, v176, v32
    v_mul_f32 v177, v177, v32
    v_mul_f32 v178, v178, v32
    v_mul_f32 v179, v179, v32
    v_mul_f32 v180, v180, v32
    v_mul_f32 v181, v181, v32
    v_mul_f32 v182, v182, v32
    v_mul_f32 v183, v183, v32
    v_mul_f32 v184, v184, v32
    v_mul_f32 v185, v185, v32
    v_mul_f32 v186, v186, v32
    v_mul_f32 v187, v187, v32
    v_mul_f32 v188, v188, v32
    v_mul_f32 v189, v189, v32
    v_mul_f32 v190, v190, v32
    v_mul_f32 v191, v191, v32
    v_mul_f32 v192, v192, v32
    v_mul_f32 v193, v193, v32
    v_mul_f32 v194, v194, v32
    v_mul_f32 v195, v195, v32
    v_mul_f32 v196, v196, v32
    v_mul_f32 v197, v197, v32
    v_mul_f32 v198, v198, v32
    v_mul_f32 v199, v199, v32
    v_mul_f32 v200, v200, v32
    v_mul_f32 v201, v201, v32
    v_mul_f32 v202, v202, v32
    v_mul_f32 v203, v203, v32
    v_mul_f32 v204, v204, v32
    v_mul_f32 v205, v205, v32
    v_mul_f32 v206, v206, v32
    v_mul_f32 v207, v207, v32
    v_mul_f32 v208, v208, v32
    v_mul_f32 v209, v209, v32
    v_mul_f32 v210, v210, v32
    v_mul_f32 v211, v211, v32
    v_mul_f32 v212, v212, v32
    v_mul_f32 v213, v213, v32
    v_mul_f32 v214, v214, v32
    v_mul_f32 v215, v215, v32
    v_mul_f32 v216, v216, v32
    v_mul_f32 v217, v217, v32
    v_mul_f32 v218, v218, v32
    v_mul_f32 v219, v219, v32
    v_mul_f32 v220, v220, v32
    v_mul_f32 v221, v221, v32
    v_mul_f32 v222, v222, v32
    v_mul_f32 v223, v223, v32
    v_mul_f32 v224, v224, v32
    v_mul_f32 v225, v225, v32
    v_mul_f32 v226, v226, v32
    v_mul_f32 v227, v227, v32
    v_mul_f32 v228, v228, v32
    v_mul_f32 v229, v229, v32
    v_mul_f32 v230, v230, v32
    v_mul_f32 v231, v231, v32
    v_mul_f32 v232, v232, v32
    v_mul_f32 v233, v233, v32
    v_mul_f32 v234, v234, v32
    v_mul_f32 v235, v235, v32
    v_mul_f32 v236, v236, v32
    v_mul_f32 v237, v237, v32
    v_mul_f32 v238, v238, v32
    v_mul_f32 v239, v239, v32
    v_mul_f32 v240, v240, v32
    v_mul_f32 v241, v241, v32
    v_mul_f32 v242, v242, v32
    v_mul_f32 v243, v243, v32
    v_mul_f32 v244, v244, v32
    v_mul_f32 v245, v245, v32
    v_mul_f32 v246, v246, v32
    v_mul_f32 v247, v247, v32
    v_mul_f32 v248, v248, v32
    v_mul_f32 v249, v249, v32
    v_mul_f32 v250, v250, v32
    v_mul_f32 v251, v251, v32
    v_mul_f32 v252, v252, v32
    v_mul_f32 v253, v253, v32
    v_mul_f32 v254, v254, v32
    v_mul_f32 v255, v255, v32
    s_branch L_resc_ret_a_83
.globl out_kernel
.p2align 8
.type out_kernel,@function
out_kernel:
    s_cmp_ge_u32 s2, 224
    s_cbranch_scc1 L_out_end
    s_load_dwordx2 s[4:5], s[0:1], 120
    s_load_dwordx2 s[6:7], s[0:1], 88
    s_load_dwordx2 s[40:41], s[0:1], 104
    s_load_dwordx2 s[42:43], s[0:1], 0
    v_lshrrev_b32 v12, 6, v0
    v_and_b32 v1, 63, v0
    v_readfirstlane_b32 s32, v12
    s_and_b32 s44, s2, 7
    s_lshr_b32 s45, s2, 3
    s_mul_i32 s46, s45, 37
    s_lshr_b32 s46, s46, 8
    s_mul_i32 s47, s46, 7
    s_sub_u32 s38, s45, s47
    s_lshl_b32 s37, s44, 2
    s_add_u32 s37, s37, s46
    s_waitcnt lgkmcnt(0)
    s_add_u32 s8, s4, 50331648
    s_addc_u32 s9, s5, 0
    s_mov_b32 s10, 16777216
    s_mov_b32 s11, 0x00020000
    s_add_u32 s12, s4, 72351744
    s_addc_u32 s13, s5, 0
    s_mov_b32 s14, 3670016
    s_mov_b32 s15, 0x00020000
    s_mov_b32 s16, s40
    s_mov_b32 s17, s41
    s_mov_b32 s18, 1835008
    s_mov_b32 s19, 0x00020000
    s_mov_b32 s20, s42
    s_mov_b32 s21, s43
    s_mov_b32 s22, 1835008
    s_mov_b32 s23, 0x00020000
    s_add_u32 s24, s4, 67108864
    s_addc_u32 s25, s5, 0
    s_mov_b32 s26, 1835008
    s_mov_b32 s27, 0x00020000
    s_add_u32 s28, s4, 71303168
    s_addc_u32 s29, s5, 0
    s_mov_b32 s30, 8192
    s_mov_b32 s31, 0x00020000
    v_lshlrev_b32 v2, 4, v1
    s_lshl_b32 s36, s32, 16
    s_lshl_b32 s34, s37, 19
    s_add_u32 s34, s34, s36
    s_add_u32 s39, s34, 262144
    s_lshl_b32 s35, s38, 19
    s_add_u32 s35, s35, s36
    s_add_u32 s33, s35, 262144
    buffer_load_dwordx4 v[64:67], v2, s[8:11], s34 offen offset:0
    buffer_load_dwordx4 v[72:75], v2, s[12:15], s35 offen offset:0
    buffer_load_dwordx4 v[68:71], v2, s[8:11], s39 offen offset:0
    buffer_load_dwordx4 v[76:79], v2, s[12:15], s33 offen offset:0
    buffer_load_dwordx4 v[80:83], v2, s[8:11], s34 offen offset:1024
    buffer_load_dwordx4 v[88:91], v2, s[12:15], s35 offen offset:1024
    buffer_load_dwordx4 v[84:87], v2, s[8:11], s39 offen offset:1024
    buffer_load_dwordx4 v[92:95], v2, s[12:15], s33 offen offset:1024
    buffer_load_dwordx4 v[96:99], v2, s[8:11], s34 offen offset:2048
    buffer_load_dwordx4 v[104:107], v2, s[12:15], s35 offen offset:2048
    buffer_load_dwordx4 v[100:103], v2, s[8:11], s39 offen offset:2048
    buffer_load_dwordx4 v[108:111], v2, s[12:15], s33 offen offset:2048
    buffer_load_dwordx4 v[112:115], v2, s[8:11], s34 offen offset:3072
    buffer_load_dwordx4 v[120:123], v2, s[12:15], s35 offen offset:3072
    buffer_load_dwordx4 v[116:119], v2, s[8:11], s39 offen offset:3072
    buffer_load_dwordx4 v[124:127], v2, s[12:15], s33 offen offset:3072
    s_add_u32 s34, s34, 4096
    s_add_u32 s39, s39, 4096
    s_add_u32 s35, s35, 4096
    s_add_u32 s33, s33, 4096
    buffer_load_dwordx4 v[128:131], v2, s[8:11], s34 offen offset:0
    buffer_load_dwordx4 v[136:139], v2, s[12:15], s35 offen offset:0
    buffer_load_dwordx4 v[132:135], v2, s[8:11], s39 offen offset:0
    buffer_load_dwordx4 v[140:143], v2, s[12:15], s33 offen offset:0
    buffer_load_dwordx4 v[144:147], v2, s[8:11], s34 offen offset:1024
    buffer_load_dwordx4 v[152:155], v2, s[12:15], s35 offen offset:1024
    buffer_load_dwordx4 v[148:151], v2, s[8:11], s39 offen offset:1024
    buffer_load_dwordx4 v[156:159], v2, s[12:15], s33 offen offset:1024
    buffer_load_dwordx4 v[160:163], v2, s[8:11], s34 offen offset:2048
    buffer_load_dwordx4 v[168:171], v2, s[12:15], s35 offen offset:2048
    buffer_load_dwordx4 v[164:167], v2, s[8:11], s39 offen offset:2048
    buffer_load_dwordx4 v[172:175], v2, s[12:15], s33 offen offset:2048
    s_lshr_b32 s44, s32, 1
    s_and_b32 s45, s32, 1
    v_and_b32 v12, 31, v1
    v_lshrrev_b32 v13, 5, v1
    s_lshl_b32 s46, s37, 6
    s_lshl_b32 s47, s44, 5
    s_add_u32 s46, s46, s47
    v_add_u32 v14, s46, v12
    s_lshl_b32 s47, s38, 6
    s_lshl_b32 s48, s45, 5
    s_add_u32 s47, s47, s48
    v_lshlrev_b32 v15, 2, v14
    buffer_load_dword v20, v15, s[28:31], 0 offen
    v_mul_u32_u24 v15, 896, v14
    v_lshl_add_u32 v15, v13, 3, v15
    s_lshl_b32 s48, s47, 1
    v_add_u32 v15, s48, v15
    buffer_load_dwordx2 v[32:33], v15, s[20:23], 0 offen offset:0
    buffer_load_dwordx2 v[34:35], v15, s[20:23], 0 offen offset:16
    buffer_load_dwordx2 v[36:37], v15, s[20:23], 0 offen offset:32
    buffer_load_dwordx2 v[38:39], v15, s[20:23], 0 offen offset:48
    v_lshlrev_b32 v16, 14, v13
    v_lshl_add_u32 v16, v14, 1, v16
    s_lshl_b32 s48, s47, 12
    s_add_u32 s49, s48, 0
    buffer_load_ushort v40, v16, s[24:27], s49 offen
    s_add_u32 s49, s48, 4096
    buffer_load_ushort v41, v16, s[24:27], s49 offen
    s_add_u32 s49, s48, 8192
    buffer_load_ushort v42, v16, s[24:27], s49 offen
    s_add_u32 s49, s48, 12288
    buffer_load_ushort v43, v16, s[24:27], s49 offen
    s_add_u32 s49, s48, 32768
    buffer_load_ushort v44, v16, s[24:27], s49 offen
    s_add_u32 s49, s48, 36864
    buffer_load_ushort v45, v16, s[24:27], s49 offen
    s_add_u32 s49, s48, 40960
    buffer_load_ushort v46, v16, s[24:27], s49 offen
    s_add_u32 s49, s48, 45056
    buffer_load_ushort v47, v16, s[24:27], s49 offen
    s_add_u32 s49, s48, 65536
    buffer_load_ushort v48, v16, s[24:27], s49 offen
    s_add_u32 s49, s48, 69632
    buffer_load_ushort v49, v16, s[24:27], s49 offen
    s_add_u32 s49, s48, 73728
    buffer_load_ushort v50, v16, s[24:27], s49 offen
    s_add_u32 s49, s48, 77824
    buffer_load_ushort v51, v16, s[24:27], s49 offen
    s_add_u32 s49, s48, 98304
    buffer_load_ushort v52, v16, s[24:27], s49 offen
    s_add_u32 s49, s48, 102400
    buffer_load_ushort v53, v16, s[24:27], s49 offen
    s_add_u32 s49, s48, 106496
    buffer_load_ushort v54, v16, s[24:27], s49 offen
    s_add_u32 s49, s48, 110592
    buffer_load_ushort v55, v16, s[24:27], s49 offen
    buffer_load_dwordx4 v[176:179], v2, s[8:11], s34 offen offset:3072
    buffer_load_dwordx4 v[184:187], v2, s[12:15], s35 offen offset:3072
    buffer_load_dwordx4 v[180:183], v2, s[8:11], s39 offen offset:3072
    buffer_load_dwordx4 v[188:191], v2, s[12:15], s33 offen offset:3072
    s_waitcnt vmcnt(49)
    v_mfma_f32_32x32x16_bf16 a[0:15], v[72:75], v[64:67], 0
    v_mfma_f32_32x32x16_bf16 a[16:31], v[76:79], v[64:67], 0
    v_mfma_f32_32x32x16_bf16 a[32:47], v[72:75], v[68:71], 0
    v_mfma_f32_32x32x16_bf16 a[48:63], v[76:79], v[68:71], 0
    s_add_u32 s34, s34, 4096
    s_add_u32 s39, s39, 4096
    s_add_u32 s35, s35, 4096
    s_add_u32 s33, s33, 4096
    buffer_load_dwordx4 v[64:67], v2, s[8:11], s34 offen offset:0
    buffer_load_dwordx4 v[72:75], v2, s[12:15], s35 offen offset:0
    buffer_load_dwordx4 v[68:71], v2, s[8:11], s39 offen offset:0
    buffer_load_dwordx4 v[76:79], v2, s[12:15], s33 offen offset:0
    s_waitcnt vmcnt(49)
    v_mfma_f32_32x32x16_bf16 a[0:15], v[88:91], v[80:83], a[0:15]
    v_mfma_f32_32x32x16_bf16 a[16:31], v[92:95], v[80:83], a[16:31]
    v_mfma_f32_32x32x16_bf16 a[32:47], v[88:91], v[84:87], a[32:47]
    v_mfma_f32_32x32x16_bf16 a[48:63], v[92:95], v[84:87], a[48:63]
    buffer_load_dwordx4 v[80:83], v2, s[8:11], s34 offen offset:1024
    buffer_load_dwordx4 v[88:91], v2, s[12:15], s35 offen offset:1024
    buffer_load_dwordx4 v[84:87], v2, s[8:11], s39 offen offset:1024
    buffer_load_dwordx4 v[92:95], v2, s[12:15], s33 offen offset:1024
    s_waitcnt vmcnt(49)
    v_mfma_f32_32x32x16_bf16 a[0:15], v[104:107], v[96:99], a[0:15]
    v_mfma_f32_32x32x16_bf16 a[16:31], v[108:111], v[96:99], a[16:31]
    v_mfma_f32_32x32x16_bf16 a[32:47], v[104:107], v[100:103], a[32:47]
    v_mfma_f32_32x32x16_bf16 a[48:63], v[108:111], v[100:103], a[48:63]
    buffer_load_dwordx4 v[96:99], v2, s[8:11], s34 offen offset:2048
    buffer_load_dwordx4 v[104:107], v2, s[12:15], s35 offen offset:2048
    buffer_load_dwordx4 v[100:103], v2, s[8:11], s39 offen offset:2048
    buffer_load_dwordx4 v[108:111], v2, s[12:15], s33 offen offset:2048
    s_waitcnt vmcnt(49)
    v_mfma_f32_32x32x16_bf16 a[0:15], v[120:123], v[112:115], a[0:15]
    v_mfma_f32_32x32x16_bf16 a[16:31], v[124:127], v[112:115], a[16:31]
    v_mfma_f32_32x32x16_bf16 a[32:47], v[120:123], v[116:119], a[32:47]
    v_mfma_f32_32x32x16_bf16 a[48:63], v[124:127], v[116:119], a[48:63]
    buffer_load_dwordx4 v[112:115], v2, s[8:11], s34 offen offset:3072
    buffer_load_dwordx4 v[120:123], v2, s[12:15], s35 offen offset:3072
    buffer_load_dwordx4 v[116:119], v2, s[8:11], s39 offen offset:3072
    buffer_load_dwordx4 v[124:127], v2, s[12:15], s33 offen offset:3072
    s_waitcnt vmcnt(49)
    v_mfma_f32_32x32x16_bf16 a[0:15], v[136:139], v[128:131], a[0:15]
    v_mfma_f32_32x32x16_bf16 a[16:31], v[140:143], v[128:131], a[16:31]
    v_mfma_f32_32x32x16_bf16 a[32:47], v[136:139], v[132:135], a[32:47]
    v_mfma_f32_32x32x16_bf16 a[48:63], v[140:143], v[132:135], a[48:63]
    s_add_u32 s34, s34, 4096
    s_add_u32 s39, s39, 4096
    s_add_u32 s35, s35, 4096
    s_add_u32 s33, s33, 4096
    buffer_load_dwordx4 v[128:131], v2, s[8:11], s34 offen offset:0
    buffer_load_dwordx4 v[136:139], v2, s[12:15], s35 offen offset:0
    buffer_load_dwordx4 v[132:135], v2, s[8:11], s39 offen offset:0
    buffer_load_dwordx4 v[140:143], v2, s[12:15], s33 offen offset:0
    s_waitcnt vmcnt(49)
    v_mfma_f32_32x32x16_bf16 a[0:15], v[152:155], v[144:147], a[0:15]
    v_mfma_f32_32x32x16_bf16 a[16:31], v[156:159], v[144:147], a[16:31]
    v_mfma_f32_32x32x16_bf16 a[32:47], v[152:155], v[148:151], a[32:47]
    v_mfma_f32_32x32x16_bf16 a[48:63], v[156:159], v[148:151], a[48:63]
    buffer_load_dwordx4 v[144:147], v2, s[8:11], s34 offen offset:1024
    buffer_load_dwordx4 v[152:155], v2, s[12:15], s35 offen offset:1024
    buffer_load_dwordx4 v[148:151], v2, s[8:11], s39 offen offset:1024
    buffer_load_dwordx4 v[156:159], v2, s[12:15], s33 offen offset:1024
    s_waitcnt vmcnt(49)
    v_mfma_f32_32x32x16_bf16 a[0:15], v[168:171], v[160:163], a[0:15]
    v_mfma_f32_32x32x16_bf16 a[16:31], v[172:175], v[160:163], a[16:31]
    v_mfma_f32_32x32x16_bf16 a[32:47], v[168:171], v[164:167], a[32:47]
    v_mfma_f32_32x32x16_bf16 a[48:63], v[172:175], v[164:167], a[48:63]
    buffer_load_dwordx4 v[160:163], v2, s[8:11], s34 offen offset:2048
    buffer_load_dwordx4 v[168:171], v2, s[12:15], s35 offen offset:2048
    buffer_load_dwordx4 v[164:167], v2, s[8:11], s39 offen offset:2048
    buffer_load_dwordx4 v[172:175], v2, s[12:15], s33 offen offset:2048
    s_waitcnt vmcnt(28)
    v_mfma_f32_32x32x16_bf16 a[0:15], v[184:187], v[176:179], a[0:15]
    v_mfma_f32_32x32x16_bf16 a[16:31], v[188:191], v[176:179], a[16:31]
    v_mfma_f32_32x32x16_bf16 a[32:47], v[184:187], v[180:183], a[32:47]
    v_mfma_f32_32x32x16_bf16 a[48:63], v[188:191], v[180:183], a[48:63]
    buffer_load_dwordx4 v[176:179], v2, s[8:11], s34 offen offset:3072
    buffer_load_dwordx4 v[184:187], v2, s[12:15], s35 offen offset:3072
    buffer_load_dwordx4 v[180:183], v2, s[8:11], s39 offen offset:3072
    buffer_load_dwordx4 v[188:191], v2, s[12:15], s33 offen offset:3072
    s_waitcnt vmcnt(28)
    v_mfma_f32_32x32x16_bf16 a[0:15], v[72:75], v[64:67], a[0:15]
    v_mfma_f32_32x32x16_bf16 a[16:31], v[76:79], v[64:67], a[16:31]
    v_mfma_f32_32x32x16_bf16 a[32:47], v[72:75], v[68:71], a[32:47]
    v_mfma_f32_32x32x16_bf16 a[48:63], v[76:79], v[68:71], a[48:63]
    s_add_u32 s34, s34, 4096
    s_add_u32 s39, s39, 4096
    s_add_u32 s35, s35, 4096
    s_add_u32 s33, s33, 4096
    buffer_load_dwordx4 v[64:67], v2, s[8:11], s34 offen offset:0
    buffer_load_dwordx4 v[72:75], v2, s[12:15], s35 offen offset:0
    buffer_load_dwordx4 v[68:71], v2, s[8:11], s39 offen offset:0
    buffer_load_dwordx4 v[76:79], v2, s[12:15], s33 offen offset:0
    s_waitcnt vmcnt(28)
    v_mfma_f32_32x32x16_bf16 a[0:15], v[88:91], v[80:83], a[0:15]
    v_mfma_f32_32x32x16_bf16 a[16:31], v[92:95], v[80:83], a[16:31]
    v_mfma_f32_32x32x16_bf16 a[32:47], v[88:91], v[84:87], a[32:47]
    v_mfma_f32_32x32x16_bf16 a[48:63], v[92:95], v[84:87], a[48:63]
    buffer_load_dwordx4 v[80:83], v2, s[8:11], s34 offen offset:1024
    buffer_load_dwordx4 v[88:91], v2, s[12:15], s35 offen offset:1024
    buffer_load_dwordx4 v[84:87], v2, s[8:11], s39 offen offset:1024
    buffer_load_dwordx4 v[92:95], v2, s[12:15], s33 offen offset:1024
    s_waitcnt vmcnt(28)
    v_mfma_f32_32x32x16_bf16 a[0:15], v[104:107], v[96:99], a[0:15]
    v_mfma_f32_32x32x16_bf16 a[16:31], v[108:111], v[96:99], a[16:31]
    v_mfma_f32_32x32x16_bf16 a[32:47], v[104:107], v[100:103], a[32:47]
    v_mfma_f32_32x32x16_bf16 a[48:63], v[108:111], v[100:103], a[48:63]
    buffer_load_dwordx4 v[96:99], v2, s[8:11], s34 offen offset:2048
    buffer_load_dwordx4 v[104:107], v2, s[12:15], s35 offen offset:2048
    buffer_load_dwordx4 v[100:103], v2, s[8:11], s39 offen offset:2048
    buffer_load_dwordx4 v[108:111], v2, s[12:15], s33 offen offset:2048
    s_waitcnt vmcnt(28)
    v_mfma_f32_32x32x16_bf16 a[0:15], v[120:123], v[112:115], a[0:15]
    v_mfma_f32_32x32x16_bf16 a[16:31], v[124:127], v[112:115], a[16:31]
    v_mfma_f32_32x32x16_bf16 a[32:47], v[120:123], v[116:119], a[32:47]
    v_mfma_f32_32x32x16_bf16 a[48:63], v[124:127], v[116:119], a[48:63]
    buffer_load_dwordx4 v[112:115], v2, s[8:11], s34 offen offset:3072
    buffer_load_dwordx4 v[120:123], v2, s[12:15], s35 offen offset:3072
    buffer_load_dwordx4 v[116:119], v2, s[8:11], s39 offen offset:3072
    buffer_load_dwordx4 v[124:127], v2, s[12:15], s33 offen offset:3072
    s_waitcnt vmcnt(28)
    v_mfma_f32_32x32x16_bf16 a[0:15], v[136:139], v[128:131], a[0:15]
    v_mfma_f32_32x32x16_bf16 a[16:31], v[140:143], v[128:131], a[16:31]
    v_mfma_f32_32x32x16_bf16 a[32:47], v[136:139], v[132:135], a[32:47]
    v_mfma_f32_32x32x16_bf16 a[48:63], v[140:143], v[132:135], a[48:63]
    s_add_u32 s34, s34, 4096
    s_add_u32 s39, s39, 4096
    s_add_u32 s35, s35, 4096
    s_add_u32 s33, s33, 4096
    buffer_load_dwordx4 v[128:131], v2, s[8:11], s34 offen offset:0
    buffer_load_dwordx4 v[136:139], v2, s[12:15], s35 offen offset:0
    buffer_load_dwordx4 v[132:135], v2, s[8:11], s39 offen offset:0
    buffer_load_dwordx4 v[140:143], v2, s[12:15], s33 offen offset:0
    s_waitcnt vmcnt(28)
    v_mfma_f32_32x32x16_bf16 a[0:15], v[152:155], v[144:147], a[0:15]
    v_mfma_f32_32x32x16_bf16 a[16:31], v[156:159], v[144:147], a[16:31]
    v_mfma_f32_32x32x16_bf16 a[32:47], v[152:155], v[148:151], a[32:47]
    v_mfma_f32_32x32x16_bf16 a[48:63], v[156:159], v[148:151], a[48:63]
    buffer_load_dwordx4 v[144:147], v2, s[8:11], s34 offen offset:1024
    buffer_load_dwordx4 v[152:155], v2, s[12:15], s35 offen offset:1024
    buffer_load_dwordx4 v[148:151], v2, s[8:11], s39 offen offset:1024
    buffer_load_dwordx4 v[156:159], v2, s[12:15], s33 offen offset:1024
    s_waitcnt vmcnt(28)
    v_mfma_f32_32x32x16_bf16 a[0:15], v[168:171], v[160:163], a[0:15]
    v_mfma_f32_32x32x16_bf16 a[16:31], v[172:175], v[160:163], a[16:31]
    v_mfma_f32_32x32x16_bf16 a[32:47], v[168:171], v[164:167], a[32:47]
    v_mfma_f32_32x32x16_bf16 a[48:63], v[172:175], v[164:167], a[48:63]
    buffer_load_dwordx4 v[160:163], v2, s[8:11], s34 offen offset:2048
    buffer_load_dwordx4 v[168:171], v2, s[12:15], s35 offen offset:2048
    buffer_load_dwordx4 v[164:167], v2, s[8:11], s39 offen offset:2048
    buffer_load_dwordx4 v[172:175], v2, s[12:15], s33 offen offset:2048
    s_waitcnt vmcnt(28)
    v_mfma_f32_32x32x16_bf16 a[0:15], v[184:187], v[176:179], a[0:15]
    v_mfma_f32_32x32x16_bf16 a[16:31], v[188:191], v[176:179], a[16:31]
    v_mfma_f32_32x32x16_bf16 a[32:47], v[184:187], v[180:183], a[32:47]
    v_mfma_f32_32x32x16_bf16 a[48:63], v[188:191], v[180:183], a[48:63]
    buffer_load_dwordx4 v[176:179], v2, s[8:11], s34 offen offset:3072
    buffer_load_dwordx4 v[184:187], v2, s[12:15], s35 offen offset:3072
    buffer_load_dwordx4 v[180:183], v2, s[8:11], s39 offen offset:3072
    buffer_load_dwordx4 v[188:191], v2, s[12:15], s33 offen offset:3072
    s_waitcnt vmcnt(28)
    v_mfma_f32_32x32x16_bf16 a[0:15], v[72:75], v[64:67], a[0:15]
    v_mfma_f32_32x32x16_bf16 a[16:31], v[76:79], v[64:67], a[16:31]
    v_mfma_f32_32x32x16_bf16 a[32:47], v[72:75], v[68:71], a[32:47]
    v_mfma_f32_32x32x16_bf16 a[48:63], v[76:79], v[68:71], a[48:63]
    s_add_u32 s34, s34, 4096
    s_add_u32 s39, s39, 4096
    s_add_u32 s35, s35, 4096
    s_add_u32 s33, s33, 4096
    buffer_load_dwordx4 v[64:67], v2, s[8:11], s34 offen offset:0
    buffer_load_dwordx4 v[72:75], v2, s[12:15], s35 offen offset:0
    buffer_load_dwordx4 v[68:71], v2, s[8:11], s39 offen offset:0
    buffer_load_dwordx4 v[76:79], v2, s[12:15], s33 offen offset:0
    s_waitcnt vmcnt(28)
    v_mfma_f32_32x32x16_bf16 a[0:15], v[88:91], v[80:83], a[0:15]
    v_mfma_f32_32x32x16_bf16 a[16:31], v[92:95], v[80:83], a[16:31]
    v_mfma_f32_32x32x16_bf16 a[32:47], v[88:91], v[84:87], a[32:47]
    v_mfma_f32_32x32x16_bf16 a[48:63], v[92:95], v[84:87], a[48:63]
    buffer_load_dwordx4 v[80:83], v2, s[8:11], s34 offen offset:1024
    buffer_load_dwordx4 v[88:91], v2, s[12:15], s35 offen offset:1024
    buffer_load_dwordx4 v[84:87], v2, s[8:11], s39 offen offset:1024
    buffer_load_dwordx4 v[92:95], v2, s[12:15], s33 offen offset:1024
    s_waitcnt vmcnt(28)
    v_mfma_f32_32x32x16_bf16 a[0:15], v[104:107], v[96:99], a[0:15]
    v_mfma_f32_32x32x16_bf16 a[16:31], v[108:111], v[96:99], a[16:31]
    v_mfma_f32_32x32x16_bf16 a[32:47], v[104:107], v[100:103], a[32:47]
    v_mfma_f32_32x32x16_bf16 a[48:63], v[108:111], v[100:103], a[48:63]
    buffer_load_dwordx4 v[96:99], v2, s[8:11], s34 offen offset:2048
    buffer_load_dwordx4 v[104:107], v2, s[12:15], s35 offen offset:2048
    buffer_load_dwordx4 v[100:103], v2, s[8:11], s39 offen offset:2048
    buffer_load_dwordx4 v[108:111], v2, s[12:15], s33 offen offset:2048
    s_waitcnt vmcnt(28)
    v_mfma_f32_32x32x16_bf16 a[0:15], v[120:123], v[112:115], a[0:15]
    v_mfma_f32_32x32x16_bf16 a[16:31], v[124:127], v[112:115], a[16:31]
    v_mfma_f32_32x32x16_bf16 a[32:47], v[120:123], v[116:119], a[32:47]
    v_mfma_f32_32x32x16_bf16 a[48:63], v[124:127], v[116:119], a[48:63]
    buffer_load_dwordx4 v[112:115], v2, s[8:11], s34 offen offset:3072
    buffer_load_dwordx4 v[120:123], v2, s[12:15], s35 offen offset:3072
    buffer_load_dwordx4 v[116:119], v2, s[8:11], s39 offen offset:3072
    buffer_load_dwordx4 v[124:127], v2, s[12:15], s33 offen offset:3072
    s_waitcnt vmcnt(28)
    v_mfma_f32_32x32x16_bf16 a[0:15], v[136:139], v[128:131], a[0:15]
    v_mfma_f32_32x32x16_bf16 a[16:31], v[140:143], v[128:131], a[16:31]
    v_mfma_f32_32x32x16_bf16 a[32:47], v[136:139], v[132:135], a[32:47]
    v_mfma_f32_32x32x16_bf16 a[48:63], v[140:143], v[132:135], a[48:63]
    s_add_u32 s34, s34, 4096
    s_add_u32 s39, s39, 4096
    s_add_u32 s35, s35, 4096
    s_add_u32 s33, s33, 4096
    buffer_load_dwordx4 v[128:131], v2, s[8:11], s34 offen offset:0
    buffer_load_dwordx4 v[136:139], v2, s[12:15], s35 offen offset:0
    buffer_load_dwordx4 v[132:135], v2, s[8:11], s39 offen offset:0
    buffer_load_dwordx4 v[140:143], v2, s[12:15], s33 offen offset:0
    s_waitcnt vmcnt(28)
    v_mfma_f32_32x32x16_bf16 a[0:15], v[152:155], v[144:147], a[0:15]
    v_mfma_f32_32x32x16_bf16 a[16:31], v[156:159], v[144:147], a[16:31]
    v_mfma_f32_32x32x16_bf16 a[32:47], v[152:155], v[148:151], a[32:47]
    v_mfma_f32_32x32x16_bf16 a[48:63], v[156:159], v[148:151], a[48:63]
    buffer_load_dwordx4 v[144:147], v2, s[8:11], s34 offen offset:1024
    buffer_load_dwordx4 v[152:155], v2, s[12:15], s35 offen offset:1024
    buffer_load_dwordx4 v[148:151], v2, s[8:11], s39 offen offset:1024
    buffer_load_dwordx4 v[156:159], v2, s[12:15], s33 offen offset:1024
    s_waitcnt vmcnt(28)
    v_mfma_f32_32x32x16_bf16 a[0:15], v[168:171], v[160:163], a[0:15]
    v_mfma_f32_32x32x16_bf16 a[16:31], v[172:175], v[160:163], a[16:31]
    v_mfma_f32_32x32x16_bf16 a[32:47], v[168:171], v[164:167], a[32:47]
    v_mfma_f32_32x32x16_bf16 a[48:63], v[172:175], v[164:167], a[48:63]
    buffer_load_dwordx4 v[160:163], v2, s[8:11], s34 offen offset:2048
    buffer_load_dwordx4 v[168:171], v2, s[12:15], s35 offen offset:2048
    buffer_load_dwordx4 v[164:167], v2, s[8:11], s39 offen offset:2048
    buffer_load_dwordx4 v[172:175], v2, s[12:15], s33 offen offset:2048
    s_waitcnt vmcnt(28)
    v_mfma_f32_32x32x16_bf16 a[0:15], v[184:187], v[176:179], a[0:15]
    v_mfma_f32_32x32x16_bf16 a[16:31], v[188:191], v[176:179], a[16:31]
    v_mfma_f32_32x32x16_bf16 a[32:47], v[184:187], v[180:183], a[32:47]
    v_mfma_f32_32x32x16_bf16 a[48:63], v[188:191], v[180:183], a[48:63]
    buffer_load_dwordx4 v[176:179], v2, s[8:11], s34 offen offset:3072
    buffer_load_dwordx4 v[184:187], v2, s[12:15], s35 offen offset:3072
    buffer_load_dwordx4 v[180:183], v2, s[8:11], s39 offen offset:3072
    buffer_load_dwordx4 v[188:191], v2, s[12:15], s33 offen offset:3072
    s_waitcnt vmcnt(28)
    v_mfma_f32_32x32x16_bf16 a[0:15], v[72:75], v[64:67], a[0:15]
    v_mfma_f32_32x32x16_bf16 a[16:31], v[76:79], v[64:67], a[16:31]
    v_mfma_f32_32x32x16_bf16 a[32:47], v[72:75], v[68:71], a[32:47]
    v_mfma_f32_32x32x16_bf16 a[48:63], v[76:79], v[68:71], a[48:63]
    s_add_u32 s34, s34, 4096
    s_add_u32 s39, s39, 4096
    s_add_u32 s35, s35, 4096
    s_add_u32 s33, s33, 4096
    buffer_load_dwordx4 v[64:67], v2, s[8:11], s34 offen offset:0
    buffer_load_dwordx4 v[72:75], v2, s[12:15], s35 offen offset:0
    buffer_load_dwordx4 v[68:71], v2, s[8:11], s39 offen offset:0
    buffer_load_dwordx4 v[76:79], v2, s[12:15], s33 offen offset:0
    s_waitcnt vmcnt(28)
    v_mfma_f32_32x32x16_bf16 a[0:15], v[88:91], v[80:83], a[0:15]
    v_mfma_f32_32x32x16_bf16 a[16:31], v[92:95], v[80:83], a[16:31]
    v_mfma_f32_32x32x16_bf16 a[32:47], v[88:91], v[84:87], a[32:47]
    v_mfma_f32_32x32x16_bf16 a[48:63], v[92:95], v[84:87], a[48:63]
    buffer_load_dwordx4 v[80:83], v2, s[8:11], s34 offen offset:1024
    buffer_load_dwordx4 v[88:91], v2, s[12:15], s35 offen offset:1024
    buffer_load_dwordx4 v[84:87], v2, s[8:11], s39 offen offset:1024
    buffer_load_dwordx4 v[92:95], v2, s[12:15], s33 offen offset:1024
    s_waitcnt vmcnt(28)
    v_mfma_f32_32x32x16_bf16 a[0:15], v[104:107], v[96:99], a[0:15]
    v_mfma_f32_32x32x16_bf16 a[16:31], v[108:111], v[96:99], a[16:31]
    v_mfma_f32_32x32x16_bf16 a[32:47], v[104:107], v[100:103], a[32:47]
    v_mfma_f32_32x32x16_bf16 a[48:63], v[108:111], v[100:103], a[48:63]
    buffer_load_dwordx4 v[96:99], v2, s[8:11], s34 offen offset:2048
    buffer_load_dwordx4 v[104:107], v2, s[12:15], s35 offen offset:2048
    buffer_load_dwordx4 v[100:103], v2, s[8:11], s39 offen offset:2048
    buffer_load_dwordx4 v[108:111], v2, s[12:15], s33 offen offset:2048
    s_waitcnt vmcnt(28)
    v_mfma_f32_32x32x16_bf16 a[0:15], v[120:123], v[112:115], a[0:15]
    v_mfma_f32_32x32x16_bf16 a[16:31], v[124:127], v[112:115], a[16:31]
    v_mfma_f32_32x32x16_bf16 a[32:47], v[120:123], v[116:119], a[32:47]
    v_mfma_f32_32x32x16_bf16 a[48:63], v[124:127], v[116:119], a[48:63]
    buffer_load_dwordx4 v[112:115], v2, s[8:11], s34 offen offset:3072
    buffer_load_dwordx4 v[120:123], v2, s[12:15], s35 offen offset:3072
    buffer_load_dwordx4 v[116:119], v2, s[8:11], s39 offen offset:3072
    buffer_load_dwordx4 v[124:127], v2, s[12:15], s33 offen offset:3072
    s_waitcnt vmcnt(28)
    v_mfma_f32_32x32x16_bf16 a[0:15], v[136:139], v[128:131], a[0:15]
    v_mfma_f32_32x32x16_bf16 a[16:31], v[140:143], v[128:131], a[16:31]
    v_mfma_f32_32x32x16_bf16 a[32:47], v[136:139], v[132:135], a[32:47]
    v_mfma_f32_32x32x16_bf16 a[48:63], v[140:143], v[132:135], a[48:63]
    s_add_u32 s34, s34, 4096
    s_add_u32 s39, s39, 4096
    s_add_u32 s35, s35, 4096
    s_add_u32 s33, s33, 4096
    buffer_load_dwordx4 v[128:131], v2, s[8:11], s34 offen offset:0
    buffer_load_dwordx4 v[136:139], v2, s[12:15], s35 offen offset:0
    buffer_load_dwordx4 v[132:135], v2, s[8:11], s39 offen offset:0
    buffer_load_dwordx4 v[140:143], v2, s[12:15], s33 offen offset:0
    s_waitcnt vmcnt(28)
    v_mfma_f32_32x32x16_bf16 a[0:15], v[152:155], v[144:147], a[0:15]
    v_mfma_f32_32x32x16_bf16 a[16:31], v[156:159], v[144:147], a[16:31]
    v_mfma_f32_32x32x16_bf16 a[32:47], v[152:155], v[148:151], a[32:47]
    v_mfma_f32_32x32x16_bf16 a[48:63], v[156:159], v[148:151], a[48:63]
    buffer_load_dwordx4 v[144:147], v2, s[8:11], s34 offen offset:1024
    buffer_load_dwordx4 v[152:155], v2, s[12:15], s35 offen offset:1024
    buffer_load_dwordx4 v[148:151], v2, s[8:11], s39 offen offset:1024
    buffer_load_dwordx4 v[156:159], v2, s[12:15], s33 offen offset:1024
    s_waitcnt vmcnt(28)
    v_mfma_f32_32x32x16_bf16 a[0:15], v[168:171], v[160:163], a[0:15]
    v_mfma_f32_32x32x16_bf16 a[16:31], v[172:175], v[160:163], a[16:31]
    v_mfma_f32_32x32x16_bf16 a[32:47], v[168:171], v[164:167], a[32:47]
    v_mfma_f32_32x32x16_bf16 a[48:63], v[172:175], v[164:167], a[48:63]
    buffer_load_dwordx4 v[160:163], v2, s[8:11], s34 offen offset:2048
    buffer_load_dwordx4 v[168:171], v2, s[12:15], s35 offen offset:2048
    buffer_load_dwordx4 v[164:167], v2, s[8:11], s39 offen offset:2048
    buffer_load_dwordx4 v[172:175], v2, s[12:15], s33 offen offset:2048
    s_waitcnt vmcnt(28)
    v_mfma_f32_32x32x16_bf16 a[0:15], v[184:187], v[176:179], a[0:15]
    v_mfma_f32_32x32x16_bf16 a[16:31], v[188:191], v[176:179], a[16:31]
    v_mfma_f32_32x32x16_bf16 a[32:47], v[184:187], v[180:183], a[32:47]
    v_mfma_f32_32x32x16_bf16 a[48:63], v[188:191], v[180:183], a[48:63]
    buffer_load_dwordx4 v[176:179], v2, s[8:11], s34 offen offset:3072
    buffer_load_dwordx4 v[184:187], v2, s[12:15], s35 offen offset:3072
    buffer_load_dwordx4 v[180:183], v2, s[8:11], s39 offen offset:3072
    buffer_load_dwordx4 v[188:191], v2, s[12:15], s33 offen offset:3072
    s_waitcnt vmcnt(28)
    v_mfma_f32_32x32x16_bf16 a[0:15], v[72:75], v[64:67], a[0:15]
    v_mfma_f32_32x32x16_bf16 a[16:31], v[76:79], v[64:67], a[16:31]
    v_mfma_f32_32x32x16_bf16 a[32:47], v[72:75], v[68:71], a[32:47]
    v_mfma_f32_32x32x16_bf16 a[48:63], v[76:79], v[68:71], a[48:63]
    s_add_u32 s34, s34, 4096
    s_add_u32 s39, s39, 4096
    s_add_u32 s35, s35, 4096
    s_add_u32 s33, s33, 4096
    buffer_load_dwordx4 v[64:67], v2, s[8:11], s34 offen offset:0
    buffer_load_dwordx4 v[72:75], v2, s[12:15], s35 offen offset:0
    buffer_load_dwordx4 v[68:71], v2, s[8:11], s39 offen offset:0
    buffer_load_dwordx4 v[76:79], v2, s[12:15], s33 offen offset:0
    s_waitcnt vmcnt(28)
    v_mfma_f32_32x32x16_bf16 a[0:15], v[88:91], v[80:83], a[0:15]
    v_mfma_f32_32x32x16_bf16 a[16:31], v[92:95], v[80:83], a[16:31]
    v_mfma_f32_32x32x16_bf16 a[32:47], v[88:91], v[84:87], a[32:47]
    v_mfma_f32_32x32x16_bf16 a[48:63], v[92:95], v[84:87], a[48:63]
    buffer_load_dwordx4 v[80:83], v2, s[8:11], s34 offen offset:1024
    buffer_load_dwordx4 v[88:91], v2, s[12:15], s35 offen offset:1024
    buffer_load_dwordx4 v[84:87], v2, s[8:11], s39 offen offset:1024
    buffer_load_dwordx4 v[92:95], v2, s[12:15], s33 offen offset:1024
    s_waitcnt vmcnt(28)
    v_mfma_f32_32x32x16_bf16 a[0:15], v[104:107], v[96:99], a[0:15]
    v_mfma_f32_32x32x16_bf16 a[16:31], v[108:111], v[96:99], a[16:31]
    v_mfma_f32_32x32x16_bf16 a[32:47], v[104:107], v[100:103], a[32:47]
    v_mfma_f32_32x32x16_bf16 a[48:63], v[108:111], v[100:103], a[48:63]
    buffer_load_dwordx4 v[96:99], v2, s[8:11], s34 offen offset:2048
    buffer_load_dwordx4 v[104:107], v2, s[12:15], s35 offen offset:2048
    buffer_load_dwordx4 v[100:103], v2, s[8:11], s39 offen offset:2048
    buffer_load_dwordx4 v[108:111], v2, s[12:15], s33 offen offset:2048
    s_waitcnt vmcnt(28)
    v_mfma_f32_32x32x16_bf16 a[0:15], v[120:123], v[112:115], a[0:15]
    v_mfma_f32_32x32x16_bf16 a[16:31], v[124:127], v[112:115], a[16:31]
    v_mfma_f32_32x32x16_bf16 a[32:47], v[120:123], v[116:119], a[32:47]
    v_mfma_f32_32x32x16_bf16 a[48:63], v[124:127], v[116:119], a[48:63]
    buffer_load_dwordx4 v[112:115], v2, s[8:11], s34 offen offset:3072
    buffer_load_dwordx4 v[120:123], v2, s[12:15], s35 offen offset:3072
    buffer_load_dwordx4 v[116:119], v2, s[8:11], s39 offen offset:3072
    buffer_load_dwordx4 v[124:127], v2, s[12:15], s33 offen offset:3072
    s_waitcnt vmcnt(28)
    v_mfma_f32_32x32x16_bf16 a[0:15], v[136:139], v[128:131], a[0:15]
    v_mfma_f32_32x32x16_bf16 a[16:31], v[140:143], v[128:131], a[16:31]
    v_mfma_f32_32x32x16_bf16 a[32:47], v[136:139], v[132:135], a[32:47]
    v_mfma_f32_32x32x16_bf16 a[48:63], v[140:143], v[132:135], a[48:63]
    s_add_u32 s34, s34, 4096
    s_add_u32 s39, s39, 4096
    s_add_u32 s35, s35, 4096
    s_add_u32 s33, s33, 4096
    buffer_load_dwordx4 v[128:131], v2, s[8:11], s34 offen offset:0
    buffer_load_dwordx4 v[136:139], v2, s[12:15], s35 offen offset:0
    buffer_load_dwordx4 v[132:135], v2, s[8:11], s39 offen offset:0
    buffer_load_dwordx4 v[140:143], v2, s[12:15], s33 offen offset:0
    s_waitcnt vmcnt(28)
    v_mfma_f32_32x32x16_bf16 a[0:15], v[152:155], v[144:147], a[0:15]
    v_mfma_f32_32x32x16_bf16 a[16:31], v[156:159], v[144:147], a[16:31]
    v_mfma_f32_32x32x16_bf16 a[32:47], v[152:155], v[148:151], a[32:47]
    v_mfma_f32_32x32x16_bf16 a[48:63], v[156:159], v[148:151], a[48:63]
    buffer_load_dwordx4 v[144:147], v2, s[8:11], s34 offen offset:1024
    buffer_load_dwordx4 v[152:155], v2, s[12:15], s35 offen offset:1024
    buffer_load_dwordx4 v[148:151], v2, s[8:11], s39 offen offset:1024
    buffer_load_dwordx4 v[156:159], v2, s[12:15], s33 offen offset:1024
    s_waitcnt vmcnt(28)
    v_mfma_f32_32x32x16_bf16 a[0:15], v[168:171], v[160:163], a[0:15]
    v_mfma_f32_32x32x16_bf16 a[16:31], v[172:175], v[160:163], a[16:31]
    v_mfma_f32_32x32x16_bf16 a[32:47], v[168:171], v[164:167], a[32:47]
    v_mfma_f32_32x32x16_bf16 a[48:63], v[172:175], v[164:167], a[48:63]
    buffer_load_dwordx4 v[160:163], v2, s[8:11], s34 offen offset:2048
    buffer_load_dwordx4 v[168:171], v2, s[12:15], s35 offen offset:2048
    buffer_load_dwordx4 v[164:167], v2, s[8:11], s39 offen offset:2048
    buffer_load_dwordx4 v[172:175], v2, s[12:15], s33 offen offset:2048
    s_waitcnt vmcnt(28)
    v_mfma_f32_32x32x16_bf16 a[0:15], v[184:187], v[176:179], a[0:15]
    v_mfma_f32_32x32x16_bf16 a[16:31], v[188:191], v[176:179], a[16:31]
    v_mfma_f32_32x32x16_bf16 a[32:47], v[184:187], v[180:183], a[32:47]
    v_mfma_f32_32x32x16_bf16 a[48:63], v[188:191], v[180:183], a[48:63]
    buffer_load_dwordx4 v[176:179], v2, s[8:11], s34 offen offset:3072
    buffer_load_dwordx4 v[184:187], v2, s[12:15], s35 offen offset:3072
    buffer_load_dwordx4 v[180:183], v2, s[8:11], s39 offen offset:3072
    buffer_load_dwordx4 v[188:191], v2, s[12:15], s33 offen offset:3072
    s_waitcnt vmcnt(28)
    v_mfma_f32_32x32x16_bf16 a[0:15], v[72:75], v[64:67], a[0:15]
    v_mfma_f32_32x32x16_bf16 a[16:31], v[76:79], v[64:67], a[16:31]
    v_mfma_f32_32x32x16_bf16 a[32:47], v[72:75], v[68:71], a[32:47]
    v_mfma_f32_32x32x16_bf16 a[48:63], v[76:79], v[68:71], a[48:63]
    s_add_u32 s34, s34, 4096
    s_add_u32 s39, s39, 4096
    s_add_u32 s35, s35, 4096
    s_add_u32 s33, s33, 4096
    buffer_load_dwordx4 v[64:67], v2, s[8:11], s34 offen offset:0
    buffer_load_dwordx4 v[72:75], v2, s[12:15], s35 offen offset:0
    buffer_load_dwordx4 v[68:71], v2, s[8:11], s39 offen offset:0
    buffer_load_dwordx4 v[76:79], v2, s[12:15], s33 offen offset:0
    s_waitcnt vmcnt(28)
    v_mfma_f32_32x32x16_bf16 a[0:15], v[88:91], v[80:83], a[0:15]
    v_mfma_f32_32x32x16_bf16 a[16:31], v[92:95], v[80:83], a[16:31]
    v_mfma_f32_32x32x16_bf16 a[32:47], v[88:91], v[84:87], a[32:47]
    v_mfma_f32_32x32x16_bf16 a[48:63], v[92:95], v[84:87], a[48:63]
    buffer_load_dwordx4 v[80:83], v2, s[8:11], s34 offen offset:1024
    buffer_load_dwordx4 v[88:91], v2, s[12:15], s35 offen offset:1024
    buffer_load_dwordx4 v[84:87], v2, s[8:11], s39 offen offset:1024
    buffer_load_dwordx4 v[92:95], v2, s[12:15], s33 offen offset:1024
    s_waitcnt vmcnt(28)
    v_mfma_f32_32x32x16_bf16 a[0:15], v[104:107], v[96:99], a[0:15]
    v_mfma_f32_32x32x16_bf16 a[16:31], v[108:111], v[96:99], a[16:31]
    v_mfma_f32_32x32x16_bf16 a[32:47], v[104:107], v[100:103], a[32:47]
    v_mfma_f32_32x32x16_bf16 a[48:63], v[108:111], v[100:103], a[48:63]
    buffer_load_dwordx4 v[96:99], v2, s[8:11], s34 offen offset:2048
    buffer_load_dwordx4 v[104:107], v2, s[12:15], s35 offen offset:2048
    buffer_load_dwordx4 v[100:103], v2, s[8:11], s39 offen offset:2048
    buffer_load_dwordx4 v[108:111], v2, s[12:15], s33 offen offset:2048
    s_waitcnt vmcnt(28)
    v_mfma_f32_32x32x16_bf16 a[0:15], v[120:123], v[112:115], a[0:15]
    v_mfma_f32_32x32x16_bf16 a[16:31], v[124:127], v[112:115], a[16:31]
    v_mfma_f32_32x32x16_bf16 a[32:47], v[120:123], v[116:119], a[32:47]
    v_mfma_f32_32x32x16_bf16 a[48:63], v[124:127], v[116:119], a[48:63]
    buffer_load_dwordx4 v[112:115], v2, s[8:11], s34 offen offset:3072
    buffer_load_dwordx4 v[120:123], v2, s[12:15], s35 offen offset:3072
    buffer_load_dwordx4 v[116:119], v2, s[8:11], s39 offen offset:3072
    buffer_load_dwordx4 v[124:127], v2, s[12:15], s33 offen offset:3072
    s_waitcnt vmcnt(28)
    v_mfma_f32_32x32x16_bf16 a[0:15], v[136:139], v[128:131], a[0:15]
    v_mfma_f32_32x32x16_bf16 a[16:31], v[140:143], v[128:131], a[16:31]
    v_mfma_f32_32x32x16_bf16 a[32:47], v[136:139], v[132:135], a[32:47]
    v_mfma_f32_32x32x16_bf16 a[48:63], v[140:143], v[132:135], a[48:63]
    s_add_u32 s34, s34, 4096
    s_add_u32 s39, s39, 4096
    s_add_u32 s35, s35, 4096
    s_add_u32 s33, s33, 4096
    buffer_load_dwordx4 v[128:131], v2, s[8:11], s34 offen offset:0
    buffer_load_dwordx4 v[136:139], v2, s[12:15], s35 offen offset:0
    buffer_load_dwordx4 v[132:135], v2, s[8:11], s39 offen offset:0
    buffer_load_dwordx4 v[140:143], v2, s[12:15], s33 offen offset:0
    s_waitcnt vmcnt(28)
    v_mfma_f32_32x32x16_bf16 a[0:15], v[152:155], v[144:147], a[0:15]
    v_mfma_f32_32x32x16_bf16 a[16:31], v[156:159], v[144:147], a[16:31]
    v_mfma_f32_32x32x16_bf16 a[32:47], v[152:155], v[148:151], a[32:47]
    v_mfma_f32_32x32x16_bf16 a[48:63], v[156:159], v[148:151], a[48:63]
    buffer_load_dwordx4 v[144:147], v2, s[8:11], s34 offen offset:1024
    buffer_load_dwordx4 v[152:155], v2, s[12:15], s35 offen offset:1024
    buffer_load_dwordx4 v[148:151], v2, s[8:11], s39 offen offset:1024
    buffer_load_dwordx4 v[156:159], v2, s[12:15], s33 offen offset:1024
    s_waitcnt vmcnt(28)
    v_mfma_f32_32x32x16_bf16 a[0:15], v[168:171], v[160:163], a[0:15]
    v_mfma_f32_32x32x16_bf16 a[16:31], v[172:175], v[160:163], a[16:31]
    v_mfma_f32_32x32x16_bf16 a[32:47], v[168:171], v[164:167], a[32:47]
    v_mfma_f32_32x32x16_bf16 a[48:63], v[172:175], v[164:167], a[48:63]
    buffer_load_dwordx4 v[160:163], v2, s[8:11], s34 offen offset:2048
    buffer_load_dwordx4 v[168:171], v2, s[12:15], s35 offen offset:2048
    buffer_load_dwordx4 v[164:167], v2, s[8:11], s39 offen offset:2048
    buffer_load_dwordx4 v[172:175], v2, s[12:15], s33 offen offset:2048
    s_waitcnt vmcnt(28)
    v_mfma_f32_32x32x16_bf16 a[0:15], v[184:187], v[176:179], a[0:15]
    v_mfma_f32_32x32x16_bf16 a[16:31], v[188:191], v[176:179], a[16:31]
    v_mfma_f32_32x32x16_bf16 a[32:47], v[184:187], v[180:183], a[32:47]
    v_mfma_f32_32x32x16_bf16 a[48:63], v[188:191], v[180:183], a[48:63]
    buffer_load_dwordx4 v[176:179], v2, s[8:11], s34 offen offset:3072
    buffer_load_dwordx4 v[184:187], v2, s[12:15], s35 offen offset:3072
    buffer_load_dwordx4 v[180:183], v2, s[8:11], s39 offen offset:3072
    buffer_load_dwordx4 v[188:191], v2, s[12:15], s33 offen offset:3072
    s_waitcnt vmcnt(28)
    v_mfma_f32_32x32x16_bf16 a[0:15], v[72:75], v[64:67], a[0:15]
    v_mfma_f32_32x32x16_bf16 a[16:31], v[76:79], v[64:67], a[16:31]
    v_mfma_f32_32x32x16_bf16 a[32:47], v[72:75], v[68:71], a[32:47]
    v_mfma_f32_32x32x16_bf16 a[48:63], v[76:79], v[68:71], a[48:63]
    s_add_u32 s34, s34, 4096
    s_add_u32 s39, s39, 4096
    s_add_u32 s35, s35, 4096
    s_add_u32 s33, s33, 4096
    buffer_load_dwordx4 v[64:67], v2, s[8:11], s34 offen offset:0
    buffer_load_dwordx4 v[72:75], v2, s[12:15], s35 offen offset:0
    buffer_load_dwordx4 v[68:71], v2, s[8:11], s39 offen offset:0
    buffer_load_dwordx4 v[76:79], v2, s[12:15], s33 offen offset:0
    s_waitcnt vmcnt(28)
    v_mfma_f32_32x32x16_bf16 a[0:15], v[88:91], v[80:83], a[0:15]
    v_mfma_f32_32x32x16_bf16 a[16:31], v[92:95], v[80:83], a[16:31]
    v_mfma_f32_32x32x16_bf16 a[32:47], v[88:91], v[84:87], a[32:47]
    v_mfma_f32_32x32x16_bf16 a[48:63], v[92:95], v[84:87], a[48:63]
    buffer_load_dwordx4 v[80:83], v2, s[8:11], s34 offen offset:1024
    buffer_load_dwordx4 v[88:91], v2, s[12:15], s35 offen offset:1024
    buffer_load_dwordx4 v[84:87], v2, s[8:11], s39 offen offset:1024
    buffer_load_dwordx4 v[92:95], v2, s[12:15], s33 offen offset:1024
    s_waitcnt vmcnt(28)
    v_mfma_f32_32x32x16_bf16 a[0:15], v[104:107], v[96:99], a[0:15]
    v_mfma_f32_32x32x16_bf16 a[16:31], v[108:111], v[96:99], a[16:31]
    v_mfma_f32_32x32x16_bf16 a[32:47], v[104:107], v[100:103], a[32:47]
    v_mfma_f32_32x32x16_bf16 a[48:63], v[108:111], v[100:103], a[48:63]
    buffer_load_dwordx4 v[96:99], v2, s[8:11], s34 offen offset:2048
    buffer_load_dwordx4 v[104:107], v2, s[12:15], s35 offen offset:2048
    buffer_load_dwordx4 v[100:103], v2, s[8:11], s39 offen offset:2048
    buffer_load_dwordx4 v[108:111], v2, s[12:15], s33 offen offset:2048
    s_waitcnt vmcnt(28)
    v_mfma_f32_32x32x16_bf16 a[0:15], v[120:123], v[112:115], a[0:15]
    v_mfma_f32_32x32x16_bf16 a[16:31], v[124:127], v[112:115], a[16:31]
    v_mfma_f32_32x32x16_bf16 a[32:47], v[120:123], v[116:119], a[32:47]
    v_mfma_f32_32x32x16_bf16 a[48:63], v[124:127], v[116:119], a[48:63]
    buffer_load_dwordx4 v[112:115], v2, s[8:11], s34 offen offset:3072
    buffer_load_dwordx4 v[120:123], v2, s[12:15], s35 offen offset:3072
    buffer_load_dwordx4 v[116:119], v2, s[8:11], s39 offen offset:3072
    buffer_load_dwordx4 v[124:127], v2, s[12:15], s33 offen offset:3072
    s_waitcnt vmcnt(28)
    v_mfma_f32_32x32x16_bf16 a[0:15], v[136:139], v[128:131], a[0:15]
    v_mfma_f32_32x32x16_bf16 a[16:31], v[140:143], v[128:131], a[16:31]
    v_mfma_f32_32x32x16_bf16 a[32:47], v[136:139], v[132:135], a[32:47]
    v_mfma_f32_32x32x16_bf16 a[48:63], v[140:143], v[132:135], a[48:63]
    s_add_u32 s34, s34, 4096
    s_add_u32 s39, s39, 4096
    s_add_u32 s35, s35, 4096
    s_add_u32 s33, s33, 4096
    buffer_load_dwordx4 v[128:131], v2, s[8:11], s34 offen offset:0
    buffer_load_dwordx4 v[136:139], v2, s[12:15], s35 offen offset:0
    buffer_load_dwordx4 v[132:135], v2, s[8:11], s39 offen offset:0
    buffer_load_dwordx4 v[140:143], v2, s[12:15], s33 offen offset:0
    s_waitcnt vmcnt(28)
    v_mfma_f32_32x32x16_bf16 a[0:15], v[152:155], v[144:147], a[0:15]
    v_mfma_f32_32x32x16_bf16 a[16:31], v[156:159], v[144:147], a[16:31]
    v_mfma_f32_32x32x16_bf16 a[32:47], v[152:155], v[148:151], a[32:47]
    v_mfma_f32_32x32x16_bf16 a[48:63], v[156:159], v[148:151], a[48:63]
    buffer_load_dwordx4 v[144:147], v2, s[8:11], s34 offen offset:1024
    buffer_load_dwordx4 v[152:155], v2, s[12:15], s35 offen offset:1024
    buffer_load_dwordx4 v[148:151], v2, s[8:11], s39 offen offset:1024
    buffer_load_dwordx4 v[156:159], v2, s[12:15], s33 offen offset:1024
    s_waitcnt vmcnt(28)
    v_mfma_f32_32x32x16_bf16 a[0:15], v[168:171], v[160:163], a[0:15]
    v_mfma_f32_32x32x16_bf16 a[16:31], v[172:175], v[160:163], a[16:31]
    v_mfma_f32_32x32x16_bf16 a[32:47], v[168:171], v[164:167], a[32:47]
    v_mfma_f32_32x32x16_bf16 a[48:63], v[172:175], v[164:167], a[48:63]
    buffer_load_dwordx4 v[160:163], v2, s[8:11], s34 offen offset:2048
    buffer_load_dwordx4 v[168:171], v2, s[12:15], s35 offen offset:2048
    buffer_load_dwordx4 v[164:167], v2, s[8:11], s39 offen offset:2048
    buffer_load_dwordx4 v[172:175], v2, s[12:15], s33 offen offset:2048
    s_waitcnt vmcnt(28)
    v_mfma_f32_32x32x16_bf16 a[0:15], v[184:187], v[176:179], a[0:15]
    v_mfma_f32_32x32x16_bf16 a[16:31], v[188:191], v[176:179], a[16:31]
    v_mfma_f32_32x32x16_bf16 a[32:47], v[184:187], v[180:183], a[32:47]
    v_mfma_f32_32x32x16_bf16 a[48:63], v[188:191], v[180:183], a[48:63]
    buffer_load_dwordx4 v[176:179], v2, s[8:11], s34 offen offset:3072
    buffer_load_dwordx4 v[184:187], v2, s[12:15], s35 offen offset:3072
    buffer_load_dwordx4 v[180:183], v2, s[8:11], s39 offen offset:3072
    buffer_load_dwordx4 v[188:191], v2, s[12:15], s33 offen offset:3072
    s_waitcnt vmcnt(28)
    v_mfma_f32_32x32x16_bf16 a[0:15], v[72:75], v[64:67], a[0:15]
    v_mfma_f32_32x32x16_bf16 a[16:31], v[76:79], v[64:67], a[16:31]
    v_mfma_f32_32x32x16_bf16 a[32:47], v[72:75], v[68:71], a[32:47]
    v_mfma_f32_32x32x16_bf16 a[48:63], v[76:79], v[68:71], a[48:63]
    s_waitcnt vmcnt(24)
    v_mfma_f32_32x32x16_bf16 a[0:15], v[88:91], v[80:83], a[0:15]
    v_mfma_f32_32x32x16_bf16 a[16:31], v[92:95], v[80:83], a[16:31]
    v_mfma_f32_32x32x16_bf16 a[32:47], v[88:91], v[84:87], a[32:47]
    v_mfma_f32_32x32x16_bf16 a[48:63], v[92:95], v[84:87], a[48:63]
    s_waitcnt vmcnt(20)
    v_mfma_f32_32x32x16_bf16 a[0:15], v[104:107], v[96:99], a[0:15]
    v_mfma_f32_32x32x16_bf16 a[16:31], v[108:111], v[96:99], a[16:31]
    v_mfma_f32_32x32x16_bf16 a[32:47], v[104:107], v[100:103], a[32:47]
    v_mfma_f32_32x32x16_bf16 a[48:63], v[108:111], v[100:103], a[48:63]
    s_waitcnt vmcnt(16)
    v_mfma_f32_32x32x16_bf16 a[0:15], v[120:123], v[112:115], a[0:15]
    v_mfma_f32_32x32x16_bf16 a[16:31], v[124:127], v[112:115], a[16:31]
    v_mfma_f32_32x32x16_bf16 a[32:47], v[120:123], v[116:119], a[32:47]
    v_mfma_f32_32x32x16_bf16 a[48:63], v[124:127], v[116:119], a[48:63]
    s_waitcnt vmcnt(12)
    v_mfma_f32_32x32x16_bf16 a[0:15], v[136:139], v[128:131], a[0:15]
    v_mfma_f32_32x32x16_bf16 a[16:31], v[140:143], v[128:131], a[16:31]
    v_mfma_f32_32x32x16_bf16 a[32:47], v[136:139], v[132:135], a[32:47]
    v_mfma_f32_32x32x16_bf16 a[48:63], v[140:143], v[132:135], a[48:63]
    s_waitcnt vmcnt(8)
    v_mfma_f32_32x32x16_bf16 a[0:15], v[152:155], v[144:147], a[0:15]
    v_mfma_f32_32x32x16_bf16 a[16:31], v[156:159], v[144:147], a[16:31]
    v_mfma_f32_32x32x16_bf16 a[32:47], v[152:155], v[148:151], a[32:47]
    v_mfma_f32_32x32x16_bf16 a[48:63], v[156:159], v[148:151], a[48:63]
    s_waitcnt vmcnt(4)
    v_mfma_f32_32x32x16_bf16 a[0:15], v[168:171], v[160:163], a[0:15]
    v_mfma_f32_32x32x16_bf16 a[16:31], v[172:175], v[160:163], a[16:31]
    v_mfma_f32_32x32x16_bf16 a[32:47], v[168:171], v[164:167], a[32:47]
    v_mfma_f32_32x32x16_bf16 a[48:63], v[172:175], v[164:167], a[48:63]
    s_waitcnt vmcnt(0)
    v_mfma_f32_32x32x16_bf16 a[0:15], v[184:187], v[176:179], a[0:15]
    v_mfma_f32_32x32x16_bf16 a[16:31], v[188:191], v[176:179], a[16:31]
    v_mfma_f32_32x32x16_bf16 a[32:47], v[184:187], v[180:183], a[32:47]
    v_mfma_f32_32x32x16_bf16 a[48:63], v[188:191], v[180:183], a[48:63]
    s_nop 7
    s_nop 3
    v_lshlrev_b32 v17, 4, v1
    s_lshl_b32 s36, s32, 15
    v_add_u32 v18, s36, v17
    ds_write_b128 v18, a[0:3] offset:0
    ds_write_b128 v18, a[4:7] offset:1024
    ds_write_b128 v18, a[8:11] offset:2048
    ds_write_b128 v18, a[12:15] offset:3072
    ds_write_b128 v18, a[16:19] offset:4096
    ds_write_b128 v18, a[20:23] offset:5120
    ds_write_b128 v18, a[24:27] offset:6144
    ds_write_b128 v18, a[28:31] offset:7168
    ds_write_b128 v18, a[32:35] offset:8192
    ds_write_b128 v18, a[36:39] offset:9216
    ds_write_b128 v18, a[40:43] offset:10240
    ds_write_b128 v18, a[44:47] offset:11264
    ds_write_b128 v18, a[48:51] offset:12288
    ds_write_b128 v18, a[52:55] offset:13312
    ds_write_b128 v18, a[56:59] offset:14336
    ds_write_b128 v18, a[60:63] offset:15360
    s_waitcnt lgkmcnt(0)
    s_barrier
    s_lshl_b32 s36, s32, 12
    v_add_u32 v18, s36, v17
    v_add_u32 v19, 0x10000, v18
    ds_read_b128 v[64:67], v18 offset:0
    ds_read_b128 v[68:71], v18 offset:1024
    ds_read_b128 v[72:75], v18 offset:2048
    ds_read_b128 v[76:79], v18 offset:3072
    ds_read_b128 v[80:83], v18 offset:32768
    ds_read_b128 v[84:87], v18 offset:33792
    ds_read_b128 v[88:91], v18 offset:34816
    ds_read_b128 v[92:95], v18 offset:35840
    ds_read_b128 v[96:99], v19 offset:0
    ds_read_b128 v[100:103], v19 offset:1024
    ds_read_b128 v[104:107], v19 offset:2048
    ds_read_b128 v[108:111], v19 offset:3072
    ds_read_b128 v[112:115], v19 offset:32768
    ds_read_b128 v[116:119], v19 offset:33792
    ds_read_b128 v[120:123], v19 offset:34816
    ds_read_b128 v[124:127], v19 offset:35840
    s_waitcnt lgkmcnt(0)
    v_add_f32 v64, v64, v80
    v_add_f32 v96, v96, v112
    v_add_f32 v64, v64, v96
    v_add_f32 v65, v65, v81
    v_add_f32 v97, v97, v113
    v_add_f32 v65, v65, v97
    v_add_f32 v66, v66, v82
    v_add_f32 v98, v98, v114
    v_add_f32 v66, v66, v98
    v_add_f32 v67, v67, v83
    v_add_f32 v99, v99, v115
    v_add_f32 v67, v67, v99
    v_add_f32 v68, v68, v84
    v_add_f32 v100, v100, v116
    v_add_f32 v68, v68, v100
    v_add_f32 v69, v69, v85
    v_add_f32 v101, v101, v117
    v_add_f32 v69, v69, v101
    v_add_f32 v70, v70, v86
    v_add_f32 v102, v102, v118
    v_add_f32 v70, v70, v102
    v_add_f32 v71, v71, v87
    v_add_f32 v103, v103, v119
    v_add_f32 v71, v71, v103
    v_add_f32 v72, v72, v88
    v_add_f32 v104, v104, v120
    v_add_f32 v72, v72, v104
    v_add_f32 v73, v73, v89
    v_add_f32 v105, v105, v121
    v_add_f32 v73, v73, v105
    v_add_f32 v74, v74, v90
    v_add_f32 v106, v106, v122
    v_add_f32 v74, v74, v106
    v_add_f32 v75, v75, v91
    v_add_f32 v107, v107, v123
    v_add_f32 v75, v75, v107
    v_add_f32 v76, v76, v92
    v_add_f32 v108, v108, v124
    v_add_f32 v76, v76, v108
    v_add_f32 v77, v77, v93
    v_add_f32 v109, v109, v125
    v_add_f32 v77, v77, v109
    v_add_f32 v78, v78, v94
    v_add_f32 v110, v110, v126
    v_add_f32 v78, v78, v110
    v_add_f32 v79, v79, v95
    v_add_f32 v111, v111, v127
    v_add_f32 v79, v79, v111
    s_waitcnt vmcnt(0)
    v_sub_f32 v21, 1.0, v20
    v_cvt_pk_bf16_f32 v21, v21, v21
    v_lshlrev_b32 v21, 16, v21
    v_cvt_pk_bf16_f32 v80, v64, v65
    v_lshlrev_b32 v81, 16, v80
    v_and_b32 v82, 0xffff0000, v80
    v_mul_f32 v81, v81, v21
    v_mul_f32 v82, v82, v21
    v_cvt_pk_bf16_f32 v80, v81, v82
    v_lshlrev_b32 v83, 16, v32
    v_and_b32 v84, 0xffff0000, v32
    v_lshlrev_b32 v85, 16, v40
    v_lshlrev_b32 v86, 16, v41
    v_mul_f32 v83, v83, v85
    v_mul_f32 v84, v84, v86
    v_cvt_pk_bf16_f32 v83, v83, v84
    v_lshlrev_b32 v84, 16, v83
    v_and_b32 v85, 0xffff0000, v83
    v_mul_f32 v84, v84, v20
    v_mul_f32 v85, v85, v20
    v_cvt_pk_bf16_f32 v83, v84, v85
    v_lshlrev_b32 v84, 16, v83
    v_and_b32 v85, 0xffff0000, v83
    v_lshlrev_b32 v81, 16, v80
    v_and_b32 v82, 0xffff0000, v80
    v_add_f32 v84, v84, v81
    v_add_f32 v85, v85, v82
    v_cvt_pk_bf16_f32 v88, v84, v85
    v_cvt_pk_bf16_f32 v80, v66, v67
    v_lshlrev_b32 v81, 16, v80
    v_and_b32 v82, 0xffff0000, v80
    v_mul_f32 v81, v81, v21
    v_mul_f32 v82, v82, v21
    v_cvt_pk_bf16_f32 v80, v81, v82
    v_lshlrev_b32 v83, 16, v33
    v_and_b32 v84, 0xffff0000, v33
    v_lshlrev_b32 v85, 16, v42
    v_lshlrev_b32 v86, 16, v43
    v_mul_f32 v83, v83, v85
    v_mul_f32 v84, v84, v86
    v_cvt_pk_bf16_f32 v83, v83, v84
    v_lshlrev_b32 v84, 16, v83
    v_and_b32 v85, 0xffff0000, v83
    v_mul_f32 v84, v84, v20
    v_mul_f32 v85, v85, v20
    v_cvt_pk_bf16_f32 v83, v84, v85
    v_lshlrev_b32 v84, 16, v83
    v_and_b32 v85, 0xffff0000, v83
    v_lshlrev_b32 v81, 16, v80
    v_and_b32 v82, 0xffff0000, v80
    v_add_f32 v84, v84, v81
    v_add_f32 v85, v85, v82
    v_cvt_pk_bf16_f32 v89, v84, v85
    buffer_store_dwordx2 v[88:89], v15, s[16:19], 0 offen offset:0
    v_cvt_pk_bf16_f32 v80, v68, v69
    v_lshlrev_b32 v81, 16, v80
    v_and_b32 v82, 0xffff0000, v80
    v_mul_f32 v81, v81, v21
    v_mul_f32 v82, v82, v21
    v_cvt_pk_bf16_f32 v80, v81, v82
    v_lshlrev_b32 v83, 16, v34
    v_and_b32 v84, 0xffff0000, v34
    v_lshlrev_b32 v85, 16, v44
    v_lshlrev_b32 v86, 16, v45
    v_mul_f32 v83, v83, v85
    v_mul_f32 v84, v84, v86
    v_cvt_pk_bf16_f32 v83, v83, v84
    v_lshlrev_b32 v84, 16, v83
    v_and_b32 v85, 0xffff0000, v83
    v_mul_f32 v84, v84, v20
    v_mul_f32 v85, v85, v20
    v_cvt_pk_bf16_f32 v83, v84, v85
    v_lshlrev_b32 v84, 16, v83
    v_and_b32 v85, 0xffff0000, v83
    v_lshlrev_b32 v81, 16, v80
    v_and_b32 v82, 0xffff0000, v80
    v_add_f32 v84, v84, v81
    v_add_f32 v85, v85, v82
    v_cvt_pk_bf16_f32 v90, v84, v85
    v_cvt_pk_bf16_f32 v80, v70, v71
    v_lshlrev_b32 v81, 16, v80
    v_and_b32 v82, 0xffff0000, v80
    v_mul_f32 v81, v81, v21
    v_mul_f32 v82, v82, v21
    v_cvt_pk_bf16_f32 v80, v81, v82
    v_lshlrev_b32 v83, 16, v35
    v_and_b32 v84, 0xffff0000, v35
    v_lshlrev_b32 v85, 16, v46
    v_lshlrev_b32 v86, 16, v47
    v_mul_f32 v83, v83, v85
    v_mul_f32 v84, v84, v86
    v_cvt_pk_bf16_f32 v83, v83, v84
    v_lshlrev_b32 v84, 16, v83
    v_and_b32 v85, 0xffff0000, v83
    v_mul_f32 v84, v84, v20
    v_mul_f32 v85, v85, v20
    v_cvt_pk_bf16_f32 v83, v84, v85
    v_lshlrev_b32 v84, 16, v83
    v_and_b32 v85, 0xffff0000, v83
    v_lshlrev_b32 v81, 16, v80
    v_and_b32 v82, 0xffff0000, v80
    v_add_f32 v84, v84, v81
    v_add_f32 v85, v85, v82
    v_cvt_pk_bf16_f32 v91, v84, v85
    buffer_store_dwordx2 v[90:91], v15, s[16:19], 0 offen offset:16
    v_cvt_pk_bf16_f32 v80, v72, v73
    v_lshlrev_b32 v81, 16, v80
    v_and_b32 v82, 0xffff0000, v80
    v_mul_f32 v81, v81, v21
    v_mul_f32 v82, v82, v21
    v_cvt_pk_bf16_f32 v80, v81, v82
    v_lshlrev_b32 v83, 16, v36
    v_and_b32 v84, 0xffff0000, v36
    v_lshlrev_b32 v85, 16, v48
    v_lshlrev_b32 v86, 16, v49
    v_mul_f32 v83, v83, v85
    v_mul_f32 v84, v84, v86
    v_cvt_pk_bf16_f32 v83, v83, v84
    v_lshlrev_b32 v84, 16, v83
    v_and_b32 v85, 0xffff0000, v83
    v_mul_f32 v84, v84, v20
    v_mul_f32 v85, v85, v20
    v_cvt_pk_bf16_f32 v83, v84, v85
    v_lshlrev_b32 v84, 16, v83
    v_and_b32 v85, 0xffff0000, v83
    v_lshlrev_b32 v81, 16, v80
    v_and_b32 v82, 0xffff0000, v80
    v_add_f32 v84, v84, v81
    v_add_f32 v85, v85, v82
    v_cvt_pk_bf16_f32 v92, v84, v85
    v_cvt_pk_bf16_f32 v80, v74, v75
    v_lshlrev_b32 v81, 16, v80
    v_and_b32 v82, 0xffff0000, v80
    v_mul_f32 v81, v81, v21
    v_mul_f32 v82, v82, v21
    v_cvt_pk_bf16_f32 v80, v81, v82
    v_lshlrev_b32 v83, 16, v37
    v_and_b32 v84, 0xffff0000, v37
    v_lshlrev_b32 v85, 16, v50
    v_lshlrev_b32 v86, 16, v51
    v_mul_f32 v83, v83, v85
    v_mul_f32 v84, v84, v86
    v_cvt_pk_bf16_f32 v83, v83, v84
    v_lshlrev_b32 v84, 16, v83
    v_and_b32 v85, 0xffff0000, v83
    v_mul_f32 v84, v84, v20
    v_mul_f32 v85, v85, v20
    v_cvt_pk_bf16_f32 v83, v84, v85
    v_lshlrev_b32 v84, 16, v83
    v_and_b32 v85, 0xffff0000, v83
    v_lshlrev_b32 v81, 16, v80
    v_and_b32 v82, 0xffff0000, v80
    v_add_f32 v84, v84, v81
    v_add_f32 v85, v85, v82
    v_cvt_pk_bf16_f32 v93, v84, v85
    buffer_store_dwordx2 v[92:93], v15, s[16:19], 0 offen offset:32
    v_cvt_pk_bf16_f32 v80, v76, v77
    v_lshlrev_b32 v81, 16, v80
    v_and_b32 v82, 0xffff0000, v80
    v_mul_f32 v81, v81, v21
    v_mul_f32 v82, v82, v21
    v_cvt_pk_bf16_f32 v80, v81, v82
    v_lshlrev_b32 v83, 16, v38
    v_and_b32 v84, 0xffff0000, v38
    v_lshlrev_b32 v85, 16, v52
    v_lshlrev_b32 v86, 16, v53
    v_mul_f32 v83, v83, v85
    v_mul_f32 v84, v84, v86
    v_cvt_pk_bf16_f32 v83, v83, v84
    v_lshlrev_b32 v84, 16, v83
    v_and_b32 v85, 0xffff0000, v83
    v_mul_f32 v84, v84, v20
    v_mul_f32 v85, v85, v20
    v_cvt_pk_bf16_f32 v83, v84, v85
    v_lshlrev_b32 v84, 16, v83
    v_and_b32 v85, 0xffff0000, v83
    v_lshlrev_b32 v81, 16, v80
    v_and_b32 v82, 0xffff0000, v80
    v_add_f32 v84, v84, v81
    v_add_f32 v85, v85, v82
    v_cvt_pk_bf16_f32 v94, v84, v85
    v_cvt_pk_bf16_f32 v80, v78, v79
    v_lshlrev_b32 v81, 16, v80
    v_and_b32 v82, 0xffff0000, v80
    v_mul_f32 v81, v81, v21
    v_mul_f32 v82, v82, v21
    v_cvt_pk_bf16_f32 v80, v81, v82
    v_lshlrev_b32 v83, 16, v39
    v_and_b32 v84, 0xffff0000, v39
    v_lshlrev_b32 v85, 16, v54
    v_lshlrev_b32 v86, 16, v55
    v_mul_f32 v83, v83, v85
    v_mul_f32 v84, v84, v86
    v_cvt_pk_bf16_f32 v83, v83, v84
    v_lshlrev_b32 v84, 16, v83
    v_and_b32 v85, 0xffff0000, v83
    v_mul_f32 v84, v84, v20
    v_mul_f32 v85, v85, v20
    v_cvt_pk_bf16_f32 v83, v84, v85
    v_lshlrev_b32 v84, 16, v83
    v_and_b32 v85, 0xffff0000, v83
    v_lshlrev_b32 v81, 16, v80
    v_and_b32 v82, 0xffff0000, v80
    v_add_f32 v84, v84, v81
    v_add_f32 v85, v85, v82
    v_cvt_pk_bf16_f32 v95, v84, v85
    buffer_store_dwordx2 v[94:95], v15, s[16:19], 0 offen offset:48
L_out_end:
    s_endpgm
.section .rodata,"a"
.p2align 6
.amdhsa_kernel proj_kernel
  .amdhsa_next_free_vgpr 256
  .amdhsa_next_free_sgpr 102
  .amdhsa_accum_offset 256
  .amdhsa_group_segment_fixed_size 0
  .amdhsa_kernarg_size 128
  .amdhsa_user_sgpr_count 2
  .amdhsa_user_sgpr_kernarg_segment_ptr 1
  .amdhsa_system_sgpr_workgroup_id_x 1
.end_amdhsa_kernel
.section .rodata,"a"
.p2align 6
.amdhsa_kernel attn_kernel
  .amdhsa_next_free_vgpr 480
  .amdhsa_next_free_sgpr 102
  .amdhsa_accum_offset 256
  .amdhsa_group_segment_fixed_size 0
  .amdhsa_kernarg_size 128
  .amdhsa_user_sgpr_count 2
  .amdhsa_user_sgpr_kernarg_segment_ptr 1
  .amdhsa_system_sgpr_workgroup_id_x 1
.end_amdhsa_kernel
.section .rodata,"a"
.p2align 6
.amdhsa_kernel out_kernel
  .amdhsa_next_free_vgpr 320
  .amdhsa_next_free_sgpr 102
  .amdhsa_accum_offset 256
  .amdhsa_group_segment_fixed_size 0
  .amdhsa_kernarg_size 128
  .amdhsa_user_sgpr_count 2
  .amdhsa_user_sgpr_kernarg_segment_ptr 1
  .amdhsa_system_sgpr_workgroup_id_x 1
.end_amdhsa_kernel
```
